```python
import torch

def _softmax(x, axis=-1):
    return torch.softmax(x, dim=axis)
def _gelu(x):
    return torch.nn.functional.gelu(x, approximate="tanh")
def _silu(x):
    return torch.nn.functional.silu(x)
def _sigmoid(x):
    return torch.sigmoid(x)
def _layernorm(x, axis=-1, eps=1e-5):
    m = x.mean(dim=axis, keepdim=True)
    v = x.var(dim=axis, keepdim=True, unbiased=False)
    return (x - m) / torch.sqrt(v + eps)
def _scatter_add(tgt, idx, src, axis=0):
    return tgt.clone().index_add_(axis, idx, src)
def _segment_sum(src, seg, n):
    out = torch.zeros((n,) + src.shape[1:], dtype=src.dtype)
    return out.index_add_(0, seg, src)
def _pad(x, pw):
    flat = tuple(v for pair in reversed(pw) for v in pair)
    return torch.nn.functional.pad(x, flat)

kernel_name = 'concat_heads__mha_block_cached__gqa_block_cached__near_ridge'

def setup_inputs():

    _w = (lambda a: (lambda t: t.to(torch.bfloat16) if t.is_floating_point() else t)(torch.as_tensor(a)))
    def _A_setup():
        B, Sq, D = 8, 96, 448
        H, Sk, Dh = 16, 512, 256
        return {
            "x": _w((lambda *s: torch.randn(*s, dtype=torch.bfloat16) * 0.8)(B, Sq, D)),
            "k_cache": _w((lambda *s: torch.randn(*s, dtype=torch.bfloat16) * 0.8)(B, H, Sk, Dh)),
            "v_cache": _w((lambda *s: torch.randn(*s, dtype=torch.bfloat16) * 0.05)(B, H, Sk, Dh)),
            "wq": _w((lambda *s: torch.randn(*s, dtype=torch.bfloat16) * 0.8)(D, H * Dh) * (D ** -0.5)),
            "wo": _w((lambda *s: torch.randn(*s, dtype=torch.bfloat16) * 0.05)(H * Dh, D) * ((H * Dh) ** -0.5)),
        }
    _A_in = _A_setup()

    def _B_setup():
        B, Sq, D = 8, 96, 448
        Hq, Hkv, Sk, Dh = 16, 16, 512, 256
        assert Hq % Hkv == 0, (Hq, Hkv)
        return {
            "x": _w((lambda *s: torch.randn(*s, dtype=torch.bfloat16) * 0.8)(B, Sq, D)),
            "k_cache": _w((lambda *s: torch.randn(*s, dtype=torch.bfloat16) * 0.8)(B, Hkv, Sk, Dh)),
            "v_cache": _w((lambda *s: torch.randn(*s, dtype=torch.bfloat16) * 0.05)(B, Hkv, Sk, Dh)),
            "wq": _w((lambda *s: torch.randn(*s, dtype=torch.bfloat16) * 0.8)(D, Hq * Dh) * (D ** -0.5)),
            "wo": _w((lambda *s: torch.randn(*s, dtype=torch.bfloat16) * 0.05)(Hq * Dh, D) * ((Hq * Dh) ** -0.5)),
        }
    _B_in = _B_setup()

    return {
        "A_x": _A_in["x"],
        "A_k_cache": _A_in["k_cache"],
        "A_v_cache": _A_in["v_cache"],
        "A_wq": _A_in["wq"],
        "A_wo": _A_in["wo"],
        "B_x": _B_in["x"],
        "B_k_cache": _B_in["k_cache"],
        "B_v_cache": _B_in["v_cache"],
        "B_wq": _B_in["wq"],
        "B_wo": _B_in["wo"],
    }

def reference(A_x, A_k_cache, A_v_cache, A_wq, A_wo, B_x, B_k_cache, B_v_cache, B_wq, B_wo):
    def _A_ref(x, k_cache, v_cache, wq, wo):
        B, Sq, D = x.shape
        H, Dh = 16, 256
        q = (lambda x, *d: x.permute(*d))((x @ wq).reshape(B, Sq, H, Dh), 0, 2, 1, 3)
        scores = torch.einsum("bhqd,bhkd->bhqk", q, k_cache) * (Dh ** -0.5)
        p = _softmax(scores, axis=-1)
        o = torch.einsum("bhqk,bhkd->bhqd", p, v_cache)
        return (lambda x, *d: x.permute(*d))(o, 0, 2, 1, 3).reshape(B, Sq, H * Dh) @ wo

    def _B_ref(x, k_cache, v_cache, wq, wo):
        B, Sq, D = x.shape
        Hq, Dh = 16, 256
        Hkv = k_cache.shape[1]
        rep = Hq // Hkv
        q = (lambda x, *d: x.permute(*d))((x @ wq).reshape(B, Sq, Hq, Dh), 0, 2, 1, 3)
        k = (lambda x, n, axis: torch.repeat_interleave(x, n, dim=axis))(k_cache, rep, axis=1)
        v = (lambda x, n, axis: torch.repeat_interleave(x, n, dim=axis))(v_cache, rep, axis=1)
        scores = torch.einsum("bhqd,bhkd->bhqk", q, k) * (Dh ** -0.5)
        p = _softmax(scores, axis=-1)
        o = torch.einsum("bhqk,bhkd->bhqd", p, v)
        return (lambda x, *d: x.permute(*d))(o, 0, 2, 1, 3).reshape(B, Sq, Hq * Dh) @ wo

    a = _A_ref(A_x, A_k_cache, A_v_cache, A_wq, A_wo)
    b = _B_ref(B_x, B_k_cache, B_v_cache, B_wq, B_wo)
    return torch.concatenate([a, b], axis=-1)
```

```asm
; @launch grid=(256,1,1) block=(256,1,1) lds=163840
.amdgcn_target "amdgcn-amd-amdhsa--gfx950"
.text
.globl concat_heads__mha_block_cached__gqa_block_cached__near_ridge_kernel
.p2align 8
.type concat_heads__mha_block_cached__gqa_block_cached__near_ridge_kernel,@function
concat_heads__mha_block_cached__gqa_block_cached__near_ridge_kernel:
  s_cmp_ge_u32 s2, 256
  s_cbranch_scc1 L_end
  s_bfe_u32 s3, s2, 0x10002
  s_mul_i32 s3, s3, 40
  s_add_u32 s20, s0, s3
  s_addc_u32 s21, s1, 0
  s_load_dwordx8 s[4:11], s[20:21], 0
  s_load_dwordx2 s[12:13], s[20:21], 32
  s_load_dwordx2 s[14:15], s[0:1], 96
  s_load_dwordx4 s[16:19], s[0:1], 80
  v_lshrrev_b32 v3, 6, v0
  s_getpc_b64 s[22:23]
L_pc:
  s_bfe_u32 s3, s2, 0x30003
  s_lshl_b32 s3, s3, 13
  v_lshl_add_u32 v6, v0, 5, s3
  v_min_u32 v7, L_codeend-L_pc-4, v6
  global_load_dword a72, v7, s[22:23]
  v_add_u32 v6, 0x10000, v6
  v_min_u32 v7, L_codeend-L_pc-4, v6
  global_load_dword a73, v7, s[22:23]
  v_readfirstlane_b32 s60, v3
  s_bfe_u32 s57, s2, 0x10002
  s_bfe_u32 s56, s2, 0x30003
  s_and_b32 s58, s2, 3
  s_lshl_b32 s58, s58, 2
  s_lshr_b32 s3, s2, 6
  s_add_u32 s58, s58, s3
  s_lshl_b32 s59, s57, 3
  s_add_u32 s59, s59, s56
  s_lshl_b32 s3, s3, 1
  s_add_u32 s64, s56, s3
  s_sub_u32 s3, s64, 7
  s_cselect_b32 s64, s64, s3
  s_cmp_eq_u32 s56, 7
  s_cselect_b32 s100, 0, s56
  s_lshl_b32 s3, s56, 4
  s_add_u32 s3, s3, s58
  s_lshl_b32 s69, s3, 18
  v_and_b32 v0, 63, v0
  v_lshlrev_b32 v2, 4, v0
  v_add_u32 v2, 159744, v2
  s_lshl_b32 s3, s60, 2
  v_add_u32 v1, s3, v2
  v_mov_b32 v2, 159744
  v_mov_b32 v4, 0
  ds_write_b32 v1, v4
  ds_write_b32 v1, v4 offset:1024
  ds_write_b32 v1, v4 offset:2048
  s_cmp_lg_u32 s60, 3
  s_cbranch_scc1 L_cons
L_loader:
  v_lshrrev_b32 v5, 5, v0
  v_and_b32 v6, 31, v0
  v_lshlrev_b32 v7, 9, v5
  v_add_u32 v3, 0, v5
  v_xor_b32 v3, v3, v6
  v_lshl_add_u32 v8, v3, 4, v7
  v_add_u32 v3, 2, v5
  v_xor_b32 v3, v3, v6
  v_lshl_add_u32 v9, v3, 4, v7
  v_add_u32 v3, 4, v5
  v_xor_b32 v3, v3, v6
  v_lshl_add_u32 v10, v3, 4, v7
  v_add_u32 v3, 6, v5
  v_xor_b32 v3, v3, v6
  v_lshl_add_u32 v11, v3, 4, v7
  v_add_u32 v3, 8, v5
  v_xor_b32 v3, v3, v6
  v_lshl_add_u32 v12, v3, 4, v7
  v_add_u32 v3, 10, v5
  v_xor_b32 v3, v3, v6
  v_lshl_add_u32 v13, v3, 4, v7
  v_add_u32 v3, 12, v5
  v_xor_b32 v3, v3, v6
  v_lshl_add_u32 v14, v3, 4, v7
  v_add_u32 v3, 14, v5
  v_xor_b32 v3, v3, v6
  v_lshl_add_u32 v15, v3, 4, v7
  s_waitcnt lgkmcnt(0)
  s_add_u32 s24, s6, s69
  s_addc_u32 s25, s7, 0
  s_mov_b32 s26, 262144
  s_mov_b32 s27, 0x20000
  s_mov_b32 s44, 0
  s_mov_b32 s3, 0
  s_xor_b32 s52, s3, 0
  s_mul_i32 s52, s52, 57344
  s_xor_b32 s53, s3, 1
  s_mul_i32 s53, s53, 57344
  s_xor_b32 s54, s3, 2
  s_mul_i32 s54, s54, 57344
  s_xor_b32 s55, s3, 3
  s_mul_i32 s55, s55, 57344
  s_lshl_b32 s3, s3, 7
  s_or_b32 s45, s44, s3
  s_add_u32 s28, s8, s69
  s_addc_u32 s29, s9, 0
  s_mov_b32 s30, 262144
  s_mov_b32 s31, 0x20000
  s_lshl_b32 s3, s58, 9
  s_add_u32 s32, s10, s3
  s_addc_u32 s33, s11, 0
  s_mov_b32 s34, 3662336
  s_mov_b32 s35, 0x20000
  s_mul_i32 s3, s58, 229376
  s_add_u32 s40, s12, s3
  s_addc_u32 s41, s13, 0
  s_mov_b32 s42, 229376
  s_mov_b32 s43, 0x20000
  s_mul_i32 s3, s56, 86016
  s_add_u32 s36, s4, s3
  s_addc_u32 s37, s5, 0
  s_mov_b32 s38, 86016
  s_mov_b32 s39, 0x20000
  v_lshlrev_b32 v18, 13, v5
  v_add_u32 v3, 0, v5
  v_lshlrev_b32 v3, 1, v3
  v_xor_b32 v3, v3, v6
  v_lshl_add_u32 v20, v3, 4, v18
  v_add_u32 v3, 2, v5
  v_lshlrev_b32 v3, 1, v3
  v_xor_b32 v3, v3, v6
  v_lshl_add_u32 v21, v3, 4, v18
  v_add_u32 v21, 15360, v21
  v_add_u32 v3, 4, v5
  v_lshlrev_b32 v3, 1, v3
  v_xor_b32 v3, v3, v6
  v_lshl_add_u32 v22, v3, 4, v18
  v_add_u32 v22, 63488, v22
  v_add_u32 v3, 6, v5
  v_lshlrev_b32 v3, 1, v3
  v_xor_b32 v3, v3, v6
  v_lshl_add_u32 v23, v3, 4, v18
  v_add_u32 v23, 78848, v23
  v_lshrrev_b32 v36, 3, v0
  v_mul_u32_u24 v37, 896, v36
  v_and_b32 v38, 7, v0
  v_lshrrev_b32 v35, 4, v0
  v_add_u32 v3, 0, v35
  v_xor_b32 v3, v3, v38
  v_lshl_add_u32 v3, v3, 4, v37
  v_add_u32 v24, 0, v3
  v_add_u32 v26, 12288, v3
  v_add_u32 v3, 4, v35
  v_xor_b32 v3, v3, v38
  v_lshl_add_u32 v3, v3, 4, v37
  v_add_u32 v25, 6144, v3
  v_add_u32 v27, 18432, v3
  v_lshlrev_b32 v3, 1, v35
  v_xor_b32 v3, v3, v38
  v_lshl_add_u32 v28, v3, 4, v37
  v_lshlrev_b32 v36, 9, v36
  v_lshl_add_u32 v16, v3, 4, v36
  v_add_u32 v29, 6144, v28
  v_add_u32 v17, 3072, v16
  v_add_u32 v30, 12288, v28
  v_add_u32 v18, 6144, v16
  v_add_u32 v31, 18432, v28
  v_add_u32 v19, 9216, v16
  s_mov_b32 s61, 0
  s_mov_b32 s86, s64
  v_min_u32 v3, 2, v0
  v_lshl_add_u32 v36, v3, 2, v2
  v_lshl_add_u32 v37, v3, 8, v2
  v_add_u32 v37, 2304, v37
  s_lshl_b32 s65, s86, 19
  s_lshl_b32 s66, s86, 7
  s_add_u32 s86, s86, 1
  s_cmp_eq_u32 s86, 7
  s_cselect_b32 s86, 0, s86
  s_mov_b32 m0, 147456
  s_add_u32 s63, s66, 0
  buffer_load_dwordx4 v24, s[36:39], s63 offen offset:0 lds
  buffer_load_dwordx4 v25, s[36:39], s63 offen offset:1024 lds
  buffer_load_dwordx4 v26, s[36:39], s63 offen offset:2048 lds
  buffer_load_dwordx4 v27, s[36:39], s63 offen offset:3072 lds
  s_mov_b32 m0, 151552
  s_add_u32 s63, s66, 28672
  buffer_load_dwordx4 v24, s[36:39], s63 offen offset:0 lds
  buffer_load_dwordx4 v25, s[36:39], s63 offen offset:1024 lds
  buffer_load_dwordx4 v26, s[36:39], s63 offen offset:2048 lds
  buffer_load_dwordx4 v27, s[36:39], s63 offen offset:3072 lds
  s_mov_b32 m0, 155648
  s_add_u32 s63, s66, 57344
  buffer_load_dwordx4 v24, s[36:39], s63 offen offset:0 lds
  buffer_load_dwordx4 v25, s[36:39], s63 offen offset:1024 lds
  buffer_load_dwordx4 v26, s[36:39], s63 offen offset:2048 lds
  buffer_load_dwordx4 v27, s[36:39], s63 offen offset:3072 lds
  s_mov_b32 m0, 0
  s_add_u32 s63, s65, 0
  buffer_load_dwordx4 v20, s[32:35], s63 offen offset:0 lds
  buffer_load_dwordx4 v21, s[32:35], s63 offen offset:1024 lds
  buffer_load_dwordx4 v22, s[32:35], s63 offen offset:2048 lds
  buffer_load_dwordx4 v23, s[32:35], s63 offen offset:3072 lds
  s_mov_b32 m0, 4096
  s_add_u32 s63, s65, 32768
  buffer_load_dwordx4 v20, s[32:35], s63 offen offset:0 lds
  buffer_load_dwordx4 v21, s[32:35], s63 offen offset:1024 lds
  buffer_load_dwordx4 v22, s[32:35], s63 offen offset:2048 lds
  buffer_load_dwordx4 v23, s[32:35], s63 offen offset:3072 lds
  s_mov_b32 m0, 8192
  s_add_u32 s63, s65, 131072
  buffer_load_dwordx4 v20, s[32:35], s63 offen offset:0 lds
  buffer_load_dwordx4 v21, s[32:35], s63 offen offset:1024 lds
  buffer_load_dwordx4 v22, s[32:35], s63 offen offset:2048 lds
  buffer_load_dwordx4 v23, s[32:35], s63 offen offset:3072 lds
  s_mov_b32 m0, 12288
  s_add_u32 s63, s65, 163840
  buffer_load_dwordx4 v20, s[32:35], s63 offen offset:0 lds
  buffer_load_dwordx4 v21, s[32:35], s63 offen offset:1024 lds
  buffer_load_dwordx4 v22, s[32:35], s63 offen offset:2048 lds
  buffer_load_dwordx4 v23, s[32:35], s63 offen offset:3072 lds
  s_waitcnt lgkmcnt(0)
  s_barrier
  s_mov_b32 m0, 161792
  v_mov_b32 v4, L_tab-L_pc+4
  global_load_lds_dword v4, s[22:23]
  s_mov_b32 m0, 16384
  s_add_u32 s63, s65, 262144
  buffer_load_dwordx4 v20, s[32:35], s63 offen offset:0 lds
  buffer_load_dwordx4 v21, s[32:35], s63 offen offset:1024 lds
  buffer_load_dwordx4 v22, s[32:35], s63 offen offset:2048 lds
  buffer_load_dwordx4 v23, s[32:35], s63 offen offset:3072 lds
  s_mov_b32 m0, 20480
  s_add_u32 s63, s65, 294912
  buffer_load_dwordx4 v20, s[32:35], s63 offen offset:0 lds
  buffer_load_dwordx4 v21, s[32:35], s63 offen offset:1024 lds
  buffer_load_dwordx4 v22, s[32:35], s63 offen offset:2048 lds
  buffer_load_dwordx4 v23, s[32:35], s63 offen offset:3072 lds
  s_mov_b32 m0, 24576
  s_add_u32 s63, s65, 393216
  buffer_load_dwordx4 v20, s[32:35], s63 offen offset:0 lds
  buffer_load_dwordx4 v21, s[32:35], s63 offen offset:1024 lds
  buffer_load_dwordx4 v22, s[32:35], s63 offen offset:2048 lds
  buffer_load_dwordx4 v23, s[32:35], s63 offen offset:3072 lds
  s_mov_b32 m0, 28672
  s_add_u32 s63, s65, 425984
  buffer_load_dwordx4 v20, s[32:35], s63 offen offset:0 lds
  buffer_load_dwordx4 v21, s[32:35], s63 offen offset:1024 lds
  buffer_load_dwordx4 v22, s[32:35], s63 offen offset:2048 lds
  buffer_load_dwordx4 v23, s[32:35], s63 offen offset:3072 lds
  s_mov_b32 m0, 161792
  v_mov_b32 v4, L_tab-L_pc+8
  global_load_lds_dword v4, s[22:23]
  s_lshl_b32 s65, s86, 19
  s_lshl_b32 s66, s86, 7
  s_add_u32 s86, s86, 1
  s_cmp_eq_u32 s86, 7
  s_cselect_b32 s86, 0, s86
  s_mov_b32 m0, 135168
  s_add_u32 s63, s66, 0
  buffer_load_dwordx4 v24, s[36:39], s63 offen offset:0 lds
  buffer_load_dwordx4 v25, s[36:39], s63 offen offset:1024 lds
  buffer_load_dwordx4 v26, s[36:39], s63 offen offset:2048 lds
  buffer_load_dwordx4 v27, s[36:39], s63 offen offset:3072 lds
  s_mov_b32 m0, 139264
  s_add_u32 s63, s66, 28672
  buffer_load_dwordx4 v24, s[36:39], s63 offen offset:0 lds
  buffer_load_dwordx4 v25, s[36:39], s63 offen offset:1024 lds
  buffer_load_dwordx4 v26, s[36:39], s63 offen offset:2048 lds
  buffer_load_dwordx4 v27, s[36:39], s63 offen offset:3072 lds
  s_waitcnt vmcnt(50)
  s_mov_b32 m0, 143360
  s_add_u32 s63, s66, 57344
  buffer_load_dwordx4 v24, s[36:39], s63 offen offset:0 lds
  buffer_load_dwordx4 v25, s[36:39], s63 offen offset:1024 lds
  buffer_load_dwordx4 v26, s[36:39], s63 offen offset:2048 lds
  buffer_load_dwordx4 v27, s[36:39], s63 offen offset:3072 lds
  s_waitcnt vmcnt(50)
  s_mov_b32 m0, 32768
  s_add_u32 s63, s65, 0
  buffer_load_dwordx4 v20, s[32:35], s63 offen offset:0 lds
  buffer_load_dwordx4 v21, s[32:35], s63 offen offset:1024 lds
  buffer_load_dwordx4 v22, s[32:35], s63 offen offset:2048 lds
  buffer_load_dwordx4 v23, s[32:35], s63 offen offset:3072 lds
  s_waitcnt vmcnt(50)
  s_mov_b32 m0, 36864
  s_add_u32 s63, s65, 32768
  buffer_load_dwordx4 v20, s[32:35], s63 offen offset:0 lds
  buffer_load_dwordx4 v21, s[32:35], s63 offen offset:1024 lds
  buffer_load_dwordx4 v22, s[32:35], s63 offen offset:2048 lds
  buffer_load_dwordx4 v23, s[32:35], s63 offen offset:3072 lds
  s_waitcnt vmcnt(50)
  s_mov_b32 m0, 40960
  s_add_u32 s63, s65, 131072
  buffer_load_dwordx4 v20, s[32:35], s63 offen offset:0 lds
  buffer_load_dwordx4 v21, s[32:35], s63 offen offset:1024 lds
  buffer_load_dwordx4 v22, s[32:35], s63 offen offset:2048 lds
  buffer_load_dwordx4 v23, s[32:35], s63 offen offset:3072 lds
  s_waitcnt vmcnt(50)
  s_mov_b32 m0, 45056
  s_add_u32 s63, s65, 163840
  buffer_load_dwordx4 v20, s[32:35], s63 offen offset:0 lds
  buffer_load_dwordx4 v21, s[32:35], s63 offen offset:1024 lds
  buffer_load_dwordx4 v22, s[32:35], s63 offen offset:2048 lds
  buffer_load_dwordx4 v23, s[32:35], s63 offen offset:3072 lds
  s_mov_b32 m0, 161792
  v_mov_b32 v4, L_tab-L_pc+12
  global_load_lds_dword v4, s[22:23]
  s_waitcnt vmcnt(51)
  s_mov_b32 m0, 49152
  s_add_u32 s63, s65, 262144
  buffer_load_dwordx4 v20, s[32:35], s63 offen offset:0 lds
  buffer_load_dwordx4 v21, s[32:35], s63 offen offset:1024 lds
  buffer_load_dwordx4 v22, s[32:35], s63 offen offset:2048 lds
  buffer_load_dwordx4 v23, s[32:35], s63 offen offset:3072 lds
  s_waitcnt vmcnt(51)
  s_mov_b32 m0, 53248
  s_add_u32 s63, s65, 294912
  buffer_load_dwordx4 v20, s[32:35], s63 offen offset:0 lds
  buffer_load_dwordx4 v21, s[32:35], s63 offen offset:1024 lds
  buffer_load_dwordx4 v22, s[32:35], s63 offen offset:2048 lds
  buffer_load_dwordx4 v23, s[32:35], s63 offen offset:3072 lds
  s_waitcnt vmcnt(50)
  s_mov_b32 m0, 57344
  s_add_u32 s63, s65, 393216
  buffer_load_dwordx4 v20, s[32:35], s63 offen offset:0 lds
  buffer_load_dwordx4 v21, s[32:35], s63 offen offset:1024 lds
  buffer_load_dwordx4 v22, s[32:35], s63 offen offset:2048 lds
  buffer_load_dwordx4 v23, s[32:35], s63 offen offset:3072 lds
  s_waitcnt vmcnt(50)
  s_mov_b32 m0, 61440
  s_add_u32 s63, s65, 425984
  buffer_load_dwordx4 v20, s[32:35], s63 offen offset:0 lds
  buffer_load_dwordx4 v21, s[32:35], s63 offen offset:1024 lds
  buffer_load_dwordx4 v22, s[32:35], s63 offen offset:2048 lds
  buffer_load_dwordx4 v23, s[32:35], s63 offen offset:3072 lds
  s_mov_b32 m0, 161792
  v_mov_b32 v4, L_tab-L_pc+16
  global_load_lds_dword v4, s[22:23]
  s_waitcnt vmcnt(51)
  s_xor_b32 s63, s44, 32768
  buffer_load_dwordx4 v[64:67], v8, s[24:27], s63 offen offset:0 nt
  buffer_load_dwordx4 v[68:71], v9, s[24:27], s63 offen offset:1024 nt
  buffer_load_dwordx4 v[72:75], v10, s[24:27], s63 offen offset:2048 nt
  buffer_load_dwordx4 v[76:79], v11, s[24:27], s63 offen offset:3072 nt
  s_xor_b32 s63, s44, 36864
  buffer_load_dwordx4 v[80:83], v12, s[24:27], s63 offen offset:0 nt
  buffer_load_dwordx4 v[84:87], v13, s[24:27], s63 offen offset:1024 nt
  buffer_load_dwordx4 v[88:91], v14, s[24:27], s63 offen offset:2048 nt
  buffer_load_dwordx4 v[92:95], v15, s[24:27], s63 offen offset:3072 nt
  s_xor_b32 s63, s44, 40960
  buffer_load_dwordx4 v[96:99], v8, s[24:27], s63 offen offset:0 nt
  buffer_load_dwordx4 v[100:103], v9, s[24:27], s63 offen offset:1024 nt
  buffer_load_dwordx4 v[104:107], v10, s[24:27], s63 offen offset:2048 nt
  buffer_load_dwordx4 v[108:111], v11, s[24:27], s63 offen offset:3072 nt
  s_waitcnt vmcnt(60)
  s_xor_b32 s63, s44, 45056
  buffer_load_dwordx4 v[112:115], v12, s[24:27], s63 offen offset:0 nt
  buffer_load_dwordx4 v[116:119], v13, s[24:27], s63 offen offset:1024 nt
  buffer_load_dwordx4 v[120:123], v14, s[24:27], s63 offen offset:2048 nt
  buffer_load_dwordx4 v[124:127], v15, s[24:27], s63 offen offset:3072 nt
  s_waitcnt vmcnt(60)
  s_lshl_b32 s65, s86, 19
  s_lshl_b32 s66, s86, 7
  s_add_u32 s86, s86, 1
  s_cmp_eq_u32 s86, 7
  s_cselect_b32 s86, 0, s86
  s_mov_b32 m0, 110592
  s_add_u32 s63, s66, 0
  buffer_load_dwordx4 v24, s[36:39], s63 offen offset:0 lds
  buffer_load_dwordx4 v25, s[36:39], s63 offen offset:1024 lds
  buffer_load_dwordx4 v26, s[36:39], s63 offen offset:2048 lds
  buffer_load_dwordx4 v27, s[36:39], s63 offen offset:3072 lds
  s_waitcnt vmcnt(60)
  s_mov_b32 m0, 114688
  s_add_u32 s63, s66, 28672
  buffer_load_dwordx4 v24, s[36:39], s63 offen offset:0 lds
  buffer_load_dwordx4 v25, s[36:39], s63 offen offset:1024 lds
  buffer_load_dwordx4 v26, s[36:39], s63 offen offset:2048 lds
  buffer_load_dwordx4 v27, s[36:39], s63 offen offset:3072 lds
  s_waitcnt vmcnt(60)
  s_mov_b32 m0, 118784
  s_add_u32 s63, s66, 57344
  buffer_load_dwordx4 v24, s[36:39], s63 offen offset:0 lds
  buffer_load_dwordx4 v25, s[36:39], s63 offen offset:1024 lds
  buffer_load_dwordx4 v26, s[36:39], s63 offen offset:2048 lds
  buffer_load_dwordx4 v27, s[36:39], s63 offen offset:3072 lds
  s_waitcnt vmcnt(60)
  s_mov_b32 m0, 65536
  s_add_u32 s63, s65, 0
  buffer_load_dwordx4 v20, s[32:35], s63 offen offset:0 lds
  buffer_load_dwordx4 v21, s[32:35], s63 offen offset:1024 lds
  buffer_load_dwordx4 v22, s[32:35], s63 offen offset:2048 lds
  buffer_load_dwordx4 v23, s[32:35], s63 offen offset:3072 lds
  s_waitcnt vmcnt(60)
  s_mov_b32 m0, 69632
  s_add_u32 s63, s65, 32768
  buffer_load_dwordx4 v20, s[32:35], s63 offen offset:0 lds
  buffer_load_dwordx4 v21, s[32:35], s63 offen offset:1024 lds
  buffer_load_dwordx4 v22, s[32:35], s63 offen offset:2048 lds
  buffer_load_dwordx4 v23, s[32:35], s63 offen offset:3072 lds
  s_waitcnt vmcnt(60)
  s_mov_b32 m0, 73728
  s_add_u32 s63, s65, 131072
  buffer_load_dwordx4 v20, s[32:35], s63 offen offset:0 lds
  buffer_load_dwordx4 v21, s[32:35], s63 offen offset:1024 lds
  buffer_load_dwordx4 v22, s[32:35], s63 offen offset:2048 lds
  buffer_load_dwordx4 v23, s[32:35], s63 offen offset:3072 lds
  s_waitcnt vmcnt(60)
  s_mov_b32 m0, 77824
  s_add_u32 s63, s65, 163840
  buffer_load_dwordx4 v20, s[32:35], s63 offen offset:0 lds
  buffer_load_dwordx4 v21, s[32:35], s63 offen offset:1024 lds
  buffer_load_dwordx4 v22, s[32:35], s63 offen offset:2048 lds
  buffer_load_dwordx4 v23, s[32:35], s63 offen offset:3072 lds
  s_mov_b32 m0, 161792
  v_mov_b32 v4, L_tab-L_pc+20
  global_load_lds_dword v4, s[22:23]
  s_waitcnt vmcnt(60)
  s_mov_b32 m0, 81920
  s_add_u32 s63, s65, 262144
  buffer_load_dwordx4 v20, s[32:35], s63 offen offset:0 lds
  buffer_load_dwordx4 v21, s[32:35], s63 offen offset:1024 lds
  buffer_load_dwordx4 v22, s[32:35], s63 offen offset:2048 lds
  buffer_load_dwordx4 v23, s[32:35], s63 offen offset:3072 lds
  s_waitcnt vmcnt(60)
  s_mov_b32 m0, 86016
  s_add_u32 s63, s65, 294912
  buffer_load_dwordx4 v20, s[32:35], s63 offen offset:0 lds
  buffer_load_dwordx4 v21, s[32:35], s63 offen offset:1024 lds
  buffer_load_dwordx4 v22, s[32:35], s63 offen offset:2048 lds
  buffer_load_dwordx4 v23, s[32:35], s63 offen offset:3072 lds
  s_waitcnt vmcnt(60)
  s_mov_b32 m0, 90112
  s_add_u32 s63, s65, 393216
  buffer_load_dwordx4 v20, s[32:35], s63 offen offset:0 lds
  buffer_load_dwordx4 v21, s[32:35], s63 offen offset:1024 lds
  buffer_load_dwordx4 v22, s[32:35], s63 offen offset:2048 lds
  buffer_load_dwordx4 v23, s[32:35], s63 offen offset:3072 lds
  s_waitcnt vmcnt(60)
  ds_read_b32 v32, v37
  s_mov_b32 m0, 94208
  s_add_u32 s63, s65, 425984
  buffer_load_dwordx4 v20, s[32:35], s63 offen offset:0 lds
  buffer_load_dwordx4 v21, s[32:35], s63 offen offset:1024 lds
  buffer_load_dwordx4 v22, s[32:35], s63 offen offset:2048 lds
  buffer_load_dwordx4 v23, s[32:35], s63 offen offset:3072 lds
  s_mov_b32 m0, 161792
  v_mov_b32 v4, L_tab-L_pc+24
  global_load_lds_dword v4, s[22:23]
  s_waitcnt vmcnt(60)
  s_waitcnt lgkmcnt(0)
  v_cmp_gt_u32 vcc, 0xb0030001, v32
  s_cbranch_vccnz L_lsQ_6
L_lbQ_6:
  s_lshl_b32 s65, s86, 19
  s_lshl_b32 s66, s86, 7
  s_add_u32 s86, s86, 1
  s_cmp_eq_u32 s86, 7
  s_cselect_b32 s86, 0, s86
  s_mov_b32 m0, 122880
  s_add_u32 s63, s66, 0
  buffer_load_dwordx4 v24, s[36:39], s63 offen offset:0 lds
  buffer_load_dwordx4 v25, s[36:39], s63 offen offset:1024 lds
  buffer_load_dwordx4 v26, s[36:39], s63 offen offset:2048 lds
  buffer_load_dwordx4 v27, s[36:39], s63 offen offset:3072 lds
  s_waitcnt vmcnt(60)
  s_mov_b32 m0, 126976
  s_add_u32 s63, s66, 28672
  buffer_load_dwordx4 v24, s[36:39], s63 offen offset:0 lds
  buffer_load_dwordx4 v25, s[36:39], s63 offen offset:1024 lds
  buffer_load_dwordx4 v26, s[36:39], s63 offen offset:2048 lds
  buffer_load_dwordx4 v27, s[36:39], s63 offen offset:3072 lds
  s_waitcnt vmcnt(50)
  s_mov_b32 m0, 131072
  s_add_u32 s63, s66, 57344
  buffer_load_dwordx4 v24, s[36:39], s63 offen offset:0 lds
  buffer_load_dwordx4 v25, s[36:39], s63 offen offset:1024 lds
  buffer_load_dwordx4 v26, s[36:39], s63 offen offset:2048 lds
  buffer_load_dwordx4 v27, s[36:39], s63 offen offset:3072 lds
  s_waitcnt vmcnt(50)
  s_mov_b32 m0, 0
  s_add_u32 s63, s65, 0
  buffer_load_dwordx4 v20, s[32:35], s63 offen offset:0 lds
  buffer_load_dwordx4 v21, s[32:35], s63 offen offset:1024 lds
  buffer_load_dwordx4 v22, s[32:35], s63 offen offset:2048 lds
  buffer_load_dwordx4 v23, s[32:35], s63 offen offset:3072 lds
  s_waitcnt vmcnt(50)
  s_mov_b32 m0, 4096
  s_add_u32 s63, s65, 32768
  buffer_load_dwordx4 v20, s[32:35], s63 offen offset:0 lds
  buffer_load_dwordx4 v21, s[32:35], s63 offen offset:1024 lds
  buffer_load_dwordx4 v22, s[32:35], s63 offen offset:2048 lds
  buffer_load_dwordx4 v23, s[32:35], s63 offen offset:3072 lds
  s_waitcnt vmcnt(50)
  s_mov_b32 m0, 8192
  s_add_u32 s63, s65, 131072
  buffer_load_dwordx4 v20, s[32:35], s63 offen offset:0 lds
  buffer_load_dwordx4 v21, s[32:35], s63 offen offset:1024 lds
  buffer_load_dwordx4 v22, s[32:35], s63 offen offset:2048 lds
  buffer_load_dwordx4 v23, s[32:35], s63 offen offset:3072 lds
  s_waitcnt vmcnt(50)
  s_mov_b32 m0, 12288
  s_add_u32 s63, s65, 163840
  buffer_load_dwordx4 v20, s[32:35], s63 offen offset:0 lds
  buffer_load_dwordx4 v21, s[32:35], s63 offen offset:1024 lds
  buffer_load_dwordx4 v22, s[32:35], s63 offen offset:2048 lds
  buffer_load_dwordx4 v23, s[32:35], s63 offen offset:3072 lds
  s_mov_b32 m0, 161792
  v_mov_b32 v4, L_tab-L_pc+28
  global_load_lds_dword v4, s[22:23]
  s_waitcnt vmcnt(51)
  s_xor_b32 s63, s44, 98304
  buffer_load_dwordx4 v[128:131], v8, s[24:27], s63 offen offset:0 nt
  buffer_load_dwordx4 v[132:135], v9, s[24:27], s63 offen offset:1024 nt
  buffer_load_dwordx4 v[136:139], v10, s[24:27], s63 offen offset:2048 nt
  buffer_load_dwordx4 v[140:143], v11, s[24:27], s63 offen offset:3072 nt
  s_xor_b32 s63, s44, 102400
  buffer_load_dwordx4 v[144:147], v12, s[24:27], s63 offen offset:0 nt
  buffer_load_dwordx4 v[148:151], v13, s[24:27], s63 offen offset:1024 nt
  buffer_load_dwordx4 v[152:155], v14, s[24:27], s63 offen offset:2048 nt
  buffer_load_dwordx4 v[156:159], v15, s[24:27], s63 offen offset:3072 nt
  s_xor_b32 s63, s44, 106496
  buffer_load_dwordx4 v[160:163], v8, s[24:27], s63 offen offset:0 nt
  buffer_load_dwordx4 v[164:167], v9, s[24:27], s63 offen offset:1024 nt
  buffer_load_dwordx4 v[168:171], v10, s[24:27], s63 offen offset:2048 nt
  buffer_load_dwordx4 v[172:175], v11, s[24:27], s63 offen offset:3072 nt
  s_waitcnt vmcnt(60)
  ds_read_b32 v32, v37
  s_xor_b32 s63, s44, 110592
  buffer_load_dwordx4 v[176:179], v12, s[24:27], s63 offen offset:0 nt
  buffer_load_dwordx4 v[180:183], v13, s[24:27], s63 offen offset:1024 nt
  buffer_load_dwordx4 v[184:187], v14, s[24:27], s63 offen offset:2048 nt
  buffer_load_dwordx4 v[188:191], v15, s[24:27], s63 offen offset:3072 nt
  s_waitcnt vmcnt(60)
  s_waitcnt lgkmcnt(0)
  v_cmp_gt_u32 vcc, 0xb0030002, v32
  s_cbranch_vccnz L_lsQ_7
L_lbQ_7:
  s_mov_b32 m0, 16384
  s_add_u32 s63, s65, 262144
  buffer_load_dwordx4 v20, s[32:35], s63 offen offset:0 lds
  buffer_load_dwordx4 v21, s[32:35], s63 offen offset:1024 lds
  buffer_load_dwordx4 v22, s[32:35], s63 offen offset:2048 lds
  buffer_load_dwordx4 v23, s[32:35], s63 offen offset:3072 lds
  s_waitcnt vmcnt(60)
  s_mov_b32 m0, 20480
  s_add_u32 s63, s65, 294912
  buffer_load_dwordx4 v20, s[32:35], s63 offen offset:0 lds
  buffer_load_dwordx4 v21, s[32:35], s63 offen offset:1024 lds
  buffer_load_dwordx4 v22, s[32:35], s63 offen offset:2048 lds
  buffer_load_dwordx4 v23, s[32:35], s63 offen offset:3072 lds
  s_waitcnt vmcnt(60)
  s_mov_b32 m0, 24576
  s_add_u32 s63, s65, 393216
  buffer_load_dwordx4 v20, s[32:35], s63 offen offset:0 lds
  buffer_load_dwordx4 v21, s[32:35], s63 offen offset:1024 lds
  buffer_load_dwordx4 v22, s[32:35], s63 offen offset:2048 lds
  buffer_load_dwordx4 v23, s[32:35], s63 offen offset:3072 lds
  s_waitcnt vmcnt(60)
  ds_read_b32 v32, v37
  s_mov_b32 m0, 28672
  s_add_u32 s63, s65, 425984
  buffer_load_dwordx4 v20, s[32:35], s63 offen offset:0 lds
  buffer_load_dwordx4 v21, s[32:35], s63 offen offset:1024 lds
  buffer_load_dwordx4 v22, s[32:35], s63 offen offset:2048 lds
  buffer_load_dwordx4 v23, s[32:35], s63 offen offset:3072 lds
  s_mov_b32 m0, 161792
  v_mov_b32 v4, L_tab-L_pc+32
  global_load_lds_dword v4, s[22:23]
  s_waitcnt vmcnt(60)
  s_waitcnt lgkmcnt(0)
  v_cmp_gt_u32 vcc, 0xb0030003, v32
  s_cbranch_vccnz L_lsQ_8
L_lbQ_8:
  s_lshl_b32 s65, s86, 19
  s_lshl_b32 s66, s86, 7
  s_add_u32 s86, s86, 1
  s_cmp_eq_u32 s86, 7
  s_cselect_b32 s86, 0, s86
  s_mov_b32 m0, 147456
  s_add_u32 s63, s66, 0
  buffer_load_dwordx4 v24, s[36:39], s63 offen offset:0 lds
  buffer_load_dwordx4 v25, s[36:39], s63 offen offset:1024 lds
  buffer_load_dwordx4 v26, s[36:39], s63 offen offset:2048 lds
  buffer_load_dwordx4 v27, s[36:39], s63 offen offset:3072 lds
  s_waitcnt vmcnt(60)
  s_mov_b32 m0, 151552
  s_add_u32 s63, s66, 28672
  buffer_load_dwordx4 v24, s[36:39], s63 offen offset:0 lds
  buffer_load_dwordx4 v25, s[36:39], s63 offen offset:1024 lds
  buffer_load_dwordx4 v26, s[36:39], s63 offen offset:2048 lds
  buffer_load_dwordx4 v27, s[36:39], s63 offen offset:3072 lds
  s_waitcnt vmcnt(60)
  s_mov_b32 m0, 155648
  s_add_u32 s63, s66, 57344
  buffer_load_dwordx4 v24, s[36:39], s63 offen offset:0 lds
  buffer_load_dwordx4 v25, s[36:39], s63 offen offset:1024 lds
  buffer_load_dwordx4 v26, s[36:39], s63 offen offset:2048 lds
  buffer_load_dwordx4 v27, s[36:39], s63 offen offset:3072 lds
  s_waitcnt vmcnt(60)
  s_mov_b32 m0, 32768
  s_add_u32 s63, s65, 0
  buffer_load_dwordx4 v20, s[32:35], s63 offen offset:0 lds
  buffer_load_dwordx4 v21, s[32:35], s63 offen offset:1024 lds
  buffer_load_dwordx4 v22, s[32:35], s63 offen offset:2048 lds
  buffer_load_dwordx4 v23, s[32:35], s63 offen offset:3072 lds
  s_waitcnt vmcnt(60)
  s_mov_b32 m0, 36864
  s_add_u32 s63, s65, 32768
  buffer_load_dwordx4 v20, s[32:35], s63 offen offset:0 lds
  buffer_load_dwordx4 v21, s[32:35], s63 offen offset:1024 lds
  buffer_load_dwordx4 v22, s[32:35], s63 offen offset:2048 lds
  buffer_load_dwordx4 v23, s[32:35], s63 offen offset:3072 lds
  s_waitcnt vmcnt(60)
  s_mov_b32 m0, 40960
  s_add_u32 s63, s65, 131072
  buffer_load_dwordx4 v20, s[32:35], s63 offen offset:0 lds
  buffer_load_dwordx4 v21, s[32:35], s63 offen offset:1024 lds
  buffer_load_dwordx4 v22, s[32:35], s63 offen offset:2048 lds
  buffer_load_dwordx4 v23, s[32:35], s63 offen offset:3072 lds
  s_waitcnt vmcnt(60)
  ds_read_b32 v32, v37
  s_mov_b32 m0, 45056
  s_add_u32 s63, s65, 163840
  buffer_load_dwordx4 v20, s[32:35], s63 offen offset:0 lds
  buffer_load_dwordx4 v21, s[32:35], s63 offen offset:1024 lds
  buffer_load_dwordx4 v22, s[32:35], s63 offen offset:2048 lds
  buffer_load_dwordx4 v23, s[32:35], s63 offen offset:3072 lds
  s_mov_b32 m0, 161792
  v_mov_b32 v4, L_tab-L_pc+36
  global_load_lds_dword v4, s[22:23]
  s_waitcnt vmcnt(60)
  s_waitcnt lgkmcnt(0)
  v_cmp_gt_u32 vcc, 0xb0030004, v32
  s_cbranch_vccnz L_lsQ_9
L_lbQ_9:
  s_mov_b32 m0, 49152
  s_add_u32 s63, s65, 262144
  buffer_load_dwordx4 v20, s[32:35], s63 offen offset:0 lds
  buffer_load_dwordx4 v21, s[32:35], s63 offen offset:1024 lds
  buffer_load_dwordx4 v22, s[32:35], s63 offen offset:2048 lds
  buffer_load_dwordx4 v23, s[32:35], s63 offen offset:3072 lds
  s_waitcnt vmcnt(60)
  s_mov_b32 m0, 53248
  s_add_u32 s63, s65, 294912
  buffer_load_dwordx4 v20, s[32:35], s63 offen offset:0 lds
  buffer_load_dwordx4 v21, s[32:35], s63 offen offset:1024 lds
  buffer_load_dwordx4 v22, s[32:35], s63 offen offset:2048 lds
  buffer_load_dwordx4 v23, s[32:35], s63 offen offset:3072 lds
  s_waitcnt vmcnt(50)
  s_mov_b32 m0, 57344
  s_add_u32 s63, s65, 393216
  buffer_load_dwordx4 v20, s[32:35], s63 offen offset:0 lds
  buffer_load_dwordx4 v21, s[32:35], s63 offen offset:1024 lds
  buffer_load_dwordx4 v22, s[32:35], s63 offen offset:2048 lds
  buffer_load_dwordx4 v23, s[32:35], s63 offen offset:3072 lds
  s_waitcnt vmcnt(50)
  s_mov_b32 m0, 61440
  s_add_u32 s63, s65, 425984
  buffer_load_dwordx4 v20, s[32:35], s63 offen offset:0 lds
  buffer_load_dwordx4 v21, s[32:35], s63 offen offset:1024 lds
  buffer_load_dwordx4 v22, s[32:35], s63 offen offset:2048 lds
  buffer_load_dwordx4 v23, s[32:35], s63 offen offset:3072 lds
  s_mov_b32 m0, 161792
  v_mov_b32 v4, L_tab-L_pc+40
  global_load_lds_dword v4, s[22:23]
  s_waitcnt vmcnt(51)
  s_xor_b32 s63, s44, 163840
  buffer_load_dwordx4 v[192:195], v8, s[24:27], s63 offen offset:0 nt
  buffer_load_dwordx4 v[196:199], v9, s[24:27], s63 offen offset:1024 nt
  buffer_load_dwordx4 v[200:203], v10, s[24:27], s63 offen offset:2048 nt
  buffer_load_dwordx4 v[204:207], v11, s[24:27], s63 offen offset:3072 nt
  s_xor_b32 s63, s44, 167936
  buffer_load_dwordx4 v[208:211], v12, s[24:27], s63 offen offset:0 nt
  buffer_load_dwordx4 v[212:215], v13, s[24:27], s63 offen offset:1024 nt
  buffer_load_dwordx4 v[216:219], v14, s[24:27], s63 offen offset:2048 nt
  buffer_load_dwordx4 v[220:223], v15, s[24:27], s63 offen offset:3072 nt
  s_xor_b32 s63, s44, 172032
  buffer_load_dwordx4 v[224:227], v8, s[24:27], s63 offen offset:0 nt
  buffer_load_dwordx4 v[228:231], v9, s[24:27], s63 offen offset:1024 nt
  buffer_load_dwordx4 v[232:235], v10, s[24:27], s63 offen offset:2048 nt
  buffer_load_dwordx4 v[236:239], v11, s[24:27], s63 offen offset:3072 nt
  s_waitcnt vmcnt(60)
  ds_read_b32 v32, v37
  s_xor_b32 s63, s44, 176128
  buffer_load_dwordx4 v[240:243], v12, s[24:27], s63 offen offset:0 nt
  buffer_load_dwordx4 v[244:247], v13, s[24:27], s63 offen offset:1024 nt
  buffer_load_dwordx4 v[248:251], v14, s[24:27], s63 offen offset:2048 nt
  buffer_load_dwordx4 v[252:255], v15, s[24:27], s63 offen offset:3072 nt
  s_waitcnt vmcnt(60)
  s_waitcnt lgkmcnt(0)
  v_cmp_gt_u32 vcc, 0xb0030005, v32
  s_cbranch_vccnz L_lsQ_10
L_lbQ_10:
  s_lshl_b32 s65, s86, 19
  s_lshl_b32 s66, s86, 7
  s_add_u32 s86, s86, 1
  s_cmp_eq_u32 s86, 7
  s_cselect_b32 s86, 0, s86
  s_mov_b32 m0, 135168
  s_add_u32 s63, s66, 0
  buffer_load_dwordx4 v24, s[36:39], s63 offen offset:0 lds
  buffer_load_dwordx4 v25, s[36:39], s63 offen offset:1024 lds
  buffer_load_dwordx4 v26, s[36:39], s63 offen offset:2048 lds
  buffer_load_dwordx4 v27, s[36:39], s63 offen offset:3072 lds
  s_waitcnt vmcnt(60)
  s_mov_b32 m0, 139264
  s_add_u32 s63, s66, 28672
  buffer_load_dwordx4 v24, s[36:39], s63 offen offset:0 lds
  buffer_load_dwordx4 v25, s[36:39], s63 offen offset:1024 lds
  buffer_load_dwordx4 v26, s[36:39], s63 offen offset:2048 lds
  buffer_load_dwordx4 v27, s[36:39], s63 offen offset:3072 lds
  s_waitcnt vmcnt(60)
  s_mov_b32 m0, 143360
  s_add_u32 s63, s66, 57344
  buffer_load_dwordx4 v24, s[36:39], s63 offen offset:0 lds
  buffer_load_dwordx4 v25, s[36:39], s63 offen offset:1024 lds
  buffer_load_dwordx4 v26, s[36:39], s63 offen offset:2048 lds
  buffer_load_dwordx4 v27, s[36:39], s63 offen offset:3072 lds
  s_waitcnt vmcnt(60)
  s_mov_b32 m0, 65536
  s_add_u32 s63, s65, 0
  buffer_load_dwordx4 v20, s[32:35], s63 offen offset:0 lds
  buffer_load_dwordx4 v21, s[32:35], s63 offen offset:1024 lds
  buffer_load_dwordx4 v22, s[32:35], s63 offen offset:2048 lds
  buffer_load_dwordx4 v23, s[32:35], s63 offen offset:3072 lds
  s_waitcnt vmcnt(60)
  s_mov_b32 m0, 69632
  s_add_u32 s63, s65, 32768
  buffer_load_dwordx4 v20, s[32:35], s63 offen offset:0 lds
  buffer_load_dwordx4 v21, s[32:35], s63 offen offset:1024 lds
  buffer_load_dwordx4 v22, s[32:35], s63 offen offset:2048 lds
  buffer_load_dwordx4 v23, s[32:35], s63 offen offset:3072 lds
  s_waitcnt vmcnt(60)
  s_mov_b32 m0, 73728
  s_add_u32 s63, s65, 131072
  buffer_load_dwordx4 v20, s[32:35], s63 offen offset:0 lds
  buffer_load_dwordx4 v21, s[32:35], s63 offen offset:1024 lds
  buffer_load_dwordx4 v22, s[32:35], s63 offen offset:2048 lds
  buffer_load_dwordx4 v23, s[32:35], s63 offen offset:3072 lds
  s_waitcnt vmcnt(60)
  ds_read_b32 v32, v37
  s_mov_b32 m0, 77824
  s_add_u32 s63, s65, 163840
  buffer_load_dwordx4 v20, s[32:35], s63 offen offset:0 lds
  buffer_load_dwordx4 v21, s[32:35], s63 offen offset:1024 lds
  buffer_load_dwordx4 v22, s[32:35], s63 offen offset:2048 lds
  buffer_load_dwordx4 v23, s[32:35], s63 offen offset:3072 lds
  s_mov_b32 m0, 161792
  v_mov_b32 v4, L_tab-L_pc+44
  global_load_lds_dword v4, s[22:23]
  s_waitcnt vmcnt(60)
  s_waitcnt lgkmcnt(0)
  v_cmp_gt_u32 vcc, 0xb0030006, v32
  s_cbranch_vccnz L_lsQ_11
L_lbQ_11:
  s_mov_b32 m0, 81920
  s_add_u32 s63, s65, 262144
  buffer_load_dwordx4 v20, s[32:35], s63 offen offset:0 lds
  buffer_load_dwordx4 v21, s[32:35], s63 offen offset:1024 lds
  buffer_load_dwordx4 v22, s[32:35], s63 offen offset:2048 lds
  buffer_load_dwordx4 v23, s[32:35], s63 offen offset:3072 lds
  s_waitcnt vmcnt(60)
  s_mov_b32 m0, 86016
  s_add_u32 s63, s65, 294912
  buffer_load_dwordx4 v20, s[32:35], s63 offen offset:0 lds
  buffer_load_dwordx4 v21, s[32:35], s63 offen offset:1024 lds
  buffer_load_dwordx4 v22, s[32:35], s63 offen offset:2048 lds
  buffer_load_dwordx4 v23, s[32:35], s63 offen offset:3072 lds
  s_waitcnt vmcnt(60)
  s_mov_b32 m0, 90112
  s_add_u32 s63, s65, 393216
  buffer_load_dwordx4 v20, s[32:35], s63 offen offset:0 lds
  buffer_load_dwordx4 v21, s[32:35], s63 offen offset:1024 lds
  buffer_load_dwordx4 v22, s[32:35], s63 offen offset:2048 lds
  buffer_load_dwordx4 v23, s[32:35], s63 offen offset:3072 lds
  s_waitcnt vmcnt(60)
  ds_read_b32 v32, v37
  s_mov_b32 m0, 94208
  s_add_u32 s63, s65, 425984
  buffer_load_dwordx4 v20, s[32:35], s63 offen offset:0 lds
  buffer_load_dwordx4 v21, s[32:35], s63 offen offset:1024 lds
  buffer_load_dwordx4 v22, s[32:35], s63 offen offset:2048 lds
  buffer_load_dwordx4 v23, s[32:35], s63 offen offset:3072 lds
  s_mov_b32 m0, 161792
  v_mov_b32 v4, L_tab-L_pc+48
  global_load_lds_dword v4, s[22:23]
  s_waitcnt vmcnt(60)
  s_waitcnt lgkmcnt(0)
  v_cmp_gt_u32 vcc, 0xb0030007, v32
  s_cbranch_vccnz L_lsQ_12
L_lbQ_12:
  s_lshl_b32 s65, s86, 19
  s_lshl_b32 s66, s86, 7
  s_add_u32 s86, s86, 1
  s_cmp_eq_u32 s86, 7
  s_cselect_b32 s86, 0, s86
  s_mov_b32 m0, 110592
  s_add_u32 s63, s66, 0
  buffer_load_dwordx4 v24, s[36:39], s63 offen offset:0 lds
  buffer_load_dwordx4 v25, s[36:39], s63 offen offset:1024 lds
  buffer_load_dwordx4 v26, s[36:39], s63 offen offset:2048 lds
  buffer_load_dwordx4 v27, s[36:39], s63 offen offset:3072 lds
  s_waitcnt vmcnt(60)
  s_mov_b32 m0, 114688
  s_add_u32 s63, s66, 28672
  buffer_load_dwordx4 v24, s[36:39], s63 offen offset:0 lds
  buffer_load_dwordx4 v25, s[36:39], s63 offen offset:1024 lds
  buffer_load_dwordx4 v26, s[36:39], s63 offen offset:2048 lds
  buffer_load_dwordx4 v27, s[36:39], s63 offen offset:3072 lds
  s_waitcnt vmcnt(50)
  s_mov_b32 m0, 118784
  s_add_u32 s63, s66, 57344
  buffer_load_dwordx4 v24, s[36:39], s63 offen offset:0 lds
  buffer_load_dwordx4 v25, s[36:39], s63 offen offset:1024 lds
  buffer_load_dwordx4 v26, s[36:39], s63 offen offset:2048 lds
  buffer_load_dwordx4 v27, s[36:39], s63 offen offset:3072 lds
  s_waitcnt vmcnt(50)
  s_mov_b32 m0, 0
  s_add_u32 s63, s65, 0
  buffer_load_dwordx4 v20, s[32:35], s63 offen offset:0 lds
  buffer_load_dwordx4 v21, s[32:35], s63 offen offset:1024 lds
  buffer_load_dwordx4 v22, s[32:35], s63 offen offset:2048 lds
  buffer_load_dwordx4 v23, s[32:35], s63 offen offset:3072 lds
  s_waitcnt vmcnt(50)
  s_mov_b32 m0, 4096
  s_add_u32 s63, s65, 32768
  buffer_load_dwordx4 v20, s[32:35], s63 offen offset:0 lds
  buffer_load_dwordx4 v21, s[32:35], s63 offen offset:1024 lds
  buffer_load_dwordx4 v22, s[32:35], s63 offen offset:2048 lds
  buffer_load_dwordx4 v23, s[32:35], s63 offen offset:3072 lds
  s_waitcnt vmcnt(50)
  s_mov_b32 m0, 8192
  s_add_u32 s63, s65, 131072
  buffer_load_dwordx4 v20, s[32:35], s63 offen offset:0 lds
  buffer_load_dwordx4 v21, s[32:35], s63 offen offset:1024 lds
  buffer_load_dwordx4 v22, s[32:35], s63 offen offset:2048 lds
  buffer_load_dwordx4 v23, s[32:35], s63 offen offset:3072 lds
  s_waitcnt vmcnt(50)
  s_mov_b32 m0, 12288
  s_add_u32 s63, s65, 163840
  buffer_load_dwordx4 v20, s[32:35], s63 offen offset:0 lds
  buffer_load_dwordx4 v21, s[32:35], s63 offen offset:1024 lds
  buffer_load_dwordx4 v22, s[32:35], s63 offen offset:2048 lds
  buffer_load_dwordx4 v23, s[32:35], s63 offen offset:3072 lds
  s_mov_b32 m0, 161792
  v_mov_b32 v4, L_tab-L_pc+52
  global_load_lds_dword v4, s[22:23]
  s_waitcnt vmcnt(51)
  s_xor_b32 s63, s44, 229376
  buffer_load_dwordx4 a[0:3], v8, s[24:27], s63 offen offset:0 nt
  buffer_load_dwordx4 a[4:7], v9, s[24:27], s63 offen offset:1024 nt
  buffer_load_dwordx4 a[8:11], v10, s[24:27], s63 offen offset:2048 nt
  buffer_load_dwordx4 a[12:15], v11, s[24:27], s63 offen offset:3072 nt
  s_xor_b32 s63, s44, 233472
  buffer_load_dwordx4 a[16:19], v12, s[24:27], s63 offen offset:0 nt
  buffer_load_dwordx4 a[20:23], v13, s[24:27], s63 offen offset:1024 nt
  buffer_load_dwordx4 a[24:27], v14, s[24:27], s63 offen offset:2048 nt
  buffer_load_dwordx4 a[28:31], v15, s[24:27], s63 offen offset:3072 nt
  s_xor_b32 s63, s44, 237568
  buffer_load_dwordx4 a[32:35], v8, s[24:27], s63 offen offset:0 nt
  buffer_load_dwordx4 a[36:39], v9, s[24:27], s63 offen offset:1024 nt
  buffer_load_dwordx4 a[40:43], v10, s[24:27], s63 offen offset:2048 nt
  buffer_load_dwordx4 a[44:47], v11, s[24:27], s63 offen offset:3072 nt
  s_waitcnt vmcnt(60)
  ds_read_b32 v32, v37
  s_xor_b32 s63, s44, 241664
  buffer_load_dwordx4 a[48:51], v12, s[24:27], s63 offen offset:0 nt
  buffer_load_dwordx4 a[52:55], v13, s[24:27], s63 offen offset:1024 nt
  buffer_load_dwordx4 a[56:59], v14, s[24:27], s63 offen offset:2048 nt
  buffer_load_dwordx4 a[60:63], v15, s[24:27], s63 offen offset:3072 nt
  s_waitcnt vmcnt(60)
  s_waitcnt lgkmcnt(0)
  v_cmp_gt_u32 vcc, 0xb0030008, v32
  s_cbranch_vccnz L_lsQ_13
L_lbQ_13:
  s_mov_b32 m0, 16384
  s_add_u32 s63, s65, 262144
  buffer_load_dwordx4 v20, s[32:35], s63 offen offset:0 lds
  buffer_load_dwordx4 v21, s[32:35], s63 offen offset:1024 lds
  buffer_load_dwordx4 v22, s[32:35], s63 offen offset:2048 lds
  buffer_load_dwordx4 v23, s[32:35], s63 offen offset:3072 lds
  s_waitcnt vmcnt(60)
  s_mov_b32 m0, 20480
  s_add_u32 s63, s65, 294912
  buffer_load_dwordx4 v20, s[32:35], s63 offen offset:0 lds
  buffer_load_dwordx4 v21, s[32:35], s63 offen offset:1024 lds
  buffer_load_dwordx4 v22, s[32:35], s63 offen offset:2048 lds
  buffer_load_dwordx4 v23, s[32:35], s63 offen offset:3072 lds
  s_waitcnt vmcnt(60)
  s_mov_b32 m0, 24576
  s_add_u32 s63, s65, 393216
  buffer_load_dwordx4 v20, s[32:35], s63 offen offset:0 lds
  buffer_load_dwordx4 v21, s[32:35], s63 offen offset:1024 lds
  buffer_load_dwordx4 v22, s[32:35], s63 offen offset:2048 lds
  buffer_load_dwordx4 v23, s[32:35], s63 offen offset:3072 lds
  s_waitcnt vmcnt(60)
  ds_read_b32 v32, v37
  s_mov_b32 m0, 28672
  s_add_u32 s63, s65, 425984
  buffer_load_dwordx4 v20, s[32:35], s63 offen offset:0 lds
  buffer_load_dwordx4 v21, s[32:35], s63 offen offset:1024 lds
  buffer_load_dwordx4 v22, s[32:35], s63 offen offset:2048 lds
  buffer_load_dwordx4 v23, s[32:35], s63 offen offset:3072 lds
  s_mov_b32 m0, 161792
  v_mov_b32 v4, L_tab-L_pc+56
  global_load_lds_dword v4, s[22:23]
  s_waitcnt vmcnt(60)
  s_waitcnt lgkmcnt(0)
  v_cmp_gt_u32 vcc, 0xb0030009, v32
  s_cbranch_vccnz L_lsK_0
L_lbK_0:
  s_mov_b32 m0, 32768
  s_xor_b32 s63, s44, 0
  buffer_load_dwordx4 v8, s[24:27], s63 offen offset:0 nt lds
  buffer_load_dwordx4 v9, s[24:27], s63 offen offset:1024 nt lds
  buffer_load_dwordx4 v10, s[24:27], s63 offen offset:2048 nt lds
  buffer_load_dwordx4 v11, s[24:27], s63 offen offset:3072 nt lds
  s_waitcnt vmcnt(60)
  s_mov_b32 m0, 36864
  s_xor_b32 s63, s44, 4096
  buffer_load_dwordx4 v12, s[24:27], s63 offen offset:0 nt lds
  buffer_load_dwordx4 v13, s[24:27], s63 offen offset:1024 nt lds
  buffer_load_dwordx4 v14, s[24:27], s63 offen offset:2048 nt lds
  buffer_load_dwordx4 v15, s[24:27], s63 offen offset:3072 nt lds
  s_waitcnt vmcnt(37)
  s_mov_b32 m0, 40960
  s_xor_b32 s63, s44, 8192
  buffer_load_dwordx4 v8, s[24:27], s63 offen offset:0 nt lds
  buffer_load_dwordx4 v9, s[24:27], s63 offen offset:1024 nt lds
  buffer_load_dwordx4 v10, s[24:27], s63 offen offset:2048 nt lds
  buffer_load_dwordx4 v11, s[24:27], s63 offen offset:3072 nt lds
  s_waitcnt vmcnt(37)
  ds_read_b32 v32, v36
  s_mov_b32 m0, 45056
  s_xor_b32 s63, s44, 12288
  buffer_load_dwordx4 v12, s[24:27], s63 offen offset:0 nt lds
  buffer_load_dwordx4 v13, s[24:27], s63 offen offset:1024 nt lds
  buffer_load_dwordx4 v14, s[24:27], s63 offen offset:2048 nt lds
  buffer_load_dwordx4 v15, s[24:27], s63 offen offset:3072 nt lds
  s_mov_b32 m0, 161792
  v_mov_b32 v4, L_tab-L_pc+60
  global_load_lds_dword v4, s[22:23]
  s_waitcnt vmcnt(38)
  s_waitcnt lgkmcnt(0)
  v_cmp_gt_u32 vcc, 0x1, v32
  s_cbranch_vccnz L_lsK_1
L_lbK_1:
  s_mov_b32 m0, 49152
  s_xor_b32 s63, s44, 16384
  buffer_load_dwordx4 v8, s[24:27], s63 offen offset:0 nt lds
  buffer_load_dwordx4 v9, s[24:27], s63 offen offset:1024 nt lds
  buffer_load_dwordx4 v10, s[24:27], s63 offen offset:2048 nt lds
  buffer_load_dwordx4 v11, s[24:27], s63 offen offset:3072 nt lds
  s_waitcnt vmcnt(38)
  s_mov_b32 m0, 53248
  s_xor_b32 s63, s44, 20480
  buffer_load_dwordx4 v12, s[24:27], s63 offen offset:0 nt lds
  buffer_load_dwordx4 v13, s[24:27], s63 offen offset:1024 nt lds
  buffer_load_dwordx4 v14, s[24:27], s63 offen offset:2048 nt lds
  buffer_load_dwordx4 v15, s[24:27], s63 offen offset:3072 nt lds
  s_waitcnt vmcnt(21)
  s_mov_b32 m0, 57344
  s_xor_b32 s63, s44, 24576
  buffer_load_dwordx4 v8, s[24:27], s63 offen offset:0 nt lds
  buffer_load_dwordx4 v9, s[24:27], s63 offen offset:1024 nt lds
  buffer_load_dwordx4 v10, s[24:27], s63 offen offset:2048 nt lds
  buffer_load_dwordx4 v11, s[24:27], s63 offen offset:3072 nt lds
  s_waitcnt vmcnt(21)
  ds_read_b32 v32, v36
  s_mov_b32 m0, 61440
  s_xor_b32 s63, s44, 28672
  buffer_load_dwordx4 v12, s[24:27], s63 offen offset:0 nt lds
  buffer_load_dwordx4 v13, s[24:27], s63 offen offset:1024 nt lds
  buffer_load_dwordx4 v14, s[24:27], s63 offen offset:2048 nt lds
  buffer_load_dwordx4 v15, s[24:27], s63 offen offset:3072 nt lds
  s_mov_b32 m0, 161792
  v_mov_b32 v4, L_tab-L_pc+64
  global_load_lds_dword v4, s[22:23]
  s_waitcnt vmcnt(22)
  s_waitcnt lgkmcnt(0)
  v_cmp_gt_u32 vcc, 0x2, v32
  s_cbranch_vccnz L_lsK_3
L_lbK_3:
  s_mov_b32 m0, 65536
  s_xor_b32 s63, s44, 49152
  buffer_load_dwordx4 v8, s[24:27], s63 offen offset:0 nt lds
  buffer_load_dwordx4 v9, s[24:27], s63 offen offset:1024 nt lds
  buffer_load_dwordx4 v10, s[24:27], s63 offen offset:2048 nt lds
  buffer_load_dwordx4 v11, s[24:27], s63 offen offset:3072 nt lds
  s_waitcnt vmcnt(22)
  s_mov_b32 m0, 69632
  s_xor_b32 s63, s44, 53248
  buffer_load_dwordx4 v12, s[24:27], s63 offen offset:0 nt lds
  buffer_load_dwordx4 v13, s[24:27], s63 offen offset:1024 nt lds
  buffer_load_dwordx4 v14, s[24:27], s63 offen offset:2048 nt lds
  buffer_load_dwordx4 v15, s[24:27], s63 offen offset:3072 nt lds
  s_waitcnt vmcnt(21)
  s_mov_b32 m0, 73728
  s_xor_b32 s63, s44, 57344
  buffer_load_dwordx4 v8, s[24:27], s63 offen offset:0 nt lds
  buffer_load_dwordx4 v9, s[24:27], s63 offen offset:1024 nt lds
  buffer_load_dwordx4 v10, s[24:27], s63 offen offset:2048 nt lds
  buffer_load_dwordx4 v11, s[24:27], s63 offen offset:3072 nt lds
  s_waitcnt vmcnt(21)
  s_mov_b32 m0, 77824
  s_xor_b32 s63, s44, 61440
  buffer_load_dwordx4 v12, s[24:27], s63 offen offset:0 nt lds
  buffer_load_dwordx4 v13, s[24:27], s63 offen offset:1024 nt lds
  buffer_load_dwordx4 v14, s[24:27], s63 offen offset:2048 nt lds
  buffer_load_dwordx4 v15, s[24:27], s63 offen offset:3072 nt lds
  s_mov_b32 m0, 161792
  v_mov_b32 v4, L_tab-L_pc+68
  global_load_lds_dword v4, s[22:23]
  s_waitcnt vmcnt(22)
  v_lshlrev_b32 v39, 4, v0
  v_add_u32 v39, 131072, v39
  ds_write_b128 v39, v[64:67] offset:4096
  ds_write_b128 v39, v[68:71] offset:5120
  ds_write_b128 v39, v[72:75] offset:6144
  ds_write_b128 v39, v[76:79] offset:7168
  ds_write_b128 v39, v[80:83] offset:8192
  ds_write_b128 v39, v[84:87] offset:9216
  ds_write_b128 v39, v[88:91] offset:10240
  ds_write_b128 v39, v[92:95] offset:11264
  ds_write_b128 v39, v[96:99] offset:12288
  ds_write_b128 v39, v[100:103] offset:13312
  ds_write_b128 v39, v[104:107] offset:14336
  ds_write_b128 v39, v[108:111] offset:15360
  ds_read_b32 v32, v36
  ds_write_b128 v39, v[112:115] offset:16384
  s_waitcnt lgkmcnt(13)
  ds_write_b128 v39, v[116:119] offset:17408
  s_waitcnt lgkmcnt(13)
  ds_write_b128 v39, v[120:123] offset:18432
  s_waitcnt lgkmcnt(13)
  ds_write_b128 v39, v[124:127] offset:19456
  v_mov_b32 v4, 1
  s_waitcnt lgkmcnt(13)
  ds_max_i32 v1, v4 offset:1024
  s_waitcnt lgkmcnt(5)
  v_cmp_gt_u32 vcc, 0x3, v32
  s_cbranch_vccnz L_lsK_4
L_lbK_4:
  s_mov_b32 m0, 81920
  s_xor_b32 s63, s44, 65536
  buffer_load_dwordx4 v8, s[24:27], s63 offen offset:0 nt lds
  buffer_load_dwordx4 v9, s[24:27], s63 offen offset:1024 nt lds
  buffer_load_dwordx4 v10, s[24:27], s63 offen offset:2048 nt lds
  buffer_load_dwordx4 v11, s[24:27], s63 offen offset:3072 nt lds
  s_waitcnt vmcnt(22)
  s_mov_b32 m0, 86016
  s_xor_b32 s63, s44, 69632
  buffer_load_dwordx4 v12, s[24:27], s63 offen offset:0 nt lds
  buffer_load_dwordx4 v13, s[24:27], s63 offen offset:1024 nt lds
  buffer_load_dwordx4 v14, s[24:27], s63 offen offset:2048 nt lds
  buffer_load_dwordx4 v15, s[24:27], s63 offen offset:3072 nt lds
  s_waitcnt vmcnt(21)
  s_mov_b32 m0, 90112
  s_xor_b32 s63, s44, 73728
  buffer_load_dwordx4 v8, s[24:27], s63 offen offset:0 nt lds
  buffer_load_dwordx4 v9, s[24:27], s63 offen offset:1024 nt lds
  buffer_load_dwordx4 v10, s[24:27], s63 offen offset:2048 nt lds
  buffer_load_dwordx4 v11, s[24:27], s63 offen offset:3072 nt lds
  s_waitcnt vmcnt(21)
  ds_read_b32 v32, v36
  s_mov_b32 m0, 94208
  s_xor_b32 s63, s44, 77824
  buffer_load_dwordx4 v12, s[24:27], s63 offen offset:0 nt lds
  buffer_load_dwordx4 v13, s[24:27], s63 offen offset:1024 nt lds
  buffer_load_dwordx4 v14, s[24:27], s63 offen offset:2048 nt lds
  buffer_load_dwordx4 v15, s[24:27], s63 offen offset:3072 nt lds
  s_mov_b32 m0, 161792
  v_mov_b32 v4, L_tab-L_pc+72
  global_load_lds_dword v4, s[22:23]
  s_waitcnt vmcnt(22)
  s_lshl_b32 s3, s59, 11
  s_add_u32 s3, s3, 67108864
  s_add_u32 s96, s14, s3
  s_addc_u32 s97, s15, 0
  s_mov_b32 s98, 2048
  s_mov_b32 s99, 0x20000
  s_lshr_b32 s3, s56, 2
  s_lshl_b32 s3, s3, 1
  s_add_u32 s3, s3, s57
  s_lshl_b32 s3, s3, 2
  s_and_b32 s20, s56, 3
  s_add_u32 s3, s3, s20
  s_lshl_b32 s3, s3, 4
  v_mov_b32 v53, s3
  global_load_dword v54, v53, s[18:19] sc1
  s_waitcnt lgkmcnt(0)
  v_cmp_gt_u32 vcc, 0x4, v32
  s_cbranch_vccnz L_lsK_5
L_lbK_5:
  s_mov_b32 m0, 0
  s_xor_b32 s63, s44, 81920
  buffer_load_dwordx4 v8, s[24:27], s63 offen offset:0 nt lds
  buffer_load_dwordx4 v9, s[24:27], s63 offen offset:1024 nt lds
  buffer_load_dwordx4 v10, s[24:27], s63 offen offset:2048 nt lds
  buffer_load_dwordx4 v11, s[24:27], s63 offen offset:3072 nt lds
  s_waitcnt vmcnt(23)
  s_mov_b32 m0, 4096
  s_xor_b32 s63, s44, 86016
  buffer_load_dwordx4 v12, s[24:27], s63 offen offset:0 nt lds
  buffer_load_dwordx4 v13, s[24:27], s63 offen offset:1024 nt lds
  buffer_load_dwordx4 v14, s[24:27], s63 offen offset:2048 nt lds
  buffer_load_dwordx4 v15, s[24:27], s63 offen offset:3072 nt lds
  s_waitcnt vmcnt(22)
  s_mov_b32 m0, 8192
  s_xor_b32 s63, s44, 90112
  buffer_load_dwordx4 v8, s[24:27], s63 offen offset:0 nt lds
  buffer_load_dwordx4 v9, s[24:27], s63 offen offset:1024 nt lds
  buffer_load_dwordx4 v10, s[24:27], s63 offen offset:2048 nt lds
  buffer_load_dwordx4 v11, s[24:27], s63 offen offset:3072 nt lds
  s_waitcnt vmcnt(22)
  s_mov_b32 m0, 12288
  s_xor_b32 s63, s44, 94208
  buffer_load_dwordx4 v12, s[24:27], s63 offen offset:0 nt lds
  buffer_load_dwordx4 v13, s[24:27], s63 offen offset:1024 nt lds
  buffer_load_dwordx4 v14, s[24:27], s63 offen offset:2048 nt lds
  buffer_load_dwordx4 v15, s[24:27], s63 offen offset:3072 nt lds
  s_mov_b32 m0, 161792
  v_mov_b32 v4, L_tab-L_pc+76
  global_load_lds_dword v4, s[22:23]
  s_waitcnt vmcnt(23)
  s_mov_b32 m0, 110592
  s_xor_b32 s63, s44, 114688
  buffer_load_dwordx4 v8, s[24:27], s63 offen offset:0 nt lds
  buffer_load_dwordx4 v9, s[24:27], s63 offen offset:1024 nt lds
  buffer_load_dwordx4 v10, s[24:27], s63 offen offset:2048 nt lds
  buffer_load_dwordx4 v11, s[24:27], s63 offen offset:3072 nt lds
  s_waitcnt vmcnt(23)
  s_mov_b32 m0, 114688
  s_xor_b32 s63, s44, 118784
  buffer_load_dwordx4 v12, s[24:27], s63 offen offset:0 nt lds
  buffer_load_dwordx4 v13, s[24:27], s63 offen offset:1024 nt lds
  buffer_load_dwordx4 v14, s[24:27], s63 offen offset:2048 nt lds
  buffer_load_dwordx4 v15, s[24:27], s63 offen offset:3072 nt lds
  s_waitcnt vmcnt(21)
  s_mov_b32 m0, 118784
  s_xor_b32 s63, s44, 122880
  buffer_load_dwordx4 v8, s[24:27], s63 offen offset:0 nt lds
  buffer_load_dwordx4 v9, s[24:27], s63 offen offset:1024 nt lds
  buffer_load_dwordx4 v10, s[24:27], s63 offen offset:2048 nt lds
  buffer_load_dwordx4 v11, s[24:27], s63 offen offset:3072 nt lds
  s_waitcnt vmcnt(21)
  ds_read_b32 v32, v36
  s_mov_b32 m0, 122880
  s_xor_b32 s63, s44, 126976
  buffer_load_dwordx4 v12, s[24:27], s63 offen offset:0 nt lds
  buffer_load_dwordx4 v13, s[24:27], s63 offen offset:1024 nt lds
  buffer_load_dwordx4 v14, s[24:27], s63 offen offset:2048 nt lds
  buffer_load_dwordx4 v15, s[24:27], s63 offen offset:3072 nt lds
  s_mov_b32 m0, 161792
  v_mov_b32 v4, L_tab-L_pc+80
  global_load_lds_dword v4, s[22:23]
  s_waitcnt vmcnt(22)
  s_waitcnt lgkmcnt(0)
  v_cmp_gt_u32 vcc, 0x5, v32
  s_cbranch_vccnz L_lsC_1
L_lbC_1:
  v_lshlrev_b32 v39, 4, v0
  ds_write_b128 v39, v[128:131] offset:16384
  ds_write_b128 v39, v[132:135] offset:17408
  ds_write_b128 v39, v[136:139] offset:18432
  ds_write_b128 v39, v[140:143] offset:19456
  ds_write_b128 v39, v[144:147] offset:20480
  ds_write_b128 v39, v[148:151] offset:21504
  ds_write_b128 v39, v[152:155] offset:22528
  ds_write_b128 v39, v[156:159] offset:23552
  ds_write_b128 v39, v[160:163] offset:24576
  ds_write_b128 v39, v[164:167] offset:25600
  ds_write_b128 v39, v[168:171] offset:26624
  ds_write_b128 v39, v[172:175] offset:27648
  ds_read_b32 v32, v36
  ds_write_b128 v39, v[176:179] offset:28672
  s_waitcnt lgkmcnt(13)
  ds_write_b128 v39, v[180:183] offset:29696
  s_waitcnt lgkmcnt(13)
  ds_write_b128 v39, v[184:187] offset:30720
  s_waitcnt lgkmcnt(13)
  ds_write_b128 v39, v[188:191] offset:31744
  v_mov_b32 v4, 2
  s_waitcnt lgkmcnt(13)
  ds_max_i32 v1, v4 offset:1024
  s_waitcnt lgkmcnt(5)
  v_cmp_gt_u32 vcc, 0x6, v32
  s_cbranch_vccnz L_lsK_8
L_lbK_8:
  s_mov_b32 m0, 32768
  s_xor_b32 s63, s44, 131072
  buffer_load_dwordx4 v8, s[24:27], s63 offen offset:0 nt lds
  buffer_load_dwordx4 v9, s[24:27], s63 offen offset:1024 nt lds
  buffer_load_dwordx4 v10, s[24:27], s63 offen offset:2048 nt lds
  buffer_load_dwordx4 v11, s[24:27], s63 offen offset:3072 nt lds
  s_waitcnt vmcnt(22)
  s_mov_b32 m0, 36864
  s_xor_b32 s63, s44, 135168
  buffer_load_dwordx4 v12, s[24:27], s63 offen offset:0 nt lds
  buffer_load_dwordx4 v13, s[24:27], s63 offen offset:1024 nt lds
  buffer_load_dwordx4 v14, s[24:27], s63 offen offset:2048 nt lds
  buffer_load_dwordx4 v15, s[24:27], s63 offen offset:3072 nt lds
  s_waitcnt vmcnt(21)
  s_mov_b32 m0, 40960
  s_xor_b32 s63, s44, 139264
  buffer_load_dwordx4 v8, s[24:27], s63 offen offset:0 nt lds
  buffer_load_dwordx4 v9, s[24:27], s63 offen offset:1024 nt lds
  buffer_load_dwordx4 v10, s[24:27], s63 offen offset:2048 nt lds
  buffer_load_dwordx4 v11, s[24:27], s63 offen offset:3072 nt lds
  s_waitcnt vmcnt(21)
  ds_read_b32 v32, v36
  s_mov_b32 m0, 45056
  s_xor_b32 s63, s44, 143360
  buffer_load_dwordx4 v12, s[24:27], s63 offen offset:0 nt lds
  buffer_load_dwordx4 v13, s[24:27], s63 offen offset:1024 nt lds
  buffer_load_dwordx4 v14, s[24:27], s63 offen offset:2048 nt lds
  buffer_load_dwordx4 v15, s[24:27], s63 offen offset:3072 nt lds
  s_mov_b32 m0, 161792
  v_mov_b32 v4, L_tab-L_pc+84
  global_load_lds_dword v4, s[22:23]
  s_waitcnt vmcnt(22)
  s_waitcnt lgkmcnt(0)
  v_cmp_gt_u32 vcc, 0x7, v32
  s_cbranch_vccnz L_lsK_9
L_lbK_9:
  s_mov_b32 m0, 49152
  s_xor_b32 s63, s44, 147456
  buffer_load_dwordx4 v8, s[24:27], s63 offen offset:0 nt lds
  buffer_load_dwordx4 v9, s[24:27], s63 offen offset:1024 nt lds
  buffer_load_dwordx4 v10, s[24:27], s63 offen offset:2048 nt lds
  buffer_load_dwordx4 v11, s[24:27], s63 offen offset:3072 nt lds
  s_waitcnt vmcnt(22)
  s_mov_b32 m0, 53248
  s_xor_b32 s63, s44, 151552
  buffer_load_dwordx4 v12, s[24:27], s63 offen offset:0 nt lds
  buffer_load_dwordx4 v13, s[24:27], s63 offen offset:1024 nt lds
  buffer_load_dwordx4 v14, s[24:27], s63 offen offset:2048 nt lds
  buffer_load_dwordx4 v15, s[24:27], s63 offen offset:3072 nt lds
  s_waitcnt vmcnt(21)
  s_mov_b32 m0, 57344
  s_xor_b32 s63, s44, 155648
  buffer_load_dwordx4 v8, s[24:27], s63 offen offset:0 nt lds
  buffer_load_dwordx4 v9, s[24:27], s63 offen offset:1024 nt lds
  buffer_load_dwordx4 v10, s[24:27], s63 offen offset:2048 nt lds
  buffer_load_dwordx4 v11, s[24:27], s63 offen offset:3072 nt lds
  s_waitcnt vmcnt(21)
  ds_read_b32 v32, v36
  s_mov_b32 m0, 61440
  s_xor_b32 s63, s44, 159744
  buffer_load_dwordx4 v12, s[24:27], s63 offen offset:0 nt lds
  buffer_load_dwordx4 v13, s[24:27], s63 offen offset:1024 nt lds
  buffer_load_dwordx4 v14, s[24:27], s63 offen offset:2048 nt lds
  buffer_load_dwordx4 v15, s[24:27], s63 offen offset:3072 nt lds
  s_mov_b32 m0, 161792
  v_mov_b32 v4, L_tab-L_pc+88
  global_load_lds_dword v4, s[22:23]
  s_waitcnt vmcnt(22)
  s_waitcnt lgkmcnt(0)
  v_cmp_gt_u32 vcc, 0x8, v32
  s_cbranch_vccnz L_lsK_11
L_lbK_11:
  s_mov_b32 m0, 135168
  s_xor_b32 s63, s44, 180224
  buffer_load_dwordx4 v8, s[24:27], s63 offen offset:0 nt lds
  buffer_load_dwordx4 v9, s[24:27], s63 offen offset:1024 nt lds
  buffer_load_dwordx4 v10, s[24:27], s63 offen offset:2048 nt lds
  buffer_load_dwordx4 v11, s[24:27], s63 offen offset:3072 nt lds
  s_waitcnt vmcnt(22)
  s_mov_b32 m0, 139264
  s_xor_b32 s63, s44, 184320
  buffer_load_dwordx4 v12, s[24:27], s63 offen offset:0 nt lds
  buffer_load_dwordx4 v13, s[24:27], s63 offen offset:1024 nt lds
  buffer_load_dwordx4 v14, s[24:27], s63 offen offset:2048 nt lds
  buffer_load_dwordx4 v15, s[24:27], s63 offen offset:3072 nt lds
  s_waitcnt vmcnt(21)
  s_mov_b32 m0, 143360
  s_xor_b32 s63, s44, 188416
  buffer_load_dwordx4 v8, s[24:27], s63 offen offset:0 nt lds
  buffer_load_dwordx4 v9, s[24:27], s63 offen offset:1024 nt lds
  buffer_load_dwordx4 v10, s[24:27], s63 offen offset:2048 nt lds
  buffer_load_dwordx4 v11, s[24:27], s63 offen offset:3072 nt lds
  s_waitcnt vmcnt(21)
  ds_read_b32 v32, v36
  s_mov_b32 m0, 147456
  s_xor_b32 s63, s44, 192512
  buffer_load_dwordx4 v12, s[24:27], s63 offen offset:0 nt lds
  buffer_load_dwordx4 v13, s[24:27], s63 offen offset:1024 nt lds
  buffer_load_dwordx4 v14, s[24:27], s63 offen offset:2048 nt lds
  buffer_load_dwordx4 v15, s[24:27], s63 offen offset:3072 nt lds
  s_mov_b32 m0, 161792
  v_mov_b32 v4, L_tab-L_pc+92
  global_load_lds_dword v4, s[22:23]
  s_waitcnt vmcnt(22)
  s_waitcnt lgkmcnt(0)
  v_cmp_gt_u32 vcc, 0x9, v32
  s_cbranch_vccnz L_lsC_2
L_lbC_2:
  v_lshlrev_b32 v39, 4, v0
  v_add_u32 v39, 65536, v39
  ds_write_b128 v39, v[192:195] offset:0
  ds_write_b128 v39, v[196:199] offset:1024
  ds_write_b128 v39, v[200:203] offset:2048
  ds_write_b128 v39, v[204:207] offset:3072
  ds_write_b128 v39, v[208:211] offset:4096
  ds_write_b128 v39, v[212:215] offset:5120
  ds_write_b128 v39, v[216:219] offset:6144
  ds_write_b128 v39, v[220:223] offset:7168
  ds_write_b128 v39, v[224:227] offset:8192
  ds_write_b128 v39, v[228:231] offset:9216
  ds_write_b128 v39, v[232:235] offset:10240
  ds_write_b128 v39, v[236:239] offset:11264
  ds_read_b32 v32, v36
  ds_write_b128 v39, v[240:243] offset:12288
  s_waitcnt lgkmcnt(13)
  ds_write_b128 v39, v[244:247] offset:13312
  s_waitcnt lgkmcnt(13)
  ds_write_b128 v39, v[248:251] offset:14336
  s_waitcnt lgkmcnt(13)
  ds_write_b128 v39, v[252:255] offset:15360
  v_mov_b32 v4, 3
  s_waitcnt lgkmcnt(13)
  ds_max_i32 v1, v4 offset:1024
  s_waitcnt lgkmcnt(5)
  v_cmp_gt_u32 vcc, 0xa, v32
  s_cbranch_vccnz L_lsK_12
L_lbK_12:
  s_mov_b32 m0, 81920
  s_xor_b32 s63, s44, 196608
  buffer_load_dwordx4 v8, s[24:27], s63 offen offset:0 nt lds
  buffer_load_dwordx4 v9, s[24:27], s63 offen offset:1024 nt lds
  buffer_load_dwordx4 v10, s[24:27], s63 offen offset:2048 nt lds
  buffer_load_dwordx4 v11, s[24:27], s63 offen offset:3072 nt lds
  s_waitcnt vmcnt(22)
  s_mov_b32 m0, 86016
  s_xor_b32 s63, s44, 200704
  buffer_load_dwordx4 v12, s[24:27], s63 offen offset:0 nt lds
  buffer_load_dwordx4 v13, s[24:27], s63 offen offset:1024 nt lds
  buffer_load_dwordx4 v14, s[24:27], s63 offen offset:2048 nt lds
  buffer_load_dwordx4 v15, s[24:27], s63 offen offset:3072 nt lds
  s_waitcnt vmcnt(21)
  s_mov_b32 m0, 90112
  s_xor_b32 s63, s44, 204800
  buffer_load_dwordx4 v8, s[24:27], s63 offen offset:0 nt lds
  buffer_load_dwordx4 v9, s[24:27], s63 offen offset:1024 nt lds
  buffer_load_dwordx4 v10, s[24:27], s63 offen offset:2048 nt lds
  buffer_load_dwordx4 v11, s[24:27], s63 offen offset:3072 nt lds
  s_waitcnt vmcnt(21)
  ds_read_b32 v32, v36
  s_mov_b32 m0, 94208
  s_xor_b32 s63, s44, 208896
  buffer_load_dwordx4 v12, s[24:27], s63 offen offset:0 nt lds
  buffer_load_dwordx4 v13, s[24:27], s63 offen offset:1024 nt lds
  buffer_load_dwordx4 v14, s[24:27], s63 offen offset:2048 nt lds
  buffer_load_dwordx4 v15, s[24:27], s63 offen offset:3072 nt lds
  s_mov_b32 m0, 161792
  v_mov_b32 v4, L_tab-L_pc+96
  global_load_lds_dword v4, s[22:23]
  s_waitcnt vmcnt(22)
  s_waitcnt lgkmcnt(0)
  v_cmp_gt_u32 vcc, 0xb, v32
  s_cbranch_vccnz L_lsK_13
L_lbK_13:
  s_mov_b32 m0, 0
  s_xor_b32 s63, s44, 212992
  buffer_load_dwordx4 v8, s[24:27], s63 offen offset:0 nt lds
  buffer_load_dwordx4 v9, s[24:27], s63 offen offset:1024 nt lds
  buffer_load_dwordx4 v10, s[24:27], s63 offen offset:2048 nt lds
  buffer_load_dwordx4 v11, s[24:27], s63 offen offset:3072 nt lds
  s_waitcnt vmcnt(22)
  s_mov_b32 m0, 4096
  s_xor_b32 s63, s44, 217088
  buffer_load_dwordx4 v12, s[24:27], s63 offen offset:0 nt lds
  buffer_load_dwordx4 v13, s[24:27], s63 offen offset:1024 nt lds
  buffer_load_dwordx4 v14, s[24:27], s63 offen offset:2048 nt lds
  buffer_load_dwordx4 v15, s[24:27], s63 offen offset:3072 nt lds
  s_waitcnt vmcnt(21)
  s_mov_b32 m0, 8192
  s_xor_b32 s63, s44, 221184
  buffer_load_dwordx4 v8, s[24:27], s63 offen offset:0 nt lds
  buffer_load_dwordx4 v9, s[24:27], s63 offen offset:1024 nt lds
  buffer_load_dwordx4 v10, s[24:27], s63 offen offset:2048 nt lds
  buffer_load_dwordx4 v11, s[24:27], s63 offen offset:3072 nt lds
  s_waitcnt vmcnt(21)
  ds_read_b32 v32, v36
  s_mov_b32 m0, 12288
  s_xor_b32 s63, s44, 225280
  buffer_load_dwordx4 v12, s[24:27], s63 offen offset:0 nt lds
  buffer_load_dwordx4 v13, s[24:27], s63 offen offset:1024 nt lds
  buffer_load_dwordx4 v14, s[24:27], s63 offen offset:2048 nt lds
  buffer_load_dwordx4 v15, s[24:27], s63 offen offset:3072 nt lds
  s_mov_b32 m0, 161792
  v_mov_b32 v4, L_tab-L_pc+100
  global_load_lds_dword v4, s[22:23]
  s_waitcnt vmcnt(22)
  s_waitcnt lgkmcnt(0)
  v_cmp_gt_u32 vcc, 0xc, v32
  s_cbranch_vccnz L_lsK_15
L_lbK_15:
  s_mov_b32 m0, 16384
  s_xor_b32 s63, s44, 245760
  buffer_load_dwordx4 v8, s[24:27], s63 offen offset:0 nt lds
  buffer_load_dwordx4 v9, s[24:27], s63 offen offset:1024 nt lds
  buffer_load_dwordx4 v10, s[24:27], s63 offen offset:2048 nt lds
  buffer_load_dwordx4 v11, s[24:27], s63 offen offset:3072 nt lds
  s_waitcnt vmcnt(22)
  s_mov_b32 m0, 20480
  s_xor_b32 s63, s44, 249856
  buffer_load_dwordx4 v12, s[24:27], s63 offen offset:0 nt lds
  buffer_load_dwordx4 v13, s[24:27], s63 offen offset:1024 nt lds
  buffer_load_dwordx4 v14, s[24:27], s63 offen offset:2048 nt lds
  buffer_load_dwordx4 v15, s[24:27], s63 offen offset:3072 nt lds
  s_waitcnt vmcnt(21)
  s_mov_b32 m0, 24576
  s_xor_b32 s63, s44, 253952
  buffer_load_dwordx4 v8, s[24:27], s63 offen offset:0 nt lds
  buffer_load_dwordx4 v9, s[24:27], s63 offen offset:1024 nt lds
  buffer_load_dwordx4 v10, s[24:27], s63 offen offset:2048 nt lds
  buffer_load_dwordx4 v11, s[24:27], s63 offen offset:3072 nt lds
  s_waitcnt vmcnt(21)
  ds_read_b32 v32, v36
  s_mov_b32 m0, 28672
  s_xor_b32 s63, s44, 258048
  buffer_load_dwordx4 v12, s[24:27], s63 offen offset:0 nt lds
  buffer_load_dwordx4 v13, s[24:27], s63 offen offset:1024 nt lds
  buffer_load_dwordx4 v14, s[24:27], s63 offen offset:2048 nt lds
  buffer_load_dwordx4 v15, s[24:27], s63 offen offset:3072 nt lds
  s_mov_b32 m0, 161792
  v_mov_b32 v4, L_tab-L_pc+104
  global_load_lds_dword v4, s[22:23]
  s_waitcnt vmcnt(22)
  s_waitcnt lgkmcnt(0)
  v_cmp_gt_u32 vcc, 0xd, v32
  s_cbranch_vccnz L_lsC_3
L_lbC_3:
  ds_write_b128 v39, a[0:3] offset:45056
  ds_write_b128 v39, a[4:7] offset:46080
  ds_write_b128 v39, a[8:11] offset:47104
  ds_write_b128 v39, a[12:15] offset:48128
  ds_write_b128 v39, a[16:19] offset:49152
  ds_write_b128 v39, a[20:23] offset:50176
  ds_write_b128 v39, a[24:27] offset:51200
  ds_write_b128 v39, a[28:31] offset:52224
  ds_write_b128 v39, a[32:35] offset:53248
  ds_write_b128 v39, a[36:39] offset:54272
  ds_write_b128 v39, a[40:43] offset:55296
  ds_write_b128 v39, a[44:47] offset:56320
  ds_read_b32 v32, v36
  ds_write_b128 v39, a[48:51] offset:57344
  s_waitcnt lgkmcnt(13)
  ds_write_b128 v39, a[52:55] offset:58368
  s_waitcnt lgkmcnt(13)
  ds_write_b128 v39, a[56:59] offset:59392
  s_waitcnt lgkmcnt(13)
  ds_write_b128 v39, a[60:63] offset:60416
  v_mov_b32 v4, 4
  s_waitcnt lgkmcnt(13)
  ds_max_i32 v1, v4 offset:1024
  s_waitcnt lgkmcnt(5)
  v_cmp_gt_u32 vcc, 0xe, v32
  s_cbranch_vccnz L_lsV_0_0
L_lbV_0_0:
  s_mov_b32 m0, 32768
  s_xor_b32 s63, s45, 0
  buffer_load_dwordx4 v16, s[28:31], s63 offen offset:0 nt lds
  buffer_load_dwordx4 v17, s[28:31], s63 offen offset:1024 nt lds
  buffer_load_dwordx4 v18, s[28:31], s63 offen offset:2048 nt lds
  buffer_load_dwordx4 v19, s[28:31], s63 offen offset:3072 nt lds
  s_waitcnt vmcnt(22)
  s_mov_b32 m0, 36864
  s_xor_b32 s63, s45, 16384
  buffer_load_dwordx4 v16, s[28:31], s63 offen offset:0 nt lds
  buffer_load_dwordx4 v17, s[28:31], s63 offen offset:1024 nt lds
  buffer_load_dwordx4 v18, s[28:31], s63 offen offset:2048 nt lds
  buffer_load_dwordx4 v19, s[28:31], s63 offen offset:3072 nt lds
  s_waitcnt vmcnt(21)
  s_mov_b32 m0, 40960
  s_xor_b32 s63, s45, 32768
  buffer_load_dwordx4 v16, s[28:31], s63 offen offset:0 nt lds
  buffer_load_dwordx4 v17, s[28:31], s63 offen offset:1024 nt lds
  buffer_load_dwordx4 v18, s[28:31], s63 offen offset:2048 nt lds
  buffer_load_dwordx4 v19, s[28:31], s63 offen offset:3072 nt lds
  s_waitcnt vmcnt(21)
  ds_read_b32 v32, v36
  s_mov_b32 m0, 45056
  s_xor_b32 s63, s45, 49152
  buffer_load_dwordx4 v16, s[28:31], s63 offen offset:0 nt lds
  buffer_load_dwordx4 v17, s[28:31], s63 offen offset:1024 nt lds
  buffer_load_dwordx4 v18, s[28:31], s63 offen offset:2048 nt lds
  buffer_load_dwordx4 v19, s[28:31], s63 offen offset:3072 nt lds
  s_mov_b32 m0, 161792
  v_mov_b32 v4, L_tab-L_pc+108
  global_load_lds_dword v4, s[22:23]
  s_waitcnt vmcnt(22)
  s_waitcnt lgkmcnt(0)
  v_cmp_gt_u32 vcc, 0xf, v32
  s_cbranch_vccnz L_lsV_0_1
L_lbV_0_1:
  s_mov_b32 m0, 49152
  s_xor_b32 s63, s45, 65536
  buffer_load_dwordx4 v16, s[28:31], s63 offen offset:0 nt lds
  buffer_load_dwordx4 v17, s[28:31], s63 offen offset:1024 nt lds
  buffer_load_dwordx4 v18, s[28:31], s63 offen offset:2048 nt lds
  buffer_load_dwordx4 v19, s[28:31], s63 offen offset:3072 nt lds
  s_waitcnt vmcnt(22)
  s_mov_b32 m0, 53248
  s_xor_b32 s63, s45, 81920
  buffer_load_dwordx4 v16, s[28:31], s63 offen offset:0 nt lds
  buffer_load_dwordx4 v17, s[28:31], s63 offen offset:1024 nt lds
  buffer_load_dwordx4 v18, s[28:31], s63 offen offset:2048 nt lds
  buffer_load_dwordx4 v19, s[28:31], s63 offen offset:3072 nt lds
  s_waitcnt vmcnt(21)
  s_mov_b32 m0, 57344
  s_xor_b32 s63, s45, 98304
  buffer_load_dwordx4 v16, s[28:31], s63 offen offset:0 nt lds
  buffer_load_dwordx4 v17, s[28:31], s63 offen offset:1024 nt lds
  buffer_load_dwordx4 v18, s[28:31], s63 offen offset:2048 nt lds
  buffer_load_dwordx4 v19, s[28:31], s63 offen offset:3072 nt lds
  s_waitcnt vmcnt(21)
  ds_read_b32 v32, v36
  s_mov_b32 m0, 61440
  s_xor_b32 s63, s45, 114688
  buffer_load_dwordx4 v16, s[28:31], s63 offen offset:0 nt lds
  buffer_load_dwordx4 v17, s[28:31], s63 offen offset:1024 nt lds
  buffer_load_dwordx4 v18, s[28:31], s63 offen offset:2048 nt lds
  buffer_load_dwordx4 v19, s[28:31], s63 offen offset:3072 nt lds
  s_mov_b32 m0, 161792
  v_mov_b32 v4, L_tab-L_pc+112
  global_load_lds_dword v4, s[22:23]
  s_waitcnt vmcnt(22)
  s_waitcnt lgkmcnt(0)
  v_cmp_gt_u32 vcc, 0x10, v32
  s_cbranch_vccnz L_lsV_0_2
L_lbV_0_2:
  s_mov_b32 m0, 65536
  s_xor_b32 s63, s45, 131072
  buffer_load_dwordx4 v16, s[28:31], s63 offen offset:0 nt lds
  buffer_load_dwordx4 v17, s[28:31], s63 offen offset:1024 nt lds
  buffer_load_dwordx4 v18, s[28:31], s63 offen offset:2048 nt lds
  buffer_load_dwordx4 v19, s[28:31], s63 offen offset:3072 nt lds
  s_waitcnt vmcnt(22)
  s_mov_b32 m0, 69632
  s_xor_b32 s63, s45, 147456
  buffer_load_dwordx4 v16, s[28:31], s63 offen offset:0 nt lds
  buffer_load_dwordx4 v17, s[28:31], s63 offen offset:1024 nt lds
  buffer_load_dwordx4 v18, s[28:31], s63 offen offset:2048 nt lds
  buffer_load_dwordx4 v19, s[28:31], s63 offen offset:3072 nt lds
  s_waitcnt vmcnt(21)
  s_mov_b32 m0, 73728
  s_xor_b32 s63, s45, 163840
  buffer_load_dwordx4 v16, s[28:31], s63 offen offset:0 nt lds
  buffer_load_dwordx4 v17, s[28:31], s63 offen offset:1024 nt lds
  buffer_load_dwordx4 v18, s[28:31], s63 offen offset:2048 nt lds
  buffer_load_dwordx4 v19, s[28:31], s63 offen offset:3072 nt lds
  s_waitcnt vmcnt(21)
  ds_read_b32 v32, v36
  s_mov_b32 m0, 77824
  s_xor_b32 s63, s45, 180224
  buffer_load_dwordx4 v16, s[28:31], s63 offen offset:0 nt lds
  buffer_load_dwordx4 v17, s[28:31], s63 offen offset:1024 nt lds
  buffer_load_dwordx4 v18, s[28:31], s63 offen offset:2048 nt lds
  buffer_load_dwordx4 v19, s[28:31], s63 offen offset:3072 nt lds
  s_mov_b32 m0, 161792
  v_mov_b32 v4, L_tab-L_pc+116
  global_load_lds_dword v4, s[22:23]
  s_waitcnt vmcnt(22)
  s_waitcnt lgkmcnt(0)
  v_cmp_gt_u32 vcc, 0x11, v32
  s_cbranch_vccnz L_lsV_0_3
L_lbV_0_3:
  s_mov_b32 m0, 135168
  s_xor_b32 s63, s45, 196608
  buffer_load_dwordx4 v16, s[28:31], s63 offen offset:0 nt lds
  buffer_load_dwordx4 v17, s[28:31], s63 offen offset:1024 nt lds
  buffer_load_dwordx4 v18, s[28:31], s63 offen offset:2048 nt lds
  buffer_load_dwordx4 v19, s[28:31], s63 offen offset:3072 nt lds
  s_waitcnt vmcnt(22)
  s_mov_b32 m0, 139264
  s_xor_b32 s63, s45, 212992
  buffer_load_dwordx4 v16, s[28:31], s63 offen offset:0 nt lds
  buffer_load_dwordx4 v17, s[28:31], s63 offen offset:1024 nt lds
  buffer_load_dwordx4 v18, s[28:31], s63 offen offset:2048 nt lds
  buffer_load_dwordx4 v19, s[28:31], s63 offen offset:3072 nt lds
  s_waitcnt vmcnt(21)
  s_mov_b32 m0, 143360
  s_xor_b32 s63, s45, 229376
  buffer_load_dwordx4 v16, s[28:31], s63 offen offset:0 nt lds
  buffer_load_dwordx4 v17, s[28:31], s63 offen offset:1024 nt lds
  buffer_load_dwordx4 v18, s[28:31], s63 offen offset:2048 nt lds
  buffer_load_dwordx4 v19, s[28:31], s63 offen offset:3072 nt lds
  s_waitcnt vmcnt(21)
  ds_read_b32 v32, v36
  s_mov_b32 m0, 147456
  s_xor_b32 s63, s45, 245760
  buffer_load_dwordx4 v16, s[28:31], s63 offen offset:0 nt lds
  buffer_load_dwordx4 v17, s[28:31], s63 offen offset:1024 nt lds
  buffer_load_dwordx4 v18, s[28:31], s63 offen offset:2048 nt lds
  buffer_load_dwordx4 v19, s[28:31], s63 offen offset:3072 nt lds
  s_mov_b32 m0, 161792
  v_mov_b32 v4, L_tab-L_pc+120
  global_load_lds_dword v4, s[22:23]
  s_waitcnt vmcnt(22)
  s_waitcnt lgkmcnt(0)
  v_cmp_gt_u32 vcc, 0x12, v32
  s_cbranch_vccnz L_lsV_1_0
L_lbV_1_0:
  s_mov_b32 m0, 81920
  s_xor_b32 s63, s45, 128
  buffer_load_dwordx4 v16, s[28:31], s63 offen offset:0 nt lds
  buffer_load_dwordx4 v17, s[28:31], s63 offen offset:1024 nt lds
  buffer_load_dwordx4 v18, s[28:31], s63 offen offset:2048 nt lds
  buffer_load_dwordx4 v19, s[28:31], s63 offen offset:3072 nt lds
  s_mov_b32 m0, 86016
  s_xor_b32 s63, s45, 16512
  buffer_load_dwordx4 v16, s[28:31], s63 offen offset:0 nt lds
  buffer_load_dwordx4 v17, s[28:31], s63 offen offset:1024 nt lds
  buffer_load_dwordx4 v18, s[28:31], s63 offen offset:2048 nt lds
  buffer_load_dwordx4 v19, s[28:31], s63 offen offset:3072 nt lds
  s_mov_b32 m0, 90112
  s_xor_b32 s63, s45, 32896
  buffer_load_dwordx4 v16, s[28:31], s63 offen offset:0 nt lds
  buffer_load_dwordx4 v17, s[28:31], s63 offen offset:1024 nt lds
  buffer_load_dwordx4 v18, s[28:31], s63 offen offset:2048 nt lds
  buffer_load_dwordx4 v19, s[28:31], s63 offen offset:3072 nt lds
  s_waitcnt vmcnt(30)
  s_mov_b32 m0, 94208
  s_xor_b32 s63, s45, 49280
  buffer_load_dwordx4 v16, s[28:31], s63 offen offset:0 nt lds
  buffer_load_dwordx4 v17, s[28:31], s63 offen offset:1024 nt lds
  buffer_load_dwordx4 v18, s[28:31], s63 offen offset:2048 nt lds
  buffer_load_dwordx4 v19, s[28:31], s63 offen offset:3072 nt lds
  s_mov_b32 m0, 161792
  v_mov_b32 v4, L_tab-L_pc+124
  global_load_lds_dword v4, s[22:23]
  s_waitcnt vmcnt(30)
  s_add_u32 s87, s100, 0
  s_sub_u32 s3, s87, 7
  s_cselect_b32 s87, s87, s3
  s_lshl_b32 s87, s87, 7
  s_mov_b32 m0, 98304
  s_add_u32 s63, s87, s52
  buffer_load_dwordx4 v28, s[40:43], s63 offen offset:0 lds
  buffer_load_dwordx4 v29, s[40:43], s63 offen offset:1024 lds
  buffer_load_dwordx4 v30, s[40:43], s63 offen offset:2048 lds
  buffer_load_dwordx4 v31, s[40:43], s63 offen offset:3072 lds
  ds_read_b32 v32, v36
  s_mov_b32 m0, 102400
  s_add_u32 s63, s63, 28672
  buffer_load_dwordx4 v28, s[40:43], s63 offen offset:0 lds
  buffer_load_dwordx4 v29, s[40:43], s63 offen offset:1024 lds
  buffer_load_dwordx4 v30, s[40:43], s63 offen offset:2048 lds
  buffer_load_dwordx4 v31, s[40:43], s63 offen offset:3072 lds
  s_mov_b32 m0, 161792
  v_mov_b32 v4, L_tab-L_pc+128
  global_load_lds_dword v4, s[22:23]
  s_waitcnt lgkmcnt(0)
  v_cmp_gt_u32 vcc, 0x13, v32
  s_cbranch_vccnz L_lsV_1_1
L_lbV_1_1:
  s_mov_b32 m0, 0
  s_xor_b32 s63, s45, 65664
  buffer_load_dwordx4 v16, s[28:31], s63 offen offset:0 nt lds
  buffer_load_dwordx4 v17, s[28:31], s63 offen offset:1024 nt lds
  buffer_load_dwordx4 v18, s[28:31], s63 offen offset:2048 nt lds
  buffer_load_dwordx4 v19, s[28:31], s63 offen offset:3072 nt lds
  s_waitcnt vmcnt(39)
  s_mov_b32 m0, 4096
  s_xor_b32 s63, s45, 82048
  buffer_load_dwordx4 v16, s[28:31], s63 offen offset:0 nt lds
  buffer_load_dwordx4 v17, s[28:31], s63 offen offset:1024 nt lds
  buffer_load_dwordx4 v18, s[28:31], s63 offen offset:2048 nt lds
  buffer_load_dwordx4 v19, s[28:31], s63 offen offset:3072 nt lds
  s_waitcnt vmcnt(39)
  s_mov_b32 m0, 8192
  s_xor_b32 s63, s45, 98432
  buffer_load_dwordx4 v16, s[28:31], s63 offen offset:0 nt lds
  buffer_load_dwordx4 v17, s[28:31], s63 offen offset:1024 nt lds
  buffer_load_dwordx4 v18, s[28:31], s63 offen offset:2048 nt lds
  buffer_load_dwordx4 v19, s[28:31], s63 offen offset:3072 nt lds
  s_waitcnt vmcnt(39)
  s_mov_b32 m0, 12288
  s_xor_b32 s63, s45, 114816
  buffer_load_dwordx4 v16, s[28:31], s63 offen offset:0 nt lds
  buffer_load_dwordx4 v17, s[28:31], s63 offen offset:1024 nt lds
  buffer_load_dwordx4 v18, s[28:31], s63 offen offset:2048 nt lds
  buffer_load_dwordx4 v19, s[28:31], s63 offen offset:3072 nt lds
  s_mov_b32 m0, 161792
  v_mov_b32 v4, L_tab-L_pc+132
  global_load_lds_dword v4, s[22:23]
  s_waitcnt vmcnt(39)
  s_add_u32 s87, s100, 1
  s_sub_u32 s3, s87, 7
  s_cselect_b32 s87, s87, s3
  s_lshl_b32 s87, s87, 7
  s_mov_b32 m0, 126976
  s_add_u32 s63, s87, s52
  buffer_load_dwordx4 v28, s[40:43], s63 offen offset:0 lds
  buffer_load_dwordx4 v29, s[40:43], s63 offen offset:1024 lds
  buffer_load_dwordx4 v30, s[40:43], s63 offen offset:2048 lds
  buffer_load_dwordx4 v31, s[40:43], s63 offen offset:3072 lds
  ds_read_b32 v32, v36
  s_mov_b32 m0, 131072
  s_add_u32 s63, s63, 28672
  buffer_load_dwordx4 v28, s[40:43], s63 offen offset:0 lds
  buffer_load_dwordx4 v29, s[40:43], s63 offen offset:1024 lds
  buffer_load_dwordx4 v30, s[40:43], s63 offen offset:2048 lds
  buffer_load_dwordx4 v31, s[40:43], s63 offen offset:3072 lds
  s_mov_b32 m0, 161792
  v_mov_b32 v4, L_tab-L_pc+136
  global_load_lds_dword v4, s[22:23]
  s_waitcnt lgkmcnt(0)
  v_cmp_gt_u32 vcc, 0x14, v32
  s_cbranch_vccnz L_lsV_1_2
L_lbV_1_2:
  s_mov_b32 m0, 110592
  s_xor_b32 s63, s45, 131200
  buffer_load_dwordx4 v16, s[28:31], s63 offen offset:0 nt lds
  buffer_load_dwordx4 v17, s[28:31], s63 offen offset:1024 nt lds
  buffer_load_dwordx4 v18, s[28:31], s63 offen offset:2048 nt lds
  buffer_load_dwordx4 v19, s[28:31], s63 offen offset:3072 nt lds
  s_waitcnt vmcnt(48)
  s_mov_b32 m0, 114688
  s_xor_b32 s63, s45, 147584
  buffer_load_dwordx4 v16, s[28:31], s63 offen offset:0 nt lds
  buffer_load_dwordx4 v17, s[28:31], s63 offen offset:1024 nt lds
  buffer_load_dwordx4 v18, s[28:31], s63 offen offset:2048 nt lds
  buffer_load_dwordx4 v19, s[28:31], s63 offen offset:3072 nt lds
  s_waitcnt vmcnt(48)
  s_mov_b32 m0, 118784
  s_xor_b32 s63, s45, 163968
  buffer_load_dwordx4 v16, s[28:31], s63 offen offset:0 nt lds
  buffer_load_dwordx4 v17, s[28:31], s63 offen offset:1024 nt lds
  buffer_load_dwordx4 v18, s[28:31], s63 offen offset:2048 nt lds
  buffer_load_dwordx4 v19, s[28:31], s63 offen offset:3072 nt lds
  s_waitcnt vmcnt(48)
  s_mov_b32 m0, 122880
  s_xor_b32 s63, s45, 180352
  buffer_load_dwordx4 v16, s[28:31], s63 offen offset:0 nt lds
  buffer_load_dwordx4 v17, s[28:31], s63 offen offset:1024 nt lds
  buffer_load_dwordx4 v18, s[28:31], s63 offen offset:2048 nt lds
  buffer_load_dwordx4 v19, s[28:31], s63 offen offset:3072 nt lds
  s_mov_b32 m0, 161792
  v_mov_b32 v4, L_tab-L_pc+140
  global_load_lds_dword v4, s[22:23]
  s_waitcnt vmcnt(39)
  s_add_u32 s87, s100, 2
  s_sub_u32 s3, s87, 7
  s_cselect_b32 s87, s87, s3
  s_lshl_b32 s87, s87, 7
  s_mov_b32 m0, 151552
  s_add_u32 s63, s87, s52
  buffer_load_dwordx4 v28, s[40:43], s63 offen offset:0 lds
  buffer_load_dwordx4 v29, s[40:43], s63 offen offset:1024 lds
  buffer_load_dwordx4 v30, s[40:43], s63 offen offset:2048 lds
  buffer_load_dwordx4 v31, s[40:43], s63 offen offset:3072 lds
  ds_read_b32 v32, v36
  s_mov_b32 m0, 155648
  s_add_u32 s63, s63, 28672
  buffer_load_dwordx4 v28, s[40:43], s63 offen offset:0 lds
  buffer_load_dwordx4 v29, s[40:43], s63 offen offset:1024 lds
  buffer_load_dwordx4 v30, s[40:43], s63 offen offset:2048 lds
  buffer_load_dwordx4 v31, s[40:43], s63 offen offset:3072 lds
  s_mov_b32 m0, 161792
  v_mov_b32 v4, L_tab-L_pc+144
  global_load_lds_dword v4, s[22:23]
  s_waitcnt lgkmcnt(0)
  v_cmp_gt_u32 vcc, 0x15, v32
  s_cbranch_vccnz L_lsV_1_3
L_lbV_1_3:
  s_mov_b32 m0, 16384
  s_xor_b32 s63, s45, 196736
  buffer_load_dwordx4 v16, s[28:31], s63 offen offset:0 nt lds
  buffer_load_dwordx4 v17, s[28:31], s63 offen offset:1024 nt lds
  buffer_load_dwordx4 v18, s[28:31], s63 offen offset:2048 nt lds
  buffer_load_dwordx4 v19, s[28:31], s63 offen offset:3072 nt lds
  s_waitcnt vmcnt(48)
  s_mov_b32 m0, 20480
  s_xor_b32 s63, s45, 213120
  buffer_load_dwordx4 v16, s[28:31], s63 offen offset:0 nt lds
  buffer_load_dwordx4 v17, s[28:31], s63 offen offset:1024 nt lds
  buffer_load_dwordx4 v18, s[28:31], s63 offen offset:2048 nt lds
  buffer_load_dwordx4 v19, s[28:31], s63 offen offset:3072 nt lds
  s_waitcnt vmcnt(48)
  s_mov_b32 m0, 24576
  s_xor_b32 s63, s45, 229504
  buffer_load_dwordx4 v16, s[28:31], s63 offen offset:0 nt lds
  buffer_load_dwordx4 v17, s[28:31], s63 offen offset:1024 nt lds
  buffer_load_dwordx4 v18, s[28:31], s63 offen offset:2048 nt lds
  buffer_load_dwordx4 v19, s[28:31], s63 offen offset:3072 nt lds
  s_waitcnt vmcnt(48)
  ds_read_b32 v32, v36
  s_mov_b32 m0, 28672
  s_xor_b32 s63, s45, 245888
  buffer_load_dwordx4 v16, s[28:31], s63 offen offset:0 nt lds
  buffer_load_dwordx4 v17, s[28:31], s63 offen offset:1024 nt lds
  buffer_load_dwordx4 v18, s[28:31], s63 offen offset:2048 nt lds
  buffer_load_dwordx4 v19, s[28:31], s63 offen offset:3072 nt lds
  s_mov_b32 m0, 161792
  v_mov_b32 v4, L_tab-L_pc+148
  global_load_lds_dword v4, s[22:23]
  s_waitcnt vmcnt(39)
  s_waitcnt lgkmcnt(0)
  v_cmp_gt_u32 vcc, 0x16, v32
  s_cbranch_vccnz L_lsO_0_3
L_lbO_0_3:
  s_add_u32 s87, s100, 3
  s_sub_u32 s3, s87, 7
  s_cselect_b32 s87, s87, s3
  s_lshl_b32 s87, s87, 7
  s_mov_b32 m0, 32768
  s_add_u32 s63, s87, s52
  buffer_load_dwordx4 v28, s[40:43], s63 offen offset:0 lds
  buffer_load_dwordx4 v29, s[40:43], s63 offen offset:1024 lds
  buffer_load_dwordx4 v30, s[40:43], s63 offen offset:2048 lds
  buffer_load_dwordx4 v31, s[40:43], s63 offen offset:3072 lds
  ds_read_b32 v32, v36
  s_mov_b32 m0, 36864
  s_add_u32 s63, s63, 28672
  buffer_load_dwordx4 v28, s[40:43], s63 offen offset:0 lds
  buffer_load_dwordx4 v29, s[40:43], s63 offen offset:1024 lds
  buffer_load_dwordx4 v30, s[40:43], s63 offen offset:2048 lds
  buffer_load_dwordx4 v31, s[40:43], s63 offen offset:3072 lds
  s_mov_b32 m0, 161792
  v_mov_b32 v4, L_tab-L_pc+152
  global_load_lds_dword v4, s[22:23]
  s_waitcnt lgkmcnt(0)
  v_cmp_gt_u32 vcc, 0x17, v32
  s_cbranch_vccnz L_lsV_2_0
L_lbV_2_0:
  s_mov_b32 m0, 49152
  s_xor_b32 s63, s45, 256
  buffer_load_dwordx4 v16, s[28:31], s63 offen offset:0 nt lds
  buffer_load_dwordx4 v17, s[28:31], s63 offen offset:1024 nt lds
  buffer_load_dwordx4 v18, s[28:31], s63 offen offset:2048 nt lds
  buffer_load_dwordx4 v19, s[28:31], s63 offen offset:3072 nt lds
  s_mov_b32 m0, 53248
  s_xor_b32 s63, s45, 16640
  buffer_load_dwordx4 v16, s[28:31], s63 offen offset:0 nt lds
  buffer_load_dwordx4 v17, s[28:31], s63 offen offset:1024 nt lds
  buffer_load_dwordx4 v18, s[28:31], s63 offen offset:2048 nt lds
  buffer_load_dwordx4 v19, s[28:31], s63 offen offset:3072 nt lds
  s_mov_b32 m0, 57344
  s_xor_b32 s63, s45, 33024
  buffer_load_dwordx4 v16, s[28:31], s63 offen offset:0 nt lds
  buffer_load_dwordx4 v17, s[28:31], s63 offen offset:1024 nt lds
  buffer_load_dwordx4 v18, s[28:31], s63 offen offset:2048 nt lds
  buffer_load_dwordx4 v19, s[28:31], s63 offen offset:3072 nt lds
  s_mov_b32 m0, 61440
  s_xor_b32 s63, s45, 49408
  buffer_load_dwordx4 v16, s[28:31], s63 offen offset:0 nt lds
  buffer_load_dwordx4 v17, s[28:31], s63 offen offset:1024 nt lds
  buffer_load_dwordx4 v18, s[28:31], s63 offen offset:2048 nt lds
  buffer_load_dwordx4 v19, s[28:31], s63 offen offset:3072 nt lds
  s_mov_b32 m0, 161792
  v_mov_b32 v4, L_tab-L_pc+156
  global_load_lds_dword v4, s[22:23]
  s_waitcnt vmcnt(60)
  s_add_u32 s87, s100, 4
  s_sub_u32 s3, s87, 7
  s_cselect_b32 s87, s87, s3
  s_lshl_b32 s87, s87, 7
  s_mov_b32 m0, 40960
  s_add_u32 s63, s87, s52
  buffer_load_dwordx4 v28, s[40:43], s63 offen offset:0 lds
  buffer_load_dwordx4 v29, s[40:43], s63 offen offset:1024 lds
  buffer_load_dwordx4 v30, s[40:43], s63 offen offset:2048 lds
  buffer_load_dwordx4 v31, s[40:43], s63 offen offset:3072 lds
  s_waitcnt vmcnt(60)
  ds_read_b32 v32, v36
  s_mov_b32 m0, 45056
  s_add_u32 s63, s63, 28672
  buffer_load_dwordx4 v28, s[40:43], s63 offen offset:0 lds
  buffer_load_dwordx4 v29, s[40:43], s63 offen offset:1024 lds
  buffer_load_dwordx4 v30, s[40:43], s63 offen offset:2048 lds
  buffer_load_dwordx4 v31, s[40:43], s63 offen offset:3072 lds
  s_mov_b32 m0, 161792
  v_mov_b32 v4, L_tab-L_pc+160
  global_load_lds_dword v4, s[22:23]
  s_waitcnt vmcnt(60)
  s_waitcnt lgkmcnt(0)
  v_cmp_gt_u32 vcc, 0x18, v32
  s_cbranch_vccnz L_lsV_2_1
L_lbV_2_1:
  s_mov_b32 m0, 65536
  s_xor_b32 s63, s45, 65792
  buffer_load_dwordx4 v16, s[28:31], s63 offen offset:0 nt lds
  buffer_load_dwordx4 v17, s[28:31], s63 offen offset:1024 nt lds
  buffer_load_dwordx4 v18, s[28:31], s63 offen offset:2048 nt lds
  buffer_load_dwordx4 v19, s[28:31], s63 offen offset:3072 nt lds
  s_waitcnt vmcnt(60)
  s_mov_b32 m0, 69632
  s_xor_b32 s63, s45, 82176
  buffer_load_dwordx4 v16, s[28:31], s63 offen offset:0 nt lds
  buffer_load_dwordx4 v17, s[28:31], s63 offen offset:1024 nt lds
  buffer_load_dwordx4 v18, s[28:31], s63 offen offset:2048 nt lds
  buffer_load_dwordx4 v19, s[28:31], s63 offen offset:3072 nt lds
  s_waitcnt vmcnt(60)
  s_mov_b32 m0, 73728
  s_xor_b32 s63, s45, 98560
  buffer_load_dwordx4 v16, s[28:31], s63 offen offset:0 nt lds
  buffer_load_dwordx4 v17, s[28:31], s63 offen offset:1024 nt lds
  buffer_load_dwordx4 v18, s[28:31], s63 offen offset:2048 nt lds
  buffer_load_dwordx4 v19, s[28:31], s63 offen offset:3072 nt lds
  s_waitcnt vmcnt(60)
  ds_read_b32 v32, v36
  s_mov_b32 m0, 77824
  s_xor_b32 s63, s45, 114944
  buffer_load_dwordx4 v16, s[28:31], s63 offen offset:0 nt lds
  buffer_load_dwordx4 v17, s[28:31], s63 offen offset:1024 nt lds
  buffer_load_dwordx4 v18, s[28:31], s63 offen offset:2048 nt lds
  buffer_load_dwordx4 v19, s[28:31], s63 offen offset:3072 nt lds
  s_mov_b32 m0, 161792
  v_mov_b32 v4, L_tab-L_pc+164
  global_load_lds_dword v4, s[22:23]
  s_waitcnt vmcnt(60)
  s_waitcnt lgkmcnt(0)
  v_cmp_gt_u32 vcc, 0x19, v32
  s_cbranch_vccnz L_lsO_0_5
L_lbO_0_5:
  s_add_u32 s87, s100, 5
  s_sub_u32 s3, s87, 7
  s_cselect_b32 s87, s87, s3
  s_lshl_b32 s87, s87, 7
  s_mov_b32 m0, 139264
  s_add_u32 s63, s87, s52
  buffer_load_dwordx4 v28, s[40:43], s63 offen offset:0 lds
  buffer_load_dwordx4 v29, s[40:43], s63 offen offset:1024 lds
  buffer_load_dwordx4 v30, s[40:43], s63 offen offset:2048 lds
  buffer_load_dwordx4 v31, s[40:43], s63 offen offset:3072 lds
  s_waitcnt vmcnt(60)
  ds_read_b32 v32, v36
  s_mov_b32 m0, 143360
  s_add_u32 s63, s63, 28672
  buffer_load_dwordx4 v28, s[40:43], s63 offen offset:0 lds
  buffer_load_dwordx4 v29, s[40:43], s63 offen offset:1024 lds
  buffer_load_dwordx4 v30, s[40:43], s63 offen offset:2048 lds
  buffer_load_dwordx4 v31, s[40:43], s63 offen offset:3072 lds
  s_mov_b32 m0, 161792
  v_mov_b32 v4, L_tab-L_pc+168
  global_load_lds_dword v4, s[22:23]
  s_waitcnt vmcnt(60)
  s_waitcnt lgkmcnt(0)
  v_cmp_gt_u32 vcc, 0x1a, v32
  s_cbranch_vccnz L_lsV_2_2
L_lbV_2_2:
  s_mov_b32 m0, 81920
  s_xor_b32 s63, s45, 131328
  buffer_load_dwordx4 v16, s[28:31], s63 offen offset:0 nt lds
  buffer_load_dwordx4 v17, s[28:31], s63 offen offset:1024 nt lds
  buffer_load_dwordx4 v18, s[28:31], s63 offen offset:2048 nt lds
  buffer_load_dwordx4 v19, s[28:31], s63 offen offset:3072 nt lds
  s_waitcnt vmcnt(60)
  s_mov_b32 m0, 86016
  s_xor_b32 s63, s45, 147712
  buffer_load_dwordx4 v16, s[28:31], s63 offen offset:0 nt lds
  buffer_load_dwordx4 v17, s[28:31], s63 offen offset:1024 nt lds
  buffer_load_dwordx4 v18, s[28:31], s63 offen offset:2048 nt lds
  buffer_load_dwordx4 v19, s[28:31], s63 offen offset:3072 nt lds
  s_waitcnt vmcnt(60)
  s_mov_b32 m0, 90112
  s_xor_b32 s63, s45, 164096
  buffer_load_dwordx4 v16, s[28:31], s63 offen offset:0 nt lds
  buffer_load_dwordx4 v17, s[28:31], s63 offen offset:1024 nt lds
  buffer_load_dwordx4 v18, s[28:31], s63 offen offset:2048 nt lds
  buffer_load_dwordx4 v19, s[28:31], s63 offen offset:3072 nt lds
  s_waitcnt vmcnt(60)
  ds_read_b32 v32, v36
  s_mov_b32 m0, 94208
  s_xor_b32 s63, s45, 180480
  buffer_load_dwordx4 v16, s[28:31], s63 offen offset:0 nt lds
  buffer_load_dwordx4 v17, s[28:31], s63 offen offset:1024 nt lds
  buffer_load_dwordx4 v18, s[28:31], s63 offen offset:2048 nt lds
  buffer_load_dwordx4 v19, s[28:31], s63 offen offset:3072 nt lds
  s_mov_b32 m0, 161792
  v_mov_b32 v4, L_tab-L_pc+172
  global_load_lds_dword v4, s[22:23]
  s_waitcnt vmcnt(60)
  s_waitcnt lgkmcnt(0)
  v_cmp_gt_u32 vcc, 0x1b, v32
  s_cbranch_vccnz L_lsO_0_6
L_lbO_0_6:
  s_add_u32 s87, s100, 6
  s_sub_u32 s3, s87, 7
  s_cselect_b32 s87, s87, s3
  s_lshl_b32 s87, s87, 7
  s_mov_b32 m0, 98304
  s_add_u32 s63, s87, s52
  buffer_load_dwordx4 v28, s[40:43], s63 offen offset:0 lds
  buffer_load_dwordx4 v29, s[40:43], s63 offen offset:1024 lds
  buffer_load_dwordx4 v30, s[40:43], s63 offen offset:2048 lds
  buffer_load_dwordx4 v31, s[40:43], s63 offen offset:3072 lds
  s_waitcnt vmcnt(60)
  ds_read_b32 v32, v36
  s_mov_b32 m0, 102400
  s_add_u32 s63, s63, 28672
  buffer_load_dwordx4 v28, s[40:43], s63 offen offset:0 lds
  buffer_load_dwordx4 v29, s[40:43], s63 offen offset:1024 lds
  buffer_load_dwordx4 v30, s[40:43], s63 offen offset:2048 lds
  buffer_load_dwordx4 v31, s[40:43], s63 offen offset:3072 lds
  s_mov_b32 m0, 161792
  v_mov_b32 v4, L_tab-L_pc+176
  global_load_lds_dword v4, s[22:23]
  s_waitcnt vmcnt(60)
  s_waitcnt lgkmcnt(0)
  v_cmp_gt_u32 vcc, 0x1c, v32
  s_cbranch_vccnz L_lsV_2_3
L_lbV_2_3:
  s_mov_b32 m0, 0
  s_xor_b32 s63, s45, 196864
  buffer_load_dwordx4 v16, s[28:31], s63 offen offset:0 nt lds
  buffer_load_dwordx4 v17, s[28:31], s63 offen offset:1024 nt lds
  buffer_load_dwordx4 v18, s[28:31], s63 offen offset:2048 nt lds
  buffer_load_dwordx4 v19, s[28:31], s63 offen offset:3072 nt lds
  s_waitcnt vmcnt(60)
  s_mov_b32 m0, 4096
  s_xor_b32 s63, s45, 213248
  buffer_load_dwordx4 v16, s[28:31], s63 offen offset:0 nt lds
  buffer_load_dwordx4 v17, s[28:31], s63 offen offset:1024 nt lds
  buffer_load_dwordx4 v18, s[28:31], s63 offen offset:2048 nt lds
  buffer_load_dwordx4 v19, s[28:31], s63 offen offset:3072 nt lds
  s_waitcnt vmcnt(60)
  s_mov_b32 m0, 8192
  s_xor_b32 s63, s45, 229632
  buffer_load_dwordx4 v16, s[28:31], s63 offen offset:0 nt lds
  buffer_load_dwordx4 v17, s[28:31], s63 offen offset:1024 nt lds
  buffer_load_dwordx4 v18, s[28:31], s63 offen offset:2048 nt lds
  buffer_load_dwordx4 v19, s[28:31], s63 offen offset:3072 nt lds
  s_waitcnt vmcnt(60)
  ds_read_b32 v32, v36
  s_mov_b32 m0, 12288
  s_xor_b32 s63, s45, 246016
  buffer_load_dwordx4 v16, s[28:31], s63 offen offset:0 nt lds
  buffer_load_dwordx4 v17, s[28:31], s63 offen offset:1024 nt lds
  buffer_load_dwordx4 v18, s[28:31], s63 offen offset:2048 nt lds
  buffer_load_dwordx4 v19, s[28:31], s63 offen offset:3072 nt lds
  s_mov_b32 m0, 161792
  v_mov_b32 v4, L_tab-L_pc+180
  global_load_lds_dword v4, s[22:23]
  s_waitcnt vmcnt(60)
  s_waitcnt lgkmcnt(0)
  v_cmp_gt_u32 vcc, 0x1e, v32
  s_cbranch_vccnz L_lsV_3_0
L_lbV_3_0:
  s_mov_b32 m0, 110592
  s_xor_b32 s63, s45, 384
  buffer_load_dwordx4 v16, s[28:31], s63 offen offset:0 nt lds
  buffer_load_dwordx4 v17, s[28:31], s63 offen offset:1024 nt lds
  buffer_load_dwordx4 v18, s[28:31], s63 offen offset:2048 nt lds
  buffer_load_dwordx4 v19, s[28:31], s63 offen offset:3072 nt lds
  s_waitcnt vmcnt(60)
  s_mov_b32 m0, 114688
  s_xor_b32 s63, s45, 16768
  buffer_load_dwordx4 v16, s[28:31], s63 offen offset:0 nt lds
  buffer_load_dwordx4 v17, s[28:31], s63 offen offset:1024 nt lds
  buffer_load_dwordx4 v18, s[28:31], s63 offen offset:2048 nt lds
  buffer_load_dwordx4 v19, s[28:31], s63 offen offset:3072 nt lds
  s_waitcnt vmcnt(60)
  s_mov_b32 m0, 118784
  s_xor_b32 s63, s45, 33152
  buffer_load_dwordx4 v16, s[28:31], s63 offen offset:0 nt lds
  buffer_load_dwordx4 v17, s[28:31], s63 offen offset:1024 nt lds
  buffer_load_dwordx4 v18, s[28:31], s63 offen offset:2048 nt lds
  buffer_load_dwordx4 v19, s[28:31], s63 offen offset:3072 nt lds
  s_waitcnt vmcnt(60)
  ds_read_b32 v32, v36
  s_mov_b32 m0, 122880
  s_xor_b32 s63, s45, 49536
  buffer_load_dwordx4 v16, s[28:31], s63 offen offset:0 nt lds
  buffer_load_dwordx4 v17, s[28:31], s63 offen offset:1024 nt lds
  buffer_load_dwordx4 v18, s[28:31], s63 offen offset:2048 nt lds
  buffer_load_dwordx4 v19, s[28:31], s63 offen offset:3072 nt lds
  s_mov_b32 m0, 161792
  v_mov_b32 v4, L_tab-L_pc+184
  global_load_lds_dword v4, s[22:23]
  s_waitcnt vmcnt(60)
  s_waitcnt lgkmcnt(0)
  v_cmp_gt_u32 vcc, 0x20, v32
  s_cbranch_vccnz L_lsV_3_1
L_lbV_3_1:
  s_mov_b32 m0, 16384
  s_xor_b32 s63, s45, 65920
  buffer_load_dwordx4 v16, s[28:31], s63 offen offset:0 nt lds
  buffer_load_dwordx4 v17, s[28:31], s63 offen offset:1024 nt lds
  buffer_load_dwordx4 v18, s[28:31], s63 offen offset:2048 nt lds
  buffer_load_dwordx4 v19, s[28:31], s63 offen offset:3072 nt lds
  s_waitcnt vmcnt(60)
  s_mov_b32 m0, 20480
  s_xor_b32 s63, s45, 82304
  buffer_load_dwordx4 v16, s[28:31], s63 offen offset:0 nt lds
  buffer_load_dwordx4 v17, s[28:31], s63 offen offset:1024 nt lds
  buffer_load_dwordx4 v18, s[28:31], s63 offen offset:2048 nt lds
  buffer_load_dwordx4 v19, s[28:31], s63 offen offset:3072 nt lds
  s_waitcnt vmcnt(60)
  s_mov_b32 m0, 24576
  s_xor_b32 s63, s45, 98688
  buffer_load_dwordx4 v16, s[28:31], s63 offen offset:0 nt lds
  buffer_load_dwordx4 v17, s[28:31], s63 offen offset:1024 nt lds
  buffer_load_dwordx4 v18, s[28:31], s63 offen offset:2048 nt lds
  buffer_load_dwordx4 v19, s[28:31], s63 offen offset:3072 nt lds
  s_waitcnt vmcnt(60)
  ds_read_b32 v32, v36
  s_mov_b32 m0, 28672
  s_xor_b32 s63, s45, 115072
  buffer_load_dwordx4 v16, s[28:31], s63 offen offset:0 nt lds
  buffer_load_dwordx4 v17, s[28:31], s63 offen offset:1024 nt lds
  buffer_load_dwordx4 v18, s[28:31], s63 offen offset:2048 nt lds
  buffer_load_dwordx4 v19, s[28:31], s63 offen offset:3072 nt lds
  s_mov_b32 m0, 161792
  v_mov_b32 v4, L_tab-L_pc+188
  global_load_lds_dword v4, s[22:23]
  s_waitcnt vmcnt(60)
  s_waitcnt lgkmcnt(0)
  v_cmp_gt_u32 vcc, 0x22, v32
  s_cbranch_vccnz L_lsV_3_2
L_lbV_3_2:
  s_mov_b32 m0, 49152
  s_xor_b32 s63, s45, 131456
  buffer_load_dwordx4 v16, s[28:31], s63 offen offset:0 nt lds
  buffer_load_dwordx4 v17, s[28:31], s63 offen offset:1024 nt lds
  buffer_load_dwordx4 v18, s[28:31], s63 offen offset:2048 nt lds
  buffer_load_dwordx4 v19, s[28:31], s63 offen offset:3072 nt lds
  s_waitcnt vmcnt(60)
  s_mov_b32 m0, 53248
  s_xor_b32 s63, s45, 147840
  buffer_load_dwordx4 v16, s[28:31], s63 offen offset:0 nt lds
  buffer_load_dwordx4 v17, s[28:31], s63 offen offset:1024 nt lds
  buffer_load_dwordx4 v18, s[28:31], s63 offen offset:2048 nt lds
  buffer_load_dwordx4 v19, s[28:31], s63 offen offset:3072 nt lds
  s_waitcnt vmcnt(60)
  s_mov_b32 m0, 57344
  s_xor_b32 s63, s45, 164224
  buffer_load_dwordx4 v16, s[28:31], s63 offen offset:0 nt lds
  buffer_load_dwordx4 v17, s[28:31], s63 offen offset:1024 nt lds
  buffer_load_dwordx4 v18, s[28:31], s63 offen offset:2048 nt lds
  buffer_load_dwordx4 v19, s[28:31], s63 offen offset:3072 nt lds
  s_waitcnt vmcnt(60)
  ds_read_b32 v32, v36
  s_mov_b32 m0, 61440
  s_xor_b32 s63, s45, 180608
  buffer_load_dwordx4 v16, s[28:31], s63 offen offset:0 nt lds
  buffer_load_dwordx4 v17, s[28:31], s63 offen offset:1024 nt lds
  buffer_load_dwordx4 v18, s[28:31], s63 offen offset:2048 nt lds
  buffer_load_dwordx4 v19, s[28:31], s63 offen offset:3072 nt lds
  s_mov_b32 m0, 161792
  v_mov_b32 v4, L_tab-L_pc+192
  global_load_lds_dword v4, s[22:23]
  s_waitcnt vmcnt(60)
L_arr:
  v_cmp_eq_u32 vcc, 0, v54
  s_cbranch_vccnz L_arrx
  s_waitcnt lgkmcnt(0)
  v_cmp_gt_u32 vcc, 0x23, v32
  s_cbranch_vccnz L_lsV_3_3
L_lbV_3_3:
  s_mov_b32 m0, 32768
  s_xor_b32 s63, s45, 196992
  buffer_load_dwordx4 v16, s[28:31], s63 offen offset:0 nt lds
  buffer_load_dwordx4 v17, s[28:31], s63 offen offset:1024 nt lds
  buffer_load_dwordx4 v18, s[28:31], s63 offen offset:2048 nt lds
  buffer_load_dwordx4 v19, s[28:31], s63 offen offset:3072 nt lds
  s_waitcnt vmcnt(60)
  s_mov_b32 m0, 36864
  s_xor_b32 s63, s45, 213376
  buffer_load_dwordx4 v16, s[28:31], s63 offen offset:0 nt lds
  buffer_load_dwordx4 v17, s[28:31], s63 offen offset:1024 nt lds
  buffer_load_dwordx4 v18, s[28:31], s63 offen offset:2048 nt lds
  buffer_load_dwordx4 v19, s[28:31], s63 offen offset:3072 nt lds
  s_waitcnt vmcnt(60)
  s_mov_b32 m0, 40960
  s_xor_b32 s63, s45, 229760
  buffer_load_dwordx4 v16, s[28:31], s63 offen offset:0 nt lds
  buffer_load_dwordx4 v17, s[28:31], s63 offen offset:1024 nt lds
  buffer_load_dwordx4 v18, s[28:31], s63 offen offset:2048 nt lds
  buffer_load_dwordx4 v19, s[28:31], s63 offen offset:3072 nt lds
  s_waitcnt vmcnt(60)
  s_mov_b32 m0, 45056
  s_xor_b32 s63, s45, 246144
  buffer_load_dwordx4 v16, s[28:31], s63 offen offset:0 nt lds
  buffer_load_dwordx4 v17, s[28:31], s63 offen offset:1024 nt lds
  buffer_load_dwordx4 v18, s[28:31], s63 offen offset:2048 nt lds
  buffer_load_dwordx4 v19, s[28:31], s63 offen offset:3072 nt lds
  s_mov_b32 m0, 161792
  v_mov_b32 v4, L_tab-L_pc+196
  global_load_lds_dword v4, s[22:23]
  s_waitcnt vmcnt(60)
  s_add_u32 s87, s100, 0
  s_sub_u32 s3, s87, 7
  s_cselect_b32 s87, s87, s3
  s_lshl_b32 s87, s87, 7
  s_mov_b32 m0, 131072
  s_add_u32 s63, s87, s53
  buffer_load_dwordx4 v28, s[40:43], s63 offen offset:0 lds
  buffer_load_dwordx4 v29, s[40:43], s63 offen offset:1024 lds
  buffer_load_dwordx4 v30, s[40:43], s63 offen offset:2048 lds
  buffer_load_dwordx4 v31, s[40:43], s63 offen offset:3072 lds
  s_waitcnt vmcnt(60)
  s_mov_b32 m0, 135168
  s_add_u32 s63, s63, 28672
  buffer_load_dwordx4 v28, s[40:43], s63 offen offset:0 lds
  buffer_load_dwordx4 v29, s[40:43], s63 offen offset:1024 lds
  buffer_load_dwordx4 v30, s[40:43], s63 offen offset:2048 lds
  buffer_load_dwordx4 v31, s[40:43], s63 offen offset:3072 lds
  s_mov_b32 m0, 161792
  v_mov_b32 v4, L_tab-L_pc+200
  global_load_lds_dword v4, s[22:23]
  s_waitcnt vmcnt(60)
  s_mov_b32 m0, 151552
  s_add_u32 s63, s87, s54
  buffer_load_dwordx4 v28, s[40:43], s63 offen offset:0 lds
  buffer_load_dwordx4 v29, s[40:43], s63 offen offset:1024 lds
  buffer_load_dwordx4 v30, s[40:43], s63 offen offset:2048 lds
  buffer_load_dwordx4 v31, s[40:43], s63 offen offset:3072 lds
  s_waitcnt vmcnt(60)
  ds_read_b32 v32, v37
  s_mov_b32 m0, 155648
  s_add_u32 s63, s63, 28672
  buffer_load_dwordx4 v28, s[40:43], s63 offen offset:0 lds
  buffer_load_dwordx4 v29, s[40:43], s63 offen offset:1024 lds
  buffer_load_dwordx4 v30, s[40:43], s63 offen offset:2048 lds
  buffer_load_dwordx4 v31, s[40:43], s63 offen offset:3072 lds
  s_mov_b32 m0, 161792
  v_mov_b32 v4, L_tab-L_pc+204
  global_load_lds_dword v4, s[22:23]
  s_waitcnt vmcnt(60)
  s_waitcnt lgkmcnt(0)
  v_cmp_gt_u32 vcc, 0xb003002d, v32
  s_cbranch_vccnz L_lsO_3_0
L_lbO_3_0:
  s_mov_b32 m0, 65536
  s_add_u32 s63, s87, s55
  buffer_load_dwordx4 v28, s[40:43], s63 offen offset:0 lds
  buffer_load_dwordx4 v29, s[40:43], s63 offen offset:1024 lds
  buffer_load_dwordx4 v30, s[40:43], s63 offen offset:2048 lds
  buffer_load_dwordx4 v31, s[40:43], s63 offen offset:3072 lds
  s_waitcnt vmcnt(60)
  s_mov_b32 m0, 69632
  s_add_u32 s63, s63, 28672
  buffer_load_dwordx4 v28, s[40:43], s63 offen offset:0 lds
  buffer_load_dwordx4 v29, s[40:43], s63 offen offset:1024 lds
  buffer_load_dwordx4 v30, s[40:43], s63 offen offset:2048 lds
  buffer_load_dwordx4 v31, s[40:43], s63 offen offset:3072 lds
  s_mov_b32 m0, 161792
  v_mov_b32 v4, L_tab-L_pc+208
  global_load_lds_dword v4, s[22:23]
  s_waitcnt vmcnt(60)
  s_add_u32 s87, s100, 1
  s_sub_u32 s3, s87, 7
  s_cselect_b32 s87, s87, s3
  s_lshl_b32 s87, s87, 7
  s_mov_b32 m0, 73728
  s_add_u32 s63, s87, s53
  buffer_load_dwordx4 v28, s[40:43], s63 offen offset:0 lds
  buffer_load_dwordx4 v29, s[40:43], s63 offen offset:1024 lds
  buffer_load_dwordx4 v30, s[40:43], s63 offen offset:2048 lds
  buffer_load_dwordx4 v31, s[40:43], s63 offen offset:3072 lds
  s_waitcnt vmcnt(60)
  ds_read_b32 v32, v37
  s_mov_b32 m0, 77824
  s_add_u32 s63, s63, 28672
  buffer_load_dwordx4 v28, s[40:43], s63 offen offset:0 lds
  buffer_load_dwordx4 v29, s[40:43], s63 offen offset:1024 lds
  buffer_load_dwordx4 v30, s[40:43], s63 offen offset:2048 lds
  buffer_load_dwordx4 v31, s[40:43], s63 offen offset:3072 lds
  s_mov_b32 m0, 161792
  v_mov_b32 v4, L_tab-L_pc+212
  global_load_lds_dword v4, s[22:23]
  s_waitcnt vmcnt(60)
  s_waitcnt lgkmcnt(0)
  v_cmp_gt_u32 vcc, 0xb003002e, v32
  s_cbranch_vccnz L_lsO_2_1
L_lbO_2_1:
  s_mov_b32 m0, 139264
  s_add_u32 s63, s87, s54
  buffer_load_dwordx4 v28, s[40:43], s63 offen offset:0 lds
  buffer_load_dwordx4 v29, s[40:43], s63 offen offset:1024 lds
  buffer_load_dwordx4 v30, s[40:43], s63 offen offset:2048 lds
  buffer_load_dwordx4 v31, s[40:43], s63 offen offset:3072 lds
  s_waitcnt vmcnt(60)
  ds_read_b32 v32, v37
  s_mov_b32 m0, 143360
  s_add_u32 s63, s63, 28672
  buffer_load_dwordx4 v28, s[40:43], s63 offen offset:0 lds
  buffer_load_dwordx4 v29, s[40:43], s63 offen offset:1024 lds
  buffer_load_dwordx4 v30, s[40:43], s63 offen offset:2048 lds
  buffer_load_dwordx4 v31, s[40:43], s63 offen offset:3072 lds
  s_mov_b32 m0, 161792
  v_mov_b32 v4, L_tab-L_pc+216
  global_load_lds_dword v4, s[22:23]
  s_waitcnt vmcnt(60)
  s_waitcnt lgkmcnt(0)
  v_cmp_gt_u32 vcc, 0xb003002f, v32
  s_cbranch_vccnz L_lsO_3_1
L_lbO_3_1:
  s_mov_b32 m0, 81920
  s_add_u32 s63, s87, s55
  buffer_load_dwordx4 v28, s[40:43], s63 offen offset:0 lds
  buffer_load_dwordx4 v29, s[40:43], s63 offen offset:1024 lds
  buffer_load_dwordx4 v30, s[40:43], s63 offen offset:2048 lds
  buffer_load_dwordx4 v31, s[40:43], s63 offen offset:3072 lds
  s_waitcnt vmcnt(60)
  s_mov_b32 m0, 86016
  s_add_u32 s63, s63, 28672
  buffer_load_dwordx4 v28, s[40:43], s63 offen offset:0 lds
  buffer_load_dwordx4 v29, s[40:43], s63 offen offset:1024 lds
  buffer_load_dwordx4 v30, s[40:43], s63 offen offset:2048 lds
  buffer_load_dwordx4 v31, s[40:43], s63 offen offset:3072 lds
  s_mov_b32 m0, 161792
  v_mov_b32 v4, L_tab-L_pc+220
  global_load_lds_dword v4, s[22:23]
  s_waitcnt vmcnt(60)
  s_add_u32 s87, s100, 2
  s_sub_u32 s3, s87, 7
  s_cselect_b32 s87, s87, s3
  s_lshl_b32 s87, s87, 7
  s_mov_b32 m0, 90112
  s_add_u32 s63, s87, s53
  buffer_load_dwordx4 v28, s[40:43], s63 offen offset:0 lds
  buffer_load_dwordx4 v29, s[40:43], s63 offen offset:1024 lds
  buffer_load_dwordx4 v30, s[40:43], s63 offen offset:2048 lds
  buffer_load_dwordx4 v31, s[40:43], s63 offen offset:3072 lds
  s_waitcnt vmcnt(54)
  ds_read_b32 v32, v37
  s_mov_b32 m0, 94208
  s_add_u32 s63, s63, 28672
  buffer_load_dwordx4 v28, s[40:43], s63 offen offset:0 lds
  buffer_load_dwordx4 v29, s[40:43], s63 offen offset:1024 lds
  buffer_load_dwordx4 v30, s[40:43], s63 offen offset:2048 lds
  buffer_load_dwordx4 v31, s[40:43], s63 offen offset:3072 lds
  s_mov_b32 m0, 161792
  v_mov_b32 v4, L_tab-L_pc+224
  global_load_lds_dword v4, s[22:23]
  s_waitcnt vmcnt(55)
  s_waitcnt lgkmcnt(0)
  v_cmp_gt_u32 vcc, 0xb0030030, v32
  s_cbranch_vccnz L_lsO_2_2
L_lbO_2_2:
  s_mov_b32 m0, 98304
  s_add_u32 s63, s87, s54
  buffer_load_dwordx4 v28, s[40:43], s63 offen offset:0 lds
  buffer_load_dwordx4 v29, s[40:43], s63 offen offset:1024 lds
  buffer_load_dwordx4 v30, s[40:43], s63 offen offset:2048 lds
  buffer_load_dwordx4 v31, s[40:43], s63 offen offset:3072 lds
  s_waitcnt vmcnt(54)
  ds_read_b32 v32, v37
  s_mov_b32 m0, 102400
  s_add_u32 s63, s63, 28672
  buffer_load_dwordx4 v28, s[40:43], s63 offen offset:0 lds
  buffer_load_dwordx4 v29, s[40:43], s63 offen offset:1024 lds
  buffer_load_dwordx4 v30, s[40:43], s63 offen offset:2048 lds
  buffer_load_dwordx4 v31, s[40:43], s63 offen offset:3072 lds
  s_mov_b32 m0, 161792
  v_mov_b32 v4, L_tab-L_pc+228
  global_load_lds_dword v4, s[22:23]
  s_waitcnt vmcnt(55)
  s_waitcnt lgkmcnt(0)
  v_cmp_gt_u32 vcc, 0xb0030031, v32
  s_cbranch_vccnz L_lsO_3_2
L_lbO_3_2:
  s_mov_b32 m0, 0
  s_add_u32 s63, s87, s55
  buffer_load_dwordx4 v28, s[40:43], s63 offen offset:0 lds
  buffer_load_dwordx4 v29, s[40:43], s63 offen offset:1024 lds
  buffer_load_dwordx4 v30, s[40:43], s63 offen offset:2048 lds
  buffer_load_dwordx4 v31, s[40:43], s63 offen offset:3072 lds
  s_waitcnt vmcnt(54)
  s_mov_b32 m0, 4096
  s_add_u32 s63, s63, 28672
  buffer_load_dwordx4 v28, s[40:43], s63 offen offset:0 lds
  buffer_load_dwordx4 v29, s[40:43], s63 offen offset:1024 lds
  buffer_load_dwordx4 v30, s[40:43], s63 offen offset:2048 lds
  buffer_load_dwordx4 v31, s[40:43], s63 offen offset:3072 lds
  s_mov_b32 m0, 161792
  v_mov_b32 v4, L_tab-L_pc+232
  global_load_lds_dword v4, s[22:23]
  s_waitcnt vmcnt(55)
  s_add_u32 s87, s100, 3
  s_sub_u32 s3, s87, 7
  s_cselect_b32 s87, s87, s3
  s_lshl_b32 s87, s87, 7
  s_mov_b32 m0, 8192
  s_add_u32 s63, s87, s53
  buffer_load_dwordx4 v28, s[40:43], s63 offen offset:0 lds
  buffer_load_dwordx4 v29, s[40:43], s63 offen offset:1024 lds
  buffer_load_dwordx4 v30, s[40:43], s63 offen offset:2048 lds
  buffer_load_dwordx4 v31, s[40:43], s63 offen offset:3072 lds
  s_waitcnt vmcnt(54)
  ds_read_b32 v32, v37
  s_mov_b32 m0, 12288
  s_add_u32 s63, s63, 28672
  buffer_load_dwordx4 v28, s[40:43], s63 offen offset:0 lds
  buffer_load_dwordx4 v29, s[40:43], s63 offen offset:1024 lds
  buffer_load_dwordx4 v30, s[40:43], s63 offen offset:2048 lds
  buffer_load_dwordx4 v31, s[40:43], s63 offen offset:3072 lds
  s_mov_b32 m0, 161792
  v_mov_b32 v4, L_tab-L_pc+236
  global_load_lds_dword v4, s[22:23]
  s_waitcnt vmcnt(55)
  s_waitcnt lgkmcnt(0)
  v_cmp_gt_u32 vcc, 0xb0030032, v32
  s_cbranch_vccnz L_lsO_2_3
L_lbO_2_3:
  s_mov_b32 m0, 114688
  s_add_u32 s63, s87, s54
  buffer_load_dwordx4 v28, s[40:43], s63 offen offset:0 lds
  buffer_load_dwordx4 v29, s[40:43], s63 offen offset:1024 lds
  buffer_load_dwordx4 v30, s[40:43], s63 offen offset:2048 lds
  buffer_load_dwordx4 v31, s[40:43], s63 offen offset:3072 lds
  s_waitcnt vmcnt(54)
  s_mov_b32 m0, 118784
  s_add_u32 s63, s63, 28672
  buffer_load_dwordx4 v28, s[40:43], s63 offen offset:0 lds
  buffer_load_dwordx4 v29, s[40:43], s63 offen offset:1024 lds
  buffer_load_dwordx4 v30, s[40:43], s63 offen offset:2048 lds
  buffer_load_dwordx4 v31, s[40:43], s63 offen offset:3072 lds
  s_mov_b32 m0, 161792
  v_mov_b32 v4, L_tab-L_pc+240
  global_load_lds_dword v4, s[22:23]
  s_waitcnt vmcnt(55)
  s_mov_b32 m0, 122880
  s_add_u32 s63, s87, s55
  buffer_load_dwordx4 v28, s[40:43], s63 offen offset:0 lds
  buffer_load_dwordx4 v29, s[40:43], s63 offen offset:1024 lds
  buffer_load_dwordx4 v30, s[40:43], s63 offen offset:2048 lds
  buffer_load_dwordx4 v31, s[40:43], s63 offen offset:3072 lds
  s_waitcnt vmcnt(54)
  s_mov_b32 m0, 126976
  s_add_u32 s63, s63, 28672
  buffer_load_dwordx4 v28, s[40:43], s63 offen offset:0 lds
  buffer_load_dwordx4 v29, s[40:43], s63 offen offset:1024 lds
  buffer_load_dwordx4 v30, s[40:43], s63 offen offset:2048 lds
  buffer_load_dwordx4 v31, s[40:43], s63 offen offset:3072 lds
  s_mov_b32 m0, 161792
  v_mov_b32 v4, L_tab-L_pc+244
  global_load_lds_dword v4, s[22:23]
  s_waitcnt vmcnt(55)
  s_add_u32 s87, s100, 4
  s_sub_u32 s3, s87, 7
  s_cselect_b32 s87, s87, s3
  s_lshl_b32 s87, s87, 7
  s_mov_b32 m0, 106496
  s_add_u32 s63, s87, s53
  buffer_load_dwordx4 v28, s[40:43], s63 offen offset:0 lds
  buffer_load_dwordx4 v29, s[40:43], s63 offen offset:1024 lds
  buffer_load_dwordx4 v30, s[40:43], s63 offen offset:2048 lds
  buffer_load_dwordx4 v31, s[40:43], s63 offen offset:3072 lds
  s_waitcnt vmcnt(54)
  ds_read_b32 v32, v37
  s_mov_b32 m0, 110592
  s_add_u32 s63, s63, 28672
  buffer_load_dwordx4 v28, s[40:43], s63 offen offset:0 lds
  buffer_load_dwordx4 v29, s[40:43], s63 offen offset:1024 lds
  buffer_load_dwordx4 v30, s[40:43], s63 offen offset:2048 lds
  buffer_load_dwordx4 v31, s[40:43], s63 offen offset:3072 lds
  s_mov_b32 m0, 161792
  v_mov_b32 v4, L_tab-L_pc+248
  global_load_lds_dword v4, s[22:23]
  s_waitcnt vmcnt(55)
  s_waitcnt lgkmcnt(0)
  v_cmp_gt_u32 vcc, 0xb0030033, v32
  s_cbranch_vccnz L_lsO_2_4
L_lbO_2_4:
  s_mov_b32 m0, 16384
  s_add_u32 s63, s87, s54
  buffer_load_dwordx4 v28, s[40:43], s63 offen offset:0 lds
  buffer_load_dwordx4 v29, s[40:43], s63 offen offset:1024 lds
  buffer_load_dwordx4 v30, s[40:43], s63 offen offset:2048 lds
  buffer_load_dwordx4 v31, s[40:43], s63 offen offset:3072 lds
  s_waitcnt vmcnt(54)
  s_mov_b32 m0, 20480
  s_add_u32 s63, s63, 28672
  buffer_load_dwordx4 v28, s[40:43], s63 offen offset:0 lds
  buffer_load_dwordx4 v29, s[40:43], s63 offen offset:1024 lds
  buffer_load_dwordx4 v30, s[40:43], s63 offen offset:2048 lds
  buffer_load_dwordx4 v31, s[40:43], s63 offen offset:3072 lds
  s_mov_b32 m0, 161792
  v_mov_b32 v4, L_tab-L_pc+252
  global_load_lds_dword v4, s[22:23]
  s_waitcnt vmcnt(55)
  s_mov_b32 m0, 24576
  s_add_u32 s63, s87, s55
  buffer_load_dwordx4 v28, s[40:43], s63 offen offset:0 lds
  buffer_load_dwordx4 v29, s[40:43], s63 offen offset:1024 lds
  buffer_load_dwordx4 v30, s[40:43], s63 offen offset:2048 lds
  buffer_load_dwordx4 v31, s[40:43], s63 offen offset:3072 lds
  s_waitcnt vmcnt(54)
  ds_read_b32 v32, v37
  s_mov_b32 m0, 28672
  s_add_u32 s63, s63, 28672
  buffer_load_dwordx4 v28, s[40:43], s63 offen offset:0 lds
  buffer_load_dwordx4 v29, s[40:43], s63 offen offset:1024 lds
  buffer_load_dwordx4 v30, s[40:43], s63 offen offset:2048 lds
  buffer_load_dwordx4 v31, s[40:43], s63 offen offset:3072 lds
  s_mov_b32 m0, 161792
  v_mov_b32 v4, L_tab-L_pc+256
  global_load_lds_dword v4, s[22:23]
  s_waitcnt vmcnt(55)
  s_waitcnt lgkmcnt(0)
  v_cmp_gt_u32 vcc, 0xb0030034, v32
  s_cbranch_vccnz L_lsO_1_5
L_lbO_1_5:
  s_add_u32 s87, s100, 5
  s_sub_u32 s3, s87, 7
  s_cselect_b32 s87, s87, s3
  s_lshl_b32 s87, s87, 7
  s_mov_b32 m0, 49152
  s_add_u32 s63, s87, s53
  buffer_load_dwordx4 v28, s[40:43], s63 offen offset:0 lds
  buffer_load_dwordx4 v29, s[40:43], s63 offen offset:1024 lds
  buffer_load_dwordx4 v30, s[40:43], s63 offen offset:2048 lds
  buffer_load_dwordx4 v31, s[40:43], s63 offen offset:3072 lds
  s_waitcnt vmcnt(54)
  s_mov_b32 m0, 53248
  s_add_u32 s63, s63, 28672
  buffer_load_dwordx4 v28, s[40:43], s63 offen offset:0 lds
  buffer_load_dwordx4 v29, s[40:43], s63 offen offset:1024 lds
  buffer_load_dwordx4 v30, s[40:43], s63 offen offset:2048 lds
  buffer_load_dwordx4 v31, s[40:43], s63 offen offset:3072 lds
  s_mov_b32 m0, 161792
  v_mov_b32 v4, L_tab-L_pc+260
  global_load_lds_dword v4, s[22:23]
  s_waitcnt vmcnt(55)
  s_mov_b32 m0, 57344
  s_add_u32 s63, s87, s54
  buffer_load_dwordx4 v28, s[40:43], s63 offen offset:0 lds
  buffer_load_dwordx4 v29, s[40:43], s63 offen offset:1024 lds
  buffer_load_dwordx4 v30, s[40:43], s63 offen offset:2048 lds
  buffer_load_dwordx4 v31, s[40:43], s63 offen offset:3072 lds
  s_waitcnt vmcnt(54)
  ds_read_b32 v32, v37
  s_mov_b32 m0, 61440
  s_add_u32 s63, s63, 28672
  buffer_load_dwordx4 v28, s[40:43], s63 offen offset:0 lds
  buffer_load_dwordx4 v29, s[40:43], s63 offen offset:1024 lds
  buffer_load_dwordx4 v30, s[40:43], s63 offen offset:2048 lds
  buffer_load_dwordx4 v31, s[40:43], s63 offen offset:3072 lds
  s_mov_b32 m0, 161792
  v_mov_b32 v4, L_tab-L_pc+264
  global_load_lds_dword v4, s[22:23]
  s_waitcnt vmcnt(55)
  s_waitcnt lgkmcnt(0)
  v_cmp_gt_u32 vcc, 0xb0030035, v32
  s_cbranch_vccnz L_lsO_3_5
L_lbO_3_5:
  s_mov_b32 m0, 32768
  s_add_u32 s63, s87, s55
  buffer_load_dwordx4 v28, s[40:43], s63 offen offset:0 lds
  buffer_load_dwordx4 v29, s[40:43], s63 offen offset:1024 lds
  buffer_load_dwordx4 v30, s[40:43], s63 offen offset:2048 lds
  buffer_load_dwordx4 v31, s[40:43], s63 offen offset:3072 lds
  s_waitcnt vmcnt(54)
  s_mov_b32 m0, 36864
  s_add_u32 s63, s63, 28672
  buffer_load_dwordx4 v28, s[40:43], s63 offen offset:0 lds
  buffer_load_dwordx4 v29, s[40:43], s63 offen offset:1024 lds
  buffer_load_dwordx4 v30, s[40:43], s63 offen offset:2048 lds
  buffer_load_dwordx4 v31, s[40:43], s63 offen offset:3072 lds
  s_mov_b32 m0, 161792
  v_mov_b32 v4, L_tab-L_pc+268
  global_load_lds_dword v4, s[22:23]
  s_waitcnt vmcnt(55)
  s_add_u32 s87, s100, 6
  s_sub_u32 s3, s87, 7
  s_cselect_b32 s87, s87, s3
  s_lshl_b32 s87, s87, 7
  s_mov_b32 m0, 40960
  s_add_u32 s63, s87, s53
  buffer_load_dwordx4 v28, s[40:43], s63 offen offset:0 lds
  buffer_load_dwordx4 v29, s[40:43], s63 offen offset:1024 lds
  buffer_load_dwordx4 v30, s[40:43], s63 offen offset:2048 lds
  buffer_load_dwordx4 v31, s[40:43], s63 offen offset:3072 lds
  s_waitcnt vmcnt(54)
  ds_read_b32 v32, v37
  s_mov_b32 m0, 45056
  s_add_u32 s63, s63, 28672
  buffer_load_dwordx4 v28, s[40:43], s63 offen offset:0 lds
  buffer_load_dwordx4 v29, s[40:43], s63 offen offset:1024 lds
  buffer_load_dwordx4 v30, s[40:43], s63 offen offset:2048 lds
  buffer_load_dwordx4 v31, s[40:43], s63 offen offset:3072 lds
  s_mov_b32 m0, 161792
  v_mov_b32 v4, L_tab-L_pc+272
  global_load_lds_dword v4, s[22:23]
  s_waitcnt vmcnt(55)
  s_waitcnt lgkmcnt(0)
  v_cmp_gt_u32 vcc, 0xb0030036, v32
  s_cbranch_vccnz L_lsO_2_6
L_lbO_2_6:
  s_mov_b32 m0, 131072
  s_add_u32 s63, s87, s54
  buffer_load_dwordx4 v28, s[40:43], s63 offen offset:0 lds
  buffer_load_dwordx4 v29, s[40:43], s63 offen offset:1024 lds
  buffer_load_dwordx4 v30, s[40:43], s63 offen offset:2048 lds
  buffer_load_dwordx4 v31, s[40:43], s63 offen offset:3072 lds
  s_waitcnt vmcnt(54)
  ds_read_b32 v32, v37
  s_mov_b32 m0, 135168
  s_add_u32 s63, s63, 28672
  buffer_load_dwordx4 v28, s[40:43], s63 offen offset:0 lds
  buffer_load_dwordx4 v29, s[40:43], s63 offen offset:1024 lds
  buffer_load_dwordx4 v30, s[40:43], s63 offen offset:2048 lds
  buffer_load_dwordx4 v31, s[40:43], s63 offen offset:3072 lds
  s_mov_b32 m0, 161792
  v_mov_b32 v4, L_tab-L_pc+276
  global_load_lds_dword v4, s[22:23]
  s_waitcnt vmcnt(55)
  s_waitcnt lgkmcnt(0)
  v_cmp_gt_u32 vcc, 0xb0030037, v32
  s_cbranch_vccnz L_lsO_3_6
L_lbO_3_6:
  s_mov_b32 m0, 151552
  s_add_u32 s63, s87, s55
  buffer_load_dwordx4 v28, s[40:43], s63 offen offset:0 lds
  buffer_load_dwordx4 v29, s[40:43], s63 offen offset:1024 lds
  buffer_load_dwordx4 v30, s[40:43], s63 offen offset:2048 lds
  buffer_load_dwordx4 v31, s[40:43], s63 offen offset:3072 lds
  s_waitcnt vmcnt(54)
  s_mov_b32 m0, 155648
  s_add_u32 s63, s63, 28672
  buffer_load_dwordx4 v28, s[40:43], s63 offen offset:0 lds
  buffer_load_dwordx4 v29, s[40:43], s63 offen offset:1024 lds
  buffer_load_dwordx4 v30, s[40:43], s63 offen offset:2048 lds
  buffer_load_dwordx4 v31, s[40:43], s63 offen offset:3072 lds
  s_mov_b32 m0, 161792
  v_mov_b32 v4, L_tab-L_pc+280
  global_load_lds_dword v4, s[22:23]
  s_waitcnt vmcnt(55)
  s_mul_i32 s3, s59, 1376256
  s_add_u32 s48, s14, s3
  s_addc_u32 s49, s15, 0
  s_mov_b32 s50, 1376256
  s_mov_b32 s51, 0x20000
  s_mov_b32 s52, s16
  s_mov_b32 s53, s17
  s_mov_b32 s54, 1376256
  s_mov_b32 s55, 0x20000
  v_lshrrev_b32 v41, 4, v0
  v_mul_u32_u24 v40, 86016, v41
  v_and_b32 v42, 15, v0
  v_lshl_add_u32 v40, v42, 4, v40
  v_bfe_u32 v44, v0, 2, 2
  v_mul_u32_u24 v43, 1792, v44
  v_and_b32 v45, 3, v0
  v_lshl_add_u32 v43, v45, 3, v43
  v_and_b32 v46, 1, v0
  v_lshl_add_u32 v43, v41, 5, v43
  v_lshlrev_b32 v46, 4, v46
  v_mov_b32 v47, 0x3f80
  v_lshlrev_b32 v46, v46, v47
  v_bfe_u32 v47, v0, 1, 3
  v_cmp_eq_u32 vcc, 0, v47
  s_nop 1
  v_cndmask_b32 v48, 0, v46, vcc
  v_cmp_eq_u32 vcc, 1, v47
  s_nop 1
  v_cndmask_b32 v49, 0, v46, vcc
  v_cmp_eq_u32 vcc, 2, v47
  s_nop 1
  v_cndmask_b32 v50, 0, v46, vcc
  v_cmp_eq_u32 vcc, 3, v47
  s_nop 1
  v_cndmask_b32 v51, 0, v46, vcc
  s_lshl_b32 s3, s58, 7
  v_lshl_add_u32 v52, v42, 2, s3
  s_mul_i32 s88, s56, 172032
  s_mul_i32 s3, s57, 896
  s_add_u32 s88, s88, s3
  s_mul_i32 s3, s58, 3
  s_add_u32 s3, s3, 0
  s_and_b32 s90, s3, 1
  s_lshl_b32 s90, s90, 6
  s_lshr_b32 s3, s3, 1
  s_mul_i32 s3, s3, 7168
  s_add_u32 s90, s90, s3
  s_add_u32 s90, s90, s88
  s_mul_i32 s3, s58, 3
  s_add_u32 s3, s3, 1
  s_and_b32 s91, s3, 1
  s_lshl_b32 s91, s91, 6
  s_lshr_b32 s3, s3, 1
  s_mul_i32 s3, s3, 7168
  s_add_u32 s91, s91, s3
  s_add_u32 s91, s91, s88
  s_mul_i32 s3, s58, 3
  s_add_u32 s3, s3, 2
  s_and_b32 s92, s3, 1
  s_lshl_b32 s92, s92, 6
  s_lshr_b32 s3, s3, 1
  s_mul_i32 s3, s3, 7168
  s_add_u32 s92, s92, s3
  s_add_u32 s92, s92, s88
  s_mul_i32 s65, s58, 768
L_own0:
  ds_read_b32 v55, v2 offset:1024
  s_waitcnt lgkmcnt(0)
  v_cmp_gt_u32 vcc, 3, v55
  s_cbranch_vccnz L_own0
L_fl0:
  buffer_load_dword v55, v52, s[96:99], 0 offen sc1
  s_waitcnt vmcnt(0)
  v_cmp_ge_u32 vcc, 0, v55
  s_cbranch_vccz L_flok0
  s_mov_b32 s3, 2
L_fg0:
  s_nop 15
  s_sub_u32 s3, s3, 1
  s_cmp_lg_u32 s3, 0
  s_cbranch_scc1 L_fg0
  s_branch L_fl0
L_flok0:
  s_add_u32 s86, s100, 0
  s_sub_u32 s3, s86, 7
  s_cselect_b32 s86, s86, s3
  s_mul_i32 s63, s86, 12288
  s_add_u32 s63, s63, s65
  buffer_load_dwordx4 v[64:67], v40, s[48:51], s63 offen offset:0 sc1
  buffer_load_dwordx4 v[68:71], v40, s[48:51], s63 offen offset:256 sc1
  buffer_load_dwordx4 v[72:75], v40, s[48:51], s63 offen offset:512 sc1
  s_add_u32 s63, s63, 344064
  buffer_load_dwordx4 v[76:79], v40, s[48:51], s63 offen offset:0 sc1
  buffer_load_dwordx4 v[80:83], v40, s[48:51], s63 offen offset:256 sc1
  buffer_load_dwordx4 v[84:87], v40, s[48:51], s63 offen offset:512 sc1
  s_add_u32 s63, s63, 344064
  buffer_load_dwordx4 v[88:91], v40, s[48:51], s63 offen offset:0 sc1
  buffer_load_dwordx4 v[92:95], v40, s[48:51], s63 offen offset:256 sc1
  buffer_load_dwordx4 v[96:99], v40, s[48:51], s63 offen offset:512 sc1
  s_add_u32 s63, s63, 344064
  buffer_load_dwordx4 v[100:103], v40, s[48:51], s63 offen offset:0 sc1
  buffer_load_dwordx4 v[104:107], v40, s[48:51], s63 offen offset:256 sc1
  buffer_load_dwordx4 v[108:111], v40, s[48:51], s63 offen offset:512 sc1
  s_add_u32 s86, s100, 1
  s_sub_u32 s3, s86, 7
  s_cselect_b32 s86, s86, s3
  s_mul_i32 s63, s86, 12288
  s_add_u32 s63, s63, s65
  buffer_load_dwordx4 v[112:115], v40, s[48:51], s63 offen offset:0 sc1
  buffer_load_dwordx4 v[116:119], v40, s[48:51], s63 offen offset:256 sc1
  buffer_load_dwordx4 v[120:123], v40, s[48:51], s63 offen offset:512 sc1
  s_add_u32 s63, s63, 344064
  buffer_load_dwordx4 v[124:127], v40, s[48:51], s63 offen offset:0 sc1
  buffer_load_dwordx4 v[128:131], v40, s[48:51], s63 offen offset:256 sc1
  buffer_load_dwordx4 v[132:135], v40, s[48:51], s63 offen offset:512 sc1
  s_add_u32 s63, s63, 344064
  buffer_load_dwordx4 v[136:139], v40, s[48:51], s63 offen offset:0 sc1
  buffer_load_dwordx4 v[140:143], v40, s[48:51], s63 offen offset:256 sc1
  buffer_load_dwordx4 v[144:147], v40, s[48:51], s63 offen offset:512 sc1
  s_add_u32 s63, s63, 344064
  buffer_load_dwordx4 v[148:151], v40, s[48:51], s63 offen offset:0 sc1
  buffer_load_dwordx4 v[152:155], v40, s[48:51], s63 offen offset:256 sc1
  buffer_load_dwordx4 v[156:159], v40, s[48:51], s63 offen offset:512 sc1
  s_add_u32 s86, s100, 2
  s_sub_u32 s3, s86, 7
  s_cselect_b32 s86, s86, s3
  s_mul_i32 s63, s86, 12288
  s_add_u32 s63, s63, s65
  buffer_load_dwordx4 v[160:163], v40, s[48:51], s63 offen offset:0 sc1
  buffer_load_dwordx4 v[164:167], v40, s[48:51], s63 offen offset:256 sc1
  buffer_load_dwordx4 v[168:171], v40, s[48:51], s63 offen offset:512 sc1
  s_add_u32 s63, s63, 344064
  buffer_load_dwordx4 v[172:175], v40, s[48:51], s63 offen offset:0 sc1
  buffer_load_dwordx4 v[176:179], v40, s[48:51], s63 offen offset:256 sc1
  buffer_load_dwordx4 v[180:183], v40, s[48:51], s63 offen offset:512 sc1
  s_add_u32 s63, s63, 344064
  buffer_load_dwordx4 v[184:187], v40, s[48:51], s63 offen offset:0 sc1
  buffer_load_dwordx4 v[188:191], v40, s[48:51], s63 offen offset:256 sc1
  buffer_load_dwordx4 v[192:195], v40, s[48:51], s63 offen offset:512 sc1
  s_add_u32 s63, s63, 344064
  buffer_load_dwordx4 v[196:199], v40, s[48:51], s63 offen offset:0 sc1
  buffer_load_dwordx4 v[200:203], v40, s[48:51], s63 offen offset:256 sc1
  buffer_load_dwordx4 v[204:207], v40, s[48:51], s63 offen offset:512 sc1
  s_add_u32 s86, s100, 3
  s_sub_u32 s3, s86, 7
  s_cselect_b32 s86, s86, s3
  s_mul_i32 s63, s86, 12288
  s_add_u32 s63, s63, s65
  buffer_load_dwordx4 v[208:211], v40, s[48:51], s63 offen offset:0 sc1
  buffer_load_dwordx4 v[212:215], v40, s[48:51], s63 offen offset:256 sc1
  buffer_load_dwordx4 v[216:219], v40, s[48:51], s63 offen offset:512 sc1
  s_add_u32 s63, s63, 344064
  buffer_load_dwordx4 v[220:223], v40, s[48:51], s63 offen offset:0 sc1
  buffer_load_dwordx4 v[224:227], v40, s[48:51], s63 offen offset:256 sc1
  buffer_load_dwordx4 v[228:231], v40, s[48:51], s63 offen offset:512 sc1
  s_add_u32 s63, s63, 344064
  buffer_load_dwordx4 v[232:235], v40, s[48:51], s63 offen offset:0 sc1
  buffer_load_dwordx4 v[236:239], v40, s[48:51], s63 offen offset:256 sc1
  buffer_load_dwordx4 v[240:243], v40, s[48:51], s63 offen offset:512 sc1
  s_add_u32 s63, s63, 344064
  buffer_load_dwordx4 v[244:247], v40, s[48:51], s63 offen offset:0 sc1
  buffer_load_dwordx4 v[248:251], v40, s[48:51], s63 offen offset:256 sc1
  buffer_load_dwordx4 v[252:255], v40, s[48:51], s63 offen offset:512 sc1
  s_waitcnt vmcnt(47)
  v_mfma_f32_16x16x32_bf16 v[8:11], v[48:51], v[64:67], 0
  s_waitcnt vmcnt(46)
  v_mfma_f32_16x16x32_bf16 v[12:15], v[48:51], v[68:71], 0
  s_waitcnt vmcnt(45)
  v_mfma_f32_16x16x32_bf16 v[16:19], v[48:51], v[72:75], 0
  s_waitcnt vmcnt(44)
  v_mfma_f32_16x16x32_bf16 v[8:11], v[48:51], v[76:79], v[8:11]
  s_waitcnt vmcnt(43)
  v_mfma_f32_16x16x32_bf16 v[12:15], v[48:51], v[80:83], v[12:15]
  s_waitcnt vmcnt(42)
  v_mfma_f32_16x16x32_bf16 v[16:19], v[48:51], v[84:87], v[16:19]
  s_waitcnt vmcnt(41)
  v_mfma_f32_16x16x32_bf16 v[8:11], v[48:51], v[88:91], v[8:11]
  s_waitcnt vmcnt(40)
  v_mfma_f32_16x16x32_bf16 v[12:15], v[48:51], v[92:95], v[12:15]
  s_waitcnt vmcnt(39)
  v_mfma_f32_16x16x32_bf16 v[16:19], v[48:51], v[96:99], v[16:19]
  s_waitcnt vmcnt(38)
  v_mfma_f32_16x16x32_bf16 v[8:11], v[48:51], v[100:103], v[8:11]
  s_waitcnt vmcnt(37)
  v_mfma_f32_16x16x32_bf16 v[12:15], v[48:51], v[104:107], v[12:15]
  s_waitcnt vmcnt(36)
  v_mfma_f32_16x16x32_bf16 v[16:19], v[48:51], v[108:111], v[16:19]
  s_add_u32 s86, s100, 0
  s_sub_u32 s3, s86, 7
  s_cselect_b32 s86, s86, s3
  s_lshl_b32 s86, s86, 7
  s_nop 4
  s_mov_b32 exec_hi, 0
  v_cvt_pk_bf16_f32 v56, v8, v9
  v_cvt_pk_bf16_f32 v57, v10, v11
  s_add_u32 s3, s90, s86
  buffer_store_dwordx2 v[56:57], v43, s[52:55], s3 offen
  v_cvt_pk_bf16_f32 v58, v12, v13
  v_cvt_pk_bf16_f32 v59, v14, v15
  s_add_u32 s3, s91, s86
  buffer_store_dwordx2 v[58:59], v43, s[52:55], s3 offen
  s_nop 1
  v_cvt_pk_bf16_f32 v60, v16, v17
  v_cvt_pk_bf16_f32 v61, v18, v19
  s_add_u32 s3, s92, s86
  buffer_store_dwordx2 v[60:61], v43, s[52:55], s3 offen
  s_mov_b32 exec_hi, -1
  s_waitcnt vmcnt(38)
  v_mfma_f32_16x16x32_bf16 v[20:23], v[48:51], v[112:115], 0
  s_waitcnt vmcnt(37)
  v_mfma_f32_16x16x32_bf16 v[24:27], v[48:51], v[116:119], 0
  s_waitcnt vmcnt(36)
  v_mfma_f32_16x16x32_bf16 v[28:31], v[48:51], v[120:123], 0
  s_waitcnt vmcnt(35)
  v_mfma_f32_16x16x32_bf16 v[20:23], v[48:51], v[124:127], v[20:23]
  s_waitcnt vmcnt(34)
  v_mfma_f32_16x16x32_bf16 v[24:27], v[48:51], v[128:131], v[24:27]
  s_waitcnt vmcnt(33)
  v_mfma_f32_16x16x32_bf16 v[28:31], v[48:51], v[132:135], v[28:31]
  s_waitcnt vmcnt(32)
  v_mfma_f32_16x16x32_bf16 v[20:23], v[48:51], v[136:139], v[20:23]
  s_waitcnt vmcnt(31)
  v_mfma_f32_16x16x32_bf16 v[24:27], v[48:51], v[140:143], v[24:27]
  s_waitcnt vmcnt(30)
  v_mfma_f32_16x16x32_bf16 v[28:31], v[48:51], v[144:147], v[28:31]
  s_waitcnt vmcnt(29)
  v_mfma_f32_16x16x32_bf16 v[20:23], v[48:51], v[148:151], v[20:23]
  s_waitcnt vmcnt(28)
  v_mfma_f32_16x16x32_bf16 v[24:27], v[48:51], v[152:155], v[24:27]
  s_waitcnt vmcnt(27)
  v_mfma_f32_16x16x32_bf16 v[28:31], v[48:51], v[156:159], v[28:31]
  s_add_u32 s86, s100, 1
  s_sub_u32 s3, s86, 7
  s_cselect_b32 s86, s86, s3
  s_lshl_b32 s86, s86, 7
  s_nop 4
  s_mov_b32 exec_hi, 0
  v_cvt_pk_bf16_f32 v56, v20, v21
  v_cvt_pk_bf16_f32 v57, v22, v23
  s_add_u32 s3, s90, s86
  buffer_store_dwordx2 v[56:57], v43, s[52:55], s3 offen
  v_cvt_pk_bf16_f32 v58, v24, v25
  v_cvt_pk_bf16_f32 v59, v26, v27
  s_add_u32 s3, s91, s86
  buffer_store_dwordx2 v[58:59], v43, s[52:55], s3 offen
  s_nop 1
  v_cvt_pk_bf16_f32 v60, v28, v29
  v_cvt_pk_bf16_f32 v61, v30, v31
  s_add_u32 s3, s92, s86
  buffer_store_dwordx2 v[60:61], v43, s[52:55], s3 offen
  s_mov_b32 exec_hi, -1
  s_waitcnt vmcnt(29)
  v_mfma_f32_16x16x32_bf16 v[8:11], v[48:51], v[160:163], 0
  s_waitcnt vmcnt(28)
  v_mfma_f32_16x16x32_bf16 v[12:15], v[48:51], v[164:167], 0
  s_waitcnt vmcnt(27)
  v_mfma_f32_16x16x32_bf16 v[16:19], v[48:51], v[168:171], 0
  s_waitcnt vmcnt(26)
  v_mfma_f32_16x16x32_bf16 v[8:11], v[48:51], v[172:175], v[8:11]
  s_waitcnt vmcnt(25)
  v_mfma_f32_16x16x32_bf16 v[12:15], v[48:51], v[176:179], v[12:15]
  s_waitcnt vmcnt(24)
  v_mfma_f32_16x16x32_bf16 v[16:19], v[48:51], v[180:183], v[16:19]
  s_waitcnt vmcnt(23)
  v_mfma_f32_16x16x32_bf16 v[8:11], v[48:51], v[184:187], v[8:11]
  s_waitcnt vmcnt(22)
  v_mfma_f32_16x16x32_bf16 v[12:15], v[48:51], v[188:191], v[12:15]
  s_waitcnt vmcnt(21)
  v_mfma_f32_16x16x32_bf16 v[16:19], v[48:51], v[192:195], v[16:19]
  s_waitcnt vmcnt(20)
  v_mfma_f32_16x16x32_bf16 v[8:11], v[48:51], v[196:199], v[8:11]
  s_waitcnt vmcnt(19)
  v_mfma_f32_16x16x32_bf16 v[12:15], v[48:51], v[200:203], v[12:15]
  s_waitcnt vmcnt(18)
  v_mfma_f32_16x16x32_bf16 v[16:19], v[48:51], v[204:207], v[16:19]
  s_add_u32 s86, s100, 2
  s_sub_u32 s3, s86, 7
  s_cselect_b32 s86, s86, s3
  s_lshl_b32 s86, s86, 7
  s_nop 4
  s_mov_b32 exec_hi, 0
  v_cvt_pk_bf16_f32 v56, v8, v9
  v_cvt_pk_bf16_f32 v57, v10, v11
  s_add_u32 s3, s90, s86
  buffer_store_dwordx2 v[56:57], v43, s[52:55], s3 offen
  v_cvt_pk_bf16_f32 v58, v12, v13
  v_cvt_pk_bf16_f32 v59, v14, v15
  s_add_u32 s3, s91, s86
  buffer_store_dwordx2 v[58:59], v43, s[52:55], s3 offen
  s_nop 1
  v_cvt_pk_bf16_f32 v60, v16, v17
  v_cvt_pk_bf16_f32 v61, v18, v19
  s_add_u32 s3, s92, s86
  buffer_store_dwordx2 v[60:61], v43, s[52:55], s3 offen
  s_mov_b32 exec_hi, -1
  s_waitcnt vmcnt(20)
  v_mfma_f32_16x16x32_bf16 v[20:23], v[48:51], v[208:211], 0
  s_waitcnt vmcnt(19)
  v_mfma_f32_16x16x32_bf16 v[24:27], v[48:51], v[212:215], 0
  s_waitcnt vmcnt(18)
  v_mfma_f32_16x16x32_bf16 v[28:31], v[48:51], v[216:219], 0
  s_waitcnt vmcnt(17)
  v_mfma_f32_16x16x32_bf16 v[20:23], v[48:51], v[220:223], v[20:23]
  s_waitcnt vmcnt(16)
  v_mfma_f32_16x16x32_bf16 v[24:27], v[48:51], v[224:227], v[24:27]
  s_waitcnt vmcnt(15)
  v_mfma_f32_16x16x32_bf16 v[28:31], v[48:51], v[228:231], v[28:31]
  s_waitcnt vmcnt(14)
  v_mfma_f32_16x16x32_bf16 v[20:23], v[48:51], v[232:235], v[20:23]
  s_waitcnt vmcnt(13)
  v_mfma_f32_16x16x32_bf16 v[24:27], v[48:51], v[236:239], v[24:27]
  s_waitcnt vmcnt(12)
  v_mfma_f32_16x16x32_bf16 v[28:31], v[48:51], v[240:243], v[28:31]
  s_waitcnt vmcnt(11)
  v_mfma_f32_16x16x32_bf16 v[20:23], v[48:51], v[244:247], v[20:23]
  s_waitcnt vmcnt(10)
  v_mfma_f32_16x16x32_bf16 v[24:27], v[48:51], v[248:251], v[24:27]
  s_waitcnt vmcnt(9)
  v_mfma_f32_16x16x32_bf16 v[28:31], v[48:51], v[252:255], v[28:31]
  s_add_u32 s86, s100, 3
  s_sub_u32 s3, s86, 7
  s_cselect_b32 s86, s86, s3
  s_lshl_b32 s86, s86, 7
  s_nop 4
  s_mov_b32 exec_hi, 0
  v_cvt_pk_bf16_f32 v56, v20, v21
  v_cvt_pk_bf16_f32 v57, v22, v23
  s_add_u32 s3, s90, s86
  buffer_store_dwordx2 v[56:57], v43, s[52:55], s3 offen
  v_cvt_pk_bf16_f32 v58, v24, v25
  v_cvt_pk_bf16_f32 v59, v26, v27
  s_add_u32 s3, s91, s86
  buffer_store_dwordx2 v[58:59], v43, s[52:55], s3 offen
  s_nop 1
  v_cvt_pk_bf16_f32 v60, v28, v29
  v_cvt_pk_bf16_f32 v61, v30, v31
  s_add_u32 s3, s92, s86
  buffer_store_dwordx2 v[60:61], v43, s[52:55], s3 offen
  s_mov_b32 exec_hi, -1
  s_branch L_fin
L_tab:
  s_movk_i32 s3, 0
  s_movk_i32 s3, 1
  s_movk_i32 s3, 2
  s_movk_i32 s3, 3
  s_movk_i32 s3, 4
  s_movk_i32 s3, 5
  s_movk_i32 s3, 6
  s_movk_i32 s3, 7
  s_movk_i32 s3, 8
  s_movk_i32 s3, 9
  s_movk_i32 s3, 10
  s_movk_i32 s3, 11
  s_movk_i32 s3, 12
  s_movk_i32 s3, 13
  s_movk_i32 s3, 14
  s_movk_i32 s3, 15
  s_movk_i32 s3, 16
  s_movk_i32 s3, 17
  s_movk_i32 s3, 18
  s_movk_i32 s3, 19
  s_movk_i32 s3, 20
  s_movk_i32 s3, 21
  s_movk_i32 s3, 22
  s_movk_i32 s3, 23
  s_movk_i32 s3, 24
  s_movk_i32 s3, 25
  s_movk_i32 s3, 26
  s_movk_i32 s3, 27
  s_movk_i32 s3, 28
  s_movk_i32 s3, 29
  s_movk_i32 s3, 30
  s_movk_i32 s3, 31
  s_movk_i32 s3, 32
  s_movk_i32 s3, 33
  s_movk_i32 s3, 34
  s_movk_i32 s3, 35
  s_movk_i32 s3, 36
  s_movk_i32 s3, 37
  s_movk_i32 s3, 38
  s_movk_i32 s3, 39
  s_movk_i32 s3, 40
  s_movk_i32 s3, 41
  s_movk_i32 s3, 42
  s_movk_i32 s3, 43
  s_movk_i32 s3, 44
  s_movk_i32 s3, 45
  s_movk_i32 s3, 46
  s_movk_i32 s3, 47
  s_movk_i32 s3, 48
  s_movk_i32 s3, 49
  s_movk_i32 s3, 50
  s_movk_i32 s3, 51
  s_movk_i32 s3, 52
  s_movk_i32 s3, 53
  s_movk_i32 s3, 54
  s_movk_i32 s3, 55
  s_movk_i32 s3, 56
  s_movk_i32 s3, 57
  s_movk_i32 s3, 58
  s_movk_i32 s3, 59
  s_movk_i32 s3, 60
  s_movk_i32 s3, 61
  s_movk_i32 s3, 62
  s_movk_i32 s3, 63
  s_movk_i32 s3, 64
  s_movk_i32 s3, 65
  s_movk_i32 s3, 66
  s_movk_i32 s3, 67
  s_movk_i32 s3, 68
  s_movk_i32 s3, 69
  s_movk_i32 s3, 70
  s_movk_i32 s3, 71
  s_movk_i32 s3, 72
  s_movk_i32 s3, 73
  s_movk_i32 s3, 74
  s_movk_i32 s3, 75
  s_movk_i32 s3, 76
  s_movk_i32 s3, 77
  s_movk_i32 s3, 78
  s_movk_i32 s3, 79
  s_movk_i32 s3, 80
  s_movk_i32 s3, 81
  s_movk_i32 s3, 82
  s_movk_i32 s3, 83
  s_movk_i32 s3, 84
  s_movk_i32 s3, 85
  s_movk_i32 s3, 86
  s_movk_i32 s3, 87
  s_movk_i32 s3, 88
  s_movk_i32 s3, 89
  s_movk_i32 s3, 90
  s_movk_i32 s3, 91
  s_movk_i32 s3, 92
  s_movk_i32 s3, 93
  s_movk_i32 s3, 94
  s_movk_i32 s3, 95
  s_endpgm
L_cons:
  s_waitcnt lgkmcnt(0)
  s_barrier
  s_lshl_b32 s3, s60, 8
  s_add_u32 m0, s3, 162048
  v_and_b32 v36, 15, v0
  v_lshrrev_b32 v37, 4, v0
  v_bfe_u32 v38, v0, 4, 1
  v_bfe_u32 v39, v0, 2, 2
  v_and_b32 v40, 3, v0
  v_lshrrev_b32 v41, 5, v0
  v_lshl_add_u32 v42, v38, 2, v39
  v_lshl_add_u32 v45, v41, 4, v42
  v_lshlrev_b32 v45, 9, v45
  v_lshl_add_u32 v45, v40, 3, v45
  v_lshl_add_u32 v20, v42, 5, v45
  v_xor_b32 v21, 32, v20
  v_xor_b32 v22, 64, v20
  v_xor_b32 v23, 96, v20
  v_xor_b32 v24, 128, v20
  v_xor_b32 v25, 160, v20
  v_xor_b32 v26, 192, v20
  v_xor_b32 v27, 224, v20
  s_lshl_b32 s3, s60, 12
  v_lshl_add_u32 v43, v36, 7, s3
  v_lshrrev_b32 v44, 1, v36
  v_xor_b32 v44, v44, v37
  v_lshl_add_u32 v28, v44, 4, v43
  v_xor_b32 v29, 64, v28
  v_lshl_add_u32 v44, v38, 1, v41
  v_xor_b32 v44, v44, v36
  v_lshlrev_b32 v43, 9, v36
  v_lshl_add_u32 v8, v44, 4, v43
  v_xor_b32 v9, 64, v8
  v_xor_b32 v10, 128, v8
  v_xor_b32 v11, 192, v8
  v_lshrrev_b32 v43, 2, v0
  v_lshlrev_b32 v43, 7, v43
  v_lshl_add_u32 v43, v40, 3, v43
  v_bfe_u32 v44, v0, 3, 2
  v_lshl_add_u32 v12, v44, 5, v43
  v_xor_b32 v13, 32, v12
  v_xor_b32 v14, 64, v12
  v_xor_b32 v15, 96, v12
  v_lshlrev_b32 v5, 9, v39
  v_lshl_add_u32 v5, v37, 4, v5
  v_lshl_add_u32 v5, v40, 6, v5
  v_mov_b32 v4, 1
  s_mov_b32 s67, 0x3db8aa3b
  s_mov_b32 s68, 0xbdb8aa3b
  s_lshl_b32 s3, s59, 4
  s_add_u32 s3, s3, s58
  s_mul_i32 s3, s3, 86016
  s_add_u32 s44, s14, s3
  s_addc_u32 s45, s15, 0
  s_mov_b32 s46, 86016
  s_mov_b32 s47, 0x20000
  s_lshl_b32 s65, s60, 12
  s_lshl_b32 s3, s59, 11
  s_add_u32 s3, s3, 67108864
  s_add_u32 s96, s14, s3
  s_addc_u32 s97, s15, 0
  s_mov_b32 s98, 2048
  s_mov_b32 s99, 0x20000
  s_mov_b32 s28, s18
  s_mov_b32 s29, s19
  s_mov_b32 s30, 256
  s_mov_b32 s31, 0x20000
  s_mul_i32 s3, s58, 229376
  s_add_u32 s40, s12, s3
  s_addc_u32 s41, s13, 0
  s_mov_b32 s42, 229376
  s_mov_b32 s43, 0x20000
  s_and_b32 s3, s56, 3
  s_lshl_b32 s3, s3, 2
  s_add_u32 s3, s3, 16
  s_lshl_b32 s20, s60, 4
  s_add_u32 s20, s20, s58
  s_cmp_lg_u32 s20, s3
  s_cselect_b32 s88, 0, 1
  s_cbranch_scc1 L_nc
  v_lshlrev_b32 v19, 4, v0
  v_mov_b32 v32, 0
  v_mov_b32 v33, 0
  v_mov_b32 v34, 0
  v_mov_b32 v35, 0
  buffer_store_dwordx4 v[32:35], v19, s[96:99], 0 offen offset:0 sc1
  buffer_store_dwordx4 v[32:35], v19, s[96:99], 0 offen offset:1024 sc1
L_nc:
  ds_read_b32 v3, v2 offset:2048
  s_waitcnt lgkmcnt(0)
  v_cmp_le_u32 vcc, 0xb0030001, v3
  s_cbranch_vccz L_csQ_0
L_cbQ_0:
  ds_read_b64_tr_b16 a[224:225], v20 offset:0
  ds_read_b64_tr_b16 a[226:227], v20 offset:4096
  v_add_u32 v28, 131072, v28
  ds_read_b128 a[0:3], v28 offset:16384
  ds_read_b64_tr_b16 a[228:229], v21 offset:0
  ds_read_b128 a[4:7], v28 offset:18432
  ds_read_b64_tr_b16 a[230:231], v21 offset:4096
  ds_read_b64_tr_b16 a[232:233], v22 offset:0
  v_add_u32 v29, 131072, v29
  ds_read_b128 a[8:11], v29 offset:16384
  ds_read_b64_tr_b16 a[234:235], v22 offset:4096
  ds_read_b128 a[12:15], v29 offset:18432
  ds_read_b64_tr_b16 a[236:237], v23 offset:0
  ds_read_b64_tr_b16 a[238:239], v23 offset:4096
  ds_read_b64_tr_b16 a[240:241], v24 offset:0
  ds_read_b64_tr_b16 a[242:243], v24 offset:4096
  s_waitcnt lgkmcnt(13)
  ds_read_b64_tr_b16 a[244:245], v25 offset:0
  s_waitcnt lgkmcnt(13)
  ds_read_b64_tr_b16 a[246:247], v25 offset:4096
  s_waitcnt lgkmcnt(10)
  v_mfma_f32_16x16x32_bf16 v[128:131], a[224:227], a[0:3], 0
  ds_read_b64_tr_b16 a[248:249], v26 offset:0
  v_mfma_f32_16x16x32_bf16 v[132:135], a[224:227], a[4:7], 0
  ds_read_b64_tr_b16 a[250:251], v26 offset:4096
  v_mfma_f32_16x16x32_bf16 v[136:139], a[228:231], a[0:3], 0
  ds_read_b64_tr_b16 a[252:253], v27 offset:0
  v_mfma_f32_16x16x32_bf16 v[140:143], a[228:231], a[4:7], 0
  ds_read_b64_tr_b16 a[254:255], v27 offset:4096
  s_waitcnt lgkmcnt(8)
  v_mfma_f32_16x16x32_bf16 v[144:147], a[232:235], a[0:3], 0
  ds_read_b64_tr_b16 a[224:225], v20 offset:256
  v_mfma_f32_16x16x32_bf16 v[148:151], a[232:235], a[4:7], 0
  ds_read_b64_tr_b16 a[226:227], v20 offset:4352
  v_mfma_f32_16x16x32_bf16 v[152:155], a[236:239], a[0:3], 0
  ds_read_b64_tr_b16 a[228:229], v21 offset:256
  v_mfma_f32_16x16x32_bf16 v[156:159], a[236:239], a[4:7], 0
  ds_read_b64_tr_b16 a[230:231], v21 offset:4352
  s_waitcnt lgkmcnt(8)
  v_mfma_f32_16x16x32_bf16 v[160:163], a[240:243], a[0:3], 0
  ds_read_b64_tr_b16 a[232:233], v22 offset:256
  v_mfma_f32_16x16x32_bf16 v[164:167], a[240:243], a[4:7], 0
  ds_read_b64_tr_b16 a[234:235], v22 offset:4352
  v_mfma_f32_16x16x32_bf16 v[168:171], a[244:247], a[0:3], 0
  ds_read_b64_tr_b16 a[236:237], v23 offset:256
  ds_read_b32 v3, v2 offset:2048
  v_mfma_f32_16x16x32_bf16 v[172:175], a[244:247], a[4:7], 0
  ds_read_b64_tr_b16 a[238:239], v23 offset:4352
  s_waitcnt lgkmcnt(9)
  v_mfma_f32_16x16x32_bf16 v[176:179], a[248:251], a[0:3], 0
  ds_read_b64_tr_b16 a[240:241], v24 offset:256
  v_mfma_f32_16x16x32_bf16 v[180:183], a[248:251], a[4:7], 0
  ds_read_b64_tr_b16 a[242:243], v24 offset:4352
  v_mfma_f32_16x16x32_bf16 v[184:187], a[252:255], a[0:3], 0
  ds_read_b64_tr_b16 a[244:245], v25 offset:256
  v_mfma_f32_16x16x32_bf16 v[188:191], a[252:255], a[4:7], 0
  ds_read_b64_tr_b16 a[246:247], v25 offset:4352
  s_waitcnt lgkmcnt(9)
  v_mfma_f32_16x16x32_bf16 v[192:195], a[224:227], a[0:3], 0
  ds_read_b64_tr_b16 a[248:249], v26 offset:256
  v_mfma_f32_16x16x32_bf16 v[196:199], a[224:227], a[4:7], 0
  ds_read_b64_tr_b16 a[250:251], v26 offset:4352
  v_mfma_f32_16x16x32_bf16 v[200:203], a[228:231], a[0:3], 0
  ds_read_b64_tr_b16 a[252:253], v27 offset:256
  s_waitcnt lgkmcnt(8)
  v_cmp_le_u32 vcc, 0xb0030002, v3
  v_mfma_f32_16x16x32_bf16 v[204:207], a[228:231], a[4:7], 0
  ds_read_b64_tr_b16 a[254:255], v27 offset:4352
  s_waitcnt lgkmcnt(8)
  v_mfma_f32_16x16x32_bf16 v[208:211], a[232:235], a[0:3], 0
  s_cbranch_vccz L_csQ_1
L_cbQ_1:
  ds_read_b64_tr_b16 a[224:225], v20 offset:16384
  v_mfma_f32_16x16x32_bf16 v[212:215], a[232:235], a[4:7], 0
  ds_read_b64_tr_b16 a[226:227], v20 offset:20480
  v_mfma_f32_16x16x32_bf16 v[216:219], a[236:239], a[0:3], 0
  ds_read_b64_tr_b16 a[228:229], v21 offset:16384
  v_mfma_f32_16x16x32_bf16 v[220:223], a[236:239], a[4:7], 0
  ds_read_b64_tr_b16 a[230:231], v21 offset:20480
  s_waitcnt lgkmcnt(8)
  v_mfma_f32_16x16x32_bf16 v[224:227], a[240:243], a[0:3], 0
  ds_read_b64_tr_b16 a[232:233], v22 offset:16384
  v_mfma_f32_16x16x32_bf16 v[228:231], a[240:243], a[4:7], 0
  ds_read_b64_tr_b16 a[234:235], v22 offset:20480
  v_mfma_f32_16x16x32_bf16 v[232:235], a[244:247], a[0:3], 0
  ds_read_b64_tr_b16 a[236:237], v23 offset:16384
  v_mfma_f32_16x16x32_bf16 v[236:239], a[244:247], a[4:7], 0
  ds_read_b64_tr_b16 a[238:239], v23 offset:20480
  s_waitcnt lgkmcnt(8)
  v_mfma_f32_16x16x32_bf16 v[240:243], a[248:251], a[0:3], 0
  ds_read_b64_tr_b16 a[240:241], v24 offset:16384
  v_mov_b32 v31, L_tab-L_pc+4
  v_mfma_f32_16x16x32_bf16 v[244:247], a[248:251], a[4:7], 0
  ds_read_b64_tr_b16 a[242:243], v24 offset:20480
  global_load_lds_dword v31, s[22:23]
  v_mfma_f32_16x16x32_bf16 v[248:251], a[252:255], a[0:3], 0
  ds_read_b64_tr_b16 a[244:245], v25 offset:16384
  v_mfma_f32_16x16x32_bf16 v[252:255], a[252:255], a[4:7], 0
  ds_read_b64_tr_b16 a[246:247], v25 offset:20480
  s_waitcnt lgkmcnt(8)
  v_mfma_f32_16x16x32_bf16 v[128:131], a[224:227], a[8:11], v[128:131]
  ds_read_b64_tr_b16 a[248:249], v26 offset:16384
  v_mfma_f32_16x16x32_bf16 v[132:135], a[224:227], a[12:15], v[132:135]
  ds_read_b64_tr_b16 a[250:251], v26 offset:20480
  v_mfma_f32_16x16x32_bf16 v[136:139], a[228:231], a[8:11], v[136:139]
  ds_read_b64_tr_b16 a[252:253], v27 offset:16384
  v_mfma_f32_16x16x32_bf16 v[140:143], a[228:231], a[12:15], v[140:143]
  ds_read_b64_tr_b16 a[254:255], v27 offset:20480
  s_waitcnt lgkmcnt(8)
  v_mfma_f32_16x16x32_bf16 v[144:147], a[232:235], a[8:11], v[144:147]
  ds_read_b64_tr_b16 a[224:225], v20 offset:16640
  v_mfma_f32_16x16x32_bf16 v[148:151], a[232:235], a[12:15], v[148:151]
  ds_read_b64_tr_b16 a[226:227], v20 offset:20736
  v_mfma_f32_16x16x32_bf16 v[152:155], a[236:239], a[8:11], v[152:155]
  ds_read_b64_tr_b16 a[228:229], v21 offset:16640
  v_mfma_f32_16x16x32_bf16 v[156:159], a[236:239], a[12:15], v[156:159]
  ds_read_b64_tr_b16 a[230:231], v21 offset:20736
  s_waitcnt lgkmcnt(8)
  v_mfma_f32_16x16x32_bf16 v[160:163], a[240:243], a[8:11], v[160:163]
  ds_read_b64_tr_b16 a[232:233], v22 offset:16640
  v_mfma_f32_16x16x32_bf16 v[164:167], a[240:243], a[12:15], v[164:167]
  ds_read_b64_tr_b16 a[234:235], v22 offset:20736
  v_mfma_f32_16x16x32_bf16 v[168:171], a[244:247], a[8:11], v[168:171]
  ds_read_b64_tr_b16 a[236:237], v23 offset:16640
  ds_read_b32 v3, v2 offset:2048
  v_mfma_f32_16x16x32_bf16 v[172:175], a[244:247], a[12:15], v[172:175]
  ds_read_b64_tr_b16 a[238:239], v23 offset:20736
  s_waitcnt lgkmcnt(9)
  v_mfma_f32_16x16x32_bf16 v[176:179], a[248:251], a[8:11], v[176:179]
  ds_read_b64_tr_b16 a[240:241], v24 offset:16640
  v_mfma_f32_16x16x32_bf16 v[180:183], a[248:251], a[12:15], v[180:183]
  ds_read_b64_tr_b16 a[242:243], v24 offset:20736
  v_mfma_f32_16x16x32_bf16 v[184:187], a[252:255], a[8:11], v[184:187]
  ds_read_b64_tr_b16 a[244:245], v25 offset:16640
  v_mfma_f32_16x16x32_bf16 v[188:191], a[252:255], a[12:15], v[188:191]
  ds_read_b64_tr_b16 a[246:247], v25 offset:20736
  s_waitcnt lgkmcnt(9)
  v_mfma_f32_16x16x32_bf16 v[192:195], a[224:227], a[8:11], v[192:195]
  ds_read_b64_tr_b16 a[248:249], v26 offset:16640
  v_mfma_f32_16x16x32_bf16 v[196:199], a[224:227], a[12:15], v[196:199]
  ds_read_b64_tr_b16 a[250:251], v26 offset:20736
  v_mfma_f32_16x16x32_bf16 v[200:203], a[228:231], a[8:11], v[200:203]
  ds_read_b64_tr_b16 a[252:253], v27 offset:16640
  s_waitcnt lgkmcnt(8)
  v_cmp_le_u32 vcc, 0xb0030003, v3
  v_mfma_f32_16x16x32_bf16 v[204:207], a[228:231], a[12:15], v[204:207]
  ds_read_b64_tr_b16 a[254:255], v27 offset:20736
  s_waitcnt lgkmcnt(8)
  v_mfma_f32_16x16x32_bf16 v[208:211], a[232:235], a[8:11], v[208:211]
  s_cbranch_vccz L_csQ_2
L_cbQ_2:
  ds_read_b64_tr_b16 a[224:225], v20 offset:32768
  v_mfma_f32_16x16x32_bf16 v[212:215], a[232:235], a[12:15], v[212:215]
  ds_read_b64_tr_b16 a[226:227], v20 offset:36864
  ds_read_b128 a[16:19], v28 offset:4096
  v_mfma_f32_16x16x32_bf16 v[216:219], a[236:239], a[8:11], v[216:219]
  ds_read_b64_tr_b16 a[228:229], v21 offset:32768
  ds_read_b128 a[20:23], v28 offset:6144
  v_mfma_f32_16x16x32_bf16 v[220:223], a[236:239], a[12:15], v[220:223]
  ds_read_b64_tr_b16 a[230:231], v21 offset:36864
  s_waitcnt lgkmcnt(10)
  v_mfma_f32_16x16x32_bf16 v[224:227], a[240:243], a[8:11], v[224:227]
  ds_read_b64_tr_b16 a[232:233], v22 offset:32768
  ds_read_b128 a[24:27], v29 offset:4096
  v_mfma_f32_16x16x32_bf16 v[228:231], a[240:243], a[12:15], v[228:231]
  ds_read_b64_tr_b16 a[234:235], v22 offset:36864
  ds_read_b128 a[28:31], v29 offset:6144
  v_mfma_f32_16x16x32_bf16 v[232:235], a[244:247], a[8:11], v[232:235]
  s_waitcnt lgkmcnt(13)
  ds_read_b64_tr_b16 a[236:237], v23 offset:32768
  v_mfma_f32_16x16x32_bf16 v[236:239], a[244:247], a[12:15], v[236:239]
  s_waitcnt lgkmcnt(13)
  ds_read_b64_tr_b16 a[238:239], v23 offset:36864
  s_waitcnt lgkmcnt(12)
  v_mfma_f32_16x16x32_bf16 v[240:243], a[248:251], a[8:11], v[240:243]
  ds_read_b64_tr_b16 a[240:241], v24 offset:32768
  v_mov_b32 v31, L_tab-L_pc+8
  v_mfma_f32_16x16x32_bf16 v[244:247], a[248:251], a[12:15], v[244:247]
  ds_read_b64_tr_b16 a[242:243], v24 offset:36864
  global_load_lds_dword v31, s[22:23]
  v_mfma_f32_16x16x32_bf16 v[248:251], a[252:255], a[8:11], v[248:251]
  s_waitcnt lgkmcnt(13)
  ds_read_b64_tr_b16 a[244:245], v25 offset:32768
  v_mfma_f32_16x16x32_bf16 v[252:255], a[252:255], a[12:15], v[252:255]
  s_waitcnt lgkmcnt(13)
  ds_read_b64_tr_b16 a[246:247], v25 offset:36864
  s_waitcnt lgkmcnt(10)
  v_mfma_f32_16x16x32_bf16 v[128:131], a[224:227], a[16:19], v[128:131]
  ds_read_b64_tr_b16 a[248:249], v26 offset:32768
  v_mfma_f32_16x16x32_bf16 v[132:135], a[224:227], a[20:23], v[132:135]
  ds_read_b64_tr_b16 a[250:251], v26 offset:36864
  v_mfma_f32_16x16x32_bf16 v[136:139], a[228:231], a[16:19], v[136:139]
  ds_read_b64_tr_b16 a[252:253], v27 offset:32768
  v_mfma_f32_16x16x32_bf16 v[140:143], a[228:231], a[20:23], v[140:143]
  ds_read_b64_tr_b16 a[254:255], v27 offset:36864
  s_waitcnt lgkmcnt(8)
  v_mfma_f32_16x16x32_bf16 v[144:147], a[232:235], a[16:19], v[144:147]
  ds_read_b64_tr_b16 a[224:225], v20 offset:33024
  v_mfma_f32_16x16x32_bf16 v[148:151], a[232:235], a[20:23], v[148:151]
  ds_read_b64_tr_b16 a[226:227], v20 offset:37120
  v_mfma_f32_16x16x32_bf16 v[152:155], a[236:239], a[16:19], v[152:155]
  ds_read_b64_tr_b16 a[228:229], v21 offset:33024
  v_mfma_f32_16x16x32_bf16 v[156:159], a[236:239], a[20:23], v[156:159]
  ds_read_b64_tr_b16 a[230:231], v21 offset:37120
  s_waitcnt lgkmcnt(8)
  v_mfma_f32_16x16x32_bf16 v[160:163], a[240:243], a[16:19], v[160:163]
  ds_read_b64_tr_b16 a[232:233], v22 offset:33024
  s_mul_i32 s63, s56, 28672
  v_mfma_f32_16x16x32_bf16 v[164:167], a[240:243], a[20:23], v[164:167]
  ds_read_b64_tr_b16 a[234:235], v22 offset:37120
  s_mul_i32 s3, s60, 9600
  v_mfma_f32_16x16x32_bf16 v[168:171], a[244:247], a[16:19], v[168:171]
  ds_read_b64_tr_b16 a[236:237], v23 offset:33024
  ds_read_b32 v3, v2 offset:2048
  v_mfma_f32_16x16x32_bf16 v[172:175], a[244:247], a[20:23], v[172:175]
  ds_read_b64_tr_b16 a[238:239], v23 offset:37120
  s_waitcnt lgkmcnt(9)
  v_mfma_f32_16x16x32_bf16 v[176:179], a[248:251], a[16:19], v[176:179]
  ds_read_b64_tr_b16 a[240:241], v24 offset:33024
  s_add_u32 s63, s63, s3
  v_mfma_f32_16x16x32_bf16 v[180:183], a[248:251], a[20:23], v[180:183]
  ds_read_b64_tr_b16 a[242:243], v24 offset:37120
  v_lshlrev_b32 v19, 7, v0
  v_mfma_f32_16x16x32_bf16 v[184:187], a[252:255], a[16:19], v[184:187]
  ds_read_b64_tr_b16 a[244:245], v25 offset:33024
  v_mfma_f32_16x16x32_bf16 v[188:191], a[252:255], a[20:23], v[188:191]
  ds_read_b64_tr_b16 a[246:247], v25 offset:37120
  s_waitcnt lgkmcnt(9)
  v_mfma_f32_16x16x32_bf16 v[192:195], a[224:227], a[16:19], v[192:195]
  ds_read_b64_tr_b16 a[248:249], v26 offset:33024
  buffer_load_dword a64, v19, s[40:43], s63 offen
  v_mfma_f32_16x16x32_bf16 v[196:199], a[224:227], a[20:23], v[196:199]
  ds_read_b64_tr_b16 a[250:251], v26 offset:37120
  v_min_u32 v18, 1280, v19
  v_mfma_f32_16x16x32_bf16 v[200:203], a[228:231], a[16:19], v[200:203]
  ds_read_b64_tr_b16 a[252:253], v27 offset:33024
  s_waitcnt lgkmcnt(8)
  v_cmp_le_u32 vcc, 0xb0030004, v3
  v_mfma_f32_16x16x32_bf16 v[204:207], a[228:231], a[20:23], v[204:207]
  ds_read_b64_tr_b16 a[254:255], v27 offset:37120
  s_waitcnt lgkmcnt(8)
  v_mfma_f32_16x16x32_bf16 v[208:211], a[232:235], a[16:19], v[208:211]
  s_cbranch_vccz L_csQ_3
L_cbQ_3:
  ds_read_b64_tr_b16 a[224:225], v20 offset:49152
  v_mfma_f32_16x16x32_bf16 v[212:215], a[232:235], a[20:23], v[212:215]
  ds_read_b64_tr_b16 a[226:227], v20 offset:53248
  s_add_u32 s63, s63, 8192
  v_mfma_f32_16x16x32_bf16 v[216:219], a[236:239], a[16:19], v[216:219]
  ds_read_b64_tr_b16 a[228:229], v21 offset:49152
  buffer_load_dword a65, v18, s[40:43], s63 offen
  v_mfma_f32_16x16x32_bf16 v[220:223], a[236:239], a[20:23], v[220:223]
  ds_read_b64_tr_b16 a[230:231], v21 offset:53248
  s_waitcnt lgkmcnt(8)
  v_mfma_f32_16x16x32_bf16 v[224:227], a[240:243], a[16:19], v[224:227]
  ds_read_b64_tr_b16 a[232:233], v22 offset:49152
  v_mfma_f32_16x16x32_bf16 v[228:231], a[240:243], a[20:23], v[228:231]
  ds_read_b64_tr_b16 a[234:235], v22 offset:53248
  v_mfma_f32_16x16x32_bf16 v[232:235], a[244:247], a[16:19], v[232:235]
  ds_read_b64_tr_b16 a[236:237], v23 offset:49152
  v_mfma_f32_16x16x32_bf16 v[236:239], a[244:247], a[20:23], v[236:239]
  ds_read_b64_tr_b16 a[238:239], v23 offset:53248
  s_waitcnt lgkmcnt(8)
  v_mfma_f32_16x16x32_bf16 v[240:243], a[248:251], a[16:19], v[240:243]
  ds_read_b64_tr_b16 a[240:241], v24 offset:49152
  v_mov_b32 v31, L_tab-L_pc+12
  v_mfma_f32_16x16x32_bf16 v[244:247], a[248:251], a[20:23], v[244:247]
  ds_read_b64_tr_b16 a[242:243], v24 offset:53248
  global_load_lds_dword v31, s[22:23]
  v_mfma_f32_16x16x32_bf16 v[248:251], a[252:255], a[16:19], v[248:251]
  ds_read_b64_tr_b16 a[244:245], v25 offset:49152
  v_mfma_f32_16x16x32_bf16 v[252:255], a[252:255], a[20:23], v[252:255]
  ds_read_b64_tr_b16 a[246:247], v25 offset:53248
  s_waitcnt lgkmcnt(8)
  v_mfma_f32_16x16x32_bf16 v[128:131], a[224:227], a[24:27], v[128:131]
  ds_read_b64_tr_b16 a[248:249], v26 offset:49152
  v_mfma_f32_16x16x32_bf16 v[132:135], a[224:227], a[28:31], v[132:135]
  ds_read_b64_tr_b16 a[250:251], v26 offset:53248
  v_mfma_f32_16x16x32_bf16 v[136:139], a[228:231], a[24:27], v[136:139]
  ds_read_b64_tr_b16 a[252:253], v27 offset:49152
  v_mfma_f32_16x16x32_bf16 v[140:143], a[228:231], a[28:31], v[140:143]
  ds_read_b64_tr_b16 a[254:255], v27 offset:53248
  s_waitcnt lgkmcnt(8)
  v_mfma_f32_16x16x32_bf16 v[144:147], a[232:235], a[24:27], v[144:147]
  ds_read_b64_tr_b16 a[224:225], v20 offset:49408
  v_mfma_f32_16x16x32_bf16 v[148:151], a[232:235], a[28:31], v[148:151]
  ds_read_b64_tr_b16 a[226:227], v20 offset:53504
  v_mfma_f32_16x16x32_bf16 v[152:155], a[236:239], a[24:27], v[152:155]
  ds_read_b64_tr_b16 a[228:229], v21 offset:49408
  v_mfma_f32_16x16x32_bf16 v[156:159], a[236:239], a[28:31], v[156:159]
  ds_read_b64_tr_b16 a[230:231], v21 offset:53504
  s_waitcnt lgkmcnt(8)
  v_mfma_f32_16x16x32_bf16 v[160:163], a[240:243], a[24:27], v[160:163]
  ds_read_b64_tr_b16 a[232:233], v22 offset:49408
  v_mfma_f32_16x16x32_bf16 v[164:167], a[240:243], a[28:31], v[164:167]
  ds_read_b64_tr_b16 a[234:235], v22 offset:53504
  v_mfma_f32_16x16x32_bf16 v[168:171], a[244:247], a[24:27], v[168:171]
  ds_read_b64_tr_b16 a[236:237], v23 offset:49408
  ds_read_b32 v3, v2 offset:2048
  v_mfma_f32_16x16x32_bf16 v[172:175], a[244:247], a[28:31], v[172:175]
  ds_read_b64_tr_b16 a[238:239], v23 offset:53504
  s_waitcnt lgkmcnt(9)
  v_mfma_f32_16x16x32_bf16 v[176:179], a[248:251], a[24:27], v[176:179]
  ds_read_b64_tr_b16 a[240:241], v24 offset:49408
  v_mfma_f32_16x16x32_bf16 v[180:183], a[248:251], a[28:31], v[180:183]
  ds_read_b64_tr_b16 a[242:243], v24 offset:53504
  v_mfma_f32_16x16x32_bf16 v[184:187], a[252:255], a[24:27], v[184:187]
  ds_read_b64_tr_b16 a[244:245], v25 offset:49408
  v_mfma_f32_16x16x32_bf16 v[188:191], a[252:255], a[28:31], v[188:191]
  ds_read_b64_tr_b16 a[246:247], v25 offset:53504
  s_waitcnt lgkmcnt(9)
  v_mfma_f32_16x16x32_bf16 v[192:195], a[224:227], a[24:27], v[192:195]
  ds_read_b64_tr_b16 a[248:249], v26 offset:49408
  v_mfma_f32_16x16x32_bf16 v[196:199], a[224:227], a[28:31], v[196:199]
  ds_read_b64_tr_b16 a[250:251], v26 offset:53504
  v_mfma_f32_16x16x32_bf16 v[200:203], a[228:231], a[24:27], v[200:203]
  ds_read_b64_tr_b16 a[252:253], v27 offset:49408
  s_waitcnt lgkmcnt(8)
  v_cmp_le_u32 vcc, 0xb0030005, v3
  v_mfma_f32_16x16x32_bf16 v[204:207], a[228:231], a[28:31], v[204:207]
  ds_read_b64_tr_b16 a[254:255], v27 offset:53504
  s_waitcnt lgkmcnt(8)
  v_mfma_f32_16x16x32_bf16 v[208:211], a[232:235], a[24:27], v[208:211]
  s_cbranch_vccz L_csQ_4
L_cbQ_4:
  v_add_u32 v20, 65536, v20
  ds_read_b64_tr_b16 a[224:225], v20 offset:0
  v_mfma_f32_16x16x32_bf16 v[212:215], a[232:235], a[28:31], v[212:215]
  ds_read_b64_tr_b16 a[226:227], v20 offset:4096
  v_subrev_u32 v28, 65536, v28
  ds_read_b128 a[0:3], v28 offset:45056
  v_mfma_f32_16x16x32_bf16 v[216:219], a[236:239], a[24:27], v[216:219]
  v_add_u32 v21, 65536, v21
  ds_read_b64_tr_b16 a[228:229], v21 offset:0
  ds_read_b128 a[4:7], v28 offset:47104
  v_mfma_f32_16x16x32_bf16 v[220:223], a[236:239], a[28:31], v[220:223]
  ds_read_b64_tr_b16 a[230:231], v21 offset:4096
  s_waitcnt lgkmcnt(10)
  v_mfma_f32_16x16x32_bf16 v[224:227], a[240:243], a[24:27], v[224:227]
  v_add_u32 v22, 65536, v22
  ds_read_b64_tr_b16 a[232:233], v22 offset:0
  v_subrev_u32 v29, 65536, v29
  ds_read_b128 a[8:11], v29 offset:45056
  v_mfma_f32_16x16x32_bf16 v[228:231], a[240:243], a[28:31], v[228:231]
  ds_read_b64_tr_b16 a[234:235], v22 offset:4096
  ds_read_b128 a[12:15], v29 offset:47104
  v_mfma_f32_16x16x32_bf16 v[232:235], a[244:247], a[24:27], v[232:235]
  v_add_u32 v23, 65536, v23
  s_waitcnt lgkmcnt(13)
  ds_read_b64_tr_b16 a[236:237], v23 offset:0
  v_mfma_f32_16x16x32_bf16 v[236:239], a[244:247], a[28:31], v[236:239]
  s_waitcnt lgkmcnt(13)
  ds_read_b64_tr_b16 a[238:239], v23 offset:4096
  s_waitcnt lgkmcnt(12)
  v_mfma_f32_16x16x32_bf16 v[240:243], a[248:251], a[24:27], v[240:243]
  v_add_u32 v24, 65536, v24
  ds_read_b64_tr_b16 a[240:241], v24 offset:0
  v_mov_b32 v31, L_tab-L_pc+16
  v_mfma_f32_16x16x32_bf16 v[244:247], a[248:251], a[28:31], v[244:247]
  ds_read_b64_tr_b16 a[242:243], v24 offset:4096
  global_load_lds_dword v31, s[22:23]
  v_mfma_f32_16x16x32_bf16 v[248:251], a[252:255], a[24:27], v[248:251]
  v_add_u32 v25, 65536, v25
  s_waitcnt lgkmcnt(13)
  ds_read_b64_tr_b16 a[244:245], v25 offset:0
  v_mfma_f32_16x16x32_bf16 v[252:255], a[252:255], a[28:31], v[252:255]
  s_waitcnt lgkmcnt(13)
  ds_read_b64_tr_b16 a[246:247], v25 offset:4096
  s_waitcnt lgkmcnt(10)
  v_mfma_f32_16x16x32_bf16 v[128:131], a[224:227], a[0:3], v[128:131]
  v_add_u32 v26, 65536, v26
  ds_read_b64_tr_b16 a[248:249], v26 offset:0
  v_mfma_f32_16x16x32_bf16 v[132:135], a[224:227], a[4:7], v[132:135]
  ds_read_b64_tr_b16 a[250:251], v26 offset:4096
  v_mfma_f32_16x16x32_bf16 v[136:139], a[228:231], a[0:3], v[136:139]
  v_add_u32 v27, 65536, v27
  ds_read_b64_tr_b16 a[252:253], v27 offset:0
  v_mfma_f32_16x16x32_bf16 v[140:143], a[228:231], a[4:7], v[140:143]
  ds_read_b64_tr_b16 a[254:255], v27 offset:4096
  s_waitcnt lgkmcnt(8)
  v_mfma_f32_16x16x32_bf16 v[144:147], a[232:235], a[0:3], v[144:147]
  ds_read_b64_tr_b16 a[224:225], v20 offset:256
  v_mfma_f32_16x16x32_bf16 v[148:151], a[232:235], a[4:7], v[148:151]
  ds_read_b64_tr_b16 a[226:227], v20 offset:4352
  v_mfma_f32_16x16x32_bf16 v[152:155], a[236:239], a[0:3], v[152:155]
  ds_read_b64_tr_b16 a[228:229], v21 offset:256
  v_mfma_f32_16x16x32_bf16 v[156:159], a[236:239], a[4:7], v[156:159]
  ds_read_b64_tr_b16 a[230:231], v21 offset:4352
  s_waitcnt lgkmcnt(8)
  v_mfma_f32_16x16x32_bf16 v[160:163], a[240:243], a[0:3], v[160:163]
  ds_read_b64_tr_b16 a[232:233], v22 offset:256
  v_mfma_f32_16x16x32_bf16 v[164:167], a[240:243], a[4:7], v[164:167]
  ds_read_b64_tr_b16 a[234:235], v22 offset:4352
  v_mfma_f32_16x16x32_bf16 v[168:171], a[244:247], a[0:3], v[168:171]
  ds_read_b64_tr_b16 a[236:237], v23 offset:256
  ds_read_b32 v3, v2 offset:2048
  v_mfma_f32_16x16x32_bf16 v[172:175], a[244:247], a[4:7], v[172:175]
  ds_read_b64_tr_b16 a[238:239], v23 offset:4352
  s_waitcnt lgkmcnt(9)
  v_mfma_f32_16x16x32_bf16 v[176:179], a[248:251], a[0:3], v[176:179]
  ds_read_b64_tr_b16 a[240:241], v24 offset:256
  v_mfma_f32_16x16x32_bf16 v[180:183], a[248:251], a[4:7], v[180:183]
  ds_read_b64_tr_b16 a[242:243], v24 offset:4352
  v_mfma_f32_16x16x32_bf16 v[184:187], a[252:255], a[0:3], v[184:187]
  ds_read_b64_tr_b16 a[244:245], v25 offset:256
  v_mfma_f32_16x16x32_bf16 v[188:191], a[252:255], a[4:7], v[188:191]
  ds_read_b64_tr_b16 a[246:247], v25 offset:4352
  s_waitcnt lgkmcnt(9)
  v_mfma_f32_16x16x32_bf16 v[192:195], a[224:227], a[0:3], v[192:195]
  ds_read_b64_tr_b16 a[248:249], v26 offset:256
  v_mfma_f32_16x16x32_bf16 v[196:199], a[224:227], a[4:7], v[196:199]
  ds_read_b64_tr_b16 a[250:251], v26 offset:4352
  v_mfma_f32_16x16x32_bf16 v[200:203], a[228:231], a[0:3], v[200:203]
  ds_read_b64_tr_b16 a[252:253], v27 offset:256
  s_waitcnt lgkmcnt(8)
  v_cmp_le_u32 vcc, 0xb0030006, v3
  v_mfma_f32_16x16x32_bf16 v[204:207], a[228:231], a[4:7], v[204:207]
  ds_read_b64_tr_b16 a[254:255], v27 offset:4352
  s_waitcnt lgkmcnt(8)
  v_mfma_f32_16x16x32_bf16 v[208:211], a[232:235], a[0:3], v[208:211]
  s_cbranch_vccz L_csQ_5
L_cbQ_5:
  ds_read_b64_tr_b16 a[224:225], v20 offset:16384
  v_mfma_f32_16x16x32_bf16 v[212:215], a[232:235], a[4:7], v[212:215]
  ds_read_b64_tr_b16 a[226:227], v20 offset:20480
  v_mfma_f32_16x16x32_bf16 v[216:219], a[236:239], a[0:3], v[216:219]
  ds_read_b64_tr_b16 a[228:229], v21 offset:16384
  v_mfma_f32_16x16x32_bf16 v[220:223], a[236:239], a[4:7], v[220:223]
  ds_read_b64_tr_b16 a[230:231], v21 offset:20480
  s_waitcnt lgkmcnt(8)
  v_mfma_f32_16x16x32_bf16 v[224:227], a[240:243], a[0:3], v[224:227]
  ds_read_b64_tr_b16 a[232:233], v22 offset:16384
  v_mfma_f32_16x16x32_bf16 v[228:231], a[240:243], a[4:7], v[228:231]
  ds_read_b64_tr_b16 a[234:235], v22 offset:20480
  v_mfma_f32_16x16x32_bf16 v[232:235], a[244:247], a[0:3], v[232:235]
  ds_read_b64_tr_b16 a[236:237], v23 offset:16384
  v_mfma_f32_16x16x32_bf16 v[236:239], a[244:247], a[4:7], v[236:239]
  ds_read_b64_tr_b16 a[238:239], v23 offset:20480
  s_waitcnt lgkmcnt(8)
  v_mfma_f32_16x16x32_bf16 v[240:243], a[248:251], a[0:3], v[240:243]
  ds_read_b64_tr_b16 a[240:241], v24 offset:16384
  v_mov_b32 v31, L_tab-L_pc+20
  v_mfma_f32_16x16x32_bf16 v[244:247], a[248:251], a[4:7], v[244:247]
  ds_read_b64_tr_b16 a[242:243], v24 offset:20480
  global_load_lds_dword v31, s[22:23]
  v_mfma_f32_16x16x32_bf16 v[248:251], a[252:255], a[0:3], v[248:251]
  ds_read_b64_tr_b16 a[244:245], v25 offset:16384
  v_mfma_f32_16x16x32_bf16 v[252:255], a[252:255], a[4:7], v[252:255]
  ds_read_b64_tr_b16 a[246:247], v25 offset:20480
  s_waitcnt lgkmcnt(8)
  v_mfma_f32_16x16x32_bf16 v[128:131], a[224:227], a[8:11], v[128:131]
  ds_read_b64_tr_b16 a[248:249], v26 offset:16384
  v_mfma_f32_16x16x32_bf16 v[132:135], a[224:227], a[12:15], v[132:135]
  ds_read_b64_tr_b16 a[250:251], v26 offset:20480
  v_mfma_f32_16x16x32_bf16 v[136:139], a[228:231], a[8:11], v[136:139]
  ds_read_b64_tr_b16 a[252:253], v27 offset:16384
  v_mfma_f32_16x16x32_bf16 v[140:143], a[228:231], a[12:15], v[140:143]
  ds_read_b64_tr_b16 a[254:255], v27 offset:20480
  s_waitcnt lgkmcnt(8)
  v_mfma_f32_16x16x32_bf16 v[144:147], a[232:235], a[8:11], v[144:147]
  ds_read_b64_tr_b16 a[224:225], v20 offset:16640
  v_mfma_f32_16x16x32_bf16 v[148:151], a[232:235], a[12:15], v[148:151]
  ds_read_b64_tr_b16 a[226:227], v20 offset:20736
  v_mfma_f32_16x16x32_bf16 v[152:155], a[236:239], a[8:11], v[152:155]
  ds_read_b64_tr_b16 a[228:229], v21 offset:16640
  v_mfma_f32_16x16x32_bf16 v[156:159], a[236:239], a[12:15], v[156:159]
  ds_read_b64_tr_b16 a[230:231], v21 offset:20736
  s_waitcnt lgkmcnt(8)
  v_mfma_f32_16x16x32_bf16 v[160:163], a[240:243], a[8:11], v[160:163]
  ds_read_b64_tr_b16 a[232:233], v22 offset:16640
  v_mfma_f32_16x16x32_bf16 v[164:167], a[240:243], a[12:15], v[164:167]
  ds_read_b64_tr_b16 a[234:235], v22 offset:20736
  v_mfma_f32_16x16x32_bf16 v[168:171], a[244:247], a[8:11], v[168:171]
  ds_read_b64_tr_b16 a[236:237], v23 offset:16640
  ds_read_b32 v3, v2 offset:2048
  v_mfma_f32_16x16x32_bf16 v[172:175], a[244:247], a[12:15], v[172:175]
  ds_read_b64_tr_b16 a[238:239], v23 offset:20736
  s_waitcnt lgkmcnt(9)
  v_mfma_f32_16x16x32_bf16 v[176:179], a[248:251], a[8:11], v[176:179]
  ds_read_b64_tr_b16 a[240:241], v24 offset:16640
  v_mfma_f32_16x16x32_bf16 v[180:183], a[248:251], a[12:15], v[180:183]
  ds_read_b64_tr_b16 a[242:243], v24 offset:20736
  v_mfma_f32_16x16x32_bf16 v[184:187], a[252:255], a[8:11], v[184:187]
  ds_read_b64_tr_b16 a[244:245], v25 offset:16640
  v_mfma_f32_16x16x32_bf16 v[188:191], a[252:255], a[12:15], v[188:191]
  ds_read_b64_tr_b16 a[246:247], v25 offset:20736
  s_waitcnt lgkmcnt(9)
  v_mfma_f32_16x16x32_bf16 v[192:195], a[224:227], a[8:11], v[192:195]
  ds_read_b64_tr_b16 a[248:249], v26 offset:16640
  v_mfma_f32_16x16x32_bf16 v[196:199], a[224:227], a[12:15], v[196:199]
  ds_read_b64_tr_b16 a[250:251], v26 offset:20736
  v_mfma_f32_16x16x32_bf16 v[200:203], a[228:231], a[8:11], v[200:203]
  ds_read_b64_tr_b16 a[252:253], v27 offset:16640
  s_waitcnt lgkmcnt(8)
  v_cmp_le_u32 vcc, 0xb0030007, v3
  v_mfma_f32_16x16x32_bf16 v[204:207], a[228:231], a[12:15], v[204:207]
  ds_read_b64_tr_b16 a[254:255], v27 offset:20736
  s_waitcnt lgkmcnt(8)
  v_mfma_f32_16x16x32_bf16 v[208:211], a[232:235], a[8:11], v[208:211]
  s_cbranch_vccz L_csQ_6
L_cbQ_6:
  v_subrev_u32 v20, 65536, v20
  ds_read_b64_tr_b16 a[224:225], v20 offset:0
  v_mfma_f32_16x16x32_bf16 v[212:215], a[232:235], a[12:15], v[212:215]
  ds_read_b64_tr_b16 a[226:227], v20 offset:4096
  ds_read_b128 a[16:19], v28 offset:57344
  v_mfma_f32_16x16x32_bf16 v[216:219], a[236:239], a[8:11], v[216:219]
  v_subrev_u32 v21, 65536, v21
  ds_read_b64_tr_b16 a[228:229], v21 offset:0
  ds_read_b128 a[20:23], v28 offset:59392
  v_mfma_f32_16x16x32_bf16 v[220:223], a[236:239], a[12:15], v[220:223]
  ds_read_b64_tr_b16 a[230:231], v21 offset:4096
  s_waitcnt lgkmcnt(10)
  v_mfma_f32_16x16x32_bf16 v[224:227], a[240:243], a[8:11], v[224:227]
  v_subrev_u32 v22, 65536, v22
  ds_read_b64_tr_b16 a[232:233], v22 offset:0
  ds_read_b128 a[24:27], v29 offset:57344
  v_mfma_f32_16x16x32_bf16 v[228:231], a[240:243], a[12:15], v[228:231]
  ds_read_b64_tr_b16 a[234:235], v22 offset:4096
  ds_read_b128 a[28:31], v29 offset:59392
  v_mfma_f32_16x16x32_bf16 v[232:235], a[244:247], a[8:11], v[232:235]
  v_subrev_u32 v23, 65536, v23
  s_waitcnt lgkmcnt(13)
  ds_read_b64_tr_b16 a[236:237], v23 offset:0
  v_mfma_f32_16x16x32_bf16 v[236:239], a[244:247], a[12:15], v[236:239]
  s_waitcnt lgkmcnt(13)
  ds_read_b64_tr_b16 a[238:239], v23 offset:4096
  s_waitcnt lgkmcnt(12)
  v_mfma_f32_16x16x32_bf16 v[240:243], a[248:251], a[8:11], v[240:243]
  v_subrev_u32 v24, 65536, v24
  ds_read_b64_tr_b16 a[240:241], v24 offset:0
  v_mov_b32 v31, L_tab-L_pc+24
  v_mfma_f32_16x16x32_bf16 v[244:247], a[248:251], a[12:15], v[244:247]
  ds_read_b64_tr_b16 a[242:243], v24 offset:4096
  global_load_lds_dword v31, s[22:23]
  v_mfma_f32_16x16x32_bf16 v[248:251], a[252:255], a[8:11], v[248:251]
  v_subrev_u32 v25, 65536, v25
  s_waitcnt lgkmcnt(13)
  ds_read_b64_tr_b16 a[244:245], v25 offset:0
  v_mfma_f32_16x16x32_bf16 v[252:255], a[252:255], a[12:15], v[252:255]
  s_waitcnt lgkmcnt(13)
  ds_read_b64_tr_b16 a[246:247], v25 offset:4096
  s_waitcnt lgkmcnt(10)
  v_mfma_f32_16x16x32_bf16 v[128:131], a[224:227], a[16:19], v[128:131]
  v_subrev_u32 v26, 65536, v26
  ds_read_b64_tr_b16 a[248:249], v26 offset:0
  v_mfma_f32_16x16x32_bf16 v[132:135], a[224:227], a[20:23], v[132:135]
  ds_read_b64_tr_b16 a[250:251], v26 offset:4096
  v_mfma_f32_16x16x32_bf16 v[136:139], a[228:231], a[16:19], v[136:139]
  v_subrev_u32 v27, 65536, v27
  ds_read_b64_tr_b16 a[252:253], v27 offset:0
  v_mfma_f32_16x16x32_bf16 v[140:143], a[228:231], a[20:23], v[140:143]
  ds_read_b64_tr_b16 a[254:255], v27 offset:4096
  s_waitcnt lgkmcnt(8)
  v_mfma_f32_16x16x32_bf16 v[144:147], a[232:235], a[16:19], v[144:147]
  ds_read_b64_tr_b16 a[224:225], v20 offset:256
  v_mfma_f32_16x16x32_bf16 v[148:151], a[232:235], a[20:23], v[148:151]
  ds_read_b64_tr_b16 a[226:227], v20 offset:4352
  v_mfma_f32_16x16x32_bf16 v[152:155], a[236:239], a[16:19], v[152:155]
  ds_read_b64_tr_b16 a[228:229], v21 offset:256
  v_mfma_f32_16x16x32_bf16 v[156:159], a[236:239], a[20:23], v[156:159]
  ds_read_b64_tr_b16 a[230:231], v21 offset:4352
  s_waitcnt lgkmcnt(8)
  v_mfma_f32_16x16x32_bf16 v[160:163], a[240:243], a[16:19], v[160:163]
  ds_read_b64_tr_b16 a[232:233], v22 offset:256
  v_mfma_f32_16x16x32_bf16 v[164:167], a[240:243], a[20:23], v[164:167]
  ds_read_b64_tr_b16 a[234:235], v22 offset:4352
  v_mfma_f32_16x16x32_bf16 v[168:171], a[244:247], a[16:19], v[168:171]
  ds_read_b64_tr_b16 a[236:237], v23 offset:256
  ds_read_b32 v3, v2 offset:2048
  v_mfma_f32_16x16x32_bf16 v[172:175], a[244:247], a[20:23], v[172:175]
  ds_read_b64_tr_b16 a[238:239], v23 offset:4352
  s_waitcnt lgkmcnt(9)
  v_mfma_f32_16x16x32_bf16 v[176:179], a[248:251], a[16:19], v[176:179]
  ds_read_b64_tr_b16 a[240:241], v24 offset:256
  v_mfma_f32_16x16x32_bf16 v[180:183], a[248:251], a[20:23], v[180:183]
  ds_read_b64_tr_b16 a[242:243], v24 offset:4352
  v_mfma_f32_16x16x32_bf16 v[184:187], a[252:255], a[16:19], v[184:187]
  ds_read_b64_tr_b16 a[244:245], v25 offset:256
  v_mfma_f32_16x16x32_bf16 v[188:191], a[252:255], a[20:23], v[188:191]
  ds_read_b64_tr_b16 a[246:247], v25 offset:4352
  s_waitcnt lgkmcnt(9)
  v_mfma_f32_16x16x32_bf16 v[192:195], a[224:227], a[16:19], v[192:195]
  ds_read_b64_tr_b16 a[248:249], v26 offset:256
  v_mfma_f32_16x16x32_bf16 v[196:199], a[224:227], a[20:23], v[196:199]
  ds_read_b64_tr_b16 a[250:251], v26 offset:4352
  v_mfma_f32_16x16x32_bf16 v[200:203], a[228:231], a[16:19], v[200:203]
  ds_read_b64_tr_b16 a[252:253], v27 offset:256
  s_waitcnt lgkmcnt(8)
  v_cmp_le_u32 vcc, 0xb0030008, v3
  v_mfma_f32_16x16x32_bf16 v[204:207], a[228:231], a[20:23], v[204:207]
  ds_read_b64_tr_b16 a[254:255], v27 offset:4352
  s_waitcnt lgkmcnt(8)
  v_mfma_f32_16x16x32_bf16 v[208:211], a[232:235], a[16:19], v[208:211]
  s_cbranch_vccz L_csQ_7
L_cbQ_7:
  ds_read_b64_tr_b16 a[224:225], v20 offset:16384
  v_mfma_f32_16x16x32_bf16 v[212:215], a[232:235], a[20:23], v[212:215]
  ds_read_b64_tr_b16 a[226:227], v20 offset:20480
  v_mfma_f32_16x16x32_bf16 v[216:219], a[236:239], a[16:19], v[216:219]
  ds_read_b64_tr_b16 a[228:229], v21 offset:16384
  v_mfma_f32_16x16x32_bf16 v[220:223], a[236:239], a[20:23], v[220:223]
  ds_read_b64_tr_b16 a[230:231], v21 offset:20480
  s_waitcnt lgkmcnt(8)
  v_mfma_f32_16x16x32_bf16 v[224:227], a[240:243], a[16:19], v[224:227]
  ds_read_b64_tr_b16 a[232:233], v22 offset:16384
  v_mfma_f32_16x16x32_bf16 v[228:231], a[240:243], a[20:23], v[228:231]
  ds_read_b64_tr_b16 a[234:235], v22 offset:20480
  v_mfma_f32_16x16x32_bf16 v[232:235], a[244:247], a[16:19], v[232:235]
  ds_read_b64_tr_b16 a[236:237], v23 offset:16384
  v_mfma_f32_16x16x32_bf16 v[236:239], a[244:247], a[20:23], v[236:239]
  ds_read_b64_tr_b16 a[238:239], v23 offset:20480
  s_waitcnt lgkmcnt(8)
  v_mfma_f32_16x16x32_bf16 v[240:243], a[248:251], a[16:19], v[240:243]
  ds_read_b64_tr_b16 a[240:241], v24 offset:16384
  v_mov_b32 v31, L_tab-L_pc+28
  v_mfma_f32_16x16x32_bf16 v[244:247], a[248:251], a[20:23], v[244:247]
  ds_read_b64_tr_b16 a[242:243], v24 offset:20480
  global_load_lds_dword v31, s[22:23]
  v_mfma_f32_16x16x32_bf16 v[248:251], a[252:255], a[16:19], v[248:251]
  ds_read_b64_tr_b16 a[244:245], v25 offset:16384
  v_mfma_f32_16x16x32_bf16 v[252:255], a[252:255], a[20:23], v[252:255]
  ds_read_b64_tr_b16 a[246:247], v25 offset:20480
  s_waitcnt lgkmcnt(8)
  v_mfma_f32_16x16x32_bf16 v[128:131], a[224:227], a[24:27], v[128:131]
  ds_read_b64_tr_b16 a[248:249], v26 offset:16384
  v_mfma_f32_16x16x32_bf16 v[132:135], a[224:227], a[28:31], v[132:135]
  ds_read_b64_tr_b16 a[250:251], v26 offset:20480
  v_mfma_f32_16x16x32_bf16 v[136:139], a[228:231], a[24:27], v[136:139]
  ds_read_b64_tr_b16 a[252:253], v27 offset:16384
  v_mfma_f32_16x16x32_bf16 v[140:143], a[228:231], a[28:31], v[140:143]
  ds_read_b64_tr_b16 a[254:255], v27 offset:20480
  s_waitcnt lgkmcnt(8)
  v_mfma_f32_16x16x32_bf16 v[144:147], a[232:235], a[24:27], v[144:147]
  ds_read_b64_tr_b16 a[224:225], v20 offset:16640
  v_mfma_f32_16x16x32_bf16 v[148:151], a[232:235], a[28:31], v[148:151]
  ds_read_b64_tr_b16 a[226:227], v20 offset:20736
  v_mfma_f32_16x16x32_bf16 v[152:155], a[236:239], a[24:27], v[152:155]
  ds_read_b64_tr_b16 a[228:229], v21 offset:16640
  v_mfma_f32_16x16x32_bf16 v[156:159], a[236:239], a[28:31], v[156:159]
  ds_read_b64_tr_b16 a[230:231], v21 offset:20736
  s_waitcnt lgkmcnt(8)
  v_mfma_f32_16x16x32_bf16 v[160:163], a[240:243], a[24:27], v[160:163]
  ds_read_b64_tr_b16 a[232:233], v22 offset:16640
  v_mfma_f32_16x16x32_bf16 v[164:167], a[240:243], a[28:31], v[164:167]
  ds_read_b64_tr_b16 a[234:235], v22 offset:20736
  v_mfma_f32_16x16x32_bf16 v[168:171], a[244:247], a[24:27], v[168:171]
  ds_read_b64_tr_b16 a[236:237], v23 offset:16640
  ds_read_b32 v3, v2 offset:2048
  v_mfma_f32_16x16x32_bf16 v[172:175], a[244:247], a[28:31], v[172:175]
  ds_read_b64_tr_b16 a[238:239], v23 offset:20736
  s_waitcnt lgkmcnt(9)
  v_mfma_f32_16x16x32_bf16 v[176:179], a[248:251], a[24:27], v[176:179]
  ds_read_b64_tr_b16 a[240:241], v24 offset:16640
  v_mfma_f32_16x16x32_bf16 v[180:183], a[248:251], a[28:31], v[180:183]
  ds_read_b64_tr_b16 a[242:243], v24 offset:20736
  v_mfma_f32_16x16x32_bf16 v[184:187], a[252:255], a[24:27], v[184:187]
  ds_read_b64_tr_b16 a[244:245], v25 offset:16640
  v_mfma_f32_16x16x32_bf16 v[188:191], a[252:255], a[28:31], v[188:191]
  ds_read_b64_tr_b16 a[246:247], v25 offset:20736
  s_waitcnt lgkmcnt(9)
  v_mfma_f32_16x16x32_bf16 v[192:195], a[224:227], a[24:27], v[192:195]
  ds_read_b64_tr_b16 a[248:249], v26 offset:16640
  v_mfma_f32_16x16x32_bf16 v[196:199], a[224:227], a[28:31], v[196:199]
  ds_read_b64_tr_b16 a[250:251], v26 offset:20736
  v_mfma_f32_16x16x32_bf16 v[200:203], a[228:231], a[24:27], v[200:203]
  ds_read_b64_tr_b16 a[252:253], v27 offset:16640
  s_waitcnt lgkmcnt(8)
  v_cmp_le_u32 vcc, 0xb0030009, v3
  v_mfma_f32_16x16x32_bf16 v[204:207], a[228:231], a[28:31], v[204:207]
  ds_read_b64_tr_b16 a[254:255], v27 offset:20736
  s_waitcnt lgkmcnt(8)
  v_mfma_f32_16x16x32_bf16 v[208:211], a[232:235], a[24:27], v[208:211]
  s_cbranch_vccz L_csQ_8
L_cbQ_8:
  ds_read_b64_tr_b16 a[224:225], v20 offset:32768
  v_mfma_f32_16x16x32_bf16 v[212:215], a[232:235], a[28:31], v[212:215]
  ds_read_b64_tr_b16 a[226:227], v20 offset:36864
  v_add_u32 v28, 65536, v28
  ds_read_b128 a[0:3], v28 offset:16384
  v_mfma_f32_16x16x32_bf16 v[216:219], a[236:239], a[24:27], v[216:219]
  ds_read_b64_tr_b16 a[228:229], v21 offset:32768
  ds_read_b128 a[4:7], v28 offset:18432
  v_mfma_f32_16x16x32_bf16 v[220:223], a[236:239], a[28:31], v[220:223]
  ds_read_b64_tr_b16 a[230:231], v21 offset:36864
  s_waitcnt lgkmcnt(10)
  v_mfma_f32_16x16x32_bf16 v[224:227], a[240:243], a[24:27], v[224:227]
  ds_read_b64_tr_b16 a[232:233], v22 offset:32768
  v_add_u32 v29, 65536, v29
  ds_read_b128 a[8:11], v29 offset:16384
  v_mfma_f32_16x16x32_bf16 v[228:231], a[240:243], a[28:31], v[228:231]
  ds_read_b64_tr_b16 a[234:235], v22 offset:36864
  ds_read_b128 a[12:15], v29 offset:18432
  v_mfma_f32_16x16x32_bf16 v[232:235], a[244:247], a[24:27], v[232:235]
  s_waitcnt lgkmcnt(13)
  ds_read_b64_tr_b16 a[236:237], v23 offset:32768
  v_mfma_f32_16x16x32_bf16 v[236:239], a[244:247], a[28:31], v[236:239]
  s_waitcnt lgkmcnt(13)
  ds_read_b64_tr_b16 a[238:239], v23 offset:36864
  s_waitcnt lgkmcnt(12)
  v_mfma_f32_16x16x32_bf16 v[240:243], a[248:251], a[24:27], v[240:243]
  ds_read_b64_tr_b16 a[240:241], v24 offset:32768
  v_mov_b32 v31, L_tab-L_pc+32
  v_mfma_f32_16x16x32_bf16 v[244:247], a[248:251], a[28:31], v[244:247]
  ds_read_b64_tr_b16 a[242:243], v24 offset:36864
  global_load_lds_dword v31, s[22:23]
  v_mfma_f32_16x16x32_bf16 v[248:251], a[252:255], a[24:27], v[248:251]
  s_waitcnt lgkmcnt(13)
  ds_read_b64_tr_b16 a[244:245], v25 offset:32768
  v_mfma_f32_16x16x32_bf16 v[252:255], a[252:255], a[28:31], v[252:255]
  s_waitcnt lgkmcnt(13)
  ds_read_b64_tr_b16 a[246:247], v25 offset:36864
  s_waitcnt lgkmcnt(10)
  v_mfma_f32_16x16x32_bf16 v[128:131], a[224:227], a[0:3], v[128:131]
  ds_read_b64_tr_b16 a[248:249], v26 offset:32768
  v_mfma_f32_16x16x32_bf16 v[132:135], a[224:227], a[4:7], v[132:135]
  ds_read_b64_tr_b16 a[250:251], v26 offset:36864
  v_mfma_f32_16x16x32_bf16 v[136:139], a[228:231], a[0:3], v[136:139]
  ds_read_b64_tr_b16 a[252:253], v27 offset:32768
  v_mfma_f32_16x16x32_bf16 v[140:143], a[228:231], a[4:7], v[140:143]
  ds_read_b64_tr_b16 a[254:255], v27 offset:36864
  s_waitcnt lgkmcnt(8)
  v_mfma_f32_16x16x32_bf16 v[144:147], a[232:235], a[0:3], v[144:147]
  ds_read_b64_tr_b16 a[224:225], v20 offset:33024
  v_mfma_f32_16x16x32_bf16 v[148:151], a[232:235], a[4:7], v[148:151]
  ds_read_b64_tr_b16 a[226:227], v20 offset:37120
  v_mfma_f32_16x16x32_bf16 v[152:155], a[236:239], a[0:3], v[152:155]
  ds_read_b64_tr_b16 a[228:229], v21 offset:33024
  v_mfma_f32_16x16x32_bf16 v[156:159], a[236:239], a[4:7], v[156:159]
  ds_read_b64_tr_b16 a[230:231], v21 offset:37120
  s_waitcnt lgkmcnt(8)
  v_mfma_f32_16x16x32_bf16 v[160:163], a[240:243], a[0:3], v[160:163]
  ds_read_b64_tr_b16 a[232:233], v22 offset:33024
  v_mfma_f32_16x16x32_bf16 v[164:167], a[240:243], a[4:7], v[164:167]
  ds_read_b64_tr_b16 a[234:235], v22 offset:37120
  v_mfma_f32_16x16x32_bf16 v[168:171], a[244:247], a[0:3], v[168:171]
  ds_read_b64_tr_b16 a[236:237], v23 offset:33024
  ds_read_b32 v3, v2 offset:2048
  v_mfma_f32_16x16x32_bf16 v[172:175], a[244:247], a[4:7], v[172:175]
  ds_read_b64_tr_b16 a[238:239], v23 offset:37120
  s_waitcnt lgkmcnt(9)
  v_mfma_f32_16x16x32_bf16 v[176:179], a[248:251], a[0:3], v[176:179]
  ds_read_b64_tr_b16 a[240:241], v24 offset:33024
  v_mfma_f32_16x16x32_bf16 v[180:183], a[248:251], a[4:7], v[180:183]
  ds_read_b64_tr_b16 a[242:243], v24 offset:37120
  v_mfma_f32_16x16x32_bf16 v[184:187], a[252:255], a[0:3], v[184:187]
  ds_read_b64_tr_b16 a[244:245], v25 offset:33024
  v_mfma_f32_16x16x32_bf16 v[188:191], a[252:255], a[4:7], v[188:191]
  ds_read_b64_tr_b16 a[246:247], v25 offset:37120
  s_waitcnt lgkmcnt(9)
  v_mfma_f32_16x16x32_bf16 v[192:195], a[224:227], a[0:3], v[192:195]
  ds_read_b64_tr_b16 a[248:249], v26 offset:33024
  v_mfma_f32_16x16x32_bf16 v[196:199], a[224:227], a[4:7], v[196:199]
  ds_read_b64_tr_b16 a[250:251], v26 offset:37120
  v_mfma_f32_16x16x32_bf16 v[200:203], a[228:231], a[0:3], v[200:203]
  ds_read_b64_tr_b16 a[252:253], v27 offset:33024
  s_waitcnt lgkmcnt(8)
  v_cmp_le_u32 vcc, 0xb003000a, v3
  v_mfma_f32_16x16x32_bf16 v[204:207], a[228:231], a[4:7], v[204:207]
  ds_read_b64_tr_b16 a[254:255], v27 offset:37120
  s_waitcnt lgkmcnt(8)
  v_mfma_f32_16x16x32_bf16 v[208:211], a[232:235], a[0:3], v[208:211]
  s_cbranch_vccz L_csQ_9
L_cbQ_9:
  ds_read_b64_tr_b16 a[224:225], v20 offset:49152
  v_mfma_f32_16x16x32_bf16 v[212:215], a[232:235], a[4:7], v[212:215]
  ds_read_b64_tr_b16 a[226:227], v20 offset:53248
  v_mfma_f32_16x16x32_bf16 v[216:219], a[236:239], a[0:3], v[216:219]
  ds_read_b64_tr_b16 a[228:229], v21 offset:49152
  v_mfma_f32_16x16x32_bf16 v[220:223], a[236:239], a[4:7], v[220:223]
  ds_read_b64_tr_b16 a[230:231], v21 offset:53248
  s_waitcnt lgkmcnt(8)
  v_mfma_f32_16x16x32_bf16 v[224:227], a[240:243], a[0:3], v[224:227]
  ds_read_b64_tr_b16 a[232:233], v22 offset:49152
  v_mfma_f32_16x16x32_bf16 v[228:231], a[240:243], a[4:7], v[228:231]
  ds_read_b64_tr_b16 a[234:235], v22 offset:53248
  v_mfma_f32_16x16x32_bf16 v[232:235], a[244:247], a[0:3], v[232:235]
  ds_read_b64_tr_b16 a[236:237], v23 offset:49152
  v_mfma_f32_16x16x32_bf16 v[236:239], a[244:247], a[4:7], v[236:239]
  ds_read_b64_tr_b16 a[238:239], v23 offset:53248
  s_waitcnt lgkmcnt(8)
  v_mfma_f32_16x16x32_bf16 v[240:243], a[248:251], a[0:3], v[240:243]
  ds_read_b64_tr_b16 a[240:241], v24 offset:49152
  v_mov_b32 v31, L_tab-L_pc+36
  v_mfma_f32_16x16x32_bf16 v[244:247], a[248:251], a[4:7], v[244:247]
  ds_read_b64_tr_b16 a[242:243], v24 offset:53248
  global_load_lds_dword v31, s[22:23]
  v_mfma_f32_16x16x32_bf16 v[248:251], a[252:255], a[0:3], v[248:251]
  ds_read_b64_tr_b16 a[244:245], v25 offset:49152
  v_mfma_f32_16x16x32_bf16 v[252:255], a[252:255], a[4:7], v[252:255]
  ds_read_b64_tr_b16 a[246:247], v25 offset:53248
  s_waitcnt lgkmcnt(8)
  v_mfma_f32_16x16x32_bf16 v[128:131], a[224:227], a[8:11], v[128:131]
  ds_read_b64_tr_b16 a[248:249], v26 offset:49152
  v_mfma_f32_16x16x32_bf16 v[132:135], a[224:227], a[12:15], v[132:135]
  ds_read_b64_tr_b16 a[250:251], v26 offset:53248
  v_mfma_f32_16x16x32_bf16 v[136:139], a[228:231], a[8:11], v[136:139]
  ds_read_b64_tr_b16 a[252:253], v27 offset:49152
  v_mfma_f32_16x16x32_bf16 v[140:143], a[228:231], a[12:15], v[140:143]
  ds_read_b64_tr_b16 a[254:255], v27 offset:53248
  s_waitcnt lgkmcnt(8)
  v_mfma_f32_16x16x32_bf16 v[144:147], a[232:235], a[8:11], v[144:147]
  ds_read_b64_tr_b16 a[224:225], v20 offset:49408
  v_mfma_f32_16x16x32_bf16 v[148:151], a[232:235], a[12:15], v[148:151]
  ds_read_b64_tr_b16 a[226:227], v20 offset:53504
  v_mfma_f32_16x16x32_bf16 v[152:155], a[236:239], a[8:11], v[152:155]
  ds_read_b64_tr_b16 a[228:229], v21 offset:49408
  v_mfma_f32_16x16x32_bf16 v[156:159], a[236:239], a[12:15], v[156:159]
  ds_read_b64_tr_b16 a[230:231], v21 offset:53504
  s_waitcnt lgkmcnt(8)
  v_mfma_f32_16x16x32_bf16 v[160:163], a[240:243], a[8:11], v[160:163]
  ds_read_b64_tr_b16 a[232:233], v22 offset:49408
  v_mfma_f32_16x16x32_bf16 v[164:167], a[240:243], a[12:15], v[164:167]
  ds_read_b64_tr_b16 a[234:235], v22 offset:53504
  v_mfma_f32_16x16x32_bf16 v[168:171], a[244:247], a[8:11], v[168:171]
  ds_read_b64_tr_b16 a[236:237], v23 offset:49408
  ds_read_b32 v3, v2 offset:2048
  v_mfma_f32_16x16x32_bf16 v[172:175], a[244:247], a[12:15], v[172:175]
  ds_read_b64_tr_b16 a[238:239], v23 offset:53504
  s_waitcnt lgkmcnt(9)
  v_mfma_f32_16x16x32_bf16 v[176:179], a[248:251], a[8:11], v[176:179]
  ds_read_b64_tr_b16 a[240:241], v24 offset:49408
  v_mfma_f32_16x16x32_bf16 v[180:183], a[248:251], a[12:15], v[180:183]
  ds_read_b64_tr_b16 a[242:243], v24 offset:53504
  v_mfma_f32_16x16x32_bf16 v[184:187], a[252:255], a[8:11], v[184:187]
  ds_read_b64_tr_b16 a[244:245], v25 offset:49408
  v_mfma_f32_16x16x32_bf16 v[188:191], a[252:255], a[12:15], v[188:191]
  ds_read_b64_tr_b16 a[246:247], v25 offset:53504
  s_waitcnt lgkmcnt(9)
  v_mfma_f32_16x16x32_bf16 v[192:195], a[224:227], a[8:11], v[192:195]
  ds_read_b64_tr_b16 a[248:249], v26 offset:49408
  v_mfma_f32_16x16x32_bf16 v[196:199], a[224:227], a[12:15], v[196:199]
  ds_read_b64_tr_b16 a[250:251], v26 offset:53504
  v_mfma_f32_16x16x32_bf16 v[200:203], a[228:231], a[8:11], v[200:203]
  ds_read_b64_tr_b16 a[252:253], v27 offset:49408
  s_waitcnt lgkmcnt(8)
  v_cmp_le_u32 vcc, 0xb003000b, v3
  v_mfma_f32_16x16x32_bf16 v[204:207], a[228:231], a[12:15], v[204:207]
  ds_read_b64_tr_b16 a[254:255], v27 offset:53504
  s_waitcnt lgkmcnt(8)
  v_mfma_f32_16x16x32_bf16 v[208:211], a[232:235], a[8:11], v[208:211]
  ds_add_u32 v1, v4
  s_cbranch_vccz L_csQ_10
L_cbQ_10:
  v_add_u32 v20, 65536, v20
  ds_read_b64_tr_b16 a[224:225], v20 offset:0
  v_mfma_f32_16x16x32_bf16 v[212:215], a[232:235], a[12:15], v[212:215]
  ds_read_b64_tr_b16 a[226:227], v20 offset:4096
  ds_read_b128 a[16:19], v28 offset:4096
  v_mfma_f32_16x16x32_bf16 v[216:219], a[236:239], a[8:11], v[216:219]
  v_add_u32 v21, 65536, v21
  ds_read_b64_tr_b16 a[228:229], v21 offset:0
  ds_read_b128 a[20:23], v28 offset:6144
  v_mfma_f32_16x16x32_bf16 v[220:223], a[236:239], a[12:15], v[220:223]
  s_waitcnt lgkmcnt(13)
  ds_read_b64_tr_b16 a[230:231], v21 offset:4096
  s_waitcnt lgkmcnt(11)
  v_mfma_f32_16x16x32_bf16 v[224:227], a[240:243], a[8:11], v[224:227]
  v_add_u32 v22, 65536, v22
  ds_read_b64_tr_b16 a[232:233], v22 offset:0
  ds_read_b128 a[24:27], v29 offset:4096
  v_mfma_f32_16x16x32_bf16 v[228:231], a[240:243], a[12:15], v[228:231]
  ds_read_b64_tr_b16 a[234:235], v22 offset:4096
  s_waitcnt lgkmcnt(13)
  ds_read_b128 a[28:31], v29 offset:6144
  v_mfma_f32_16x16x32_bf16 v[232:235], a[244:247], a[8:11], v[232:235]
  v_add_u32 v23, 65536, v23
  s_waitcnt lgkmcnt(13)
  ds_read_b64_tr_b16 a[236:237], v23 offset:0
  v_mfma_f32_16x16x32_bf16 v[236:239], a[244:247], a[12:15], v[236:239]
  s_waitcnt lgkmcnt(13)
  ds_read_b64_tr_b16 a[238:239], v23 offset:4096
  s_waitcnt lgkmcnt(13)
  v_mfma_f32_16x16x32_bf16 v[240:243], a[248:251], a[8:11], v[240:243]
  v_add_u32 v24, 65536, v24
  ds_read_b64_tr_b16 a[240:241], v24 offset:0
  v_mfma_f32_16x16x32_bf16 v[244:247], a[248:251], a[12:15], v[244:247]
  s_waitcnt lgkmcnt(13)
  ds_read_b64_tr_b16 a[242:243], v24 offset:4096
  v_mfma_f32_16x16x32_bf16 v[248:251], a[252:255], a[8:11], v[248:251]
  v_add_u32 v25, 65536, v25
  s_waitcnt lgkmcnt(13)
  ds_read_b64_tr_b16 a[244:245], v25 offset:0
  v_mfma_f32_16x16x32_bf16 v[252:255], a[252:255], a[12:15], v[252:255]
  s_waitcnt lgkmcnt(13)
  ds_read_b64_tr_b16 a[246:247], v25 offset:4096
  s_waitcnt lgkmcnt(10)
  v_mfma_f32_16x16x32_bf16 v[128:131], a[224:227], a[16:19], v[128:131]
  v_add_u32 v26, 65536, v26
  ds_read_b64_tr_b16 a[248:249], v26 offset:0
  v_mfma_f32_16x16x32_bf16 v[132:135], a[224:227], a[20:23], v[132:135]
  ds_read_b64_tr_b16 a[250:251], v26 offset:4096
  s_cmp_eq_u32 s88, 0
  s_cbranch_scc1 L_nr
  s_lshr_b32 s3, s56, 2
  s_lshl_b32 s3, s3, 1
  s_add_u32 s3, s3, s57
  s_lshl_b32 s3, s3, 2
  s_and_b32 s20, s56, 3
  s_add_u32 s3, s3, s20
  s_lshl_b32 s3, s3, 4
  v_lshl_add_u32 v19, v0, 8, s3
  s_waitcnt vmcnt(0)
  buffer_store_dword v4, v19, s[28:31], 0 offen sc1
L_nr:
  v_mfma_f32_16x16x32_bf16 v[136:139], a[228:231], a[16:19], v[136:139]
  v_add_u32 v27, 65536, v27
  ds_read_b64_tr_b16 a[252:253], v27 offset:0
  v_mfma_f32_16x16x32_bf16 v[140:143], a[228:231], a[20:23], v[140:143]
  ds_read_b64_tr_b16 a[254:255], v27 offset:4096
  s_waitcnt lgkmcnt(8)
  v_mfma_f32_16x16x32_bf16 v[144:147], a[232:235], a[16:19], v[144:147]
  ds_read_b64_tr_b16 a[224:225], v20 offset:256
  v_mfma_f32_16x16x32_bf16 v[148:151], a[232:235], a[20:23], v[148:151]
  ds_read_b64_tr_b16 a[226:227], v20 offset:4352
  v_mfma_f32_16x16x32_bf16 v[152:155], a[236:239], a[16:19], v[152:155]
  ds_read_b64_tr_b16 a[228:229], v21 offset:256
  v_mfma_f32_16x16x32_bf16 v[156:159], a[236:239], a[20:23], v[156:159]
  ds_read_b64_tr_b16 a[230:231], v21 offset:4352
  s_waitcnt lgkmcnt(8)
  v_mfma_f32_16x16x32_bf16 v[160:163], a[240:243], a[16:19], v[160:163]
  ds_read_b64_tr_b16 a[232:233], v22 offset:256
  v_mfma_f32_16x16x32_bf16 v[164:167], a[240:243], a[20:23], v[164:167]
  ds_read_b64_tr_b16 a[234:235], v22 offset:4352
  v_mfma_f32_16x16x32_bf16 v[168:171], a[244:247], a[16:19], v[168:171]
  ds_read_b64_tr_b16 a[236:237], v23 offset:256
  ds_read_b32 v3, v2 offset:2048
  v_mfma_f32_16x16x32_bf16 v[172:175], a[244:247], a[20:23], v[172:175]
  ds_read_b64_tr_b16 a[238:239], v23 offset:4352
  s_waitcnt lgkmcnt(9)
  v_mfma_f32_16x16x32_bf16 v[176:179], a[248:251], a[16:19], v[176:179]
  ds_read_b64_tr_b16 a[240:241], v24 offset:256
  v_mfma_f32_16x16x32_bf16 v[180:183], a[248:251], a[20:23], v[180:183]
  ds_read_b64_tr_b16 a[242:243], v24 offset:4352
  v_mfma_f32_16x16x32_bf16 v[184:187], a[252:255], a[16:19], v[184:187]
  ds_read_b64_tr_b16 a[244:245], v25 offset:256
  v_mfma_f32_16x16x32_bf16 v[188:191], a[252:255], a[20:23], v[188:191]
  ds_read_b64_tr_b16 a[246:247], v25 offset:4352
  s_waitcnt lgkmcnt(9)
  v_mfma_f32_16x16x32_bf16 v[192:195], a[224:227], a[16:19], v[192:195]
  ds_read_b64_tr_b16 a[248:249], v26 offset:256
  v_mfma_f32_16x16x32_bf16 v[196:199], a[224:227], a[20:23], v[196:199]
  ds_read_b64_tr_b16 a[250:251], v26 offset:4352
  v_mfma_f32_16x16x32_bf16 v[200:203], a[228:231], a[16:19], v[200:203]
  ds_read_b64_tr_b16 a[252:253], v27 offset:256
  s_waitcnt lgkmcnt(8)
  v_cmp_le_u32 vcc, 0xb003000c, v3
  v_mfma_f32_16x16x32_bf16 v[204:207], a[228:231], a[20:23], v[204:207]
  ds_read_b64_tr_b16 a[254:255], v27 offset:4352
  s_waitcnt lgkmcnt(8)
  v_mfma_f32_16x16x32_bf16 v[208:211], a[232:235], a[16:19], v[208:211]
  ds_add_u32 v1, v4
  s_cbranch_vccz L_csQ_11
L_cbQ_11:
  ds_read_b64_tr_b16 a[224:225], v20 offset:16384
  v_mfma_f32_16x16x32_bf16 v[212:215], a[232:235], a[20:23], v[212:215]
  ds_read_b64_tr_b16 a[226:227], v20 offset:20480
  v_mfma_f32_16x16x32_bf16 v[216:219], a[236:239], a[16:19], v[216:219]
  ds_read_b64_tr_b16 a[228:229], v21 offset:16384
  v_mfma_f32_16x16x32_bf16 v[220:223], a[236:239], a[20:23], v[220:223]
  ds_read_b64_tr_b16 a[230:231], v21 offset:20480
  s_waitcnt lgkmcnt(9)
  v_mfma_f32_16x16x32_bf16 v[224:227], a[240:243], a[16:19], v[224:227]
  ds_read_b64_tr_b16 a[232:233], v22 offset:16384
  v_mfma_f32_16x16x32_bf16 v[228:231], a[240:243], a[20:23], v[228:231]
  ds_read_b64_tr_b16 a[234:235], v22 offset:20480
  v_mfma_f32_16x16x32_bf16 v[232:235], a[244:247], a[16:19], v[232:235]
  ds_read_b64_tr_b16 a[236:237], v23 offset:16384
  v_mfma_f32_16x16x32_bf16 v[236:239], a[244:247], a[20:23], v[236:239]
  ds_read_b64_tr_b16 a[238:239], v23 offset:20480
  s_waitcnt lgkmcnt(9)
  v_mfma_f32_16x16x32_bf16 v[240:243], a[248:251], a[16:19], v[240:243]
  ds_read_b64_tr_b16 a[240:241], v24 offset:16384
  v_mfma_f32_16x16x32_bf16 v[244:247], a[248:251], a[20:23], v[244:247]
  ds_read_b64_tr_b16 a[242:243], v24 offset:20480
  v_mfma_f32_16x16x32_bf16 v[248:251], a[252:255], a[16:19], v[248:251]
  ds_read_b64_tr_b16 a[244:245], v25 offset:16384
  v_mfma_f32_16x16x32_bf16 v[252:255], a[252:255], a[20:23], v[252:255]
  ds_read_b64_tr_b16 a[246:247], v25 offset:20480
  s_waitcnt lgkmcnt(8)
  v_mfma_f32_16x16x32_bf16 v[128:131], a[224:227], a[24:27], v[128:131]
  ds_read_b64_tr_b16 a[248:249], v26 offset:16384
  v_mfma_f32_16x16x32_bf16 v[132:135], a[224:227], a[28:31], v[132:135]
  ds_read_b64_tr_b16 a[250:251], v26 offset:20480
  v_mfma_f32_16x16x32_bf16 v[136:139], a[228:231], a[24:27], v[136:139]
  ds_read_b64_tr_b16 a[252:253], v27 offset:16384
  v_mfma_f32_16x16x32_bf16 v[140:143], a[228:231], a[28:31], v[140:143]
  ds_read_b64_tr_b16 a[254:255], v27 offset:20480
  s_waitcnt lgkmcnt(8)
  v_mfma_f32_16x16x32_bf16 v[144:147], a[232:235], a[24:27], v[144:147]
  ds_read_b64_tr_b16 a[224:225], v20 offset:16640
  v_mfma_f32_16x16x32_bf16 v[148:151], a[232:235], a[28:31], v[148:151]
  ds_read_b64_tr_b16 a[226:227], v20 offset:20736
  v_mfma_f32_16x16x32_bf16 v[152:155], a[236:239], a[24:27], v[152:155]
  ds_read_b64_tr_b16 a[228:229], v21 offset:16640
  v_mfma_f32_16x16x32_bf16 v[156:159], a[236:239], a[28:31], v[156:159]
  ds_read_b64_tr_b16 a[230:231], v21 offset:20736
  s_waitcnt lgkmcnt(8)
  v_mfma_f32_16x16x32_bf16 v[160:163], a[240:243], a[24:27], v[160:163]
  ds_read_b64_tr_b16 a[232:233], v22 offset:16640
  v_mfma_f32_16x16x32_bf16 v[164:167], a[240:243], a[28:31], v[164:167]
  ds_read_b64_tr_b16 a[234:235], v22 offset:20736
  v_mfma_f32_16x16x32_bf16 v[168:171], a[244:247], a[24:27], v[168:171]
  ds_read_b64_tr_b16 a[236:237], v23 offset:16640
  ds_read_b32 v3, v2 offset:2048
  v_mfma_f32_16x16x32_bf16 v[172:175], a[244:247], a[28:31], v[172:175]
  ds_read_b64_tr_b16 a[238:239], v23 offset:20736
  s_waitcnt lgkmcnt(9)
  v_mfma_f32_16x16x32_bf16 v[176:179], a[248:251], a[24:27], v[176:179]
  ds_read_b64_tr_b16 a[240:241], v24 offset:16640
  v_mfma_f32_16x16x32_bf16 v[180:183], a[248:251], a[28:31], v[180:183]
  ds_read_b64_tr_b16 a[242:243], v24 offset:20736
  v_mfma_f32_16x16x32_bf16 v[184:187], a[252:255], a[24:27], v[184:187]
  ds_read_b64_tr_b16 a[244:245], v25 offset:16640
  v_mfma_f32_16x16x32_bf16 v[188:191], a[252:255], a[28:31], v[188:191]
  ds_read_b64_tr_b16 a[246:247], v25 offset:20736
  s_waitcnt lgkmcnt(9)
  v_mfma_f32_16x16x32_bf16 v[192:195], a[224:227], a[24:27], v[192:195]
  ds_read_b64_tr_b16 a[248:249], v26 offset:16640
  v_mfma_f32_16x16x32_bf16 v[196:199], a[224:227], a[28:31], v[196:199]
  ds_read_b64_tr_b16 a[250:251], v26 offset:20736
  v_mfma_f32_16x16x32_bf16 v[200:203], a[228:231], a[24:27], v[200:203]
  ds_read_b64_tr_b16 a[252:253], v27 offset:16640
  s_waitcnt lgkmcnt(8)
  v_cmp_le_u32 vcc, 0xb003000d, v3
  v_mfma_f32_16x16x32_bf16 v[204:207], a[228:231], a[28:31], v[204:207]
  ds_read_b64_tr_b16 a[254:255], v27 offset:20736
  s_waitcnt lgkmcnt(8)
  v_mfma_f32_16x16x32_bf16 v[208:211], a[232:235], a[24:27], v[208:211]
  ds_add_u32 v1, v4
  s_cbranch_vccz L_csQ_12
L_cbQ_12:
  v_subrev_u32 v20, 65536, v20
  ds_read_b64_tr_b16 a[224:225], v20 offset:0
  v_mfma_f32_16x16x32_bf16 v[212:215], a[232:235], a[28:31], v[212:215]
  ds_read_b64_tr_b16 a[226:227], v20 offset:4096
  v_subrev_u32 v28, 65536, v28
  ds_read_b128 a[0:3], v28 offset:45056
  v_mfma_f32_16x16x32_bf16 v[216:219], a[236:239], a[24:27], v[216:219]
  v_subrev_u32 v21, 65536, v21
  ds_read_b64_tr_b16 a[228:229], v21 offset:0
  ds_read_b128 a[4:7], v28 offset:47104
  v_mfma_f32_16x16x32_bf16 v[220:223], a[236:239], a[28:31], v[220:223]
  s_waitcnt lgkmcnt(13)
  ds_read_b64_tr_b16 a[230:231], v21 offset:4096
  s_waitcnt lgkmcnt(11)
  v_mfma_f32_16x16x32_bf16 v[224:227], a[240:243], a[24:27], v[224:227]
  v_subrev_u32 v22, 65536, v22
  ds_read_b64_tr_b16 a[232:233], v22 offset:0
  v_subrev_u32 v29, 65536, v29
  ds_read_b128 a[8:11], v29 offset:45056
  v_mfma_f32_16x16x32_bf16 v[228:231], a[240:243], a[28:31], v[228:231]
  ds_read_b64_tr_b16 a[234:235], v22 offset:4096
  s_waitcnt lgkmcnt(13)
  ds_read_b128 a[12:15], v29 offset:47104
  v_mfma_f32_16x16x32_bf16 v[232:235], a[244:247], a[24:27], v[232:235]
  v_subrev_u32 v23, 65536, v23
  s_waitcnt lgkmcnt(13)
  ds_read_b64_tr_b16 a[236:237], v23 offset:0
  v_mfma_f32_16x16x32_bf16 v[236:239], a[244:247], a[28:31], v[236:239]
  s_waitcnt lgkmcnt(13)
  ds_read_b64_tr_b16 a[238:239], v23 offset:4096
  s_waitcnt lgkmcnt(13)
  v_mfma_f32_16x16x32_bf16 v[240:243], a[248:251], a[24:27], v[240:243]
  v_subrev_u32 v24, 65536, v24
  ds_read_b64_tr_b16 a[240:241], v24 offset:0
  v_mfma_f32_16x16x32_bf16 v[244:247], a[248:251], a[28:31], v[244:247]
  s_waitcnt lgkmcnt(13)
  ds_read_b64_tr_b16 a[242:243], v24 offset:4096
  v_mfma_f32_16x16x32_bf16 v[248:251], a[252:255], a[24:27], v[248:251]
  v_subrev_u32 v25, 65536, v25
  s_waitcnt lgkmcnt(13)
  ds_read_b64_tr_b16 a[244:245], v25 offset:0
  v_mfma_f32_16x16x32_bf16 v[252:255], a[252:255], a[28:31], v[252:255]
  s_waitcnt lgkmcnt(13)
  ds_read_b64_tr_b16 a[246:247], v25 offset:4096
  s_waitcnt lgkmcnt(10)
  v_mfma_f32_16x16x32_bf16 v[128:131], a[224:227], a[0:3], v[128:131]
  v_subrev_u32 v26, 65536, v26
  ds_read_b64_tr_b16 a[248:249], v26 offset:0
  v_mfma_f32_16x16x32_bf16 v[132:135], a[224:227], a[4:7], v[132:135]
  ds_read_b64_tr_b16 a[250:251], v26 offset:4096
  v_mfma_f32_16x16x32_bf16 v[136:139], a[228:231], a[0:3], v[136:139]
  v_subrev_u32 v27, 65536, v27
  ds_read_b64_tr_b16 a[252:253], v27 offset:0
  v_mfma_f32_16x16x32_bf16 v[140:143], a[228:231], a[4:7], v[140:143]
  ds_read_b64_tr_b16 a[254:255], v27 offset:4096
  s_waitcnt lgkmcnt(8)
  v_mfma_f32_16x16x32_bf16 v[144:147], a[232:235], a[0:3], v[144:147]
  ds_read_b64_tr_b16 a[224:225], v20 offset:256
  v_mfma_f32_16x16x32_bf16 v[148:151], a[232:235], a[4:7], v[148:151]
  ds_read_b64_tr_b16 a[226:227], v20 offset:4352
  v_mfma_f32_16x16x32_bf16 v[152:155], a[236:239], a[0:3], v[152:155]
  ds_read_b64_tr_b16 a[228:229], v21 offset:256
  v_mfma_f32_16x16x32_bf16 v[156:159], a[236:239], a[4:7], v[156:159]
  ds_read_b64_tr_b16 a[230:231], v21 offset:4352
  s_waitcnt lgkmcnt(8)
  v_mfma_f32_16x16x32_bf16 v[160:163], a[240:243], a[0:3], v[160:163]
  ds_read_b64_tr_b16 a[232:233], v22 offset:256
  v_mfma_f32_16x16x32_bf16 v[164:167], a[240:243], a[4:7], v[164:167]
  ds_read_b64_tr_b16 a[234:235], v22 offset:4352
  v_mfma_f32_16x16x32_bf16 v[168:171], a[244:247], a[0:3], v[168:171]
  ds_read_b64_tr_b16 a[236:237], v23 offset:256
  ds_read_b32 v3, v2 offset:2048
  v_mfma_f32_16x16x32_bf16 v[172:175], a[244:247], a[4:7], v[172:175]
  ds_read_b64_tr_b16 a[238:239], v23 offset:4352
  s_waitcnt lgkmcnt(9)
  v_mfma_f32_16x16x32_bf16 v[176:179], a[248:251], a[0:3], v[176:179]
  ds_read_b64_tr_b16 a[240:241], v24 offset:256
  v_mfma_f32_16x16x32_bf16 v[180:183], a[248:251], a[4:7], v[180:183]
  ds_read_b64_tr_b16 a[242:243], v24 offset:4352
  v_mfma_f32_16x16x32_bf16 v[184:187], a[252:255], a[0:3], v[184:187]
  ds_read_b64_tr_b16 a[244:245], v25 offset:256
  v_mfma_f32_16x16x32_bf16 v[188:191], a[252:255], a[4:7], v[188:191]
  ds_read_b64_tr_b16 a[246:247], v25 offset:4352
  s_waitcnt lgkmcnt(9)
  v_mfma_f32_16x16x32_bf16 v[192:195], a[224:227], a[0:3], v[192:195]
  ds_read_b64_tr_b16 a[248:249], v26 offset:256
  v_mfma_f32_16x16x32_bf16 v[196:199], a[224:227], a[4:7], v[196:199]
  ds_read_b64_tr_b16 a[250:251], v26 offset:4352
  v_mfma_f32_16x16x32_bf16 v[200:203], a[228:231], a[0:3], v[200:203]
  ds_read_b64_tr_b16 a[252:253], v27 offset:256
  s_waitcnt lgkmcnt(8)
  v_cmp_le_u32 vcc, 0xb003000e, v3
  v_mfma_f32_16x16x32_bf16 v[204:207], a[228:231], a[4:7], v[204:207]
  ds_read_b64_tr_b16 a[254:255], v27 offset:4352
  s_waitcnt lgkmcnt(8)
  v_mfma_f32_16x16x32_bf16 v[208:211], a[232:235], a[0:3], v[208:211]
  ds_add_u32 v1, v4
  s_cbranch_vccz L_csQ_13
L_cbQ_13:
  ds_read_b64_tr_b16 a[224:225], v20 offset:16384
  v_mfma_f32_16x16x32_bf16 v[212:215], a[232:235], a[4:7], v[212:215]
  ds_read_b64_tr_b16 a[226:227], v20 offset:20480
  v_mfma_f32_16x16x32_bf16 v[216:219], a[236:239], a[0:3], v[216:219]
  ds_read_b64_tr_b16 a[228:229], v21 offset:16384
  v_mfma_f32_16x16x32_bf16 v[220:223], a[236:239], a[4:7], v[220:223]
  ds_read_b64_tr_b16 a[230:231], v21 offset:20480
  s_waitcnt lgkmcnt(9)
  v_mfma_f32_16x16x32_bf16 v[224:227], a[240:243], a[0:3], v[224:227]
  ds_read_b64_tr_b16 a[232:233], v22 offset:16384
  v_mfma_f32_16x16x32_bf16 v[228:231], a[240:243], a[4:7], v[228:231]
  ds_read_b64_tr_b16 a[234:235], v22 offset:20480
  v_mfma_f32_16x16x32_bf16 v[232:235], a[244:247], a[0:3], v[232:235]
  ds_read_b64_tr_b16 a[236:237], v23 offset:16384
  v_mfma_f32_16x16x32_bf16 v[236:239], a[244:247], a[4:7], v[236:239]
  ds_read_b64_tr_b16 a[238:239], v23 offset:20480
  s_waitcnt lgkmcnt(9)
  v_mfma_f32_16x16x32_bf16 v[240:243], a[248:251], a[0:3], v[240:243]
  ds_read_b64_tr_b16 a[240:241], v24 offset:16384
  v_mfma_f32_16x16x32_bf16 v[244:247], a[248:251], a[4:7], v[244:247]
  ds_read_b64_tr_b16 a[242:243], v24 offset:20480
  v_mfma_f32_16x16x32_bf16 v[248:251], a[252:255], a[0:3], v[248:251]
  ds_read_b64_tr_b16 a[244:245], v25 offset:16384
  v_mfma_f32_16x16x32_bf16 v[252:255], a[252:255], a[4:7], v[252:255]
  ds_read_b64_tr_b16 a[246:247], v25 offset:20480
  s_waitcnt lgkmcnt(8)
  v_mfma_f32_16x16x32_bf16 v[128:131], a[224:227], a[8:11], v[128:131]
  ds_read_b64_tr_b16 a[248:249], v26 offset:16384
  v_mfma_f32_16x16x32_bf16 v[132:135], a[224:227], a[12:15], v[132:135]
  ds_read_b64_tr_b16 a[250:251], v26 offset:20480
  v_mfma_f32_16x16x32_bf16 v[136:139], a[228:231], a[8:11], v[136:139]
  ds_read_b64_tr_b16 a[252:253], v27 offset:16384
  v_mfma_f32_16x16x32_bf16 v[140:143], a[228:231], a[12:15], v[140:143]
  ds_read_b64_tr_b16 a[254:255], v27 offset:20480
  s_waitcnt lgkmcnt(8)
  v_mfma_f32_16x16x32_bf16 v[144:147], a[232:235], a[8:11], v[144:147]
  ds_read_b64_tr_b16 a[224:225], v20 offset:16640
  v_mfma_f32_16x16x32_bf16 v[148:151], a[232:235], a[12:15], v[148:151]
  ds_read_b64_tr_b16 a[226:227], v20 offset:20736
  v_mfma_f32_16x16x32_bf16 v[152:155], a[236:239], a[8:11], v[152:155]
  ds_read_b64_tr_b16 a[228:229], v21 offset:16640
  v_mfma_f32_16x16x32_bf16 v[156:159], a[236:239], a[12:15], v[156:159]
  ds_read_b64_tr_b16 a[230:231], v21 offset:20736
  v_cvt_pk_bf16_f32 v64, v128, v129
  v_cvt_pk_bf16_f32 v65, v130, v131
  s_waitcnt lgkmcnt(8)
  v_mfma_f32_16x16x32_bf16 v[160:163], a[240:243], a[8:11], v[160:163]
  ds_read_b64_tr_b16 a[232:233], v22 offset:16640
  v_cvt_pk_bf16_f32 v66, v136, v137
  v_cvt_pk_bf16_f32 v67, v138, v139
  v_mfma_f32_16x16x32_bf16 v[164:167], a[240:243], a[12:15], v[164:167]
  ds_read_b64_tr_b16 a[234:235], v22 offset:20736
  v_cvt_pk_bf16_f32 v68, v132, v133
  v_cvt_pk_bf16_f32 v69, v134, v135
  v_cvt_pk_bf16_f32 v70, v140, v141
  v_mfma_f32_16x16x32_bf16 v[168:171], a[244:247], a[8:11], v[168:171]
  ds_read_b64_tr_b16 a[236:237], v23 offset:16640
  ds_read_b32 v3, v2 offset:2048
  v_cvt_pk_bf16_f32 v71, v142, v143
  v_mfma_f32_16x16x32_bf16 v[172:175], a[244:247], a[12:15], v[172:175]
  ds_read_b64_tr_b16 a[238:239], v23 offset:20736
  v_permlane16_swap_b32 v64, v66
  v_permlane16_swap_b32 v65, v67
  s_waitcnt lgkmcnt(9)
  v_mfma_f32_16x16x32_bf16 v[176:179], a[248:251], a[8:11], v[176:179]
  ds_read_b64_tr_b16 a[240:241], v24 offset:16640
  v_permlane16_swap_b32 v68, v70
  v_permlane16_swap_b32 v69, v71
  v_cvt_pk_bf16_f32 v72, v144, v145
  v_mfma_f32_16x16x32_bf16 v[180:183], a[248:251], a[12:15], v[180:183]
  ds_read_b64_tr_b16 a[242:243], v24 offset:20736
  v_cvt_pk_bf16_f32 v73, v146, v147
  v_cvt_pk_bf16_f32 v74, v152, v153
  v_cvt_pk_bf16_f32 v75, v154, v155
  v_mfma_f32_16x16x32_bf16 v[184:187], a[252:255], a[8:11], v[184:187]
  ds_read_b64_tr_b16 a[244:245], v25 offset:16640
  v_cvt_pk_bf16_f32 v76, v148, v149
  v_cvt_pk_bf16_f32 v77, v150, v151
  v_cvt_pk_bf16_f32 v78, v156, v157
  v_mfma_f32_16x16x32_bf16 v[188:191], a[252:255], a[12:15], v[188:191]
  ds_read_b64_tr_b16 a[246:247], v25 offset:20736
  v_cvt_pk_bf16_f32 v79, v158, v159
  v_permlane16_swap_b32 v72, v74
  v_cvt_pk_bf16_f32 v80, v160, v161
  s_waitcnt lgkmcnt(9)
  v_mfma_f32_16x16x32_bf16 v[192:195], a[224:227], a[8:11], v[192:195]
  ds_read_b64_tr_b16 a[248:249], v26 offset:16640
  v_permlane16_swap_b32 v73, v75
  v_permlane16_swap_b32 v76, v78
  v_permlane16_swap_b32 v77, v79
  v_cvt_pk_bf16_f32 v81, v162, v163
  v_mfma_f32_16x16x32_bf16 v[196:199], a[224:227], a[12:15], v[196:199]
  ds_read_b64_tr_b16 a[250:251], v26 offset:20736
  v_cvt_pk_bf16_f32 v82, v168, v169
  v_cvt_pk_bf16_f32 v83, v170, v171
  v_cvt_pk_bf16_f32 v84, v164, v165
  v_cvt_pk_bf16_f32 v85, v166, v167
  v_mfma_f32_16x16x32_bf16 v[200:203], a[228:231], a[8:11], v[200:203]
  ds_read_b64_tr_b16 a[252:253], v27 offset:16640
  s_waitcnt lgkmcnt(8)
  v_cmp_le_u32 vcc, 0xb003000f, v3
  v_cvt_pk_bf16_f32 v86, v172, v173
  v_cvt_pk_bf16_f32 v87, v174, v175
  v_mfma_f32_16x16x32_bf16 v[204:207], a[228:231], a[12:15], v[204:207]
  ds_read_b64_tr_b16 a[254:255], v27 offset:20736
  v_permlane16_swap_b32 v80, v82
  v_permlane16_swap_b32 v81, v83
  v_permlane16_swap_b32 v84, v86
  s_waitcnt lgkmcnt(8)
  v_mfma_f32_16x16x32_bf16 v[208:211], a[232:235], a[8:11], v[208:211]
  ds_add_u32 v1, v4
  s_cbranch_vccz L_csK_0
L_cbK_0:
  ds_read_b128 a[224:227], v8 offset:32768
  v_permlane16_swap_b32 v85, v87
  v_mfma_f32_16x16x32_bf16 v[212:215], a[232:235], a[12:15], v[212:215]
  v_cvt_pk_bf16_f32 v88, v176, v177
  v_cvt_pk_bf16_f32 v89, v178, v179
  v_cvt_pk_bf16_f32 v90, v184, v185
  v_cvt_pk_bf16_f32 v91, v186, v187
  v_mfma_f32_16x16x32_bf16 v[216:219], a[236:239], a[8:11], v[216:219]
  ds_read_b128 a[228:231], v8 offset:40960
  v_cvt_pk_bf16_f32 v92, v180, v181
  v_cvt_pk_bf16_f32 v93, v182, v183
  v_cvt_pk_bf16_f32 v94, v188, v189
  v_mfma_f32_16x16x32_bf16 v[220:223], a[236:239], a[12:15], v[220:223]
  v_cvt_pk_bf16_f32 v95, v190, v191
  v_permlane16_swap_b32 v88, v90
  v_permlane16_swap_b32 v89, v91
  s_waitcnt lgkmcnt(7)
  v_mfma_f32_16x16x32_bf16 v[224:227], a[240:243], a[8:11], v[224:227]
  ds_read_b128 a[232:235], v9 offset:32768
  v_permlane16_swap_b32 v92, v94
  v_permlane16_swap_b32 v93, v95
  v_cvt_pk_bf16_f32 v96, v192, v193
  v_mfma_f32_16x16x32_bf16 v[228:231], a[240:243], a[12:15], v[228:231]
  v_cvt_pk_bf16_f32 v97, v194, v195
  v_cvt_pk_bf16_f32 v98, v200, v201
  v_cvt_pk_bf16_f32 v99, v202, v203
  v_cvt_pk_bf16_f32 v100, v196, v197
  v_mfma_f32_16x16x32_bf16 v[232:235], a[244:247], a[8:11], v[232:235]
  ds_read_b128 a[236:239], v9 offset:40960
  v_cvt_pk_bf16_f32 v101, v198, v199
  v_cvt_pk_bf16_f32 v102, v204, v205
  v_mfma_f32_16x16x32_bf16 v[236:239], a[244:247], a[12:15], v[236:239]
  v_cvt_pk_bf16_f32 v103, v206, v207
  v_permlane16_swap_b32 v96, v98
  v_permlane16_swap_b32 v97, v99
  s_waitcnt lgkmcnt(5)
  v_mfma_f32_16x16x32_bf16 v[240:243], a[248:251], a[8:11], v[240:243]
  ds_read_b128 a[240:243], v10 offset:32768
  v_permlane16_swap_b32 v100, v102
  v_permlane16_swap_b32 v101, v103
  v_cvt_pk_bf16_f32 v104, v208, v209
  v_mfma_f32_16x16x32_bf16 v[244:247], a[248:251], a[12:15], v[244:247]
  v_cvt_pk_bf16_f32 v105, v210, v211
  v_cvt_pk_bf16_f32 v106, v216, v217
  v_cvt_pk_bf16_f32 v107, v218, v219
  v_cvt_pk_bf16_f32 v108, v212, v213
  v_mfma_f32_16x16x32_bf16 v[248:251], a[252:255], a[8:11], v[248:251]
  ds_read_b128 a[244:247], v10 offset:40960
  v_cvt_pk_bf16_f32 v109, v214, v215
  v_cvt_pk_bf16_f32 v110, v220, v221
  v_mfma_f32_16x16x32_bf16 v[252:255], a[252:255], a[12:15], v[252:255]
  v_cvt_pk_bf16_f32 v111, v222, v223
  v_permlane16_swap_b32 v104, v106
  v_permlane16_swap_b32 v105, v107
  s_waitcnt lgkmcnt(4)
  v_mfma_f32_16x16x32_bf16 v[32:35], a[224:227], v[64:67], 0
  ds_read_b128 a[248:251], v11 offset:32768
  v_permlane16_swap_b32 v108, v110
  v_permlane16_swap_b32 v109, v111
  v_cvt_pk_bf16_f32 v112, v224, v225
  v_mfma_f32_16x16x32_bf16 v[40:43], a[224:227], v[68:71], 0
  v_cvt_pk_bf16_f32 v113, v226, v227
  v_cvt_pk_bf16_f32 v114, v232, v233
  v_cvt_pk_bf16_f32 v115, v234, v235
  v_cvt_pk_bf16_f32 v116, v228, v229
  v_mfma_f32_16x16x32_bf16 v[36:39], a[228:231], v[64:67], 0
  ds_read_b128 a[252:255], v11 offset:40960
  v_cvt_pk_bf16_f32 v117, v230, v231
  v_cvt_pk_bf16_f32 v118, v236, v237
  v_mfma_f32_16x16x32_bf16 v[44:47], a[228:231], v[68:71], 0
  v_cvt_pk_bf16_f32 v119, v238, v239
  v_permlane16_swap_b32 v112, v114
  v_permlane16_swap_b32 v113, v115
  s_waitcnt lgkmcnt(4)
  v_mfma_f32_16x16x32_bf16 v[32:35], a[232:235], v[72:75], v[32:35]
  ds_read_b128 a[224:227], v8 offset:33024
  v_permlane16_swap_b32 v116, v118
  v_permlane16_swap_b32 v117, v119
  v_cvt_pk_bf16_f32 v120, v240, v241
  v_mfma_f32_16x16x32_bf16 v[40:43], a[232:235], v[76:79], v[40:43]
  v_cvt_pk_bf16_f32 v121, v242, v243
  v_cvt_pk_bf16_f32 v122, v248, v249
  v_cvt_pk_bf16_f32 v123, v250, v251
  v_cvt_pk_bf16_f32 v124, v244, v245
  v_mfma_f32_16x16x32_bf16 v[36:39], a[236:239], v[72:75], v[36:39]
  ds_read_b128 a[228:231], v8 offset:41216
  v_cvt_pk_bf16_f32 v125, v246, v247
  v_cvt_pk_bf16_f32 v126, v252, v253
  v_mfma_f32_16x16x32_bf16 v[44:47], a[236:239], v[76:79], v[44:47]
  v_cvt_pk_bf16_f32 v127, v254, v255
  v_permlane16_swap_b32 v120, v122
  v_permlane16_swap_b32 v121, v123
  s_waitcnt lgkmcnt(4)
  v_mfma_f32_16x16x32_bf16 v[32:35], a[240:243], v[80:83], v[32:35]
  ds_read_b128 a[232:235], v9 offset:33024
  v_permlane16_swap_b32 v124, v126
  v_permlane16_swap_b32 v125, v127
  v_mfma_f32_16x16x32_bf16 v[40:43], a[240:243], v[84:87], v[40:43]
  v_mfma_f32_16x16x32_bf16 v[36:39], a[244:247], v[80:83], v[36:39]
  ds_read_b128 a[236:239], v9 offset:41216
  ds_read_b32 v3, v2 offset:2048
  v_mfma_f32_16x16x32_bf16 v[44:47], a[244:247], v[84:87], v[44:47]
  s_waitcnt lgkmcnt(5)
  v_mfma_f32_16x16x32_bf16 v[32:35], a[248:251], v[88:91], v[32:35]
  ds_read_b128 a[240:243], v10 offset:33024
  v_mfma_f32_16x16x32_bf16 v[40:43], a[248:251], v[92:95], v[40:43]
  v_mfma_f32_16x16x32_bf16 v[36:39], a[252:255], v[88:91], v[36:39]
  ds_read_b128 a[244:247], v10 offset:41216
  v_mfma_f32_16x16x32_bf16 v[44:47], a[252:255], v[92:95], v[44:47]
  s_waitcnt lgkmcnt(5)
  v_mfma_f32_16x16x32_bf16 v[32:35], a[224:227], v[96:99], v[32:35]
  ds_read_b128 a[248:251], v11 offset:33024
  v_mov_b32 v22, 0x3f803f80
  v_mfma_f32_16x16x32_bf16 v[40:43], a[224:227], v[100:103], v[40:43]
  v_mfma_f32_16x16x32_bf16 v[36:39], a[228:231], v[96:99], v[36:39]
  ds_read_b128 a[252:255], v11 offset:41216
  s_waitcnt lgkmcnt(4)
  v_cmp_le_u32 vcc, 0xb0030010, v3
  v_mfma_f32_16x16x32_bf16 v[44:47], a[228:231], v[100:103], v[44:47]
  v_accvgpr_write_b32 a96, v22
  v_mfma_f32_16x16x32_bf16 v[32:35], a[232:235], v[104:107], v[32:35]
  ds_add_u32 v1, v4
  s_cbranch_vccz L_csK_1
L_cbK_1:
  ds_read_b128 a[224:227], v8 offset:49152
  v_mfma_f32_16x16x32_bf16 v[40:43], a[232:235], v[108:111], v[40:43]
  v_mfma_f32_16x16x32_bf16 v[36:39], a[236:239], v[104:107], v[36:39]
  ds_read_b128 a[228:231], v8 offset:57344
  v_accvgpr_write_b32 a97, v22
  v_mfma_f32_16x16x32_bf16 v[44:47], a[236:239], v[108:111], v[44:47]
  s_waitcnt lgkmcnt(5)
  v_mfma_f32_16x16x32_bf16 v[32:35], a[240:243], v[112:115], v[32:35]
  ds_read_b128 a[232:235], v9 offset:49152
  v_mfma_f32_16x16x32_bf16 v[40:43], a[240:243], v[116:119], v[40:43]
  v_accvgpr_write_b32 a98, v22
  v_mfma_f32_16x16x32_bf16 v[36:39], a[244:247], v[112:115], v[36:39]
  ds_read_b128 a[236:239], v9 offset:57344
  v_mfma_f32_16x16x32_bf16 v[44:47], a[244:247], v[116:119], v[44:47]
  s_waitcnt lgkmcnt(5)
  v_mfma_f32_16x16x32_bf16 v[32:35], a[248:251], v[120:123], v[32:35]
  ds_read_b128 a[240:243], v10 offset:49152
  v_accvgpr_write_b32 a99, v22
  v_mfma_f32_16x16x32_bf16 v[40:43], a[248:251], v[124:127], v[40:43]
  v_mfma_f32_16x16x32_bf16 v[36:39], a[252:255], v[120:123], v[36:39]
  ds_read_b128 a[244:247], v10 offset:57344
  v_mfma_f32_16x16x32_bf16 v[44:47], a[252:255], v[124:127], v[44:47]
  s_waitcnt lgkmcnt(4)
  v_mfma_f32_16x16x32_bf16 v[48:51], a[224:227], v[64:67], 0
  ds_read_b128 a[248:251], v11 offset:49152
  v_mfma_f32_16x16x32_bf16 v[56:59], a[224:227], v[68:71], 0
  v_mfma_f32_16x16x32_bf16 v[52:55], a[228:231], v[64:67], 0
  ds_read_b128 a[252:255], v11 offset:57344
  v_mfma_f32_16x16x32_bf16 v[60:63], a[228:231], v[68:71], 0
  s_waitcnt lgkmcnt(4)
  v_mfma_f32_16x16x32_bf16 v[48:51], a[232:235], v[72:75], v[48:51]
  ds_read_b128 a[224:227], v8 offset:49408
  v_mfma_f32_16x16x32_bf16 v[56:59], a[232:235], v[76:79], v[56:59]
  v_max_f32 v20, v32, v33
  v_max_f32 v21, v40, v41
  v_max3_f32 v20, v20, v34, v35
  v_max3_f32 v21, v21, v42, v43
  v_mfma_f32_16x16x32_bf16 v[52:55], a[236:239], v[72:75], v[52:55]
  ds_read_b128 a[228:231], v8 offset:57600
  v_max3_f32 v20, v20, v36, v37
  v_max3_f32 v21, v21, v44, v45
  v_mfma_f32_16x16x32_bf16 v[60:63], a[236:239], v[76:79], v[60:63]
  v_max3_f32 v20, v20, v38, v39
  v_max3_f32 v21, v21, v46, v47
  v_mul_f32 v18, s68, v20
  s_waitcnt lgkmcnt(4)
  v_mfma_f32_16x16x32_bf16 v[48:51], a[240:243], v[80:83], v[48:51]
  ds_read_b128 a[232:235], v9 offset:49408
  v_mul_f32 v16, s68, v21
  v_floor_f32 v24, v18
  v_mfma_f32_16x16x32_bf16 v[56:59], a[240:243], v[84:87], v[56:59]
  v_floor_f32 v26, v16
  v_accvgpr_write_b32 a32, v24
  v_accvgpr_write_b32 a33, v26
  v_fma_f32 v32, v32, s67, v24
  v_mfma_f32_16x16x32_bf16 v[52:55], a[244:247], v[80:83], v[52:55]
  ds_read_b128 a[236:239], v9 offset:57600
  ds_read_b32 v3, v2 offset:1036
  v_fma_f32 v33, v33, s67, v24
  v_mfma_f32_16x16x32_bf16 v[60:63], a[244:247], v[84:87], v[60:63]
  v_fma_f32 v34, v34, s67, v24
  v_fma_f32 v35, v35, s67, v24
  v_exp_f32 v32, v32
  s_waitcnt lgkmcnt(5)
  v_mfma_f32_16x16x32_bf16 v[48:51], a[248:251], v[88:91], v[48:51]
  ds_read_b128 a[240:243], v10 offset:49408
  v_exp_f32 v33, v33
  v_mfma_f32_16x16x32_bf16 v[56:59], a[248:251], v[92:95], v[56:59]
  v_exp_f32 v34, v34
  v_exp_f32 v35, v35
  v_mfma_f32_16x16x32_bf16 v[52:55], a[252:255], v[88:91], v[52:55]
  ds_read_b128 a[244:247], v10 offset:57600
  v_fma_f32 v36, v36, s67, v24
  v_mfma_f32_16x16x32_bf16 v[60:63], a[252:255], v[92:95], v[60:63]
  v_fma_f32 v37, v37, s67, v24
  v_fma_f32 v38, v38, s67, v24
  v_fma_f32 v39, v39, s67, v24
  s_waitcnt lgkmcnt(5)
  v_mfma_f32_16x16x32_bf16 v[48:51], a[224:227], v[96:99], v[48:51]
  ds_read_b128 a[248:251], v11 offset:49408
  v_exp_f32 v36, v36
  v_mfma_f32_16x16x32_bf16 v[56:59], a[224:227], v[100:103], v[56:59]
  v_exp_f32 v37, v37
  v_exp_f32 v38, v38
  v_mfma_f32_16x16x32_bf16 v[52:55], a[228:231], v[96:99], v[52:55]
  ds_read_b128 a[252:255], v11 offset:57600
  s_waitcnt lgkmcnt(4)
  v_cmp_le_u32 vcc, 0x1, v3
  v_exp_f32 v39, v39
  v_mfma_f32_16x16x32_bf16 v[60:63], a[228:231], v[100:103], v[60:63]
  v_cvt_pk_bf16_f32 v128, v32, v33
  v_cvt_pk_bf16_f32 v129, v34, v35
  v_mfma_f32_16x16x32_bf16 v[48:51], a[232:235], v[104:107], v[48:51]
  ds_add_u32 v1, v4
  s_cbranch_vccz L_csK_2
L_cbK_2:
  v_add_u32 v8, 131072, v8
  ds_read_b128 a[224:227], v8 offset:4096
  v_mfma_f32_16x16x32_bf16 v[56:59], a[232:235], v[108:111], v[56:59]
  v_fma_f32 v40, v40, s67, v26
  v_fma_f32 v41, v41, s67, v26
  v_fma_f32 v42, v42, s67, v26
  v_fma_f32 v43, v43, s67, v26
  v_mfma_f32_16x16x32_bf16 v[52:55], a[236:239], v[104:107], v[52:55]
  ds_read_b128 a[228:231], v8 offset:12288
  v_exp_f32 v40, v40
  v_mfma_f32_16x16x32_bf16 v[60:63], a[236:239], v[108:111], v[60:63]
  v_exp_f32 v41, v41
  v_exp_f32 v42, v42
  s_waitcnt lgkmcnt(5)
  v_mfma_f32_16x16x32_bf16 v[48:51], a[240:243], v[112:115], v[48:51]
  v_add_u32 v9, 131072, v9
  ds_read_b128 a[232:235], v9 offset:4096
  v_exp_f32 v43, v43
  v_mfma_f32_16x16x32_bf16 v[56:59], a[240:243], v[116:119], v[56:59]
  v_cvt_pk_bf16_f32 v130, v36, v37
  v_cvt_pk_bf16_f32 v131, v38, v39
  v_fma_f32 v44, v44, s67, v26
  v_mfma_f32_16x16x32_bf16 v[52:55], a[244:247], v[112:115], v[52:55]
  ds_read_b128 a[236:239], v9 offset:12288
  v_fma_f32 v45, v45, s67, v26
  v_fma_f32 v46, v46, s67, v26
  v_mfma_f32_16x16x32_bf16 v[60:63], a[244:247], v[116:119], v[60:63]
  v_fma_f32 v47, v47, s67, v26
  v_exp_f32 v44, v44
  s_waitcnt lgkmcnt(5)
  v_mfma_f32_16x16x32_bf16 v[48:51], a[248:251], v[120:123], v[48:51]
  v_add_u32 v10, 131072, v10
  ds_read_b128 a[240:243], v10 offset:4096
  v_exp_f32 v45, v45
  v_mfma_f32_16x16x32_bf16 v[56:59], a[248:251], v[124:127], v[56:59]
  v_exp_f32 v46, v46
  v_exp_f32 v47, v47
  v_mfma_f32_16x16x32_bf16 v[52:55], a[252:255], v[120:123], v[52:55]
  ds_read_b128 a[244:247], v10 offset:12288
  v_cvt_pk_bf16_f32 v132, v40, v41
  v_cvt_pk_bf16_f32 v133, v42, v43
  v_mfma_f32_16x16x32_bf16 v[60:63], a[252:255], v[124:127], v[60:63]
  v_cvt_pk_bf16_f32 v134, v44, v45
  v_cvt_pk_bf16_f32 v135, v46, v47
  s_waitcnt lgkmcnt(4)
  v_mfma_f32_16x16x32_bf16 v[32:35], a[224:227], v[64:67], 0
  v_add_u32 v11, 131072, v11
  ds_read_b128 a[248:251], v11 offset:4096
  v_mfma_f32_16x16x32_bf16 v[40:43], a[224:227], v[68:71], 0
  v_mfma_f32_16x16x32_bf16 v[36:39], a[228:231], v[64:67], 0
  ds_read_b128 a[252:255], v11 offset:12288
  v_mfma_f32_16x16x32_bf16 v[44:47], a[228:231], v[68:71], 0
  s_waitcnt lgkmcnt(4)
  v_mfma_f32_16x16x32_bf16 v[32:35], a[232:235], v[72:75], v[32:35]
  ds_read_b128 a[224:227], v8 offset:4352
  v_mfma_f32_16x16x32_bf16 v[40:43], a[232:235], v[76:79], v[40:43]
  v_max3_f32 v20, v20, v48, v49
  v_max3_f32 v21, v21, v56, v57
  v_max3_f32 v20, v20, v50, v51
  v_max3_f32 v21, v21, v58, v59
  v_mfma_f32_16x16x32_bf16 v[36:39], a[236:239], v[72:75], v[36:39]
  ds_read_b128 a[228:231], v8 offset:12544
  v_max3_f32 v20, v20, v52, v53
  v_max3_f32 v21, v21, v60, v61
  v_mfma_f32_16x16x32_bf16 v[44:47], a[236:239], v[76:79], v[44:47]
  v_max3_f32 v20, v20, v54, v55
  v_max3_f32 v21, v21, v62, v63
  v_mul_f32 v18, s68, v20
  s_waitcnt lgkmcnt(4)
  v_mfma_f32_16x16x32_bf16 v[32:35], a[240:243], v[80:83], v[32:35]
  ds_read_b128 a[232:235], v9 offset:4352
  v_mul_f32 v16, s68, v21
  v_floor_f32 v25, v18
  v_mfma_f32_16x16x32_bf16 v[40:43], a[240:243], v[84:87], v[40:43]
  v_floor_f32 v27, v16
  v_accvgpr_write_b32 a34, v25
  v_accvgpr_write_b32 a35, v27
  v_fma_f32 v48, v48, s67, v25
  v_mfma_f32_16x16x32_bf16 v[36:39], a[244:247], v[80:83], v[36:39]
  ds_read_b128 a[236:239], v9 offset:12544
  ds_read_b32 v3, v2 offset:2048
  v_fma_f32 v49, v49, s67, v25
  v_mfma_f32_16x16x32_bf16 v[44:47], a[244:247], v[84:87], v[44:47]
  v_fma_f32 v50, v50, s67, v25
  v_fma_f32 v51, v51, s67, v25
  v_exp_f32 v48, v48
  s_waitcnt lgkmcnt(5)
  v_mfma_f32_16x16x32_bf16 v[32:35], a[248:251], v[88:91], v[32:35]
  ds_read_b128 a[240:243], v10 offset:4352
  v_exp_f32 v49, v49
  v_mfma_f32_16x16x32_bf16 v[40:43], a[248:251], v[92:95], v[40:43]
  v_exp_f32 v50, v50
  v_exp_f32 v51, v51
  v_mfma_f32_16x16x32_bf16 v[36:39], a[252:255], v[88:91], v[36:39]
  ds_read_b128 a[244:247], v10 offset:12544
  v_fma_f32 v52, v52, s67, v25
  v_mfma_f32_16x16x32_bf16 v[44:47], a[252:255], v[92:95], v[44:47]
  v_fma_f32 v53, v53, s67, v25
  v_fma_f32 v54, v54, s67, v25
  v_fma_f32 v55, v55, s67, v25
  s_waitcnt lgkmcnt(5)
  v_mfma_f32_16x16x32_bf16 v[32:35], a[224:227], v[96:99], v[32:35]
  ds_read_b128 a[248:251], v11 offset:4352
  v_exp_f32 v52, v52
  v_mfma_f32_16x16x32_bf16 v[40:43], a[224:227], v[100:103], v[40:43]
  v_exp_f32 v53, v53
  v_exp_f32 v54, v54
  v_mfma_f32_16x16x32_bf16 v[36:39], a[228:231], v[96:99], v[36:39]
  ds_read_b128 a[252:255], v11 offset:12544
  s_waitcnt lgkmcnt(4)
  v_cmp_le_u32 vcc, 0xb0030011, v3
  v_exp_f32 v55, v55
  v_mfma_f32_16x16x32_bf16 v[44:47], a[228:231], v[100:103], v[44:47]
  v_cvt_pk_bf16_f32 v136, v48, v49
  v_cvt_pk_bf16_f32 v137, v50, v51
  v_mfma_f32_16x16x32_bf16 v[32:35], a[232:235], v[104:107], v[32:35]
  ds_add_u32 v1, v4
  s_cbranch_vccz L_csK_3
L_cbK_3:
  v_subrev_u32 v8, 65536, v8
  ds_read_b128 a[224:227], v8 offset:0
  v_mfma_f32_16x16x32_bf16 v[40:43], a[232:235], v[108:111], v[40:43]
  v_fma_f32 v56, v56, s67, v27
  v_fma_f32 v57, v57, s67, v27
  v_fma_f32 v58, v58, s67, v27
  v_fma_f32 v59, v59, s67, v27
  v_mfma_f32_16x16x32_bf16 v[36:39], a[236:239], v[104:107], v[36:39]
  ds_read_b128 a[228:231], v8 offset:8192
  v_exp_f32 v56, v56
  v_mfma_f32_16x16x32_bf16 v[44:47], a[236:239], v[108:111], v[44:47]
  v_exp_f32 v57, v57
  v_exp_f32 v58, v58
  s_waitcnt lgkmcnt(5)
  v_mfma_f32_16x16x32_bf16 v[32:35], a[240:243], v[112:115], v[32:35]
  v_subrev_u32 v9, 65536, v9
  ds_read_b128 a[232:235], v9 offset:0
  v_exp_f32 v59, v59
  v_mfma_f32_16x16x32_bf16 v[40:43], a[240:243], v[116:119], v[40:43]
  v_cvt_pk_bf16_f32 v138, v52, v53
  v_cvt_pk_bf16_f32 v139, v54, v55
  v_fma_f32 v60, v60, s67, v27
  v_mfma_f32_16x16x32_bf16 v[36:39], a[244:247], v[112:115], v[36:39]
  ds_read_b128 a[236:239], v9 offset:8192
  v_fma_f32 v61, v61, s67, v27
  v_fma_f32 v62, v62, s67, v27
  v_mfma_f32_16x16x32_bf16 v[44:47], a[244:247], v[116:119], v[44:47]
  v_fma_f32 v63, v63, s67, v27
  v_exp_f32 v60, v60
  s_waitcnt lgkmcnt(5)
  v_mfma_f32_16x16x32_bf16 v[32:35], a[248:251], v[120:123], v[32:35]
  v_subrev_u32 v10, 65536, v10
  ds_read_b128 a[240:243], v10 offset:0
  v_exp_f32 v61, v61
  v_mfma_f32_16x16x32_bf16 v[40:43], a[248:251], v[124:127], v[40:43]
  v_exp_f32 v62, v62
  v_exp_f32 v63, v63
  v_mfma_f32_16x16x32_bf16 v[36:39], a[252:255], v[120:123], v[36:39]
  ds_read_b128 a[244:247], v10 offset:8192
  v_cvt_pk_bf16_f32 v140, v56, v57
  v_cvt_pk_bf16_f32 v141, v58, v59
  v_mfma_f32_16x16x32_bf16 v[44:47], a[252:255], v[124:127], v[44:47]
  v_cvt_pk_bf16_f32 v142, v60, v61
  v_cvt_pk_bf16_f32 v143, v62, v63
  s_waitcnt lgkmcnt(4)
  v_mfma_f32_16x16x32_bf16 v[48:51], a[224:227], v[64:67], 0
  v_subrev_u32 v11, 65536, v11
  ds_read_b128 a[248:251], v11 offset:0
  v_mfma_f32_16x16x32_bf16 v[56:59], a[224:227], v[68:71], 0
  v_mfma_f32_16x16x32_bf16 v[52:55], a[228:231], v[64:67], 0
  ds_read_b128 a[252:255], v11 offset:8192
  v_mfma_f32_16x16x32_bf16 v[60:63], a[228:231], v[68:71], 0
  s_waitcnt lgkmcnt(4)
  v_mfma_f32_16x16x32_bf16 v[48:51], a[232:235], v[72:75], v[48:51]
  ds_read_b128 a[224:227], v8 offset:256
  v_mfma_f32_16x16x32_bf16 v[56:59], a[232:235], v[76:79], v[56:59]
  v_max3_f32 v20, v20, v32, v33
  v_max3_f32 v21, v21, v40, v41
  v_max3_f32 v20, v20, v34, v35
  v_max3_f32 v21, v21, v42, v43
  v_mfma_f32_16x16x32_bf16 v[52:55], a[236:239], v[72:75], v[52:55]
  ds_read_b128 a[228:231], v8 offset:8448
  v_max3_f32 v20, v20, v36, v37
  v_max3_f32 v21, v21, v44, v45
  v_mfma_f32_16x16x32_bf16 v[60:63], a[236:239], v[76:79], v[60:63]
  v_max3_f32 v20, v20, v38, v39
  v_max3_f32 v21, v21, v46, v47
  v_mul_f32 v18, s68, v20
  s_waitcnt lgkmcnt(4)
  v_mfma_f32_16x16x32_bf16 v[48:51], a[240:243], v[80:83], v[48:51]
  ds_read_b128 a[232:235], v9 offset:256
  v_mul_f32 v16, s68, v21
  v_floor_f32 v24, v18
  v_mfma_f32_16x16x32_bf16 v[56:59], a[240:243], v[84:87], v[56:59]
  v_floor_f32 v26, v16
  v_accvgpr_write_b32 a36, v24
  v_accvgpr_write_b32 a37, v26
  v_fma_f32 v32, v32, s67, v24
  v_mfma_f32_16x16x32_bf16 v[52:55], a[244:247], v[80:83], v[52:55]
  ds_read_b128 a[236:239], v9 offset:8448
  ds_read_b32 v3, v2 offset:2048
  v_fma_f32 v33, v33, s67, v24
  v_mfma_f32_16x16x32_bf16 v[60:63], a[244:247], v[84:87], v[60:63]
  v_fma_f32 v34, v34, s67, v24
  v_fma_f32 v35, v35, s67, v24
  v_exp_f32 v32, v32
  s_waitcnt lgkmcnt(5)
  v_mfma_f32_16x16x32_bf16 v[48:51], a[248:251], v[88:91], v[48:51]
  ds_read_b128 a[240:243], v10 offset:256
  v_exp_f32 v33, v33
  v_mfma_f32_16x16x32_bf16 v[56:59], a[248:251], v[92:95], v[56:59]
  v_exp_f32 v34, v34
  v_exp_f32 v35, v35
  v_mfma_f32_16x16x32_bf16 v[52:55], a[252:255], v[88:91], v[52:55]
  ds_read_b128 a[244:247], v10 offset:8448
  v_fma_f32 v36, v36, s67, v24
  v_mfma_f32_16x16x32_bf16 v[60:63], a[252:255], v[92:95], v[60:63]
  v_fma_f32 v37, v37, s67, v24
  v_fma_f32 v38, v38, s67, v24
  v_fma_f32 v39, v39, s67, v24
  s_waitcnt lgkmcnt(5)
  v_mfma_f32_16x16x32_bf16 v[48:51], a[224:227], v[96:99], v[48:51]
  ds_read_b128 a[248:251], v11 offset:256
  v_exp_f32 v36, v36
  v_mfma_f32_16x16x32_bf16 v[56:59], a[224:227], v[100:103], v[56:59]
  v_exp_f32 v37, v37
  v_exp_f32 v38, v38
  v_mfma_f32_16x16x32_bf16 v[52:55], a[228:231], v[96:99], v[52:55]
  ds_read_b128 a[252:255], v11 offset:8448
  s_waitcnt lgkmcnt(4)
  v_cmp_le_u32 vcc, 0xb0030012, v3
  v_exp_f32 v39, v39
  v_mfma_f32_16x16x32_bf16 v[60:63], a[228:231], v[100:103], v[60:63]
  v_cvt_pk_bf16_f32 v144, v32, v33
  v_cvt_pk_bf16_f32 v145, v34, v35
  v_mfma_f32_16x16x32_bf16 v[48:51], a[232:235], v[104:107], v[48:51]
  ds_add_u32 v1, v4
  s_cbranch_vccz L_csK_4
L_cbK_4:
  ds_read_b128 a[224:227], v8 offset:16384
  v_mfma_f32_16x16x32_bf16 v[56:59], a[232:235], v[108:111], v[56:59]
  v_fma_f32 v40, v40, s67, v26
  v_fma_f32 v41, v41, s67, v26
  v_fma_f32 v42, v42, s67, v26
  v_fma_f32 v43, v43, s67, v26
  v_mfma_f32_16x16x32_bf16 v[52:55], a[236:239], v[104:107], v[52:55]
  ds_read_b128 a[228:231], v8 offset:24576
  v_exp_f32 v40, v40
  v_mfma_f32_16x16x32_bf16 v[60:63], a[236:239], v[108:111], v[60:63]
  v_exp_f32 v41, v41
  v_exp_f32 v42, v42
  s_waitcnt lgkmcnt(5)
  v_mfma_f32_16x16x32_bf16 v[48:51], a[240:243], v[112:115], v[48:51]
  ds_read_b128 a[232:235], v9 offset:16384
  v_exp_f32 v43, v43
  v_mfma_f32_16x16x32_bf16 v[56:59], a[240:243], v[116:119], v[56:59]
  v_cvt_pk_bf16_f32 v146, v36, v37
  v_cvt_pk_bf16_f32 v147, v38, v39
  v_fma_f32 v44, v44, s67, v26
  v_mfma_f32_16x16x32_bf16 v[52:55], a[244:247], v[112:115], v[52:55]
  ds_read_b128 a[236:239], v9 offset:24576
  v_fma_f32 v45, v45, s67, v26
  v_fma_f32 v46, v46, s67, v26
  v_mfma_f32_16x16x32_bf16 v[60:63], a[244:247], v[116:119], v[60:63]
  v_fma_f32 v47, v47, s67, v26
  v_exp_f32 v44, v44
  s_waitcnt lgkmcnt(5)
  v_mfma_f32_16x16x32_bf16 v[48:51], a[248:251], v[120:123], v[48:51]
  ds_read_b128 a[240:243], v10 offset:16384
  v_exp_f32 v45, v45
  v_mfma_f32_16x16x32_bf16 v[56:59], a[248:251], v[124:127], v[56:59]
  v_exp_f32 v46, v46
  v_exp_f32 v47, v47
  v_mfma_f32_16x16x32_bf16 v[52:55], a[252:255], v[120:123], v[52:55]
  ds_read_b128 a[244:247], v10 offset:24576
  v_cvt_pk_bf16_f32 v148, v40, v41
  v_cvt_pk_bf16_f32 v149, v42, v43
  v_mfma_f32_16x16x32_bf16 v[60:63], a[252:255], v[124:127], v[60:63]
  v_cvt_pk_bf16_f32 v150, v44, v45
  v_cvt_pk_bf16_f32 v151, v46, v47
  s_waitcnt lgkmcnt(4)
  v_mfma_f32_16x16x32_bf16 v[32:35], a[224:227], v[64:67], 0
  ds_read_b128 a[248:251], v11 offset:16384
  v_mfma_f32_16x16x32_bf16 v[40:43], a[224:227], v[68:71], 0
  v_mfma_f32_16x16x32_bf16 v[36:39], a[228:231], v[64:67], 0
  ds_read_b128 a[252:255], v11 offset:24576
  v_mfma_f32_16x16x32_bf16 v[44:47], a[228:231], v[68:71], 0
  s_waitcnt lgkmcnt(4)
  v_mfma_f32_16x16x32_bf16 v[32:35], a[232:235], v[72:75], v[32:35]
  ds_read_b128 a[224:227], v8 offset:16640
  v_mfma_f32_16x16x32_bf16 v[40:43], a[232:235], v[76:79], v[40:43]
  v_max3_f32 v20, v20, v48, v49
  v_max3_f32 v21, v21, v56, v57
  v_max3_f32 v20, v20, v50, v51
  v_max3_f32 v21, v21, v58, v59
  v_mfma_f32_16x16x32_bf16 v[36:39], a[236:239], v[72:75], v[36:39]
  ds_read_b128 a[228:231], v8 offset:24832
  v_max3_f32 v20, v20, v52, v53
  v_max3_f32 v21, v21, v60, v61
  v_mfma_f32_16x16x32_bf16 v[44:47], a[236:239], v[76:79], v[44:47]
  v_max3_f32 v20, v20, v54, v55
  v_max3_f32 v21, v21, v62, v63
  v_mul_f32 v18, s68, v20
  s_waitcnt lgkmcnt(4)
  v_mfma_f32_16x16x32_bf16 v[32:35], a[240:243], v[80:83], v[32:35]
  ds_read_b128 a[232:235], v9 offset:16640
  v_mul_f32 v16, s68, v21
  v_floor_f32 v25, v18
  v_mfma_f32_16x16x32_bf16 v[40:43], a[240:243], v[84:87], v[40:43]
  v_floor_f32 v27, v16
  v_accvgpr_write_b32 a38, v25
  v_accvgpr_write_b32 a39, v27
  v_fma_f32 v48, v48, s67, v25
  v_mfma_f32_16x16x32_bf16 v[36:39], a[244:247], v[80:83], v[36:39]
  ds_read_b128 a[236:239], v9 offset:24832
  ds_read_b32 v3, v2 offset:2048
  v_fma_f32 v49, v49, s67, v25
  v_mfma_f32_16x16x32_bf16 v[44:47], a[244:247], v[84:87], v[44:47]
  v_fma_f32 v50, v50, s67, v25
  v_fma_f32 v51, v51, s67, v25
  v_exp_f32 v48, v48
  s_waitcnt lgkmcnt(5)
  v_mfma_f32_16x16x32_bf16 v[32:35], a[248:251], v[88:91], v[32:35]
  ds_read_b128 a[240:243], v10 offset:16640
  v_exp_f32 v49, v49
  v_mfma_f32_16x16x32_bf16 v[40:43], a[248:251], v[92:95], v[40:43]
  v_exp_f32 v50, v50
  v_exp_f32 v51, v51
  v_mfma_f32_16x16x32_bf16 v[36:39], a[252:255], v[88:91], v[36:39]
  ds_read_b128 a[244:247], v10 offset:24832
  v_fma_f32 v52, v52, s67, v25
  v_mfma_f32_16x16x32_bf16 v[44:47], a[252:255], v[92:95], v[44:47]
  v_fma_f32 v53, v53, s67, v25
  v_fma_f32 v54, v54, s67, v25
  v_fma_f32 v55, v55, s67, v25
  s_waitcnt lgkmcnt(5)
  v_mfma_f32_16x16x32_bf16 v[32:35], a[224:227], v[96:99], v[32:35]
  ds_read_b128 a[248:251], v11 offset:16640
  v_exp_f32 v52, v52
  v_mfma_f32_16x16x32_bf16 v[40:43], a[224:227], v[100:103], v[40:43]
  v_exp_f32 v53, v53
  v_exp_f32 v54, v54
  v_mfma_f32_16x16x32_bf16 v[36:39], a[228:231], v[96:99], v[36:39]
  ds_read_b128 a[252:255], v11 offset:24832
  s_waitcnt lgkmcnt(4)
  v_cmp_le_u32 vcc, 0xb0030013, v3
  v_exp_f32 v55, v55
  v_mfma_f32_16x16x32_bf16 v[44:47], a[228:231], v[100:103], v[44:47]
  v_cvt_pk_bf16_f32 v152, v48, v49
  v_cvt_pk_bf16_f32 v153, v50, v51
  v_mfma_f32_16x16x32_bf16 v[32:35], a[232:235], v[104:107], v[32:35]
  ds_add_u32 v1, v4
  s_cbranch_vccz L_csK_5
L_cbK_5:
  v_subrev_u32 v8, 65536, v8
  ds_read_b128 a[224:227], v8 offset:0
  v_mfma_f32_16x16x32_bf16 v[40:43], a[232:235], v[108:111], v[40:43]
  v_fma_f32 v56, v56, s67, v27
  v_fma_f32 v57, v57, s67, v27
  v_fma_f32 v58, v58, s67, v27
  v_fma_f32 v59, v59, s67, v27
  v_mfma_f32_16x16x32_bf16 v[36:39], a[236:239], v[104:107], v[36:39]
  ds_read_b128 a[228:231], v8 offset:8192
  v_exp_f32 v56, v56
  v_mfma_f32_16x16x32_bf16 v[44:47], a[236:239], v[108:111], v[44:47]
  v_exp_f32 v57, v57
  v_exp_f32 v58, v58
  s_waitcnt lgkmcnt(5)
  v_mfma_f32_16x16x32_bf16 v[32:35], a[240:243], v[112:115], v[32:35]
  v_subrev_u32 v9, 65536, v9
  ds_read_b128 a[232:235], v9 offset:0
  v_exp_f32 v59, v59
  v_mfma_f32_16x16x32_bf16 v[40:43], a[240:243], v[116:119], v[40:43]
  v_cvt_pk_bf16_f32 v154, v52, v53
  v_cvt_pk_bf16_f32 v155, v54, v55
  v_fma_f32 v60, v60, s67, v27
  v_mfma_f32_16x16x32_bf16 v[36:39], a[244:247], v[112:115], v[36:39]
  ds_read_b128 a[236:239], v9 offset:8192
  v_fma_f32 v61, v61, s67, v27
  v_fma_f32 v62, v62, s67, v27
  v_mfma_f32_16x16x32_bf16 v[44:47], a[244:247], v[116:119], v[44:47]
  v_fma_f32 v63, v63, s67, v27
  v_exp_f32 v60, v60
  s_waitcnt lgkmcnt(5)
  v_mfma_f32_16x16x32_bf16 v[32:35], a[248:251], v[120:123], v[32:35]
  v_subrev_u32 v10, 65536, v10
  ds_read_b128 a[240:243], v10 offset:0
  v_exp_f32 v61, v61
  v_mfma_f32_16x16x32_bf16 v[40:43], a[248:251], v[124:127], v[40:43]
  v_exp_f32 v62, v62
  v_exp_f32 v63, v63
  v_mfma_f32_16x16x32_bf16 v[36:39], a[252:255], v[120:123], v[36:39]
  ds_read_b128 a[244:247], v10 offset:8192
  v_cvt_pk_bf16_f32 v156, v56, v57
  v_cvt_pk_bf16_f32 v157, v58, v59
  v_mfma_f32_16x16x32_bf16 v[44:47], a[252:255], v[124:127], v[44:47]
  v_cvt_pk_bf16_f32 v158, v60, v61
  v_cvt_pk_bf16_f32 v159, v62, v63
  s_waitcnt lgkmcnt(4)
  v_mfma_f32_16x16x32_bf16 v[48:51], a[224:227], v[64:67], 0
  v_subrev_u32 v11, 65536, v11
  ds_read_b128 a[248:251], v11 offset:0
  v_mfma_f32_16x16x32_bf16 v[56:59], a[224:227], v[68:71], 0
  v_mfma_f32_16x16x32_bf16 v[52:55], a[228:231], v[64:67], 0
  ds_read_b128 a[252:255], v11 offset:8192
  v_mfma_f32_16x16x32_bf16 v[60:63], a[228:231], v[68:71], 0
  s_waitcnt lgkmcnt(4)
  v_mfma_f32_16x16x32_bf16 v[48:51], a[232:235], v[72:75], v[48:51]
  ds_read_b128 a[224:227], v8 offset:256
  v_mfma_f32_16x16x32_bf16 v[56:59], a[232:235], v[76:79], v[56:59]
  v_max3_f32 v20, v20, v32, v33
  v_max3_f32 v21, v21, v40, v41
  v_max3_f32 v20, v20, v34, v35
  v_max3_f32 v21, v21, v42, v43
  v_mfma_f32_16x16x32_bf16 v[52:55], a[236:239], v[72:75], v[52:55]
  ds_read_b128 a[228:231], v8 offset:8448
  v_max3_f32 v20, v20, v36, v37
  v_max3_f32 v21, v21, v44, v45
  v_mfma_f32_16x16x32_bf16 v[60:63], a[236:239], v[76:79], v[60:63]
  v_max3_f32 v20, v20, v38, v39
  v_max3_f32 v21, v21, v46, v47
  v_mul_f32 v18, s68, v20
  s_waitcnt lgkmcnt(4)
  v_mfma_f32_16x16x32_bf16 v[48:51], a[240:243], v[80:83], v[48:51]
  ds_read_b128 a[232:235], v9 offset:256
  v_mul_f32 v16, s68, v21
  v_floor_f32 v24, v18
  v_mfma_f32_16x16x32_bf16 v[56:59], a[240:243], v[84:87], v[56:59]
  v_floor_f32 v26, v16
  v_accvgpr_write_b32 a40, v24
  v_accvgpr_write_b32 a41, v26
  v_fma_f32 v32, v32, s67, v24
  v_mfma_f32_16x16x32_bf16 v[52:55], a[244:247], v[80:83], v[52:55]
  ds_read_b128 a[236:239], v9 offset:8448
  ds_read_b32 v3, v2 offset:1036
  v_fma_f32 v33, v33, s67, v24
  v_mfma_f32_16x16x32_bf16 v[60:63], a[244:247], v[84:87], v[60:63]
  v_fma_f32 v34, v34, s67, v24
  v_fma_f32 v35, v35, s67, v24
  v_exp_f32 v32, v32
  s_waitcnt lgkmcnt(5)
  v_mfma_f32_16x16x32_bf16 v[48:51], a[248:251], v[88:91], v[48:51]
  ds_read_b128 a[240:243], v10 offset:256
  v_exp_f32 v33, v33
  v_mfma_f32_16x16x32_bf16 v[56:59], a[248:251], v[92:95], v[56:59]
  v_exp_f32 v34, v34
  v_exp_f32 v35, v35
  v_mfma_f32_16x16x32_bf16 v[52:55], a[252:255], v[88:91], v[52:55]
  ds_read_b128 a[244:247], v10 offset:8448
  v_fma_f32 v36, v36, s67, v24
  v_mfma_f32_16x16x32_bf16 v[60:63], a[252:255], v[92:95], v[60:63]
  v_fma_f32 v37, v37, s67, v24
  v_fma_f32 v38, v38, s67, v24
  v_fma_f32 v39, v39, s67, v24
  s_waitcnt lgkmcnt(5)
  v_mfma_f32_16x16x32_bf16 v[48:51], a[224:227], v[96:99], v[48:51]
  ds_read_b128 a[248:251], v11 offset:256
  v_exp_f32 v36, v36
  v_mfma_f32_16x16x32_bf16 v[56:59], a[224:227], v[100:103], v[56:59]
  v_exp_f32 v37, v37
  v_exp_f32 v38, v38
  v_mfma_f32_16x16x32_bf16 v[52:55], a[228:231], v[96:99], v[52:55]
  ds_read_b128 a[252:255], v11 offset:8448
  s_waitcnt lgkmcnt(4)
  v_cmp_le_u32 vcc, 0x2, v3
  v_exp_f32 v39, v39
  v_mfma_f32_16x16x32_bf16 v[60:63], a[228:231], v[100:103], v[60:63]
  v_cvt_pk_bf16_f32 v160, v32, v33
  v_cvt_pk_bf16_f32 v161, v34, v35
  v_mfma_f32_16x16x32_bf16 v[48:51], a[232:235], v[104:107], v[48:51]
  ds_add_u32 v1, v4
  s_cbranch_vccz L_csK_6
L_cbK_6:
  ds_read_b128 a[224:227], v8 offset:16384
  v_mfma_f32_16x16x32_bf16 v[56:59], a[232:235], v[108:111], v[56:59]
  v_fma_f32 v40, v40, s67, v26
  v_fma_f32 v41, v41, s67, v26
  v_fma_f32 v42, v42, s67, v26
  v_fma_f32 v43, v43, s67, v26
  v_mfma_f32_16x16x32_bf16 v[52:55], a[236:239], v[104:107], v[52:55]
  ds_read_b128 a[228:231], v8 offset:24576
  v_exp_f32 v40, v40
  v_mfma_f32_16x16x32_bf16 v[60:63], a[236:239], v[108:111], v[60:63]
  v_exp_f32 v41, v41
  v_exp_f32 v42, v42
  s_waitcnt lgkmcnt(5)
  v_mfma_f32_16x16x32_bf16 v[48:51], a[240:243], v[112:115], v[48:51]
  ds_read_b128 a[232:235], v9 offset:16384
  v_exp_f32 v43, v43
  v_mfma_f32_16x16x32_bf16 v[56:59], a[240:243], v[116:119], v[56:59]
  v_cvt_pk_bf16_f32 v162, v36, v37
  v_cvt_pk_bf16_f32 v163, v38, v39
  v_fma_f32 v44, v44, s67, v26
  v_mfma_f32_16x16x32_bf16 v[52:55], a[244:247], v[112:115], v[52:55]
  ds_read_b128 a[236:239], v9 offset:24576
  v_fma_f32 v45, v45, s67, v26
  v_fma_f32 v46, v46, s67, v26
  v_mfma_f32_16x16x32_bf16 v[60:63], a[244:247], v[116:119], v[60:63]
  v_fma_f32 v47, v47, s67, v26
  v_exp_f32 v44, v44
  s_waitcnt lgkmcnt(5)
  v_mfma_f32_16x16x32_bf16 v[48:51], a[248:251], v[120:123], v[48:51]
  ds_read_b128 a[240:243], v10 offset:16384
  v_exp_f32 v45, v45
  v_mfma_f32_16x16x32_bf16 v[56:59], a[248:251], v[124:127], v[56:59]
  v_exp_f32 v46, v46
  v_exp_f32 v47, v47
  v_mfma_f32_16x16x32_bf16 v[52:55], a[252:255], v[120:123], v[52:55]
  ds_read_b128 a[244:247], v10 offset:24576
  v_cvt_pk_bf16_f32 v164, v40, v41
  v_cvt_pk_bf16_f32 v165, v42, v43
  v_mfma_f32_16x16x32_bf16 v[60:63], a[252:255], v[124:127], v[60:63]
  v_cvt_pk_bf16_f32 v166, v44, v45
  v_cvt_pk_bf16_f32 v167, v46, v47
  s_waitcnt lgkmcnt(4)
  v_mfma_f32_16x16x32_bf16 v[32:35], a[224:227], v[64:67], 0
  ds_read_b128 a[248:251], v11 offset:16384
  v_mfma_f32_16x16x32_bf16 v[40:43], a[224:227], v[68:71], 0
  v_mfma_f32_16x16x32_bf16 v[36:39], a[228:231], v[64:67], 0
  ds_read_b128 a[252:255], v11 offset:24576
  v_mfma_f32_16x16x32_bf16 v[44:47], a[228:231], v[68:71], 0
  s_waitcnt lgkmcnt(4)
  v_mfma_f32_16x16x32_bf16 v[32:35], a[232:235], v[72:75], v[32:35]
  ds_read_b128 a[224:227], v8 offset:16640
  v_mfma_f32_16x16x32_bf16 v[40:43], a[232:235], v[76:79], v[40:43]
  v_max3_f32 v20, v20, v48, v49
  v_max3_f32 v21, v21, v56, v57
  v_max3_f32 v20, v20, v50, v51
  v_max3_f32 v21, v21, v58, v59
  v_mfma_f32_16x16x32_bf16 v[36:39], a[236:239], v[72:75], v[36:39]
  ds_read_b128 a[228:231], v8 offset:24832
  v_max3_f32 v20, v20, v52, v53
  v_max3_f32 v21, v21, v60, v61
  v_mfma_f32_16x16x32_bf16 v[44:47], a[236:239], v[76:79], v[44:47]
  v_max3_f32 v20, v20, v54, v55
  v_max3_f32 v21, v21, v62, v63
  v_mul_f32 v18, s68, v20
  s_waitcnt lgkmcnt(4)
  v_mfma_f32_16x16x32_bf16 v[32:35], a[240:243], v[80:83], v[32:35]
  ds_read_b128 a[232:235], v9 offset:16640
  v_mul_f32 v16, s68, v21
  v_floor_f32 v25, v18
  v_mfma_f32_16x16x32_bf16 v[40:43], a[240:243], v[84:87], v[40:43]
  v_floor_f32 v27, v16
  v_accvgpr_write_b32 a42, v25
  v_accvgpr_write_b32 a43, v27
  v_fma_f32 v48, v48, s67, v25
  v_mfma_f32_16x16x32_bf16 v[36:39], a[244:247], v[80:83], v[36:39]
  ds_read_b128 a[236:239], v9 offset:24832
  ds_read_b32 v3, v2 offset:2048
  v_fma_f32 v49, v49, s67, v25
  v_mfma_f32_16x16x32_bf16 v[44:47], a[244:247], v[84:87], v[44:47]
  v_fma_f32 v50, v50, s67, v25
  v_fma_f32 v51, v51, s67, v25
  v_exp_f32 v48, v48
  s_waitcnt lgkmcnt(5)
  v_mfma_f32_16x16x32_bf16 v[32:35], a[248:251], v[88:91], v[32:35]
  ds_read_b128 a[240:243], v10 offset:16640
  v_exp_f32 v49, v49
  v_mfma_f32_16x16x32_bf16 v[40:43], a[248:251], v[92:95], v[40:43]
  v_exp_f32 v50, v50
  v_exp_f32 v51, v51
  v_mfma_f32_16x16x32_bf16 v[36:39], a[252:255], v[88:91], v[36:39]
  ds_read_b128 a[244:247], v10 offset:24832
  v_fma_f32 v52, v52, s67, v25
  v_mfma_f32_16x16x32_bf16 v[44:47], a[252:255], v[92:95], v[44:47]
  v_fma_f32 v53, v53, s67, v25
  v_fma_f32 v54, v54, s67, v25
  v_fma_f32 v55, v55, s67, v25
  s_waitcnt lgkmcnt(5)
  v_mfma_f32_16x16x32_bf16 v[32:35], a[224:227], v[96:99], v[32:35]
  ds_read_b128 a[248:251], v11 offset:16640
  v_exp_f32 v52, v52
  v_mfma_f32_16x16x32_bf16 v[40:43], a[224:227], v[100:103], v[40:43]
  v_exp_f32 v53, v53
  v_exp_f32 v54, v54
  v_mfma_f32_16x16x32_bf16 v[36:39], a[228:231], v[96:99], v[36:39]
  ds_read_b128 a[252:255], v11 offset:24832
  s_waitcnt lgkmcnt(4)
  v_cmp_le_u32 vcc, 0xb0030014, v3
  v_exp_f32 v55, v55
  v_mfma_f32_16x16x32_bf16 v[44:47], a[228:231], v[100:103], v[44:47]
  v_cvt_pk_bf16_f32 v168, v48, v49
  v_cvt_pk_bf16_f32 v169, v50, v51
  v_mfma_f32_16x16x32_bf16 v[32:35], a[232:235], v[104:107], v[32:35]
  ds_add_u32 v1, v4
  s_cbranch_vccz L_csK_7
L_cbK_7:
  v_add_u32 v8, 65536, v8
  ds_read_b128 a[224:227], v8 offset:45056
  v_mfma_f32_16x16x32_bf16 v[40:43], a[232:235], v[108:111], v[40:43]
  v_fma_f32 v56, v56, s67, v27
  v_fma_f32 v57, v57, s67, v27
  v_fma_f32 v58, v58, s67, v27
  v_fma_f32 v59, v59, s67, v27
  v_mfma_f32_16x16x32_bf16 v[36:39], a[236:239], v[104:107], v[36:39]
  ds_read_b128 a[228:231], v8 offset:53248
  v_exp_f32 v56, v56
  v_mfma_f32_16x16x32_bf16 v[44:47], a[236:239], v[108:111], v[44:47]
  v_exp_f32 v57, v57
  v_exp_f32 v58, v58
  s_waitcnt lgkmcnt(5)
  v_mfma_f32_16x16x32_bf16 v[32:35], a[240:243], v[112:115], v[32:35]
  v_add_u32 v9, 65536, v9
  ds_read_b128 a[232:235], v9 offset:45056
  v_exp_f32 v59, v59
  v_mfma_f32_16x16x32_bf16 v[40:43], a[240:243], v[116:119], v[40:43]
  v_cvt_pk_bf16_f32 v170, v52, v53
  v_cvt_pk_bf16_f32 v171, v54, v55
  v_fma_f32 v60, v60, s67, v27
  v_mfma_f32_16x16x32_bf16 v[36:39], a[244:247], v[112:115], v[36:39]
  ds_read_b128 a[236:239], v9 offset:53248
  v_fma_f32 v61, v61, s67, v27
  v_fma_f32 v62, v62, s67, v27
  v_mfma_f32_16x16x32_bf16 v[44:47], a[244:247], v[116:119], v[44:47]
  v_fma_f32 v63, v63, s67, v27
  v_exp_f32 v60, v60
  s_waitcnt lgkmcnt(5)
  v_mfma_f32_16x16x32_bf16 v[32:35], a[248:251], v[120:123], v[32:35]
  v_add_u32 v10, 65536, v10
  ds_read_b128 a[240:243], v10 offset:45056
  v_exp_f32 v61, v61
  v_mfma_f32_16x16x32_bf16 v[40:43], a[248:251], v[124:127], v[40:43]
  v_exp_f32 v62, v62
  v_exp_f32 v63, v63
  v_mfma_f32_16x16x32_bf16 v[36:39], a[252:255], v[120:123], v[36:39]
  ds_read_b128 a[244:247], v10 offset:53248
  v_cvt_pk_bf16_f32 v172, v56, v57
  v_cvt_pk_bf16_f32 v173, v58, v59
  v_mfma_f32_16x16x32_bf16 v[44:47], a[252:255], v[124:127], v[44:47]
  v_cvt_pk_bf16_f32 v174, v60, v61
  v_cvt_pk_bf16_f32 v175, v62, v63
  s_waitcnt lgkmcnt(4)
  v_mfma_f32_16x16x32_bf16 v[48:51], a[224:227], v[64:67], 0
  v_add_u32 v11, 65536, v11
  ds_read_b128 a[248:251], v11 offset:45056
  v_mfma_f32_16x16x32_bf16 v[56:59], a[224:227], v[68:71], 0
  v_mfma_f32_16x16x32_bf16 v[52:55], a[228:231], v[64:67], 0
  ds_read_b128 a[252:255], v11 offset:53248
  v_mfma_f32_16x16x32_bf16 v[60:63], a[228:231], v[68:71], 0
  s_waitcnt lgkmcnt(4)
  v_mfma_f32_16x16x32_bf16 v[48:51], a[232:235], v[72:75], v[48:51]
  ds_read_b128 a[224:227], v8 offset:45312
  v_mfma_f32_16x16x32_bf16 v[56:59], a[232:235], v[76:79], v[56:59]
  v_max3_f32 v20, v20, v32, v33
  v_max3_f32 v21, v21, v40, v41
  v_max3_f32 v20, v20, v34, v35
  v_max3_f32 v21, v21, v42, v43
  v_mfma_f32_16x16x32_bf16 v[52:55], a[236:239], v[72:75], v[52:55]
  ds_read_b128 a[228:231], v8 offset:53504
  v_max3_f32 v20, v20, v36, v37
  v_max3_f32 v21, v21, v44, v45
  v_mfma_f32_16x16x32_bf16 v[60:63], a[236:239], v[76:79], v[60:63]
  v_max3_f32 v20, v20, v38, v39
  v_max3_f32 v21, v21, v46, v47
  v_mul_f32 v18, s68, v20
  s_waitcnt lgkmcnt(4)
  v_mfma_f32_16x16x32_bf16 v[48:51], a[240:243], v[80:83], v[48:51]
  ds_read_b128 a[232:235], v9 offset:45312
  v_mul_f32 v16, s68, v21
  v_floor_f32 v24, v18
  v_mfma_f32_16x16x32_bf16 v[56:59], a[240:243], v[84:87], v[56:59]
  v_floor_f32 v26, v16
  v_accvgpr_write_b32 a44, v24
  v_accvgpr_write_b32 a45, v26
  v_fma_f32 v32, v32, s67, v24
  v_mfma_f32_16x16x32_bf16 v[52:55], a[244:247], v[80:83], v[52:55]
  ds_read_b128 a[236:239], v9 offset:53504
  ds_read_b32 v3, v2 offset:2048
  v_fma_f32 v33, v33, s67, v24
  v_mfma_f32_16x16x32_bf16 v[60:63], a[244:247], v[84:87], v[60:63]
  v_fma_f32 v34, v34, s67, v24
  v_fma_f32 v35, v35, s67, v24
  v_exp_f32 v32, v32
  s_waitcnt lgkmcnt(5)
  v_mfma_f32_16x16x32_bf16 v[48:51], a[248:251], v[88:91], v[48:51]
  ds_read_b128 a[240:243], v10 offset:45312
  v_exp_f32 v33, v33
  v_mfma_f32_16x16x32_bf16 v[56:59], a[248:251], v[92:95], v[56:59]
  v_exp_f32 v34, v34
  v_exp_f32 v35, v35
  v_mfma_f32_16x16x32_bf16 v[52:55], a[252:255], v[88:91], v[52:55]
  ds_read_b128 a[244:247], v10 offset:53504
  v_fma_f32 v36, v36, s67, v24
  v_mfma_f32_16x16x32_bf16 v[60:63], a[252:255], v[92:95], v[60:63]
  v_fma_f32 v37, v37, s67, v24
  v_fma_f32 v38, v38, s67, v24
  v_fma_f32 v39, v39, s67, v24
  s_waitcnt lgkmcnt(5)
  v_mfma_f32_16x16x32_bf16 v[48:51], a[224:227], v[96:99], v[48:51]
  ds_read_b128 a[248:251], v11 offset:45312
  v_exp_f32 v36, v36
  v_mfma_f32_16x16x32_bf16 v[56:59], a[224:227], v[100:103], v[56:59]
  v_exp_f32 v37, v37
  v_exp_f32 v38, v38
  v_mfma_f32_16x16x32_bf16 v[52:55], a[228:231], v[96:99], v[52:55]
  ds_read_b128 a[252:255], v11 offset:53504
  s_waitcnt lgkmcnt(4)
  v_cmp_le_u32 vcc, 0xb0030015, v3
  v_exp_f32 v39, v39
  v_mfma_f32_16x16x32_bf16 v[60:63], a[228:231], v[100:103], v[60:63]
  v_cvt_pk_bf16_f32 v176, v32, v33
  v_cvt_pk_bf16_f32 v177, v34, v35
  v_mfma_f32_16x16x32_bf16 v[48:51], a[232:235], v[104:107], v[48:51]
  ds_add_u32 v1, v4
  s_cbranch_vccz L_csK_8
L_cbK_8:
  v_subrev_u32 v8, 65536, v8
  ds_read_b128 a[224:227], v8 offset:32768
  v_mfma_f32_16x16x32_bf16 v[56:59], a[232:235], v[108:111], v[56:59]
  v_fma_f32 v40, v40, s67, v26
  v_fma_f32 v41, v41, s67, v26
  v_fma_f32 v42, v42, s67, v26
  v_fma_f32 v43, v43, s67, v26
  v_mfma_f32_16x16x32_bf16 v[52:55], a[236:239], v[104:107], v[52:55]
  ds_read_b128 a[228:231], v8 offset:40960
  v_exp_f32 v40, v40
  v_mfma_f32_16x16x32_bf16 v[60:63], a[236:239], v[108:111], v[60:63]
  v_exp_f32 v41, v41
  v_exp_f32 v42, v42
  s_waitcnt lgkmcnt(5)
  v_mfma_f32_16x16x32_bf16 v[48:51], a[240:243], v[112:115], v[48:51]
  v_subrev_u32 v9, 65536, v9
  ds_read_b128 a[232:235], v9 offset:32768
  v_exp_f32 v43, v43
  v_mfma_f32_16x16x32_bf16 v[56:59], a[240:243], v[116:119], v[56:59]
  v_cvt_pk_bf16_f32 v178, v36, v37
  v_cvt_pk_bf16_f32 v179, v38, v39
  v_fma_f32 v44, v44, s67, v26
  v_mfma_f32_16x16x32_bf16 v[52:55], a[244:247], v[112:115], v[52:55]
  ds_read_b128 a[236:239], v9 offset:40960
  v_fma_f32 v45, v45, s67, v26
  v_fma_f32 v46, v46, s67, v26
  v_mfma_f32_16x16x32_bf16 v[60:63], a[244:247], v[116:119], v[60:63]
  v_fma_f32 v47, v47, s67, v26
  v_exp_f32 v44, v44
  s_waitcnt lgkmcnt(5)
  v_mfma_f32_16x16x32_bf16 v[48:51], a[248:251], v[120:123], v[48:51]
  v_subrev_u32 v10, 65536, v10
  ds_read_b128 a[240:243], v10 offset:32768
  v_exp_f32 v45, v45
  v_mfma_f32_16x16x32_bf16 v[56:59], a[248:251], v[124:127], v[56:59]
  v_exp_f32 v46, v46
  v_exp_f32 v47, v47
  v_mfma_f32_16x16x32_bf16 v[52:55], a[252:255], v[120:123], v[52:55]
  ds_read_b128 a[244:247], v10 offset:40960
  v_cvt_pk_bf16_f32 v180, v40, v41
  v_cvt_pk_bf16_f32 v181, v42, v43
  v_mfma_f32_16x16x32_bf16 v[60:63], a[252:255], v[124:127], v[60:63]
  v_cvt_pk_bf16_f32 v182, v44, v45
  v_cvt_pk_bf16_f32 v183, v46, v47
  s_waitcnt lgkmcnt(4)
  v_mfma_f32_16x16x32_bf16 v[32:35], a[224:227], v[64:67], 0
  v_subrev_u32 v11, 65536, v11
  ds_read_b128 a[248:251], v11 offset:32768
  v_mfma_f32_16x16x32_bf16 v[40:43], a[224:227], v[68:71], 0
  v_mfma_f32_16x16x32_bf16 v[36:39], a[228:231], v[64:67], 0
  ds_read_b128 a[252:255], v11 offset:40960
  v_mfma_f32_16x16x32_bf16 v[44:47], a[228:231], v[68:71], 0
  s_waitcnt lgkmcnt(4)
  v_mfma_f32_16x16x32_bf16 v[32:35], a[232:235], v[72:75], v[32:35]
  ds_read_b128 a[224:227], v8 offset:33024
  v_mfma_f32_16x16x32_bf16 v[40:43], a[232:235], v[76:79], v[40:43]
  v_max3_f32 v20, v20, v48, v49
  v_max3_f32 v21, v21, v56, v57
  v_max3_f32 v20, v20, v50, v51
  v_max3_f32 v21, v21, v58, v59
  v_mfma_f32_16x16x32_bf16 v[36:39], a[236:239], v[72:75], v[36:39]
  ds_read_b128 a[228:231], v8 offset:41216
  v_max3_f32 v20, v20, v52, v53
  v_max3_f32 v21, v21, v60, v61
  v_mfma_f32_16x16x32_bf16 v[44:47], a[236:239], v[76:79], v[44:47]
  v_max3_f32 v20, v20, v54, v55
  v_max3_f32 v21, v21, v62, v63
  v_mul_f32 v18, s68, v20
  s_waitcnt lgkmcnt(4)
  v_mfma_f32_16x16x32_bf16 v[32:35], a[240:243], v[80:83], v[32:35]
  ds_read_b128 a[232:235], v9 offset:33024
  v_mul_f32 v16, s68, v21
  v_floor_f32 v25, v18
  v_mfma_f32_16x16x32_bf16 v[40:43], a[240:243], v[84:87], v[40:43]
  v_floor_f32 v27, v16
  v_accvgpr_write_b32 a46, v25
  v_accvgpr_write_b32 a47, v27
  v_fma_f32 v48, v48, s67, v25
  v_mfma_f32_16x16x32_bf16 v[36:39], a[244:247], v[80:83], v[36:39]
  ds_read_b128 a[236:239], v9 offset:41216
  ds_read_b32 v3, v2 offset:2048
  v_fma_f32 v49, v49, s67, v25
  v_mfma_f32_16x16x32_bf16 v[44:47], a[244:247], v[84:87], v[44:47]
  v_fma_f32 v50, v50, s67, v25
  v_fma_f32 v51, v51, s67, v25
  v_exp_f32 v48, v48
  s_waitcnt lgkmcnt(5)
  v_mfma_f32_16x16x32_bf16 v[32:35], a[248:251], v[88:91], v[32:35]
  ds_read_b128 a[240:243], v10 offset:33024
  v_exp_f32 v49, v49
  v_mfma_f32_16x16x32_bf16 v[40:43], a[248:251], v[92:95], v[40:43]
  v_exp_f32 v50, v50
  v_exp_f32 v51, v51
  v_mfma_f32_16x16x32_bf16 v[36:39], a[252:255], v[88:91], v[36:39]
  ds_read_b128 a[244:247], v10 offset:41216
  v_fma_f32 v52, v52, s67, v25
  v_mfma_f32_16x16x32_bf16 v[44:47], a[252:255], v[92:95], v[44:47]
  v_fma_f32 v53, v53, s67, v25
  v_fma_f32 v54, v54, s67, v25
  v_fma_f32 v55, v55, s67, v25
  s_waitcnt lgkmcnt(5)
  v_mfma_f32_16x16x32_bf16 v[32:35], a[224:227], v[96:99], v[32:35]
  ds_read_b128 a[248:251], v11 offset:33024
  v_exp_f32 v52, v52
  v_mfma_f32_16x16x32_bf16 v[40:43], a[224:227], v[100:103], v[40:43]
  v_exp_f32 v53, v53
  v_exp_f32 v54, v54
  v_mfma_f32_16x16x32_bf16 v[36:39], a[228:231], v[96:99], v[36:39]
  ds_read_b128 a[252:255], v11 offset:41216
  s_waitcnt lgkmcnt(4)
  v_cmp_le_u32 vcc, 0xb0030016, v3
  v_exp_f32 v55, v55
  v_mfma_f32_16x16x32_bf16 v[44:47], a[228:231], v[100:103], v[44:47]
  v_cvt_pk_bf16_f32 v184, v48, v49
  v_cvt_pk_bf16_f32 v185, v50, v51
  v_mfma_f32_16x16x32_bf16 v[32:35], a[232:235], v[104:107], v[32:35]
  ds_add_u32 v1, v4
  s_cbranch_vccz L_csK_9
L_cbK_9:
  ds_read_b128 a[224:227], v8 offset:49152
  v_mfma_f32_16x16x32_bf16 v[40:43], a[232:235], v[108:111], v[40:43]
  v_fma_f32 v56, v56, s67, v27
  v_fma_f32 v57, v57, s67, v27
  v_fma_f32 v58, v58, s67, v27
  v_fma_f32 v59, v59, s67, v27
  v_mfma_f32_16x16x32_bf16 v[36:39], a[236:239], v[104:107], v[36:39]
  ds_read_b128 a[228:231], v8 offset:57344
  v_exp_f32 v56, v56
  v_mfma_f32_16x16x32_bf16 v[44:47], a[236:239], v[108:111], v[44:47]
  v_exp_f32 v57, v57
  v_exp_f32 v58, v58
  s_waitcnt lgkmcnt(5)
  v_mfma_f32_16x16x32_bf16 v[32:35], a[240:243], v[112:115], v[32:35]
  ds_read_b128 a[232:235], v9 offset:49152
  v_exp_f32 v59, v59
  v_mfma_f32_16x16x32_bf16 v[40:43], a[240:243], v[116:119], v[40:43]
  v_cvt_pk_bf16_f32 v186, v52, v53
  v_cvt_pk_bf16_f32 v187, v54, v55
  v_fma_f32 v60, v60, s67, v27
  v_mfma_f32_16x16x32_bf16 v[36:39], a[244:247], v[112:115], v[36:39]
  ds_read_b128 a[236:239], v9 offset:57344
  v_fma_f32 v61, v61, s67, v27
  v_fma_f32 v62, v62, s67, v27
  v_mfma_f32_16x16x32_bf16 v[44:47], a[244:247], v[116:119], v[44:47]
  v_fma_f32 v63, v63, s67, v27
  v_exp_f32 v60, v60
  s_waitcnt lgkmcnt(5)
  v_mfma_f32_16x16x32_bf16 v[32:35], a[248:251], v[120:123], v[32:35]
  ds_read_b128 a[240:243], v10 offset:49152
  v_exp_f32 v61, v61
  v_mfma_f32_16x16x32_bf16 v[40:43], a[248:251], v[124:127], v[40:43]
  v_exp_f32 v62, v62
  v_exp_f32 v63, v63
  v_mfma_f32_16x16x32_bf16 v[36:39], a[252:255], v[120:123], v[36:39]
  ds_read_b128 a[244:247], v10 offset:57344
  v_cvt_pk_bf16_f32 v188, v56, v57
  v_cvt_pk_bf16_f32 v189, v58, v59
  v_mfma_f32_16x16x32_bf16 v[44:47], a[252:255], v[124:127], v[44:47]
  v_cvt_pk_bf16_f32 v190, v60, v61
  v_cvt_pk_bf16_f32 v191, v62, v63
  s_waitcnt lgkmcnt(4)
  v_mfma_f32_16x16x32_bf16 v[48:51], a[224:227], v[64:67], 0
  ds_read_b128 a[248:251], v11 offset:49152
  v_mfma_f32_16x16x32_bf16 v[56:59], a[224:227], v[68:71], 0
  v_mfma_f32_16x16x32_bf16 v[52:55], a[228:231], v[64:67], 0
  ds_read_b128 a[252:255], v11 offset:57344
  v_mfma_f32_16x16x32_bf16 v[60:63], a[228:231], v[68:71], 0
  s_waitcnt lgkmcnt(4)
  v_mfma_f32_16x16x32_bf16 v[48:51], a[232:235], v[72:75], v[48:51]
  ds_read_b128 a[224:227], v8 offset:49408
  v_mfma_f32_16x16x32_bf16 v[56:59], a[232:235], v[76:79], v[56:59]
  v_max3_f32 v20, v20, v32, v33
  v_max3_f32 v21, v21, v40, v41
  v_max3_f32 v20, v20, v34, v35
  v_max3_f32 v21, v21, v42, v43
  v_mfma_f32_16x16x32_bf16 v[52:55], a[236:239], v[72:75], v[52:55]
  ds_read_b128 a[228:231], v8 offset:57600
  v_max3_f32 v20, v20, v36, v37
  v_max3_f32 v21, v21, v44, v45
  v_mfma_f32_16x16x32_bf16 v[60:63], a[236:239], v[76:79], v[60:63]
  v_max3_f32 v20, v20, v38, v39
  v_max3_f32 v21, v21, v46, v47
  v_mul_f32 v18, s68, v20
  s_waitcnt lgkmcnt(4)
  v_mfma_f32_16x16x32_bf16 v[48:51], a[240:243], v[80:83], v[48:51]
  ds_read_b128 a[232:235], v9 offset:49408
  v_mul_f32 v16, s68, v21
  v_floor_f32 v24, v18
  v_mfma_f32_16x16x32_bf16 v[56:59], a[240:243], v[84:87], v[56:59]
  v_floor_f32 v26, v16
  v_accvgpr_write_b32 a48, v24
  v_accvgpr_write_b32 a49, v26
  v_fma_f32 v32, v32, s67, v24
  v_mfma_f32_16x16x32_bf16 v[52:55], a[244:247], v[80:83], v[52:55]
  ds_read_b128 a[236:239], v9 offset:57600
  ds_read_b32 v3, v2 offset:1036
  v_fma_f32 v33, v33, s67, v24
  v_mfma_f32_16x16x32_bf16 v[60:63], a[244:247], v[84:87], v[60:63]
  v_fma_f32 v34, v34, s67, v24
  v_fma_f32 v35, v35, s67, v24
  v_exp_f32 v32, v32
  s_waitcnt lgkmcnt(5)
  v_mfma_f32_16x16x32_bf16 v[48:51], a[248:251], v[88:91], v[48:51]
  ds_read_b128 a[240:243], v10 offset:49408
  v_exp_f32 v33, v33
  v_mfma_f32_16x16x32_bf16 v[56:59], a[248:251], v[92:95], v[56:59]
  v_exp_f32 v34, v34
  v_exp_f32 v35, v35
  v_mfma_f32_16x16x32_bf16 v[52:55], a[252:255], v[88:91], v[52:55]
  ds_read_b128 a[244:247], v10 offset:57600
  v_fma_f32 v36, v36, s67, v24
  v_mfma_f32_16x16x32_bf16 v[60:63], a[252:255], v[92:95], v[60:63]
  v_fma_f32 v37, v37, s67, v24
  v_fma_f32 v38, v38, s67, v24
  v_fma_f32 v39, v39, s67, v24
  s_waitcnt lgkmcnt(5)
  v_mfma_f32_16x16x32_bf16 v[48:51], a[224:227], v[96:99], v[48:51]
  ds_read_b128 a[248:251], v11 offset:49408
  v_exp_f32 v36, v36
  v_mfma_f32_16x16x32_bf16 v[56:59], a[224:227], v[100:103], v[56:59]
  v_exp_f32 v37, v37
  v_exp_f32 v38, v38
  v_mfma_f32_16x16x32_bf16 v[52:55], a[228:231], v[96:99], v[52:55]
  ds_read_b128 a[252:255], v11 offset:57600
  s_waitcnt lgkmcnt(4)
  v_cmp_le_u32 vcc, 0x3, v3
  v_exp_f32 v39, v39
  v_mfma_f32_16x16x32_bf16 v[60:63], a[228:231], v[100:103], v[60:63]
  v_cvt_pk_bf16_f32 v192, v32, v33
  v_cvt_pk_bf16_f32 v193, v34, v35
  v_mfma_f32_16x16x32_bf16 v[48:51], a[232:235], v[104:107], v[48:51]
  ds_add_u32 v1, v4
  s_cbranch_vccz L_csK_10
L_cbK_10:
  v_add_u32 v8, 65536, v8
  ds_read_b128 a[224:227], v8 offset:0
  v_mfma_f32_16x16x32_bf16 v[56:59], a[232:235], v[108:111], v[56:59]
  v_fma_f32 v40, v40, s67, v26
  v_fma_f32 v41, v41, s67, v26
  v_fma_f32 v42, v42, s67, v26
  v_fma_f32 v43, v43, s67, v26
  v_mfma_f32_16x16x32_bf16 v[52:55], a[236:239], v[104:107], v[52:55]
  ds_read_b128 a[228:231], v8 offset:8192
  v_exp_f32 v40, v40
  v_mfma_f32_16x16x32_bf16 v[60:63], a[236:239], v[108:111], v[60:63]
  v_exp_f32 v41, v41
  v_exp_f32 v42, v42
  s_waitcnt lgkmcnt(5)
  v_mfma_f32_16x16x32_bf16 v[48:51], a[240:243], v[112:115], v[48:51]
  v_add_u32 v9, 65536, v9
  ds_read_b128 a[232:235], v9 offset:0
  v_exp_f32 v43, v43
  v_mfma_f32_16x16x32_bf16 v[56:59], a[240:243], v[116:119], v[56:59]
  v_cvt_pk_bf16_f32 v194, v36, v37
  v_cvt_pk_bf16_f32 v195, v38, v39
  v_fma_f32 v44, v44, s67, v26
  v_mfma_f32_16x16x32_bf16 v[52:55], a[244:247], v[112:115], v[52:55]
  ds_read_b128 a[236:239], v9 offset:8192
  v_fma_f32 v45, v45, s67, v26
  v_fma_f32 v46, v46, s67, v26
  v_mfma_f32_16x16x32_bf16 v[60:63], a[244:247], v[116:119], v[60:63]
  v_fma_f32 v47, v47, s67, v26
  v_exp_f32 v44, v44
  s_waitcnt lgkmcnt(5)
  v_mfma_f32_16x16x32_bf16 v[48:51], a[248:251], v[120:123], v[48:51]
  v_add_u32 v10, 65536, v10
  ds_read_b128 a[240:243], v10 offset:0
  v_exp_f32 v45, v45
  v_mfma_f32_16x16x32_bf16 v[56:59], a[248:251], v[124:127], v[56:59]
  v_exp_f32 v46, v46
  v_exp_f32 v47, v47
  v_mfma_f32_16x16x32_bf16 v[52:55], a[252:255], v[120:123], v[52:55]
  ds_read_b128 a[244:247], v10 offset:8192
  v_cvt_pk_bf16_f32 v196, v40, v41
  v_cvt_pk_bf16_f32 v197, v42, v43
  v_mfma_f32_16x16x32_bf16 v[60:63], a[252:255], v[124:127], v[60:63]
  v_cvt_pk_bf16_f32 v198, v44, v45
  v_cvt_pk_bf16_f32 v199, v46, v47
  s_waitcnt lgkmcnt(4)
  v_mfma_f32_16x16x32_bf16 v[32:35], a[224:227], v[64:67], 0
  v_add_u32 v11, 65536, v11
  ds_read_b128 a[248:251], v11 offset:0
  v_mfma_f32_16x16x32_bf16 v[40:43], a[224:227], v[68:71], 0
  v_mfma_f32_16x16x32_bf16 v[36:39], a[228:231], v[64:67], 0
  ds_read_b128 a[252:255], v11 offset:8192
  v_mfma_f32_16x16x32_bf16 v[44:47], a[228:231], v[68:71], 0
  s_waitcnt lgkmcnt(4)
  v_mfma_f32_16x16x32_bf16 v[32:35], a[232:235], v[72:75], v[32:35]
  ds_read_b128 a[224:227], v8 offset:256
  v_mfma_f32_16x16x32_bf16 v[40:43], a[232:235], v[76:79], v[40:43]
  v_max3_f32 v20, v20, v48, v49
  v_max3_f32 v21, v21, v56, v57
  v_max3_f32 v20, v20, v50, v51
  v_max3_f32 v21, v21, v58, v59
  v_mfma_f32_16x16x32_bf16 v[36:39], a[236:239], v[72:75], v[36:39]
  ds_read_b128 a[228:231], v8 offset:8448
  v_max3_f32 v20, v20, v52, v53
  v_max3_f32 v21, v21, v60, v61
  v_mfma_f32_16x16x32_bf16 v[44:47], a[236:239], v[76:79], v[44:47]
  v_max3_f32 v20, v20, v54, v55
  v_max3_f32 v21, v21, v62, v63
  v_mul_f32 v18, s68, v20
  s_waitcnt lgkmcnt(4)
  v_mfma_f32_16x16x32_bf16 v[32:35], a[240:243], v[80:83], v[32:35]
  ds_read_b128 a[232:235], v9 offset:256
  v_mul_f32 v16, s68, v21
  v_floor_f32 v25, v18
  v_mfma_f32_16x16x32_bf16 v[40:43], a[240:243], v[84:87], v[40:43]
  v_floor_f32 v27, v16
  v_accvgpr_write_b32 a50, v25
  v_accvgpr_write_b32 a51, v27
  v_fma_f32 v48, v48, s67, v25
  v_mfma_f32_16x16x32_bf16 v[36:39], a[244:247], v[80:83], v[36:39]
  ds_read_b128 a[236:239], v9 offset:8448
  ds_read_b32 v3, v2 offset:2048
  v_fma_f32 v49, v49, s67, v25
  v_mfma_f32_16x16x32_bf16 v[44:47], a[244:247], v[84:87], v[44:47]
  v_fma_f32 v50, v50, s67, v25
  v_fma_f32 v51, v51, s67, v25
  v_exp_f32 v48, v48
  s_waitcnt lgkmcnt(5)
  v_mfma_f32_16x16x32_bf16 v[32:35], a[248:251], v[88:91], v[32:35]
  ds_read_b128 a[240:243], v10 offset:256
  v_exp_f32 v49, v49
  v_mfma_f32_16x16x32_bf16 v[40:43], a[248:251], v[92:95], v[40:43]
  v_exp_f32 v50, v50
  v_exp_f32 v51, v51
  v_mfma_f32_16x16x32_bf16 v[36:39], a[252:255], v[88:91], v[36:39]
  ds_read_b128 a[244:247], v10 offset:8448
  v_fma_f32 v52, v52, s67, v25
  v_mfma_f32_16x16x32_bf16 v[44:47], a[252:255], v[92:95], v[44:47]
  v_fma_f32 v53, v53, s67, v25
  v_fma_f32 v54, v54, s67, v25
  v_fma_f32 v55, v55, s67, v25
  s_waitcnt lgkmcnt(5)
  v_mfma_f32_16x16x32_bf16 v[32:35], a[224:227], v[96:99], v[32:35]
  ds_read_b128 a[248:251], v11 offset:256
  v_exp_f32 v52, v52
  v_mfma_f32_16x16x32_bf16 v[40:43], a[224:227], v[100:103], v[40:43]
  v_exp_f32 v53, v53
  v_exp_f32 v54, v54
  v_mfma_f32_16x16x32_bf16 v[36:39], a[228:231], v[96:99], v[36:39]
  ds_read_b128 a[252:255], v11 offset:8448
  s_waitcnt lgkmcnt(4)
  v_cmp_le_u32 vcc, 0xb0030017, v3
  v_exp_f32 v55, v55
  v_mfma_f32_16x16x32_bf16 v[44:47], a[228:231], v[100:103], v[44:47]
  v_cvt_pk_bf16_f32 v200, v48, v49
  v_cvt_pk_bf16_f32 v201, v50, v51
  v_mfma_f32_16x16x32_bf16 v[32:35], a[232:235], v[104:107], v[32:35]
  ds_add_u32 v1, v4
  s_cbranch_vccz L_csK_11
L_cbK_11:
  v_add_u32 v8, 65536, v8
  ds_read_b128 a[224:227], v8 offset:4096
  v_mfma_f32_16x16x32_bf16 v[40:43], a[232:235], v[108:111], v[40:43]
  v_fma_f32 v56, v56, s67, v27
  v_fma_f32 v57, v57, s67, v27
  v_fma_f32 v58, v58, s67, v27
  v_fma_f32 v59, v59, s67, v27
  v_mfma_f32_16x16x32_bf16 v[36:39], a[236:239], v[104:107], v[36:39]
  ds_read_b128 a[228:231], v8 offset:12288
  v_exp_f32 v56, v56
  v_mfma_f32_16x16x32_bf16 v[44:47], a[236:239], v[108:111], v[44:47]
  v_exp_f32 v57, v57
  v_exp_f32 v58, v58
  s_waitcnt lgkmcnt(5)
  v_mfma_f32_16x16x32_bf16 v[32:35], a[240:243], v[112:115], v[32:35]
  v_add_u32 v9, 65536, v9
  ds_read_b128 a[232:235], v9 offset:4096
  v_exp_f32 v59, v59
  v_mfma_f32_16x16x32_bf16 v[40:43], a[240:243], v[116:119], v[40:43]
  v_cvt_pk_bf16_f32 v202, v52, v53
  v_cvt_pk_bf16_f32 v203, v54, v55
  v_fma_f32 v60, v60, s67, v27
  v_mfma_f32_16x16x32_bf16 v[36:39], a[244:247], v[112:115], v[36:39]
  ds_read_b128 a[236:239], v9 offset:12288
  v_fma_f32 v61, v61, s67, v27
  v_fma_f32 v62, v62, s67, v27
  v_mfma_f32_16x16x32_bf16 v[44:47], a[244:247], v[116:119], v[44:47]
  v_fma_f32 v63, v63, s67, v27
  v_exp_f32 v60, v60
  s_waitcnt lgkmcnt(5)
  v_mfma_f32_16x16x32_bf16 v[32:35], a[248:251], v[120:123], v[32:35]
  v_add_u32 v10, 65536, v10
  ds_read_b128 a[240:243], v10 offset:4096
  v_exp_f32 v61, v61
  v_mfma_f32_16x16x32_bf16 v[40:43], a[248:251], v[124:127], v[40:43]
  v_exp_f32 v62, v62
  v_exp_f32 v63, v63
  v_mfma_f32_16x16x32_bf16 v[36:39], a[252:255], v[120:123], v[36:39]
  ds_read_b128 a[244:247], v10 offset:12288
  v_cvt_pk_bf16_f32 v204, v56, v57
  v_cvt_pk_bf16_f32 v205, v58, v59
  v_mfma_f32_16x16x32_bf16 v[44:47], a[252:255], v[124:127], v[44:47]
  v_cvt_pk_bf16_f32 v206, v60, v61
  v_cvt_pk_bf16_f32 v207, v62, v63
  s_waitcnt lgkmcnt(4)
  v_mfma_f32_16x16x32_bf16 v[48:51], a[224:227], v[64:67], 0
  v_add_u32 v11, 65536, v11
  ds_read_b128 a[248:251], v11 offset:4096
  v_mfma_f32_16x16x32_bf16 v[56:59], a[224:227], v[68:71], 0
  v_mfma_f32_16x16x32_bf16 v[52:55], a[228:231], v[64:67], 0
  ds_read_b128 a[252:255], v11 offset:12288
  v_mfma_f32_16x16x32_bf16 v[60:63], a[228:231], v[68:71], 0
  s_waitcnt lgkmcnt(4)
  v_mfma_f32_16x16x32_bf16 v[48:51], a[232:235], v[72:75], v[48:51]
  ds_read_b128 a[224:227], v8 offset:4352
  v_mfma_f32_16x16x32_bf16 v[56:59], a[232:235], v[76:79], v[56:59]
  v_max3_f32 v20, v20, v32, v33
  v_max3_f32 v21, v21, v40, v41
  v_max3_f32 v20, v20, v34, v35
  v_max3_f32 v21, v21, v42, v43
  v_mfma_f32_16x16x32_bf16 v[52:55], a[236:239], v[72:75], v[52:55]
  ds_read_b128 a[228:231], v8 offset:12544
  v_max3_f32 v20, v20, v36, v37
  v_max3_f32 v21, v21, v44, v45
  v_mfma_f32_16x16x32_bf16 v[60:63], a[236:239], v[76:79], v[60:63]
  v_max3_f32 v20, v20, v38, v39
  v_max3_f32 v21, v21, v46, v47
  v_mul_f32 v18, s68, v20
  s_waitcnt lgkmcnt(4)
  v_mfma_f32_16x16x32_bf16 v[48:51], a[240:243], v[80:83], v[48:51]
  ds_read_b128 a[232:235], v9 offset:4352
  v_mul_f32 v16, s68, v21
  v_floor_f32 v24, v18
  v_mfma_f32_16x16x32_bf16 v[56:59], a[240:243], v[84:87], v[56:59]
  v_floor_f32 v26, v16
  v_accvgpr_write_b32 a52, v24
  v_accvgpr_write_b32 a53, v26
  v_fma_f32 v32, v32, s67, v24
  v_mfma_f32_16x16x32_bf16 v[52:55], a[244:247], v[80:83], v[52:55]
  ds_read_b128 a[236:239], v9 offset:12544
  ds_read_b32 v3, v2 offset:2048
  v_fma_f32 v33, v33, s67, v24
  v_mfma_f32_16x16x32_bf16 v[60:63], a[244:247], v[84:87], v[60:63]
  v_fma_f32 v34, v34, s67, v24
  v_fma_f32 v35, v35, s67, v24
  v_exp_f32 v32, v32
  s_waitcnt lgkmcnt(5)
  v_mfma_f32_16x16x32_bf16 v[48:51], a[248:251], v[88:91], v[48:51]
  ds_read_b128 a[240:243], v10 offset:4352
  v_exp_f32 v33, v33
  v_mfma_f32_16x16x32_bf16 v[56:59], a[248:251], v[92:95], v[56:59]
  v_exp_f32 v34, v34
  v_exp_f32 v35, v35
  v_mfma_f32_16x16x32_bf16 v[52:55], a[252:255], v[88:91], v[52:55]
  ds_read_b128 a[244:247], v10 offset:12544
  v_fma_f32 v36, v36, s67, v24
  v_mfma_f32_16x16x32_bf16 v[60:63], a[252:255], v[92:95], v[60:63]
  v_fma_f32 v37, v37, s67, v24
  v_fma_f32 v38, v38, s67, v24
  v_fma_f32 v39, v39, s67, v24
  s_waitcnt lgkmcnt(5)
  v_mfma_f32_16x16x32_bf16 v[48:51], a[224:227], v[96:99], v[48:51]
  ds_read_b128 a[248:251], v11 offset:4352
  v_exp_f32 v36, v36
  v_mfma_f32_16x16x32_bf16 v[56:59], a[224:227], v[100:103], v[56:59]
  v_exp_f32 v37, v37
  v_exp_f32 v38, v38
  v_mfma_f32_16x16x32_bf16 v[52:55], a[228:231], v[96:99], v[52:55]
  ds_read_b128 a[252:255], v11 offset:12544
  s_waitcnt lgkmcnt(4)
  v_cmp_le_u32 vcc, 0xb0030018, v3
  v_exp_f32 v39, v39
  v_mfma_f32_16x16x32_bf16 v[60:63], a[228:231], v[100:103], v[60:63]
  v_cvt_pk_bf16_f32 v208, v32, v33
  v_cvt_pk_bf16_f32 v209, v34, v35
  v_mfma_f32_16x16x32_bf16 v[48:51], a[232:235], v[104:107], v[48:51]
  ds_add_u32 v1, v4
  s_cbranch_vccz L_csK_12
L_cbK_12:
  v_subrev_u32 v8, 65536, v8
  ds_read_b128 a[224:227], v8 offset:16384
  v_mfma_f32_16x16x32_bf16 v[56:59], a[232:235], v[108:111], v[56:59]
  v_fma_f32 v40, v40, s67, v26
  v_fma_f32 v41, v41, s67, v26
  v_fma_f32 v42, v42, s67, v26
  v_fma_f32 v43, v43, s67, v26
  v_mfma_f32_16x16x32_bf16 v[52:55], a[236:239], v[104:107], v[52:55]
  ds_read_b128 a[228:231], v8 offset:24576
  v_exp_f32 v40, v40
  v_mfma_f32_16x16x32_bf16 v[60:63], a[236:239], v[108:111], v[60:63]
  v_exp_f32 v41, v41
  v_exp_f32 v42, v42
  s_waitcnt lgkmcnt(5)
  v_mfma_f32_16x16x32_bf16 v[48:51], a[240:243], v[112:115], v[48:51]
  v_subrev_u32 v9, 65536, v9
  ds_read_b128 a[232:235], v9 offset:16384
  v_exp_f32 v43, v43
  v_mfma_f32_16x16x32_bf16 v[56:59], a[240:243], v[116:119], v[56:59]
  v_cvt_pk_bf16_f32 v210, v36, v37
  v_cvt_pk_bf16_f32 v211, v38, v39
  v_fma_f32 v44, v44, s67, v26
  v_mfma_f32_16x16x32_bf16 v[52:55], a[244:247], v[112:115], v[52:55]
  ds_read_b128 a[236:239], v9 offset:24576
  v_fma_f32 v45, v45, s67, v26
  v_fma_f32 v46, v46, s67, v26
  v_mfma_f32_16x16x32_bf16 v[60:63], a[244:247], v[116:119], v[60:63]
  v_fma_f32 v47, v47, s67, v26
  v_exp_f32 v44, v44
  s_waitcnt lgkmcnt(5)
  v_mfma_f32_16x16x32_bf16 v[48:51], a[248:251], v[120:123], v[48:51]
  v_subrev_u32 v10, 65536, v10
  ds_read_b128 a[240:243], v10 offset:16384
  v_exp_f32 v45, v45
  v_mfma_f32_16x16x32_bf16 v[56:59], a[248:251], v[124:127], v[56:59]
  v_exp_f32 v46, v46
  v_exp_f32 v47, v47
  v_mfma_f32_16x16x32_bf16 v[52:55], a[252:255], v[120:123], v[52:55]
  ds_read_b128 a[244:247], v10 offset:24576
  v_cvt_pk_bf16_f32 v212, v40, v41
  v_cvt_pk_bf16_f32 v213, v42, v43
  v_mfma_f32_16x16x32_bf16 v[60:63], a[252:255], v[124:127], v[60:63]
  v_cvt_pk_bf16_f32 v214, v44, v45
  v_cvt_pk_bf16_f32 v215, v46, v47
  s_waitcnt lgkmcnt(4)
  v_mfma_f32_16x16x32_bf16 v[32:35], a[224:227], v[64:67], 0
  v_subrev_u32 v11, 65536, v11
  ds_read_b128 a[248:251], v11 offset:16384
  v_mfma_f32_16x16x32_bf16 v[40:43], a[224:227], v[68:71], 0
  v_mfma_f32_16x16x32_bf16 v[36:39], a[228:231], v[64:67], 0
  ds_read_b128 a[252:255], v11 offset:24576
  v_mfma_f32_16x16x32_bf16 v[44:47], a[228:231], v[68:71], 0
  s_waitcnt lgkmcnt(4)
  v_mfma_f32_16x16x32_bf16 v[32:35], a[232:235], v[72:75], v[32:35]
  ds_read_b128 a[224:227], v8 offset:16640
  v_mfma_f32_16x16x32_bf16 v[40:43], a[232:235], v[76:79], v[40:43]
  v_max3_f32 v20, v20, v48, v49
  v_max3_f32 v21, v21, v56, v57
  v_max3_f32 v20, v20, v50, v51
  v_max3_f32 v21, v21, v58, v59
  v_mfma_f32_16x16x32_bf16 v[36:39], a[236:239], v[72:75], v[36:39]
  ds_read_b128 a[228:231], v8 offset:24832
  v_max3_f32 v20, v20, v52, v53
  v_max3_f32 v21, v21, v60, v61
  v_mfma_f32_16x16x32_bf16 v[44:47], a[236:239], v[76:79], v[44:47]
  v_max3_f32 v20, v20, v54, v55
  v_max3_f32 v21, v21, v62, v63
  v_mul_f32 v18, s68, v20
  s_waitcnt lgkmcnt(4)
  v_mfma_f32_16x16x32_bf16 v[32:35], a[240:243], v[80:83], v[32:35]
  ds_read_b128 a[232:235], v9 offset:16640
  v_mul_f32 v16, s68, v21
  v_floor_f32 v25, v18
  v_mfma_f32_16x16x32_bf16 v[40:43], a[240:243], v[84:87], v[40:43]
  v_floor_f32 v27, v16
  v_accvgpr_write_b32 a54, v25
  v_accvgpr_write_b32 a55, v27
  v_fma_f32 v48, v48, s67, v25
  v_mfma_f32_16x16x32_bf16 v[36:39], a[244:247], v[80:83], v[36:39]
  ds_read_b128 a[236:239], v9 offset:24832
  ds_read_b32 v3, v2 offset:2048
  v_fma_f32 v49, v49, s67, v25
  v_mfma_f32_16x16x32_bf16 v[44:47], a[244:247], v[84:87], v[44:47]
  v_fma_f32 v50, v50, s67, v25
  v_fma_f32 v51, v51, s67, v25
  v_exp_f32 v48, v48
  s_waitcnt lgkmcnt(5)
  v_mfma_f32_16x16x32_bf16 v[32:35], a[248:251], v[88:91], v[32:35]
  ds_read_b128 a[240:243], v10 offset:16640
  v_exp_f32 v49, v49
  v_mfma_f32_16x16x32_bf16 v[40:43], a[248:251], v[92:95], v[40:43]
  v_exp_f32 v50, v50
  v_exp_f32 v51, v51
  v_mfma_f32_16x16x32_bf16 v[36:39], a[252:255], v[88:91], v[36:39]
  ds_read_b128 a[244:247], v10 offset:24832
  v_fma_f32 v52, v52, s67, v25
  v_mfma_f32_16x16x32_bf16 v[44:47], a[252:255], v[92:95], v[44:47]
  v_fma_f32 v53, v53, s67, v25
  v_fma_f32 v54, v54, s67, v25
  v_fma_f32 v55, v55, s67, v25
  s_waitcnt lgkmcnt(5)
  v_mfma_f32_16x16x32_bf16 v[32:35], a[224:227], v[96:99], v[32:35]
  ds_read_b128 a[248:251], v11 offset:16640
  v_exp_f32 v52, v52
  v_mfma_f32_16x16x32_bf16 v[40:43], a[224:227], v[100:103], v[40:43]
  v_exp_f32 v53, v53
  v_exp_f32 v54, v54
  v_mfma_f32_16x16x32_bf16 v[36:39], a[228:231], v[96:99], v[36:39]
  ds_read_b128 a[252:255], v11 offset:24832
  s_waitcnt lgkmcnt(4)
  v_cmp_le_u32 vcc, 0xb0030019, v3
  v_exp_f32 v55, v55
  v_mfma_f32_16x16x32_bf16 v[44:47], a[228:231], v[100:103], v[44:47]
  v_cvt_pk_bf16_f32 v216, v48, v49
  v_cvt_pk_bf16_f32 v217, v50, v51
  v_mfma_f32_16x16x32_bf16 v[32:35], a[232:235], v[104:107], v[32:35]
  ds_add_u32 v1, v4
  s_cbranch_vccz L_csK_13
L_cbK_13:
  v_subrev_u32 v8, 65536, v8
  ds_read_b128 a[224:227], v8 offset:0
  v_mfma_f32_16x16x32_bf16 v[40:43], a[232:235], v[108:111], v[40:43]
  v_fma_f32 v56, v56, s67, v27
  v_fma_f32 v57, v57, s67, v27
  v_fma_f32 v58, v58, s67, v27
  v_fma_f32 v59, v59, s67, v27
  v_mfma_f32_16x16x32_bf16 v[36:39], a[236:239], v[104:107], v[36:39]
  ds_read_b128 a[228:231], v8 offset:8192
  v_exp_f32 v56, v56
  v_mfma_f32_16x16x32_bf16 v[44:47], a[236:239], v[108:111], v[44:47]
  v_exp_f32 v57, v57
  v_exp_f32 v58, v58
  s_waitcnt lgkmcnt(5)
  v_mfma_f32_16x16x32_bf16 v[32:35], a[240:243], v[112:115], v[32:35]
  v_subrev_u32 v9, 65536, v9
  ds_read_b128 a[232:235], v9 offset:0
  v_exp_f32 v59, v59
  v_mfma_f32_16x16x32_bf16 v[40:43], a[240:243], v[116:119], v[40:43]
  v_cvt_pk_bf16_f32 v218, v52, v53
  v_cvt_pk_bf16_f32 v219, v54, v55
  v_fma_f32 v60, v60, s67, v27
  v_mfma_f32_16x16x32_bf16 v[36:39], a[244:247], v[112:115], v[36:39]
  ds_read_b128 a[236:239], v9 offset:8192
  v_fma_f32 v61, v61, s67, v27
  v_fma_f32 v62, v62, s67, v27
  v_mfma_f32_16x16x32_bf16 v[44:47], a[244:247], v[116:119], v[44:47]
  v_fma_f32 v63, v63, s67, v27
  v_exp_f32 v60, v60
  s_waitcnt lgkmcnt(5)
  v_mfma_f32_16x16x32_bf16 v[32:35], a[248:251], v[120:123], v[32:35]
  v_subrev_u32 v10, 65536, v10
  ds_read_b128 a[240:243], v10 offset:0
  v_exp_f32 v61, v61
  v_mfma_f32_16x16x32_bf16 v[40:43], a[248:251], v[124:127], v[40:43]
  v_exp_f32 v62, v62
  v_exp_f32 v63, v63
  v_mfma_f32_16x16x32_bf16 v[36:39], a[252:255], v[120:123], v[36:39]
  ds_read_b128 a[244:247], v10 offset:8192
  v_cvt_pk_bf16_f32 v220, v56, v57
  v_cvt_pk_bf16_f32 v221, v58, v59
  v_mfma_f32_16x16x32_bf16 v[44:47], a[252:255], v[124:127], v[44:47]
  v_cvt_pk_bf16_f32 v222, v60, v61
  v_cvt_pk_bf16_f32 v223, v62, v63
  s_waitcnt lgkmcnt(4)
  v_mfma_f32_16x16x32_bf16 v[48:51], a[224:227], v[64:67], 0
  v_subrev_u32 v11, 65536, v11
  ds_read_b128 a[248:251], v11 offset:0
  v_mfma_f32_16x16x32_bf16 v[56:59], a[224:227], v[68:71], 0
  v_mfma_f32_16x16x32_bf16 v[52:55], a[228:231], v[64:67], 0
  ds_read_b128 a[252:255], v11 offset:8192
  v_mfma_f32_16x16x32_bf16 v[60:63], a[228:231], v[68:71], 0
  s_waitcnt lgkmcnt(4)
  v_mfma_f32_16x16x32_bf16 v[48:51], a[232:235], v[72:75], v[48:51]
  ds_read_b128 a[224:227], v8 offset:256
  v_mfma_f32_16x16x32_bf16 v[56:59], a[232:235], v[76:79], v[56:59]
  v_max3_f32 v20, v20, v32, v33
  v_max3_f32 v21, v21, v40, v41
  v_max3_f32 v20, v20, v34, v35
  v_max3_f32 v21, v21, v42, v43
  v_mfma_f32_16x16x32_bf16 v[52:55], a[236:239], v[72:75], v[52:55]
  ds_read_b128 a[228:231], v8 offset:8448
  v_max3_f32 v20, v20, v36, v37
  v_max3_f32 v21, v21, v44, v45
  v_mfma_f32_16x16x32_bf16 v[60:63], a[236:239], v[76:79], v[60:63]
  v_max3_f32 v20, v20, v38, v39
  v_max3_f32 v21, v21, v46, v47
  v_mul_f32 v18, s68, v20
  s_waitcnt lgkmcnt(4)
  v_mfma_f32_16x16x32_bf16 v[48:51], a[240:243], v[80:83], v[48:51]
  ds_read_b128 a[232:235], v9 offset:256
  v_mul_f32 v16, s68, v21
  v_floor_f32 v24, v18
  v_mfma_f32_16x16x32_bf16 v[56:59], a[240:243], v[84:87], v[56:59]
  v_floor_f32 v26, v16
  v_accvgpr_write_b32 a56, v24
  v_accvgpr_write_b32 a57, v26
  v_fma_f32 v32, v32, s67, v24
  v_mfma_f32_16x16x32_bf16 v[52:55], a[244:247], v[80:83], v[52:55]
  ds_read_b128 a[236:239], v9 offset:8448
  ds_read_b32 v3, v2 offset:1036
  v_fma_f32 v33, v33, s67, v24
  v_mfma_f32_16x16x32_bf16 v[60:63], a[244:247], v[84:87], v[60:63]
  v_fma_f32 v34, v34, s67, v24
  v_fma_f32 v35, v35, s67, v24
  v_exp_f32 v32, v32
  s_waitcnt lgkmcnt(5)
  v_mfma_f32_16x16x32_bf16 v[48:51], a[248:251], v[88:91], v[48:51]
  ds_read_b128 a[240:243], v10 offset:256
  v_exp_f32 v33, v33
  v_mfma_f32_16x16x32_bf16 v[56:59], a[248:251], v[92:95], v[56:59]
  v_exp_f32 v34, v34
  v_exp_f32 v35, v35
  v_mfma_f32_16x16x32_bf16 v[52:55], a[252:255], v[88:91], v[52:55]
  ds_read_b128 a[244:247], v10 offset:8448
  v_fma_f32 v36, v36, s67, v24
  v_mfma_f32_16x16x32_bf16 v[60:63], a[252:255], v[92:95], v[60:63]
  v_fma_f32 v37, v37, s67, v24
  v_fma_f32 v38, v38, s67, v24
  v_fma_f32 v39, v39, s67, v24
  s_waitcnt lgkmcnt(5)
  v_mfma_f32_16x16x32_bf16 v[48:51], a[224:227], v[96:99], v[48:51]
  ds_read_b128 a[248:251], v11 offset:256
  v_exp_f32 v36, v36
  v_mfma_f32_16x16x32_bf16 v[56:59], a[224:227], v[100:103], v[56:59]
  v_exp_f32 v37, v37
  v_exp_f32 v38, v38
  v_mfma_f32_16x16x32_bf16 v[52:55], a[228:231], v[96:99], v[52:55]
  ds_read_b128 a[252:255], v11 offset:8448
  s_waitcnt lgkmcnt(4)
  v_cmp_le_u32 vcc, 0x4, v3
  v_exp_f32 v39, v39
  v_mfma_f32_16x16x32_bf16 v[60:63], a[228:231], v[100:103], v[60:63]
  v_cvt_pk_bf16_f32 v224, v32, v33
  v_cvt_pk_bf16_f32 v225, v34, v35
  v_mfma_f32_16x16x32_bf16 v[48:51], a[232:235], v[104:107], v[48:51]
  ds_add_u32 v1, v4
  s_cbranch_vccz L_csK_14
L_cbK_14:
  v_add_u32 v8, 65536, v8
  ds_read_b128 a[224:227], v8 offset:45056
  v_mfma_f32_16x16x32_bf16 v[56:59], a[232:235], v[108:111], v[56:59]
  v_fma_f32 v40, v40, s67, v26
  v_fma_f32 v41, v41, s67, v26
  v_fma_f32 v42, v42, s67, v26
  v_fma_f32 v43, v43, s67, v26
  v_mfma_f32_16x16x32_bf16 v[52:55], a[236:239], v[104:107], v[52:55]
  ds_read_b128 a[228:231], v8 offset:53248
  v_exp_f32 v40, v40
  v_mfma_f32_16x16x32_bf16 v[60:63], a[236:239], v[108:111], v[60:63]
  v_exp_f32 v41, v41
  v_exp_f32 v42, v42
  s_waitcnt lgkmcnt(5)
  v_mfma_f32_16x16x32_bf16 v[48:51], a[240:243], v[112:115], v[48:51]
  v_add_u32 v9, 65536, v9
  ds_read_b128 a[232:235], v9 offset:45056
  v_exp_f32 v43, v43
  v_mfma_f32_16x16x32_bf16 v[56:59], a[240:243], v[116:119], v[56:59]
  v_cvt_pk_bf16_f32 v226, v36, v37
  v_cvt_pk_bf16_f32 v227, v38, v39
  v_fma_f32 v44, v44, s67, v26
  v_mfma_f32_16x16x32_bf16 v[52:55], a[244:247], v[112:115], v[52:55]
  ds_read_b128 a[236:239], v9 offset:53248
  v_fma_f32 v45, v45, s67, v26
  v_fma_f32 v46, v46, s67, v26
  v_mfma_f32_16x16x32_bf16 v[60:63], a[244:247], v[116:119], v[60:63]
  v_fma_f32 v47, v47, s67, v26
  v_exp_f32 v44, v44
  s_waitcnt lgkmcnt(5)
  v_mfma_f32_16x16x32_bf16 v[48:51], a[248:251], v[120:123], v[48:51]
  v_add_u32 v10, 65536, v10
  ds_read_b128 a[240:243], v10 offset:45056
  v_exp_f32 v45, v45
  v_mfma_f32_16x16x32_bf16 v[56:59], a[248:251], v[124:127], v[56:59]
  v_exp_f32 v46, v46
  v_exp_f32 v47, v47
  v_mfma_f32_16x16x32_bf16 v[52:55], a[252:255], v[120:123], v[52:55]
  ds_read_b128 a[244:247], v10 offset:53248
  v_cvt_pk_bf16_f32 v228, v40, v41
  v_cvt_pk_bf16_f32 v229, v42, v43
  v_mfma_f32_16x16x32_bf16 v[60:63], a[252:255], v[124:127], v[60:63]
  v_cvt_pk_bf16_f32 v230, v44, v45
  v_cvt_pk_bf16_f32 v231, v46, v47
  s_waitcnt lgkmcnt(4)
  v_mfma_f32_16x16x32_bf16 v[32:35], a[224:227], v[64:67], 0
  v_add_u32 v11, 65536, v11
  ds_read_b128 a[248:251], v11 offset:45056
  v_mfma_f32_16x16x32_bf16 v[40:43], a[224:227], v[68:71], 0
  v_mfma_f32_16x16x32_bf16 v[36:39], a[228:231], v[64:67], 0
  ds_read_b128 a[252:255], v11 offset:53248
  v_mfma_f32_16x16x32_bf16 v[44:47], a[228:231], v[68:71], 0
  s_waitcnt lgkmcnt(4)
  v_mfma_f32_16x16x32_bf16 v[32:35], a[232:235], v[72:75], v[32:35]
  ds_read_b128 a[224:227], v8 offset:45312
  v_mfma_f32_16x16x32_bf16 v[40:43], a[232:235], v[76:79], v[40:43]
  v_max3_f32 v20, v20, v48, v49
  v_max3_f32 v21, v21, v56, v57
  v_max3_f32 v20, v20, v50, v51
  v_max3_f32 v21, v21, v58, v59
  v_mfma_f32_16x16x32_bf16 v[36:39], a[236:239], v[72:75], v[36:39]
  ds_read_b128 a[228:231], v8 offset:53504
  v_max3_f32 v20, v20, v52, v53
  v_max3_f32 v21, v21, v60, v61
  v_mfma_f32_16x16x32_bf16 v[44:47], a[236:239], v[76:79], v[44:47]
  v_max3_f32 v20, v20, v54, v55
  v_max3_f32 v21, v21, v62, v63
  v_mul_f32 v18, s68, v20
  s_waitcnt lgkmcnt(4)
  v_mfma_f32_16x16x32_bf16 v[32:35], a[240:243], v[80:83], v[32:35]
  ds_read_b128 a[232:235], v9 offset:45312
  v_mul_f32 v16, s68, v21
  v_floor_f32 v25, v18
  v_mfma_f32_16x16x32_bf16 v[40:43], a[240:243], v[84:87], v[40:43]
  v_floor_f32 v27, v16
  v_accvgpr_write_b32 a58, v25
  v_accvgpr_write_b32 a59, v27
  v_fma_f32 v48, v48, s67, v25
  v_mfma_f32_16x16x32_bf16 v[36:39], a[244:247], v[80:83], v[36:39]
  ds_read_b128 a[236:239], v9 offset:53504
  ds_read_b32 v3, v2 offset:2048
  v_fma_f32 v49, v49, s67, v25
  v_mfma_f32_16x16x32_bf16 v[44:47], a[244:247], v[84:87], v[44:47]
  v_fma_f32 v50, v50, s67, v25
  v_fma_f32 v51, v51, s67, v25
  v_exp_f32 v48, v48
  s_waitcnt lgkmcnt(5)
  v_mfma_f32_16x16x32_bf16 v[32:35], a[248:251], v[88:91], v[32:35]
  ds_read_b128 a[240:243], v10 offset:45312
  v_exp_f32 v49, v49
  v_mfma_f32_16x16x32_bf16 v[40:43], a[248:251], v[92:95], v[40:43]
  v_exp_f32 v50, v50
  v_exp_f32 v51, v51
  v_mfma_f32_16x16x32_bf16 v[36:39], a[252:255], v[88:91], v[36:39]
  ds_read_b128 a[244:247], v10 offset:53504
  v_fma_f32 v52, v52, s67, v25
  v_mfma_f32_16x16x32_bf16 v[44:47], a[252:255], v[92:95], v[44:47]
  v_fma_f32 v53, v53, s67, v25
  v_fma_f32 v54, v54, s67, v25
  v_fma_f32 v55, v55, s67, v25
  s_waitcnt lgkmcnt(5)
  v_mfma_f32_16x16x32_bf16 v[32:35], a[224:227], v[96:99], v[32:35]
  ds_read_b128 a[248:251], v11 offset:45312
  v_exp_f32 v52, v52
  v_mfma_f32_16x16x32_bf16 v[40:43], a[224:227], v[100:103], v[40:43]
  v_exp_f32 v53, v53
  v_exp_f32 v54, v54
  v_mfma_f32_16x16x32_bf16 v[36:39], a[228:231], v[96:99], v[36:39]
  ds_read_b128 a[252:255], v11 offset:53504
  s_waitcnt lgkmcnt(4)
  v_cmp_le_u32 vcc, 0xb003001a, v3
  v_exp_f32 v55, v55
  v_mfma_f32_16x16x32_bf16 v[44:47], a[228:231], v[100:103], v[44:47]
  v_cvt_pk_bf16_f32 v232, v48, v49
  v_cvt_pk_bf16_f32 v233, v50, v51
  v_mfma_f32_16x16x32_bf16 v[32:35], a[232:235], v[104:107], v[32:35]
  ds_add_u32 v1, v4
  s_cbranch_vccz L_csK_15
L_cbK_15:
  v_subrev_u32 v8, 65536, v8
  ds_read_b128 a[224:227], v8 offset:16384
  v_mfma_f32_16x16x32_bf16 v[40:43], a[232:235], v[108:111], v[40:43]
  v_fma_f32 v56, v56, s67, v27
  v_fma_f32 v57, v57, s67, v27
  v_fma_f32 v58, v58, s67, v27
  v_fma_f32 v59, v59, s67, v27
  v_mfma_f32_16x16x32_bf16 v[36:39], a[236:239], v[104:107], v[36:39]
  ds_read_b128 a[228:231], v8 offset:24576
  v_exp_f32 v56, v56
  v_mfma_f32_16x16x32_bf16 v[44:47], a[236:239], v[108:111], v[44:47]
  v_exp_f32 v57, v57
  v_exp_f32 v58, v58
  s_waitcnt lgkmcnt(5)
  v_mfma_f32_16x16x32_bf16 v[32:35], a[240:243], v[112:115], v[32:35]
  v_subrev_u32 v9, 65536, v9
  ds_read_b128 a[232:235], v9 offset:16384
  v_exp_f32 v59, v59
  v_mfma_f32_16x16x32_bf16 v[40:43], a[240:243], v[116:119], v[40:43]
  v_cvt_pk_bf16_f32 v234, v52, v53
  v_cvt_pk_bf16_f32 v235, v54, v55
  v_fma_f32 v60, v60, s67, v27
  v_mfma_f32_16x16x32_bf16 v[36:39], a[244:247], v[112:115], v[36:39]
  ds_read_b128 a[236:239], v9 offset:24576
  v_fma_f32 v61, v61, s67, v27
  v_fma_f32 v62, v62, s67, v27
  v_mfma_f32_16x16x32_bf16 v[44:47], a[244:247], v[116:119], v[44:47]
  v_fma_f32 v63, v63, s67, v27
  v_exp_f32 v60, v60
  s_waitcnt lgkmcnt(5)
  v_mfma_f32_16x16x32_bf16 v[32:35], a[248:251], v[120:123], v[32:35]
  v_subrev_u32 v10, 65536, v10
  ds_read_b128 a[240:243], v10 offset:16384
  v_exp_f32 v61, v61
  v_mfma_f32_16x16x32_bf16 v[40:43], a[248:251], v[124:127], v[40:43]
  v_exp_f32 v62, v62
  v_exp_f32 v63, v63
  v_mfma_f32_16x16x32_bf16 v[36:39], a[252:255], v[120:123], v[36:39]
  ds_read_b128 a[244:247], v10 offset:24576
  v_cvt_pk_bf16_f32 v236, v56, v57
  v_cvt_pk_bf16_f32 v237, v58, v59
  v_mfma_f32_16x16x32_bf16 v[44:47], a[252:255], v[124:127], v[44:47]
  v_cvt_pk_bf16_f32 v238, v60, v61
  v_cvt_pk_bf16_f32 v239, v62, v63
  s_waitcnt lgkmcnt(4)
  v_mfma_f32_16x16x32_bf16 v[48:51], a[224:227], v[64:67], 0
  v_subrev_u32 v11, 65536, v11
  ds_read_b128 a[248:251], v11 offset:16384
  v_mfma_f32_16x16x32_bf16 v[56:59], a[224:227], v[68:71], 0
  v_mfma_f32_16x16x32_bf16 v[52:55], a[228:231], v[64:67], 0
  ds_read_b128 a[252:255], v11 offset:24576
  v_mfma_f32_16x16x32_bf16 v[60:63], a[228:231], v[68:71], 0
  s_waitcnt lgkmcnt(4)
  v_mfma_f32_16x16x32_bf16 v[48:51], a[232:235], v[72:75], v[48:51]
  ds_read_b128 a[224:227], v8 offset:16640
  v_mfma_f32_16x16x32_bf16 v[56:59], a[232:235], v[76:79], v[56:59]
  v_max3_f32 v20, v20, v32, v33
  v_max3_f32 v21, v21, v40, v41
  v_max3_f32 v20, v20, v34, v35
  v_max3_f32 v21, v21, v42, v43
  v_mfma_f32_16x16x32_bf16 v[52:55], a[236:239], v[72:75], v[52:55]
  ds_read_b128 a[228:231], v8 offset:24832
  v_max3_f32 v20, v20, v36, v37
  v_max3_f32 v21, v21, v44, v45
  v_max3_f32 v20, v20, v38, v39
  v_mfma_f32_16x16x32_bf16 v[60:63], a[236:239], v[76:79], v[60:63]
  v_max3_f32 v21, v21, v46, v47
  v_mul_f32 v18, s68, v20
  s_waitcnt lgkmcnt(4)
  v_mfma_f32_16x16x32_bf16 v[48:51], a[240:243], v[80:83], v[48:51]
  ds_read_b128 a[232:235], v9 offset:16640
  v_mul_f32 v16, s68, v21
  v_floor_f32 v24, v18
  v_floor_f32 v26, v16
  v_mfma_f32_16x16x32_bf16 v[56:59], a[240:243], v[84:87], v[56:59]
  v_accvgpr_write_b32 a60, v24
  v_accvgpr_write_b32 a61, v26
  v_fma_f32 v32, v32, s67, v24
  v_fma_f32 v33, v33, s67, v24
  v_mfma_f32_16x16x32_bf16 v[52:55], a[244:247], v[80:83], v[52:55]
  ds_read_b128 a[236:239], v9 offset:24832
  ds_read_b32 v3, v2 offset:2048
  v_fma_f32 v34, v34, s67, v24
  v_fma_f32 v35, v35, s67, v24
  v_mfma_f32_16x16x32_bf16 v[60:63], a[244:247], v[84:87], v[60:63]
  v_exp_f32 v32, v32
  s_waitcnt lgkmcnt(5)
  v_mfma_f32_16x16x32_bf16 v[48:51], a[248:251], v[88:91], v[48:51]
  ds_read_b128 a[240:243], v10 offset:16640
  v_exp_f32 v33, v33
  v_exp_f32 v34, v34
  v_mfma_f32_16x16x32_bf16 v[56:59], a[248:251], v[92:95], v[56:59]
  v_exp_f32 v35, v35
  v_fma_f32 v36, v36, s67, v24
  v_mfma_f32_16x16x32_bf16 v[52:55], a[252:255], v[88:91], v[52:55]
  ds_read_b128 a[244:247], v10 offset:24832
  v_fma_f32 v37, v37, s67, v24
  v_fma_f32 v38, v38, s67, v24
  v_mfma_f32_16x16x32_bf16 v[60:63], a[252:255], v[92:95], v[60:63]
  v_fma_f32 v39, v39, s67, v24
  v_exp_f32 v36, v36
  s_waitcnt lgkmcnt(5)
  v_mfma_f32_16x16x32_bf16 v[48:51], a[224:227], v[96:99], v[48:51]
  ds_read_b128 a[248:251], v11 offset:16640
  v_exp_f32 v37, v37
  v_exp_f32 v38, v38
  v_mfma_f32_16x16x32_bf16 v[56:59], a[224:227], v[100:103], v[56:59]
  v_exp_f32 v39, v39
  v_mfma_f32_16x16x32_bf16 v[52:55], a[228:231], v[96:99], v[52:55]
  ds_read_b128 a[252:255], v11 offset:24832
  s_waitcnt lgkmcnt(4)
  v_cmp_le_u32 vcc, 0xb003001b, v3
  v_cvt_pk_bf16_f32 v240, v32, v33
  v_cvt_pk_bf16_f32 v241, v34, v35
  v_mfma_f32_16x16x32_bf16 v[60:63], a[228:231], v[100:103], v[60:63]
  v_fma_f32 v40, v40, s67, v26
  v_fma_f32 v41, v41, s67, v26
  v_fma_f32 v42, v42, s67, v26
  v_mfma_f32_16x16x32_bf16 v[48:51], a[232:235], v[104:107], v[48:51]
  ds_add_u32 v1, v4
  s_cbranch_vccz L_csV_0_0
L_cbV_0_0:
  ds_read_b64_tr_b16 a[224:225], v12 offset:32768
  v_fma_f32 v43, v43, s67, v26
  v_mfma_f32_16x16x32_bf16 v[56:59], a[232:235], v[108:111], v[56:59]
  ds_read_b64_tr_b16 a[226:227], v12 offset:34816
  v_exp_f32 v40, v40
  v_mfma_f32_16x16x32_bf16 v[52:55], a[236:239], v[104:107], v[52:55]
  ds_read_b64_tr_b16 a[228:229], v13 offset:32768
  v_exp_f32 v41, v41
  v_exp_f32 v42, v42
  v_mfma_f32_16x16x32_bf16 v[60:63], a[236:239], v[108:111], v[60:63]
  ds_read_b64_tr_b16 a[230:231], v13 offset:34816
  v_exp_f32 v43, v43
  s_waitcnt lgkmcnt(7)
  v_mfma_f32_16x16x32_bf16 v[48:51], a[240:243], v[112:115], v[48:51]
  ds_read_b64_tr_b16 a[232:233], v14 offset:32768
  v_cvt_pk_bf16_f32 v242, v36, v37
  v_mfma_f32_16x16x32_bf16 v[56:59], a[240:243], v[116:119], v[56:59]
  ds_read_b64_tr_b16 a[234:235], v14 offset:34816
  v_cvt_pk_bf16_f32 v243, v38, v39
  v_fma_f32 v44, v44, s67, v26
  v_fma_f32 v45, v45, s67, v26
  v_mfma_f32_16x16x32_bf16 v[52:55], a[244:247], v[112:115], v[52:55]
  ds_read_b64_tr_b16 a[236:237], v15 offset:32768
  v_fma_f32 v46, v46, s67, v26
  v_fma_f32 v47, v47, s67, v26
  v_exp_f32 v44, v44
  v_mfma_f32_16x16x32_bf16 v[60:63], a[244:247], v[116:119], v[60:63]
  ds_read_b64_tr_b16 a[238:239], v15 offset:34816
  v_exp_f32 v45, v45
  s_waitcnt lgkmcnt(9)
  v_mfma_f32_16x16x32_bf16 v[48:51], a[248:251], v[120:123], v[48:51]
  ds_read_b64_tr_b16 a[240:241], v12 offset:36864
  v_exp_f32 v46, v46
  v_mfma_f32_16x16x32_bf16 v[56:59], a[248:251], v[124:127], v[56:59]
  ds_read_b64_tr_b16 a[242:243], v12 offset:38912
  v_exp_f32 v47, v47
  v_mfma_f32_16x16x32_bf16 v[52:55], a[252:255], v[120:123], v[52:55]
  ds_read_b64_tr_b16 a[244:245], v13 offset:36864
  v_cvt_pk_bf16_f32 v244, v40, v41
  v_cvt_pk_bf16_f32 v245, v42, v43
  v_cvt_pk_bf16_f32 v246, v44, v45
  v_mfma_f32_16x16x32_bf16 v[60:63], a[252:255], v[124:127], v[60:63]
  ds_read_b64_tr_b16 a[246:247], v13 offset:38912
  v_cvt_pk_bf16_f32 v247, v46, v47
  v_max3_f32 v20, v20, v48, v49
  v_max3_f32 v21, v21, v56, v57
  v_max3_f32 v20, v20, v50, v51
  v_max3_f32 v21, v21, v58, v59
  v_max3_f32 v20, v20, v52, v53
  s_nop 0
  v_max3_f32 v21, v21, v60, v61
  v_max3_f32 v20, v20, v54, v55
  v_max3_f32 v21, v21, v62, v63
  s_nop 1
  v_permlane16_swap_b32 v20, v21
  v_max_f32 v20, v20, v21
  v_mov_b32 v21, v20
  s_nop 1
  v_permlane32_swap_b32 v20, v21
  v_max_f32 v20, v20, v21
  v_mov_b32 v21, v20
  s_nop 1
  v_permlane16_swap_b32 v20, v21
  v_mul_f32 v18, s68, v20
  v_mul_f32 v16, s68, v21
  v_floor_f32 v25, v18
  v_floor_f32 v27, v16
  v_accvgpr_read_b32 v19, a32
  v_accvgpr_read_b32 v17, a33
  v_sub_f32 v19, v19, v25
  v_sub_f32 v17, v17, v27
  v_cvt_u32_f32 v19, v19
  v_cvt_u32_f32 v17, v17
  v_min_u32 v19, 0xff, v19
  v_min_u32 v17, 0xff, v17
  v_mul_u32_u24 v19, 0x800080, v19
  v_mul_u32_u24 v17, 0x800080, v17
  v_pk_sub_u16 v128, v128, v19 clamp
  v_pk_sub_u16 v132, v132, v17 clamp
  v_pk_sub_u16 v129, v129, v19 clamp
  v_pk_sub_u16 v133, v133, v17 clamp
  v_pk_sub_u16 v130, v130, v19 clamp
  v_pk_sub_u16 v134, v134, v17 clamp
  v_pk_sub_u16 v131, v131, v19 clamp
  v_pk_sub_u16 v135, v135, v17 clamp
  s_waitcnt lgkmcnt(8)
  v_mfma_f32_16x16x32_bf16 v[64:67], a[224:227], v[128:131], 0
  ds_read_b64_tr_b16 a[248:249], v14 offset:36864
  v_accvgpr_read_b32 v19, a34
  v_accvgpr_read_b32 v17, a35
  v_sub_f32 v19, v19, v25
  v_mfma_f32_16x16x32_bf16 v[68:71], a[224:227], v[132:135], 0
  ds_read_b64_tr_b16 a[250:251], v14 offset:38912
  v_sub_f32 v17, v17, v27
  v_cvt_u32_f32 v19, v19
  v_cvt_u32_f32 v17, v17
  v_mfma_f32_16x16x32_bf16 a[100:103], a[96:99], v[128:131], 0
  v_mfma_f32_16x16x32_bf16 v[72:75], a[228:231], v[128:131], 0
  ds_read_b64_tr_b16 a[252:253], v15 offset:36864
  v_min_u32 v19, 0xff, v19
  v_min_u32 v17, 0xff, v17
  v_mul_u32_u24 v19, 0x800080, v19
  v_mfma_f32_16x16x32_bf16 v[76:79], a[228:231], v[132:135], 0
  ds_read_b64_tr_b16 a[254:255], v15 offset:38912
  v_mul_u32_u24 v17, 0x800080, v17
  v_fma_f32 v48, v48, s67, v25
  s_waitcnt lgkmcnt(8)
  v_mfma_f32_16x16x32_bf16 v[80:83], a[232:235], v[128:131], 0
  ds_read_b64_tr_b16 a[224:225], v12 offset:40960
  v_pk_sub_u16 v136, v136, v19 clamp
  v_pk_sub_u16 v140, v140, v17 clamp
  v_pk_sub_u16 v137, v137, v19 clamp
  v_mfma_f32_16x16x32_bf16 v[84:87], a[232:235], v[132:135], 0
  ds_read_b64_tr_b16 a[226:227], v12 offset:43008
  v_pk_sub_u16 v141, v141, v17 clamp
  v_pk_sub_u16 v138, v138, v19 clamp
  v_pk_sub_u16 v142, v142, v17 clamp
  v_mfma_f32_16x16x32_bf16 a[104:107], a[96:99], v[132:135], 0
  v_mfma_f32_16x16x32_bf16 v[88:91], a[236:239], v[128:131], 0
  ds_read_b64_tr_b16 a[228:229], v13 offset:40960
  v_pk_sub_u16 v139, v139, v19 clamp
  v_pk_sub_u16 v143, v143, v17 clamp
  v_fma_f32 v49, v49, s67, v25
  v_mfma_f32_16x16x32_bf16 v[92:95], a[236:239], v[132:135], 0
  ds_read_b64_tr_b16 a[230:231], v13 offset:43008
  v_fma_f32 v50, v50, s67, v25
  v_fma_f32 v51, v51, s67, v25
  s_waitcnt lgkmcnt(8)
  v_mfma_f32_16x16x32_bf16 v[64:67], a[240:243], v[136:139], v[64:67]
  ds_read_b64_tr_b16 a[232:233], v14 offset:40960
  v_accvgpr_read_b32 v19, a36
  v_accvgpr_read_b32 v17, a37
  v_sub_f32 v19, v19, v25
  v_mfma_f32_16x16x32_bf16 v[68:71], a[240:243], v[140:143], v[68:71]
  ds_read_b64_tr_b16 a[234:235], v14 offset:43008
  v_sub_f32 v17, v17, v27
  v_cvt_u32_f32 v19, v19
  v_cvt_u32_f32 v17, v17
  v_mfma_f32_16x16x32_bf16 a[100:103], a[96:99], v[136:139], a[100:103]
  v_mfma_f32_16x16x32_bf16 v[72:75], a[244:247], v[136:139], v[72:75]
  ds_read_b64_tr_b16 a[236:237], v15 offset:40960
  ds_read_b32 v3, v2 offset:2048
  v_min_u32 v19, 0xff, v19
  v_min_u32 v17, 0xff, v17
  v_mfma_f32_16x16x32_bf16 v[76:79], a[244:247], v[140:143], v[76:79]
  ds_read_b64_tr_b16 a[238:239], v15 offset:43008
  v_mul_u32_u24 v19, 0x800080, v19
  v_mul_u32_u24 v17, 0x800080, v17
  s_waitcnt lgkmcnt(9)
  v_mfma_f32_16x16x32_bf16 v[80:83], a[248:251], v[136:139], v[80:83]
  ds_read_b64_tr_b16 a[240:241], v12 offset:45056
  v_pk_sub_u16 v144, v144, v19 clamp
  v_pk_sub_u16 v148, v148, v17 clamp
  v_pk_sub_u16 v145, v145, v19 clamp
  v_mfma_f32_16x16x32_bf16 v[84:87], a[248:251], v[140:143], v[84:87]
  ds_read_b64_tr_b16 a[242:243], v12 offset:47104
  v_pk_sub_u16 v149, v149, v17 clamp
  v_pk_sub_u16 v146, v146, v19 clamp
  v_pk_sub_u16 v150, v150, v17 clamp
  v_mfma_f32_16x16x32_bf16 a[104:107], a[96:99], v[140:143], a[104:107]
  v_mfma_f32_16x16x32_bf16 v[88:91], a[252:255], v[136:139], v[88:91]
  ds_read_b64_tr_b16 a[244:245], v13 offset:45056
  v_pk_sub_u16 v147, v147, v19 clamp
  v_pk_sub_u16 v151, v151, v17 clamp
  v_exp_f32 v48, v48
  v_mfma_f32_16x16x32_bf16 v[92:95], a[252:255], v[140:143], v[92:95]
  ds_read_b64_tr_b16 a[246:247], v13 offset:47104
  v_exp_f32 v49, v49
  s_waitcnt lgkmcnt(9)
  v_mfma_f32_16x16x32_bf16 v[64:67], a[224:227], v[144:147], v[64:67]
  ds_read_b64_tr_b16 a[248:249], v14 offset:45056
  v_accvgpr_read_b32 v19, a38
  v_accvgpr_read_b32 v17, a39
  v_sub_f32 v19, v19, v25
  v_mfma_f32_16x16x32_bf16 v[68:71], a[224:227], v[148:151], v[68:71]
  ds_read_b64_tr_b16 a[250:251], v14 offset:47104
  v_sub_f32 v17, v17, v27
  v_cvt_u32_f32 v19, v19
  v_cvt_u32_f32 v17, v17
  v_mfma_f32_16x16x32_bf16 a[100:103], a[96:99], v[144:147], a[100:103]
  v_mfma_f32_16x16x32_bf16 v[72:75], a[228:231], v[144:147], v[72:75]
  ds_read_b64_tr_b16 a[252:253], v15 offset:45056
  s_waitcnt lgkmcnt(8)
  v_cmp_le_u32 vcc, 0xb003001c, v3
  v_min_u32 v19, 0xff, v19
  v_min_u32 v17, 0xff, v17
  v_mul_u32_u24 v19, 0x800080, v19
  v_mfma_f32_16x16x32_bf16 v[76:79], a[228:231], v[148:151], v[76:79]
  ds_read_b64_tr_b16 a[254:255], v15 offset:47104
  v_mul_u32_u24 v17, 0x800080, v17
  v_pk_sub_u16 v152, v152, v19 clamp
  s_waitcnt lgkmcnt(8)
  v_mfma_f32_16x16x32_bf16 v[80:83], a[232:235], v[144:147], v[80:83]
  ds_add_u32 v1, v4
  s_cbranch_vccz L_csV_0_1
L_cbV_0_1:
  ds_read_b64_tr_b16 a[224:225], v12 offset:49152
  v_pk_sub_u16 v156, v156, v17 clamp
  v_mfma_f32_16x16x32_bf16 v[84:87], a[232:235], v[148:151], v[84:87]
  ds_read_b64_tr_b16 a[226:227], v12 offset:51200
  v_pk_sub_u16 v153, v153, v19 clamp
  v_pk_sub_u16 v157, v157, v17 clamp
  v_pk_sub_u16 v154, v154, v19 clamp
  v_mfma_f32_16x16x32_bf16 a[104:107], a[96:99], v[148:151], a[104:107]
  v_mfma_f32_16x16x32_bf16 v[88:91], a[236:239], v[144:147], v[88:91]
  ds_read_b64_tr_b16 a[228:229], v13 offset:49152
  v_pk_sub_u16 v158, v158, v17 clamp
  v_pk_sub_u16 v155, v155, v19 clamp
  v_pk_sub_u16 v159, v159, v17 clamp
  v_mfma_f32_16x16x32_bf16 v[92:95], a[236:239], v[148:151], v[92:95]
  ds_read_b64_tr_b16 a[230:231], v13 offset:51200
  v_exp_f32 v50, v50
  s_waitcnt lgkmcnt(9)
  v_mfma_f32_16x16x32_bf16 v[64:67], a[240:243], v[152:155], v[64:67]
  ds_read_b64_tr_b16 a[232:233], v14 offset:49152
  v_accvgpr_read_b32 v19, a40
  v_accvgpr_read_b32 v17, a41
  v_sub_f32 v19, v19, v25
  v_mfma_f32_16x16x32_bf16 v[68:71], a[240:243], v[156:159], v[68:71]
  ds_read_b64_tr_b16 a[234:235], v14 offset:51200
  v_sub_f32 v17, v17, v27
  v_cvt_u32_f32 v19, v19
  v_cvt_u32_f32 v17, v17
  v_mfma_f32_16x16x32_bf16 a[100:103], a[96:99], v[152:155], a[100:103]
  v_mfma_f32_16x16x32_bf16 v[72:75], a[244:247], v[152:155], v[72:75]
  ds_read_b64_tr_b16 a[236:237], v15 offset:49152
  v_min_u32 v19, 0xff, v19
  v_min_u32 v17, 0xff, v17
  v_mul_u32_u24 v19, 0x800080, v19
  v_mfma_f32_16x16x32_bf16 v[76:79], a[244:247], v[156:159], v[76:79]
  ds_read_b64_tr_b16 a[238:239], v15 offset:51200
  v_mul_u32_u24 v17, 0x800080, v17
  s_waitcnt lgkmcnt(9)
  v_mfma_f32_16x16x32_bf16 v[80:83], a[248:251], v[152:155], v[80:83]
  ds_read_b64_tr_b16 a[240:241], v12 offset:53248
  v_pk_sub_u16 v160, v160, v19 clamp
  v_pk_sub_u16 v164, v164, v17 clamp
  v_pk_sub_u16 v161, v161, v19 clamp
  v_mfma_f32_16x16x32_bf16 v[84:87], a[248:251], v[156:159], v[84:87]
  ds_read_b64_tr_b16 a[242:243], v12 offset:55296
  v_pk_sub_u16 v165, v165, v17 clamp
  v_pk_sub_u16 v162, v162, v19 clamp
  v_pk_sub_u16 v166, v166, v17 clamp
  v_mfma_f32_16x16x32_bf16 a[104:107], a[96:99], v[156:159], a[104:107]
  v_mfma_f32_16x16x32_bf16 v[88:91], a[252:255], v[152:155], v[88:91]
  ds_read_b64_tr_b16 a[244:245], v13 offset:53248
  v_pk_sub_u16 v163, v163, v19 clamp
  v_pk_sub_u16 v167, v167, v17 clamp
  v_exp_f32 v51, v51
  v_mfma_f32_16x16x32_bf16 v[92:95], a[252:255], v[156:159], v[92:95]
  ds_read_b64_tr_b16 a[246:247], v13 offset:55296
  v_fma_f32 v52, v52, s67, v25
  s_waitcnt lgkmcnt(8)
  v_mfma_f32_16x16x32_bf16 v[64:67], a[224:227], v[160:163], v[64:67]
  ds_read_b64_tr_b16 a[248:249], v14 offset:53248
  v_accvgpr_read_b32 v19, a42
  v_accvgpr_read_b32 v17, a43
  v_sub_f32 v19, v19, v25
  v_mfma_f32_16x16x32_bf16 v[68:71], a[224:227], v[164:167], v[68:71]
  ds_read_b64_tr_b16 a[250:251], v14 offset:55296
  v_sub_f32 v17, v17, v27
  v_cvt_u32_f32 v19, v19
  v_cvt_u32_f32 v17, v17
  v_mfma_f32_16x16x32_bf16 a[100:103], a[96:99], v[160:163], a[100:103]
  v_mfma_f32_16x16x32_bf16 v[72:75], a[228:231], v[160:163], v[72:75]
  ds_read_b64_tr_b16 a[252:253], v15 offset:53248
  v_min_u32 v19, 0xff, v19
  v_min_u32 v17, 0xff, v17
  v_mul_u32_u24 v19, 0x800080, v19
  v_mfma_f32_16x16x32_bf16 v[76:79], a[228:231], v[164:167], v[76:79]
  ds_read_b64_tr_b16 a[254:255], v15 offset:55296
  v_mul_u32_u24 v17, 0x800080, v17
  v_fma_f32 v53, v53, s67, v25
  s_waitcnt lgkmcnt(8)
  v_mfma_f32_16x16x32_bf16 v[80:83], a[232:235], v[160:163], v[80:83]
  ds_read_b64_tr_b16 a[224:225], v12 offset:57344
  v_pk_sub_u16 v168, v168, v19 clamp
  v_pk_sub_u16 v172, v172, v17 clamp
  v_pk_sub_u16 v169, v169, v19 clamp
  v_mfma_f32_16x16x32_bf16 v[84:87], a[232:235], v[164:167], v[84:87]
  ds_read_b64_tr_b16 a[226:227], v12 offset:59392
  v_pk_sub_u16 v173, v173, v17 clamp
  v_pk_sub_u16 v170, v170, v19 clamp
  v_pk_sub_u16 v174, v174, v17 clamp
  v_mfma_f32_16x16x32_bf16 a[104:107], a[96:99], v[164:167], a[104:107]
  v_mfma_f32_16x16x32_bf16 v[88:91], a[236:239], v[160:163], v[88:91]
  ds_read_b64_tr_b16 a[228:229], v13 offset:57344
  v_pk_sub_u16 v171, v171, v19 clamp
  v_pk_sub_u16 v175, v175, v17 clamp
  v_fma_f32 v54, v54, s67, v25
  v_mfma_f32_16x16x32_bf16 v[92:95], a[236:239], v[164:167], v[92:95]
  ds_read_b64_tr_b16 a[230:231], v13 offset:59392
  v_fma_f32 v55, v55, s67, v25
  v_exp_f32 v52, v52
  s_waitcnt lgkmcnt(8)
  v_mfma_f32_16x16x32_bf16 v[64:67], a[240:243], v[168:171], v[64:67]
  ds_read_b64_tr_b16 a[232:233], v14 offset:57344
  v_accvgpr_read_b32 v19, a44
  v_accvgpr_read_b32 v17, a45
  v_sub_f32 v19, v19, v25
  v_mfma_f32_16x16x32_bf16 v[68:71], a[240:243], v[172:175], v[68:71]
  ds_read_b64_tr_b16 a[234:235], v14 offset:59392
  v_sub_f32 v17, v17, v27
  v_cvt_u32_f32 v19, v19
  v_cvt_u32_f32 v17, v17
  v_mfma_f32_16x16x32_bf16 a[100:103], a[96:99], v[168:171], a[100:103]
  v_mfma_f32_16x16x32_bf16 v[72:75], a[244:247], v[168:171], v[72:75]
  ds_read_b64_tr_b16 a[236:237], v15 offset:57344
  ds_read_b32 v3, v2 offset:2048
  v_min_u32 v19, 0xff, v19
  v_min_u32 v17, 0xff, v17
  v_mfma_f32_16x16x32_bf16 v[76:79], a[244:247], v[172:175], v[76:79]
  ds_read_b64_tr_b16 a[238:239], v15 offset:59392
  v_mul_u32_u24 v19, 0x800080, v19
  v_mul_u32_u24 v17, 0x800080, v17
  s_waitcnt lgkmcnt(9)
  v_mfma_f32_16x16x32_bf16 v[80:83], a[248:251], v[168:171], v[80:83]
  ds_read_b64_tr_b16 a[240:241], v12 offset:61440
  v_pk_sub_u16 v176, v176, v19 clamp
  v_pk_sub_u16 v180, v180, v17 clamp
  v_pk_sub_u16 v177, v177, v19 clamp
  v_mfma_f32_16x16x32_bf16 v[84:87], a[248:251], v[172:175], v[84:87]
  ds_read_b64_tr_b16 a[242:243], v12 offset:63488
  v_pk_sub_u16 v181, v181, v17 clamp
  v_pk_sub_u16 v178, v178, v19 clamp
  v_pk_sub_u16 v182, v182, v17 clamp
  v_mfma_f32_16x16x32_bf16 a[104:107], a[96:99], v[172:175], a[104:107]
  v_mfma_f32_16x16x32_bf16 v[88:91], a[252:255], v[168:171], v[88:91]
  ds_read_b64_tr_b16 a[244:245], v13 offset:61440
  v_pk_sub_u16 v179, v179, v19 clamp
  v_pk_sub_u16 v183, v183, v17 clamp
  v_mfma_f32_16x16x32_bf16 v[92:95], a[252:255], v[172:175], v[92:95]
  ds_read_b64_tr_b16 a[246:247], v13 offset:63488
  v_exp_f32 v53, v53
  s_waitcnt lgkmcnt(9)
  v_mfma_f32_16x16x32_bf16 v[64:67], a[224:227], v[176:179], v[64:67]
  ds_read_b64_tr_b16 a[248:249], v14 offset:61440
  v_accvgpr_read_b32 v19, a46
  v_accvgpr_read_b32 v17, a47
  v_sub_f32 v19, v19, v25
  v_mfma_f32_16x16x32_bf16 v[68:71], a[224:227], v[180:183], v[68:71]
  ds_read_b64_tr_b16 a[250:251], v14 offset:63488
  v_sub_f32 v17, v17, v27
  v_cvt_u32_f32 v19, v19
  v_cvt_u32_f32 v17, v17
  v_mfma_f32_16x16x32_bf16 a[100:103], a[96:99], v[176:179], a[100:103]
  v_mfma_f32_16x16x32_bf16 v[72:75], a[228:231], v[176:179], v[72:75]
  ds_read_b64_tr_b16 a[252:253], v15 offset:61440
  s_waitcnt lgkmcnt(8)
  v_cmp_le_u32 vcc, 0xb003001d, v3
  v_min_u32 v19, 0xff, v19
  v_min_u32 v17, 0xff, v17
  v_mul_u32_u24 v19, 0x800080, v19
  v_mfma_f32_16x16x32_bf16 v[76:79], a[228:231], v[180:183], v[76:79]
  ds_read_b64_tr_b16 a[254:255], v15 offset:63488
  v_mul_u32_u24 v17, 0x800080, v17
  v_pk_sub_u16 v184, v184, v19 clamp
  s_waitcnt lgkmcnt(8)
  v_mfma_f32_16x16x32_bf16 v[80:83], a[232:235], v[176:179], v[80:83]
  ds_add_u32 v1, v4
  s_cbranch_vccz L_csV_0_2
L_cbV_0_2:
  v_add_u32 v12, 65536, v12
  ds_read_b64_tr_b16 a[224:225], v12 offset:0
  v_pk_sub_u16 v188, v188, v17 clamp
  v_mfma_f32_16x16x32_bf16 v[84:87], a[232:235], v[180:183], v[84:87]
  ds_read_b64_tr_b16 a[226:227], v12 offset:2048
  v_pk_sub_u16 v185, v185, v19 clamp
  v_pk_sub_u16 v189, v189, v17 clamp
  v_pk_sub_u16 v186, v186, v19 clamp
  v_mfma_f32_16x16x32_bf16 a[104:107], a[96:99], v[180:183], a[104:107]
  v_mfma_f32_16x16x32_bf16 v[88:91], a[236:239], v[176:179], v[88:91]
  v_add_u32 v13, 65536, v13
  ds_read_b64_tr_b16 a[228:229], v13 offset:0
  v_pk_sub_u16 v190, v190, v17 clamp
  v_pk_sub_u16 v187, v187, v19 clamp
  v_pk_sub_u16 v191, v191, v17 clamp
  v_mfma_f32_16x16x32_bf16 v[92:95], a[236:239], v[180:183], v[92:95]
  ds_read_b64_tr_b16 a[230:231], v13 offset:2048
  v_exp_f32 v54, v54
  s_waitcnt lgkmcnt(9)
  v_mfma_f32_16x16x32_bf16 v[64:67], a[240:243], v[184:187], v[64:67]
  v_add_u32 v14, 65536, v14
  ds_read_b64_tr_b16 a[232:233], v14 offset:0
  v_accvgpr_read_b32 v19, a48
  v_accvgpr_read_b32 v17, a49
  v_sub_f32 v19, v19, v25
  v_mfma_f32_16x16x32_bf16 v[68:71], a[240:243], v[188:191], v[68:71]
  ds_read_b64_tr_b16 a[234:235], v14 offset:2048
  v_sub_f32 v17, v17, v27
  v_cvt_u32_f32 v19, v19
  v_cvt_u32_f32 v17, v17
  v_mfma_f32_16x16x32_bf16 a[100:103], a[96:99], v[184:187], a[100:103]
  v_mfma_f32_16x16x32_bf16 v[72:75], a[244:247], v[184:187], v[72:75]
  v_add_u32 v15, 65536, v15
  ds_read_b64_tr_b16 a[236:237], v15 offset:0
  v_min_u32 v19, 0xff, v19
  v_min_u32 v17, 0xff, v17
  v_mul_u32_u24 v19, 0x800080, v19
  v_mfma_f32_16x16x32_bf16 v[76:79], a[244:247], v[188:191], v[76:79]
  ds_read_b64_tr_b16 a[238:239], v15 offset:2048
  v_mul_u32_u24 v17, 0x800080, v17
  v_exp_f32 v55, v55
  s_waitcnt lgkmcnt(9)
  v_mfma_f32_16x16x32_bf16 v[80:83], a[248:251], v[184:187], v[80:83]
  ds_read_b64_tr_b16 a[240:241], v12 offset:4096
  v_pk_sub_u16 v192, v192, v19 clamp
  v_pk_sub_u16 v196, v196, v17 clamp
  v_pk_sub_u16 v193, v193, v19 clamp
  v_mfma_f32_16x16x32_bf16 v[84:87], a[248:251], v[188:191], v[84:87]
  ds_read_b64_tr_b16 a[242:243], v12 offset:6144
  v_pk_sub_u16 v197, v197, v17 clamp
  v_pk_sub_u16 v194, v194, v19 clamp
  v_pk_sub_u16 v198, v198, v17 clamp
  v_mfma_f32_16x16x32_bf16 a[104:107], a[96:99], v[188:191], a[104:107]
  v_mfma_f32_16x16x32_bf16 v[88:91], a[252:255], v[184:187], v[88:91]
  ds_read_b64_tr_b16 a[244:245], v13 offset:4096
  v_pk_sub_u16 v195, v195, v19 clamp
  v_pk_sub_u16 v199, v199, v17 clamp
  v_mfma_f32_16x16x32_bf16 v[92:95], a[252:255], v[188:191], v[92:95]
  ds_read_b64_tr_b16 a[246:247], v13 offset:6144
  v_cvt_pk_bf16_f32 v248, v48, v49
  v_cvt_pk_bf16_f32 v249, v50, v51
  s_waitcnt lgkmcnt(8)
  v_mfma_f32_16x16x32_bf16 v[64:67], a[224:227], v[192:195], v[64:67]
  ds_read_b64_tr_b16 a[248:249], v14 offset:4096
  v_accvgpr_read_b32 v19, a50
  v_accvgpr_read_b32 v17, a51
  v_sub_f32 v19, v19, v25
  v_mfma_f32_16x16x32_bf16 v[68:71], a[224:227], v[196:199], v[68:71]
  ds_read_b64_tr_b16 a[250:251], v14 offset:6144
  v_sub_f32 v17, v17, v27
  v_cvt_u32_f32 v19, v19
  v_cvt_u32_f32 v17, v17
  v_mfma_f32_16x16x32_bf16 a[100:103], a[96:99], v[192:195], a[100:103]
  v_mfma_f32_16x16x32_bf16 v[72:75], a[228:231], v[192:195], v[72:75]
  ds_read_b64_tr_b16 a[252:253], v15 offset:4096
  v_min_u32 v19, 0xff, v19
  v_min_u32 v17, 0xff, v17
  v_mul_u32_u24 v19, 0x800080, v19
  v_mfma_f32_16x16x32_bf16 v[76:79], a[228:231], v[196:199], v[76:79]
  ds_read_b64_tr_b16 a[254:255], v15 offset:6144
  v_mul_u32_u24 v17, 0x800080, v17
  v_fma_f32 v56, v56, s67, v27
  s_waitcnt lgkmcnt(8)
  v_mfma_f32_16x16x32_bf16 v[80:83], a[232:235], v[192:195], v[80:83]
  ds_read_b64_tr_b16 a[224:225], v12 offset:8192
  v_pk_sub_u16 v200, v200, v19 clamp
  v_pk_sub_u16 v204, v204, v17 clamp
  v_pk_sub_u16 v201, v201, v19 clamp
  v_mfma_f32_16x16x32_bf16 v[84:87], a[232:235], v[196:199], v[84:87]
  ds_read_b64_tr_b16 a[226:227], v12 offset:10240
  v_pk_sub_u16 v205, v205, v17 clamp
  v_pk_sub_u16 v202, v202, v19 clamp
  v_pk_sub_u16 v206, v206, v17 clamp
  v_mfma_f32_16x16x32_bf16 a[104:107], a[96:99], v[196:199], a[104:107]
  v_mfma_f32_16x16x32_bf16 v[88:91], a[236:239], v[192:195], v[88:91]
  ds_read_b64_tr_b16 a[228:229], v13 offset:8192
  v_pk_sub_u16 v203, v203, v19 clamp
  v_pk_sub_u16 v207, v207, v17 clamp
  v_fma_f32 v57, v57, s67, v27
  v_mfma_f32_16x16x32_bf16 v[92:95], a[236:239], v[196:199], v[92:95]
  ds_read_b64_tr_b16 a[230:231], v13 offset:10240
  v_fma_f32 v58, v58, s67, v27
  v_fma_f32 v59, v59, s67, v27
  s_waitcnt lgkmcnt(8)
  v_mfma_f32_16x16x32_bf16 v[64:67], a[240:243], v[200:203], v[64:67]
  ds_read_b64_tr_b16 a[232:233], v14 offset:8192
  v_accvgpr_read_b32 v19, a52
  v_accvgpr_read_b32 v17, a53
  v_sub_f32 v19, v19, v25
  v_mfma_f32_16x16x32_bf16 v[68:71], a[240:243], v[204:207], v[68:71]
  ds_read_b64_tr_b16 a[234:235], v14 offset:10240
  v_sub_f32 v17, v17, v27
  v_cvt_u32_f32 v19, v19
  v_cvt_u32_f32 v17, v17
  v_mfma_f32_16x16x32_bf16 a[100:103], a[96:99], v[200:203], a[100:103]
  v_mfma_f32_16x16x32_bf16 v[72:75], a[244:247], v[200:203], v[72:75]
  ds_read_b64_tr_b16 a[236:237], v15 offset:8192
  ds_read_b32 v3, v2 offset:2048
  v_min_u32 v19, 0xff, v19
  v_min_u32 v17, 0xff, v17
  v_mfma_f32_16x16x32_bf16 v[76:79], a[244:247], v[204:207], v[76:79]
  ds_read_b64_tr_b16 a[238:239], v15 offset:10240
  v_mul_u32_u24 v19, 0x800080, v19
  v_mul_u32_u24 v17, 0x800080, v17
  s_waitcnt lgkmcnt(9)
  v_mfma_f32_16x16x32_bf16 v[80:83], a[248:251], v[200:203], v[80:83]
  ds_read_b64_tr_b16 a[240:241], v12 offset:12288
  v_pk_sub_u16 v208, v208, v19 clamp
  v_pk_sub_u16 v212, v212, v17 clamp
  v_pk_sub_u16 v209, v209, v19 clamp
  v_mfma_f32_16x16x32_bf16 v[84:87], a[248:251], v[204:207], v[84:87]
  ds_read_b64_tr_b16 a[242:243], v12 offset:14336
  v_pk_sub_u16 v213, v213, v17 clamp
  v_pk_sub_u16 v210, v210, v19 clamp
  v_pk_sub_u16 v214, v214, v17 clamp
  v_mfma_f32_16x16x32_bf16 a[104:107], a[96:99], v[204:207], a[104:107]
  v_mfma_f32_16x16x32_bf16 v[88:91], a[252:255], v[200:203], v[88:91]
  ds_read_b64_tr_b16 a[244:245], v13 offset:12288
  v_pk_sub_u16 v211, v211, v19 clamp
  v_pk_sub_u16 v215, v215, v17 clamp
  v_exp_f32 v56, v56
  v_mfma_f32_16x16x32_bf16 v[92:95], a[252:255], v[204:207], v[92:95]
  ds_read_b64_tr_b16 a[246:247], v13 offset:14336
  v_exp_f32 v57, v57
  s_waitcnt lgkmcnt(9)
  v_mfma_f32_16x16x32_bf16 v[64:67], a[224:227], v[208:211], v[64:67]
  ds_read_b64_tr_b16 a[248:249], v14 offset:12288
  v_accvgpr_read_b32 v19, a54
  v_accvgpr_read_b32 v17, a55
  v_sub_f32 v19, v19, v25
  v_mfma_f32_16x16x32_bf16 v[68:71], a[224:227], v[212:215], v[68:71]
  ds_read_b64_tr_b16 a[250:251], v14 offset:14336
  v_sub_f32 v17, v17, v27
  v_cvt_u32_f32 v19, v19
  v_cvt_u32_f32 v17, v17
  v_mfma_f32_16x16x32_bf16 a[100:103], a[96:99], v[208:211], a[100:103]
  v_mfma_f32_16x16x32_bf16 v[72:75], a[228:231], v[208:211], v[72:75]
  ds_read_b64_tr_b16 a[252:253], v15 offset:12288
  s_waitcnt lgkmcnt(8)
  v_cmp_le_u32 vcc, 0xb003001e, v3
  v_min_u32 v19, 0xff, v19
  v_min_u32 v17, 0xff, v17
  v_mul_u32_u24 v19, 0x800080, v19
  v_mfma_f32_16x16x32_bf16 v[76:79], a[228:231], v[212:215], v[76:79]
  ds_read_b64_tr_b16 a[254:255], v15 offset:14336
  v_mul_u32_u24 v17, 0x800080, v17
  v_pk_sub_u16 v216, v216, v19 clamp
  s_waitcnt lgkmcnt(8)
  v_mfma_f32_16x16x32_bf16 v[80:83], a[232:235], v[208:211], v[80:83]
  ds_add_u32 v1, v4
  s_cbranch_vccz L_csV_0_3
L_cbV_0_3:
  v_add_u32 v12, 65536, v12
  ds_read_b64_tr_b16 a[224:225], v12 offset:4096
  v_pk_sub_u16 v220, v220, v17 clamp
  v_mfma_f32_16x16x32_bf16 v[84:87], a[232:235], v[212:215], v[84:87]
  ds_read_b64_tr_b16 a[226:227], v12 offset:6144
  v_pk_sub_u16 v217, v217, v19 clamp
  v_pk_sub_u16 v221, v221, v17 clamp
  v_pk_sub_u16 v218, v218, v19 clamp
  v_mfma_f32_16x16x32_bf16 a[104:107], a[96:99], v[212:215], a[104:107]
  v_mfma_f32_16x16x32_bf16 v[88:91], a[236:239], v[208:211], v[88:91]
  v_add_u32 v13, 65536, v13
  ds_read_b64_tr_b16 a[228:229], v13 offset:4096
  v_pk_sub_u16 v222, v222, v17 clamp
  v_pk_sub_u16 v219, v219, v19 clamp
  v_pk_sub_u16 v223, v223, v17 clamp
  v_mfma_f32_16x16x32_bf16 v[92:95], a[236:239], v[212:215], v[92:95]
  ds_read_b64_tr_b16 a[230:231], v13 offset:6144
  v_exp_f32 v58, v58
  s_waitcnt lgkmcnt(9)
  v_mfma_f32_16x16x32_bf16 v[64:67], a[240:243], v[216:219], v[64:67]
  v_add_u32 v14, 65536, v14
  ds_read_b64_tr_b16 a[232:233], v14 offset:4096
  v_accvgpr_read_b32 v19, a56
  v_accvgpr_read_b32 v17, a57
  v_sub_f32 v19, v19, v25
  v_mfma_f32_16x16x32_bf16 v[68:71], a[240:243], v[220:223], v[68:71]
  ds_read_b64_tr_b16 a[234:235], v14 offset:6144
  v_sub_f32 v17, v17, v27
  v_cvt_u32_f32 v19, v19
  v_cvt_u32_f32 v17, v17
  v_mfma_f32_16x16x32_bf16 a[100:103], a[96:99], v[216:219], a[100:103]
  v_mfma_f32_16x16x32_bf16 v[72:75], a[244:247], v[216:219], v[72:75]
  v_add_u32 v15, 65536, v15
  ds_read_b64_tr_b16 a[236:237], v15 offset:4096
  v_min_u32 v19, 0xff, v19
  v_min_u32 v17, 0xff, v17
  v_mul_u32_u24 v19, 0x800080, v19
  v_mfma_f32_16x16x32_bf16 v[76:79], a[244:247], v[220:223], v[76:79]
  ds_read_b64_tr_b16 a[238:239], v15 offset:6144
  v_mul_u32_u24 v17, 0x800080, v17
  s_waitcnt lgkmcnt(9)
  v_mfma_f32_16x16x32_bf16 v[80:83], a[248:251], v[216:219], v[80:83]
  ds_read_b64_tr_b16 a[240:241], v12 offset:8192
  v_pk_sub_u16 v224, v224, v19 clamp
  v_pk_sub_u16 v228, v228, v17 clamp
  v_pk_sub_u16 v225, v225, v19 clamp
  v_mfma_f32_16x16x32_bf16 v[84:87], a[248:251], v[220:223], v[84:87]
  ds_read_b64_tr_b16 a[242:243], v12 offset:10240
  v_pk_sub_u16 v229, v229, v17 clamp
  v_pk_sub_u16 v226, v226, v19 clamp
  v_pk_sub_u16 v230, v230, v17 clamp
  v_mfma_f32_16x16x32_bf16 a[104:107], a[96:99], v[220:223], a[104:107]
  v_mfma_f32_16x16x32_bf16 v[88:91], a[252:255], v[216:219], v[88:91]
  ds_read_b64_tr_b16 a[244:245], v13 offset:8192
  v_pk_sub_u16 v227, v227, v19 clamp
  v_pk_sub_u16 v231, v231, v17 clamp
  v_exp_f32 v59, v59
  v_mfma_f32_16x16x32_bf16 v[92:95], a[252:255], v[220:223], v[92:95]
  ds_read_b64_tr_b16 a[246:247], v13 offset:10240
  v_cvt_pk_bf16_f32 v250, v52, v53
  s_waitcnt lgkmcnt(8)
  v_mfma_f32_16x16x32_bf16 v[64:67], a[224:227], v[224:227], v[64:67]
  ds_read_b64_tr_b16 a[248:249], v14 offset:8192
  v_accvgpr_read_b32 v19, a58
  v_accvgpr_read_b32 v17, a59
  v_sub_f32 v19, v19, v25
  v_mfma_f32_16x16x32_bf16 v[68:71], a[224:227], v[228:231], v[68:71]
  ds_read_b64_tr_b16 a[250:251], v14 offset:10240
  v_sub_f32 v17, v17, v27
  v_cvt_u32_f32 v19, v19
  v_cvt_u32_f32 v17, v17
  v_mfma_f32_16x16x32_bf16 a[100:103], a[96:99], v[224:227], a[100:103]
  v_mfma_f32_16x16x32_bf16 v[72:75], a[228:231], v[224:227], v[72:75]
  ds_read_b64_tr_b16 a[252:253], v15 offset:8192
  v_min_u32 v19, 0xff, v19
  v_min_u32 v17, 0xff, v17
  v_mul_u32_u24 v19, 0x800080, v19
  v_mfma_f32_16x16x32_bf16 v[76:79], a[228:231], v[228:231], v[76:79]
  ds_read_b64_tr_b16 a[254:255], v15 offset:10240
  v_mul_u32_u24 v17, 0x800080, v17
  v_cvt_pk_bf16_f32 v251, v54, v55
  s_waitcnt lgkmcnt(8)
  v_mfma_f32_16x16x32_bf16 v[80:83], a[232:235], v[224:227], v[80:83]
  ds_read_b64_tr_b16 a[224:225], v12 offset:12288
  v_pk_sub_u16 v232, v232, v19 clamp
  v_pk_sub_u16 v236, v236, v17 clamp
  v_pk_sub_u16 v233, v233, v19 clamp
  v_mfma_f32_16x16x32_bf16 v[84:87], a[232:235], v[228:231], v[84:87]
  ds_read_b64_tr_b16 a[226:227], v12 offset:14336
  v_pk_sub_u16 v237, v237, v17 clamp
  v_pk_sub_u16 v234, v234, v19 clamp
  v_pk_sub_u16 v238, v238, v17 clamp
  v_mfma_f32_16x16x32_bf16 a[104:107], a[96:99], v[228:231], a[104:107]
  v_mfma_f32_16x16x32_bf16 v[88:91], a[236:239], v[224:227], v[88:91]
  ds_read_b64_tr_b16 a[228:229], v13 offset:12288
  v_pk_sub_u16 v235, v235, v19 clamp
  v_pk_sub_u16 v239, v239, v17 clamp
  v_fma_f32 v60, v60, s67, v27
  v_mfma_f32_16x16x32_bf16 v[92:95], a[236:239], v[228:231], v[92:95]
  ds_read_b64_tr_b16 a[230:231], v13 offset:14336
  v_fma_f32 v61, v61, s67, v27
  v_fma_f32 v62, v62, s67, v27
  s_waitcnt lgkmcnt(8)
  v_mfma_f32_16x16x32_bf16 v[64:67], a[240:243], v[232:235], v[64:67]
  ds_read_b64_tr_b16 a[232:233], v14 offset:12288
  v_accvgpr_read_b32 v19, a60
  v_accvgpr_read_b32 v17, a61
  v_sub_f32 v19, v19, v25
  v_mfma_f32_16x16x32_bf16 v[68:71], a[240:243], v[236:239], v[68:71]
  ds_read_b64_tr_b16 a[234:235], v14 offset:14336
  v_sub_f32 v17, v17, v27
  v_cvt_u32_f32 v19, v19
  v_cvt_u32_f32 v17, v17
  v_mfma_f32_16x16x32_bf16 a[100:103], a[96:99], v[232:235], a[100:103]
  v_mfma_f32_16x16x32_bf16 v[72:75], a[244:247], v[232:235], v[72:75]
  ds_read_b64_tr_b16 a[236:237], v15 offset:12288
  ds_read_b32 v3, v2 offset:2048
  v_min_u32 v19, 0xff, v19
  v_min_u32 v17, 0xff, v17
  v_mfma_f32_16x16x32_bf16 v[76:79], a[244:247], v[236:239], v[76:79]
  ds_read_b64_tr_b16 a[238:239], v15 offset:14336
  v_mul_u32_u24 v19, 0x800080, v19
  v_mul_u32_u24 v17, 0x800080, v17
  s_waitcnt lgkmcnt(9)
  v_mfma_f32_16x16x32_bf16 v[80:83], a[248:251], v[232:235], v[80:83]
  ds_read_b64_tr_b16 a[240:241], v12 offset:16384
  v_pk_sub_u16 v240, v240, v19 clamp
  v_pk_sub_u16 v244, v244, v17 clamp
  v_pk_sub_u16 v241, v241, v19 clamp
  v_mfma_f32_16x16x32_bf16 v[84:87], a[248:251], v[236:239], v[84:87]
  ds_read_b64_tr_b16 a[242:243], v12 offset:18432
  v_pk_sub_u16 v245, v245, v17 clamp
  v_pk_sub_u16 v242, v242, v19 clamp
  v_pk_sub_u16 v246, v246, v17 clamp
  v_mfma_f32_16x16x32_bf16 a[104:107], a[96:99], v[236:239], a[104:107]
  v_mfma_f32_16x16x32_bf16 v[88:91], a[252:255], v[232:235], v[88:91]
  ds_read_b64_tr_b16 a[244:245], v13 offset:16384
  v_pk_sub_u16 v243, v243, v19 clamp
  v_pk_sub_u16 v247, v247, v17 clamp
  v_fma_f32 v63, v63, s67, v27
  v_mfma_f32_16x16x32_bf16 v[92:95], a[252:255], v[236:239], v[92:95]
  ds_read_b64_tr_b16 a[246:247], v13 offset:18432
  v_exp_f32 v60, v60
  s_waitcnt lgkmcnt(9)
  v_mfma_f32_16x16x32_bf16 v[64:67], a[224:227], v[240:243], v[64:67]
  ds_read_b64_tr_b16 a[248:249], v14 offset:16384
  v_exp_f32 v61, v61
  v_exp_f32 v62, v62
  v_mfma_f32_16x16x32_bf16 v[68:71], a[224:227], v[244:247], v[68:71]
  ds_read_b64_tr_b16 a[250:251], v14 offset:18432
  v_exp_f32 v63, v63
  v_mfma_f32_16x16x32_bf16 a[100:103], a[96:99], v[240:243], a[100:103]
  v_mfma_f32_16x16x32_bf16 v[72:75], a[228:231], v[240:243], v[72:75]
  ds_read_b64_tr_b16 a[252:253], v15 offset:16384
  s_waitcnt lgkmcnt(8)
  v_cmp_le_u32 vcc, 0xb003001f, v3
  v_cvt_pk_bf16_f32 v252, v56, v57
  v_cvt_pk_bf16_f32 v253, v58, v59
  v_mfma_f32_16x16x32_bf16 v[76:79], a[228:231], v[244:247], v[76:79]
  ds_read_b64_tr_b16 a[254:255], v15 offset:18432
  v_cvt_pk_bf16_f32 v254, v60, v61
  v_cvt_pk_bf16_f32 v255, v62, v63
  s_waitcnt lgkmcnt(8)
  v_mfma_f32_16x16x32_bf16 v[80:83], a[232:235], v[240:243], v[80:83]
  ds_add_u32 v1, v4
  s_cbranch_vccz L_csV_1_0
L_cbV_1_0:
  v_subrev_u32 v12, 65536, v12
  ds_read_b64_tr_b16 a[224:225], v12 offset:16384
  v_mfma_f32_16x16x32_bf16 v[84:87], a[232:235], v[244:247], v[84:87]
  ds_read_b64_tr_b16 a[226:227], v12 offset:18432
  v_mfma_f32_16x16x32_bf16 a[104:107], a[96:99], v[244:247], a[104:107]
  v_mfma_f32_16x16x32_bf16 v[88:91], a[236:239], v[240:243], v[88:91]
  v_subrev_u32 v13, 65536, v13
  ds_read_b64_tr_b16 a[228:229], v13 offset:16384
  v_mfma_f32_16x16x32_bf16 a[100:103], a[96:99], v[248:251], a[100:103]
  v_mfma_f32_16x16x32_bf16 v[92:95], a[236:239], v[244:247], v[92:95]
  ds_read_b64_tr_b16 a[230:231], v13 offset:18432
  s_waitcnt lgkmcnt(9)
  v_mfma_f32_16x16x32_bf16 v[64:67], a[240:243], v[248:251], v[64:67]
  v_subrev_u32 v14, 65536, v14
  ds_read_b64_tr_b16 a[232:233], v14 offset:16384
  v_mfma_f32_16x16x32_bf16 a[104:107], a[96:99], v[252:255], a[104:107]
  v_mfma_f32_16x16x32_bf16 v[68:71], a[240:243], v[252:255], v[68:71]
  ds_read_b64_tr_b16 a[234:235], v14 offset:18432
  v_mfma_f32_16x16x32_bf16 v[72:75], a[244:247], v[248:251], v[72:75]
  v_subrev_u32 v15, 65536, v15
  ds_read_b64_tr_b16 a[236:237], v15 offset:16384
  v_mfma_f32_16x16x32_bf16 v[76:79], a[244:247], v[252:255], v[76:79]
  ds_read_b64_tr_b16 a[238:239], v15 offset:18432
  s_waitcnt lgkmcnt(9)
  v_mfma_f32_16x16x32_bf16 v[80:83], a[248:251], v[248:251], v[80:83]
  ds_read_b64_tr_b16 a[240:241], v12 offset:20480
  v_mfma_f32_16x16x32_bf16 v[84:87], a[248:251], v[252:255], v[84:87]
  ds_read_b64_tr_b16 a[242:243], v12 offset:22528
  v_accvgpr_read_b32 v22, a100
  v_mfma_f32_16x16x32_bf16 v[88:91], a[252:255], v[248:251], v[88:91]
  ds_read_b64_tr_b16 a[244:245], v13 offset:20480
  v_accvgpr_read_b32 v23, a104
  v_mfma_f32_16x16x32_bf16 v[92:95], a[252:255], v[252:255], v[92:95]
  ds_read_b64_tr_b16 a[246:247], v13 offset:22528
  s_waitcnt lgkmcnt(8)
  v_mfma_f32_16x16x32_bf16 v[96:99], a[224:227], v[128:131], 0
  ds_read_b64_tr_b16 a[248:249], v14 offset:20480
  v_rcp_f32 v20, v22
  v_mfma_f32_16x16x32_bf16 v[100:103], a[224:227], v[132:135], 0
  ds_read_b64_tr_b16 a[250:251], v14 offset:22528
  v_mfma_f32_16x16x32_bf16 v[104:107], a[228:231], v[128:131], 0
  ds_read_b64_tr_b16 a[252:253], v15 offset:20480
  v_rcp_f32 v21, v23
  v_mfma_f32_16x16x32_bf16 v[108:111], a[228:231], v[132:135], 0
  ds_read_b64_tr_b16 a[254:255], v15 offset:22528
  s_waitcnt lgkmcnt(8)
  v_mfma_f32_16x16x32_bf16 v[112:115], a[232:235], v[128:131], 0
  ds_read_b64_tr_b16 a[224:225], v12 offset:24576
  v_mfma_f32_16x16x32_bf16 v[116:119], a[232:235], v[132:135], 0
  ds_read_b64_tr_b16 a[226:227], v12 offset:26624
  v_mul_f32 v64, v64, v20
  v_mul_f32 v65, v65, v20
  v_cvt_pk_bf16_f32 v32, v64, v65
  v_mfma_f32_16x16x32_bf16 v[120:123], a[236:239], v[128:131], 0
  ds_read_b64_tr_b16 a[228:229], v13 offset:24576
  v_mul_f32 v66, v66, v20
  v_mul_f32 v67, v67, v20
  v_mfma_f32_16x16x32_bf16 v[124:127], a[236:239], v[132:135], 0
  ds_read_b64_tr_b16 a[230:231], v13 offset:26624
  v_cvt_pk_bf16_f32 v33, v66, v67
  s_waitcnt lgkmcnt(8)
  v_mfma_f32_16x16x32_bf16 v[96:99], a[240:243], v[136:139], v[96:99]
  ds_read_b64_tr_b16 a[232:233], v14 offset:24576
  v_mul_f32 v72, v72, v20
  v_mul_f32 v73, v73, v20
  v_cvt_pk_bf16_f32 v34, v72, v73
  v_mfma_f32_16x16x32_bf16 v[100:103], a[240:243], v[140:143], v[100:103]
  ds_read_b64_tr_b16 a[234:235], v14 offset:26624
  v_mul_f32 v74, v74, v20
  v_mul_f32 v75, v75, v20
  v_mfma_f32_16x16x32_bf16 v[104:107], a[244:247], v[136:139], v[104:107]
  ds_read_b64_tr_b16 a[236:237], v15 offset:24576
  ds_read_b32 v3, v2 offset:2048
  v_cvt_pk_bf16_f32 v35, v74, v75
  v_mfma_f32_16x16x32_bf16 v[108:111], a[244:247], v[140:143], v[108:111]
  ds_read_b64_tr_b16 a[238:239], v15 offset:26624
  v_mul_f32 v68, v68, v21
  v_mul_f32 v69, v69, v21
  s_waitcnt lgkmcnt(9)
  v_mfma_f32_16x16x32_bf16 v[112:115], a[248:251], v[136:139], v[112:115]
  ds_read_b64_tr_b16 a[240:241], v12 offset:28672
  v_cvt_pk_bf16_f32 v36, v68, v69
  v_mul_f32 v70, v70, v21
  v_mfma_f32_16x16x32_bf16 v[116:119], a[248:251], v[140:143], v[116:119]
  ds_read_b64_tr_b16 a[242:243], v12 offset:30720
  v_mul_f32 v71, v71, v21
  v_cvt_pk_bf16_f32 v37, v70, v71
  v_mfma_f32_16x16x32_bf16 v[120:123], a[252:255], v[136:139], v[120:123]
  ds_read_b64_tr_b16 a[244:245], v13 offset:28672
  v_mul_f32 v76, v76, v21
  v_mul_f32 v77, v77, v21
  v_cvt_pk_bf16_f32 v38, v76, v77
  v_mfma_f32_16x16x32_bf16 v[124:127], a[252:255], v[140:143], v[124:127]
  ds_read_b64_tr_b16 a[246:247], v13 offset:30720
  v_mul_f32 v78, v78, v21
  s_waitcnt lgkmcnt(9)
  v_mfma_f32_16x16x32_bf16 v[96:99], a[224:227], v[144:147], v[96:99]
  ds_read_b64_tr_b16 a[248:249], v14 offset:28672
  v_mul_f32 v79, v79, v21
  v_cvt_pk_bf16_f32 v39, v78, v79
  v_mfma_f32_16x16x32_bf16 v[100:103], a[224:227], v[148:151], v[100:103]
  ds_read_b64_tr_b16 a[250:251], v14 offset:30720
  v_mul_f32 v80, v80, v20
  v_mul_f32 v81, v81, v20
  v_cvt_pk_bf16_f32 v40, v80, v81
  v_mfma_f32_16x16x32_bf16 v[104:107], a[228:231], v[144:147], v[104:107]
  ds_read_b64_tr_b16 a[252:253], v15 offset:28672
  s_waitcnt lgkmcnt(8)
  v_cmp_le_u32 vcc, 0xb0030020, v3
  v_mul_f32 v82, v82, v20
  v_mfma_f32_16x16x32_bf16 v[108:111], a[228:231], v[148:151], v[108:111]
  ds_read_b64_tr_b16 a[254:255], v15 offset:30720
  v_mul_f32 v83, v83, v20
  v_cvt_pk_bf16_f32 v41, v82, v83
  s_waitcnt lgkmcnt(8)
  v_mfma_f32_16x16x32_bf16 v[112:115], a[232:235], v[144:147], v[112:115]
  ds_add_u32 v1, v4
  s_cbranch_vccz L_csO_0_0
L_cbO_0_0:
  ds_read_b64_tr_b16 a[224:225], v12 offset:32768
  v_mfma_f32_16x16x32_bf16 v[116:119], a[232:235], v[148:151], v[116:119]
  ds_read_b64_tr_b16 a[226:227], v12 offset:34816
  v_mul_f32 v88, v88, v20
  v_mul_f32 v89, v89, v20
  v_cvt_pk_bf16_f32 v42, v88, v89
  v_mfma_f32_16x16x32_bf16 v[120:123], a[236:239], v[144:147], v[120:123]
  ds_read_b64_tr_b16 a[228:229], v13 offset:32768
  v_mul_f32 v90, v90, v20
  v_mul_f32 v91, v91, v20
  v_mfma_f32_16x16x32_bf16 v[124:127], a[236:239], v[148:151], v[124:127]
  ds_read_b64_tr_b16 a[230:231], v13 offset:34816
  v_cvt_pk_bf16_f32 v43, v90, v91
  s_waitcnt lgkmcnt(9)
  v_mfma_f32_16x16x32_bf16 v[96:99], a[240:243], v[152:155], v[96:99]
  ds_read_b64_tr_b16 a[232:233], v14 offset:32768
  v_mul_f32 v84, v84, v21
  v_mul_f32 v85, v85, v21
  v_cvt_pk_bf16_f32 v44, v84, v85
  v_mfma_f32_16x16x32_bf16 v[100:103], a[240:243], v[156:159], v[100:103]
  ds_read_b64_tr_b16 a[234:235], v14 offset:34816
  v_mul_f32 v86, v86, v21
  v_mul_f32 v87, v87, v21
  v_mfma_f32_16x16x32_bf16 v[104:107], a[244:247], v[152:155], v[104:107]
  ds_read_b64_tr_b16 a[236:237], v15 offset:32768
  ds_read_b32 v3, v2 offset:2048
  v_cvt_pk_bf16_f32 v45, v86, v87
  v_mfma_f32_16x16x32_bf16 v[108:111], a[244:247], v[156:159], v[108:111]
  ds_read_b64_tr_b16 a[238:239], v15 offset:34816
  v_mul_f32 v92, v92, v21
  v_mul_f32 v93, v93, v21
  s_waitcnt lgkmcnt(10)
  v_mfma_f32_16x16x32_bf16 v[112:115], a[248:251], v[152:155], v[112:115]
  ds_read_b64_tr_b16 a[240:241], v12 offset:36864
  v_cvt_pk_bf16_f32 v46, v92, v93
  v_mul_f32 v94, v94, v21
  v_mfma_f32_16x16x32_bf16 v[116:119], a[248:251], v[156:159], v[116:119]
  ds_read_b64_tr_b16 a[242:243], v12 offset:38912
  v_mul_f32 v95, v95, v21
  v_cvt_pk_bf16_f32 v47, v94, v95
  v_mfma_f32_16x16x32_bf16 v[120:123], a[252:255], v[152:155], v[120:123]
  ds_read_b64_tr_b16 a[244:245], v13 offset:36864
  v_mfma_f32_16x16x32_bf16 v[124:127], a[252:255], v[156:159], v[124:127]
  ds_read_b64_tr_b16 a[246:247], v13 offset:38912
  s_waitcnt vmcnt(0)
  s_waitcnt lgkmcnt(9)
  v_mfma_f32_16x16x32_bf16 a[0:3], a[224:227], v[32:35], 0
  ds_read_b64_tr_b16 a[248:249], v14 offset:36864
  v_mfma_f32_16x16x32_bf16 a[4:7], a[224:227], v[36:39], 0
  ds_read_b64_tr_b16 a[250:251], v14 offset:38912
  v_mfma_f32_16x16x32_bf16 a[8:11], a[228:231], v[32:35], 0
  ds_read_b64_tr_b16 a[252:253], v15 offset:36864
  s_waitcnt lgkmcnt(8)
  v_cmp_le_u32 vcc, 0xb0030021, v3
  v_mfma_f32_16x16x32_bf16 a[12:15], a[228:231], v[36:39], 0
  ds_read_b64_tr_b16 a[254:255], v15 offset:38912
  s_waitcnt lgkmcnt(8)
  v_mfma_f32_16x16x32_bf16 a[16:19], a[232:235], v[32:35], 0
  ds_add_u32 v1, v4
  s_cbranch_vccz L_csV_1_1
L_cbV_1_1:
  v_subrev_u32 v12, 65536, v12
  ds_read_b64_tr_b16 a[224:225], v12 offset:0
  v_mfma_f32_16x16x32_bf16 a[20:23], a[232:235], v[36:39], 0
  ds_read_b64_tr_b16 a[226:227], v12 offset:2048
  v_mfma_f32_16x16x32_bf16 a[24:27], a[236:239], v[32:35], 0
  v_subrev_u32 v13, 65536, v13
  ds_read_b64_tr_b16 a[228:229], v13 offset:0
  v_mfma_f32_16x16x32_bf16 a[28:31], a[236:239], v[36:39], 0
  ds_read_b64_tr_b16 a[230:231], v13 offset:2048
  s_waitcnt lgkmcnt(9)
  v_mfma_f32_16x16x32_bf16 a[0:3], a[240:243], v[40:43], a[0:3]
  v_subrev_u32 v14, 65536, v14
  ds_read_b64_tr_b16 a[232:233], v14 offset:0
  v_mfma_f32_16x16x32_bf16 a[4:7], a[240:243], v[44:47], a[4:7]
  ds_read_b64_tr_b16 a[234:235], v14 offset:2048
  v_mfma_f32_16x16x32_bf16 a[8:11], a[244:247], v[40:43], a[8:11]
  v_subrev_u32 v15, 65536, v15
  ds_read_b64_tr_b16 a[236:237], v15 offset:0
  v_mfma_f32_16x16x32_bf16 a[12:15], a[244:247], v[44:47], a[12:15]
  ds_read_b64_tr_b16 a[238:239], v15 offset:2048
  s_waitcnt lgkmcnt(9)
  v_mfma_f32_16x16x32_bf16 a[16:19], a[248:251], v[40:43], a[16:19]
  ds_read_b64_tr_b16 a[240:241], v12 offset:4096
  v_mfma_f32_16x16x32_bf16 a[20:23], a[248:251], v[44:47], a[20:23]
  ds_read_b64_tr_b16 a[242:243], v12 offset:6144
  v_mfma_f32_16x16x32_bf16 a[24:27], a[252:255], v[40:43], a[24:27]
  ds_read_b64_tr_b16 a[244:245], v13 offset:4096
  v_mfma_f32_16x16x32_bf16 a[28:31], a[252:255], v[44:47], a[28:31]
  ds_read_b64_tr_b16 a[246:247], v13 offset:6144
  s_waitcnt lgkmcnt(8)
  v_mfma_f32_16x16x32_bf16 v[96:99], a[224:227], v[160:163], v[96:99]
  ds_read_b64_tr_b16 a[248:249], v14 offset:4096
  v_mfma_f32_16x16x32_bf16 v[100:103], a[224:227], v[164:167], v[100:103]
  ds_read_b64_tr_b16 a[250:251], v14 offset:6144
  v_mfma_f32_16x16x32_bf16 v[104:107], a[228:231], v[160:163], v[104:107]
  ds_read_b64_tr_b16 a[252:253], v15 offset:4096
  v_mfma_f32_16x16x32_bf16 v[108:111], a[228:231], v[164:167], v[108:111]
  ds_read_b64_tr_b16 a[254:255], v15 offset:6144
  s_waitcnt lgkmcnt(8)
  v_mfma_f32_16x16x32_bf16 v[112:115], a[232:235], v[160:163], v[112:115]
  ds_read_b64_tr_b16 a[224:225], v12 offset:8192
  v_mfma_f32_16x16x32_bf16 v[116:119], a[232:235], v[164:167], v[116:119]
  ds_read_b64_tr_b16 a[226:227], v12 offset:10240
  v_mfma_f32_16x16x32_bf16 v[120:123], a[236:239], v[160:163], v[120:123]
  ds_read_b64_tr_b16 a[228:229], v13 offset:8192
  v_mfma_f32_16x16x32_bf16 v[124:127], a[236:239], v[164:167], v[124:127]
  ds_read_b64_tr_b16 a[230:231], v13 offset:10240
  s_waitcnt lgkmcnt(8)
  v_mfma_f32_16x16x32_bf16 v[96:99], a[240:243], v[168:171], v[96:99]
  ds_read_b64_tr_b16 a[232:233], v14 offset:8192
  v_mfma_f32_16x16x32_bf16 v[100:103], a[240:243], v[172:175], v[100:103]
  ds_read_b64_tr_b16 a[234:235], v14 offset:10240
  v_mfma_f32_16x16x32_bf16 v[104:107], a[244:247], v[168:171], v[104:107]
  ds_read_b64_tr_b16 a[236:237], v15 offset:8192
  ds_read_b32 v3, v2 offset:2048
  v_mfma_f32_16x16x32_bf16 v[108:111], a[244:247], v[172:175], v[108:111]
  ds_read_b64_tr_b16 a[238:239], v15 offset:10240
  s_waitcnt lgkmcnt(9)
  v_mfma_f32_16x16x32_bf16 v[112:115], a[248:251], v[168:171], v[112:115]
  ds_read_b64_tr_b16 a[240:241], v12 offset:12288
  v_mfma_f32_16x16x32_bf16 v[116:119], a[248:251], v[172:175], v[116:119]
  ds_read_b64_tr_b16 a[242:243], v12 offset:14336
  v_mfma_f32_16x16x32_bf16 v[120:123], a[252:255], v[168:171], v[120:123]
  ds_read_b64_tr_b16 a[244:245], v13 offset:12288
  v_mfma_f32_16x16x32_bf16 v[124:127], a[252:255], v[172:175], v[124:127]
  ds_read_b64_tr_b16 a[246:247], v13 offset:14336
  s_waitcnt lgkmcnt(9)
  v_mfma_f32_16x16x32_bf16 v[96:99], a[224:227], v[176:179], v[96:99]
  ds_read_b64_tr_b16 a[248:249], v14 offset:12288
  v_mfma_f32_16x16x32_bf16 v[100:103], a[224:227], v[180:183], v[100:103]
  ds_read_b64_tr_b16 a[250:251], v14 offset:14336
  v_mfma_f32_16x16x32_bf16 v[104:107], a[228:231], v[176:179], v[104:107]
  ds_read_b64_tr_b16 a[252:253], v15 offset:12288
  s_waitcnt lgkmcnt(8)
  v_cmp_le_u32 vcc, 0xb0030022, v3
  v_mfma_f32_16x16x32_bf16 v[108:111], a[228:231], v[180:183], v[108:111]
  ds_read_b64_tr_b16 a[254:255], v15 offset:14336
  s_waitcnt lgkmcnt(8)
  v_mfma_f32_16x16x32_bf16 v[112:115], a[232:235], v[176:179], v[112:115]
  ds_add_u32 v1, v4
  s_cbranch_vccz L_csO_0_1
L_cbO_0_1:
  v_add_u32 v12, 65536, v12
  ds_read_b64_tr_b16 a[224:225], v12 offset:61440
  v_mfma_f32_16x16x32_bf16 v[116:119], a[232:235], v[180:183], v[116:119]
  ds_read_b64_tr_b16 a[226:227], v12 offset:63488
  v_mfma_f32_16x16x32_bf16 v[120:123], a[236:239], v[176:179], v[120:123]
  v_add_u32 v13, 65536, v13
  ds_read_b64_tr_b16 a[228:229], v13 offset:61440
  v_mfma_f32_16x16x32_bf16 v[124:127], a[236:239], v[180:183], v[124:127]
  ds_read_b64_tr_b16 a[230:231], v13 offset:63488
  s_waitcnt lgkmcnt(9)
  v_mfma_f32_16x16x32_bf16 v[96:99], a[240:243], v[184:187], v[96:99]
  v_add_u32 v14, 65536, v14
  ds_read_b64_tr_b16 a[232:233], v14 offset:61440
  v_mfma_f32_16x16x32_bf16 v[100:103], a[240:243], v[188:191], v[100:103]
  ds_read_b64_tr_b16 a[234:235], v14 offset:63488
  v_mfma_f32_16x16x32_bf16 v[104:107], a[244:247], v[184:187], v[104:107]
  v_add_u32 v15, 65536, v15
  ds_read_b64_tr_b16 a[236:237], v15 offset:61440
  ds_read_b32 v3, v2 offset:2048
  v_mfma_f32_16x16x32_bf16 v[108:111], a[244:247], v[188:191], v[108:111]
  ds_read_b64_tr_b16 a[238:239], v15 offset:63488
  s_waitcnt lgkmcnt(10)
  v_mfma_f32_16x16x32_bf16 v[112:115], a[248:251], v[184:187], v[112:115]
  v_add_u32 v12, 65536, v12
  ds_read_b64_tr_b16 a[240:241], v12 offset:0
  v_mfma_f32_16x16x32_bf16 v[116:119], a[248:251], v[188:191], v[116:119]
  ds_read_b64_tr_b16 a[242:243], v12 offset:2048
  v_mfma_f32_16x16x32_bf16 v[120:123], a[252:255], v[184:187], v[120:123]
  v_add_u32 v13, 65536, v13
  ds_read_b64_tr_b16 a[244:245], v13 offset:0
  v_mfma_f32_16x16x32_bf16 v[124:127], a[252:255], v[188:191], v[124:127]
  ds_read_b64_tr_b16 a[246:247], v13 offset:2048
  s_waitcnt lgkmcnt(9)
  v_mfma_f32_16x16x32_bf16 a[32:35], a[224:227], v[32:35], 0
  v_add_u32 v14, 65536, v14
  ds_read_b64_tr_b16 a[248:249], v14 offset:0
  v_mfma_f32_16x16x32_bf16 a[36:39], a[224:227], v[36:39], 0
  ds_read_b64_tr_b16 a[250:251], v14 offset:2048
  v_mfma_f32_16x16x32_bf16 a[40:43], a[228:231], v[32:35], 0
  v_add_u32 v15, 65536, v15
  ds_read_b64_tr_b16 a[252:253], v15 offset:0
  s_waitcnt lgkmcnt(8)
  v_cmp_le_u32 vcc, 0xb0030023, v3
  v_mfma_f32_16x16x32_bf16 a[44:47], a[228:231], v[36:39], 0
  ds_read_b64_tr_b16 a[254:255], v15 offset:2048
  s_waitcnt lgkmcnt(8)
  v_mfma_f32_16x16x32_bf16 a[48:51], a[232:235], v[32:35], 0
  ds_add_u32 v1, v4
  s_cbranch_vccz L_csV_1_2
L_cbV_1_2:
  v_subrev_u32 v12, 65536, v12
  ds_read_b64_tr_b16 a[224:225], v12 offset:45056
  v_mfma_f32_16x16x32_bf16 a[52:55], a[232:235], v[36:39], 0
  ds_read_b64_tr_b16 a[226:227], v12 offset:47104
  v_mfma_f32_16x16x32_bf16 a[56:59], a[236:239], v[32:35], 0
  v_subrev_u32 v13, 65536, v13
  ds_read_b64_tr_b16 a[228:229], v13 offset:45056
  v_mfma_f32_16x16x32_bf16 a[60:63], a[236:239], v[36:39], 0
  ds_read_b64_tr_b16 a[230:231], v13 offset:47104
  s_waitcnt lgkmcnt(9)
  v_mfma_f32_16x16x32_bf16 a[32:35], a[240:243], v[40:43], a[32:35]
  v_subrev_u32 v14, 65536, v14
  ds_read_b64_tr_b16 a[232:233], v14 offset:45056
  v_mfma_f32_16x16x32_bf16 a[36:39], a[240:243], v[44:47], a[36:39]
  ds_read_b64_tr_b16 a[234:235], v14 offset:47104
  v_mfma_f32_16x16x32_bf16 a[40:43], a[244:247], v[40:43], a[40:43]
  v_subrev_u32 v15, 65536, v15
  ds_read_b64_tr_b16 a[236:237], v15 offset:45056
  v_mfma_f32_16x16x32_bf16 a[44:47], a[244:247], v[44:47], a[44:47]
  ds_read_b64_tr_b16 a[238:239], v15 offset:47104
  s_waitcnt lgkmcnt(9)
  v_mfma_f32_16x16x32_bf16 a[48:51], a[248:251], v[40:43], a[48:51]
  ds_read_b64_tr_b16 a[240:241], v12 offset:49152
  v_mfma_f32_16x16x32_bf16 a[52:55], a[248:251], v[44:47], a[52:55]
  ds_read_b64_tr_b16 a[242:243], v12 offset:51200
  v_mfma_f32_16x16x32_bf16 a[56:59], a[252:255], v[40:43], a[56:59]
  ds_read_b64_tr_b16 a[244:245], v13 offset:49152
  v_mfma_f32_16x16x32_bf16 a[60:63], a[252:255], v[44:47], a[60:63]
  ds_read_b64_tr_b16 a[246:247], v13 offset:51200
  s_waitcnt lgkmcnt(8)
  v_mfma_f32_16x16x32_bf16 v[96:99], a[224:227], v[192:195], v[96:99]
  ds_read_b64_tr_b16 a[248:249], v14 offset:49152
  v_mfma_f32_16x16x32_bf16 v[100:103], a[224:227], v[196:199], v[100:103]
  ds_read_b64_tr_b16 a[250:251], v14 offset:51200
  v_mfma_f32_16x16x32_bf16 v[104:107], a[228:231], v[192:195], v[104:107]
  ds_read_b64_tr_b16 a[252:253], v15 offset:49152
  v_mfma_f32_16x16x32_bf16 v[108:111], a[228:231], v[196:199], v[108:111]
  ds_read_b64_tr_b16 a[254:255], v15 offset:51200
  s_waitcnt lgkmcnt(8)
  v_mfma_f32_16x16x32_bf16 v[112:115], a[232:235], v[192:195], v[112:115]
  ds_read_b64_tr_b16 a[224:225], v12 offset:53248
  v_mfma_f32_16x16x32_bf16 v[116:119], a[232:235], v[196:199], v[116:119]
  ds_read_b64_tr_b16 a[226:227], v12 offset:55296
  v_mfma_f32_16x16x32_bf16 v[120:123], a[236:239], v[192:195], v[120:123]
  ds_read_b64_tr_b16 a[228:229], v13 offset:53248
  v_mfma_f32_16x16x32_bf16 v[124:127], a[236:239], v[196:199], v[124:127]
  ds_read_b64_tr_b16 a[230:231], v13 offset:55296
  s_waitcnt lgkmcnt(8)
  v_mfma_f32_16x16x32_bf16 v[96:99], a[240:243], v[200:203], v[96:99]
  ds_read_b64_tr_b16 a[232:233], v14 offset:53248
  v_mfma_f32_16x16x32_bf16 v[100:103], a[240:243], v[204:207], v[100:103]
  ds_read_b64_tr_b16 a[234:235], v14 offset:55296
  v_mfma_f32_16x16x32_bf16 v[104:107], a[244:247], v[200:203], v[104:107]
  ds_read_b64_tr_b16 a[236:237], v15 offset:53248
  ds_read_b32 v3, v2 offset:2048
  v_mfma_f32_16x16x32_bf16 v[108:111], a[244:247], v[204:207], v[108:111]
  ds_read_b64_tr_b16 a[238:239], v15 offset:55296
  s_waitcnt lgkmcnt(9)
  v_mfma_f32_16x16x32_bf16 v[112:115], a[248:251], v[200:203], v[112:115]
  ds_read_b64_tr_b16 a[240:241], v12 offset:57344
  v_mfma_f32_16x16x32_bf16 v[116:119], a[248:251], v[204:207], v[116:119]
  ds_read_b64_tr_b16 a[242:243], v12 offset:59392
  v_mfma_f32_16x16x32_bf16 v[120:123], a[252:255], v[200:203], v[120:123]
  ds_read_b64_tr_b16 a[244:245], v13 offset:57344
  v_mfma_f32_16x16x32_bf16 v[124:127], a[252:255], v[204:207], v[124:127]
  ds_read_b64_tr_b16 a[246:247], v13 offset:59392
  s_waitcnt lgkmcnt(9)
  v_mfma_f32_16x16x32_bf16 v[96:99], a[224:227], v[208:211], v[96:99]
  ds_read_b64_tr_b16 a[248:249], v14 offset:57344
  v_mfma_f32_16x16x32_bf16 v[100:103], a[224:227], v[212:215], v[100:103]
  ds_read_b64_tr_b16 a[250:251], v14 offset:59392
  v_mfma_f32_16x16x32_bf16 v[104:107], a[228:231], v[208:211], v[104:107]
  ds_read_b64_tr_b16 a[252:253], v15 offset:57344
  s_waitcnt lgkmcnt(8)
  v_cmp_le_u32 vcc, 0xb0030024, v3
  v_mfma_f32_16x16x32_bf16 v[108:111], a[228:231], v[212:215], v[108:111]
  ds_read_b64_tr_b16 a[254:255], v15 offset:59392
  s_waitcnt lgkmcnt(8)
  v_mfma_f32_16x16x32_bf16 v[112:115], a[232:235], v[208:211], v[112:115]
  ds_add_u32 v1, v4
  s_cbranch_vccz L_csO_0_2
L_cbO_0_2:
  v_add_u32 v12, 65536, v12
  ds_read_b64_tr_b16 a[224:225], v12 offset:20480
  v_mfma_f32_16x16x32_bf16 v[116:119], a[232:235], v[212:215], v[116:119]
  ds_read_b64_tr_b16 a[226:227], v12 offset:22528
  v_mfma_f32_16x16x32_bf16 v[120:123], a[236:239], v[208:211], v[120:123]
  v_add_u32 v13, 65536, v13
  ds_read_b64_tr_b16 a[228:229], v13 offset:20480
  v_mfma_f32_16x16x32_bf16 v[124:127], a[236:239], v[212:215], v[124:127]
  ds_read_b64_tr_b16 a[230:231], v13 offset:22528
  s_waitcnt lgkmcnt(9)
  v_mfma_f32_16x16x32_bf16 v[96:99], a[240:243], v[216:219], v[96:99]
  v_add_u32 v14, 65536, v14
  ds_read_b64_tr_b16 a[232:233], v14 offset:20480
  v_mfma_f32_16x16x32_bf16 v[100:103], a[240:243], v[220:223], v[100:103]
  ds_read_b64_tr_b16 a[234:235], v14 offset:22528
  v_mfma_f32_16x16x32_bf16 v[104:107], a[244:247], v[216:219], v[104:107]
  v_add_u32 v15, 65536, v15
  ds_read_b64_tr_b16 a[236:237], v15 offset:20480
  ds_read_b32 v3, v2 offset:2048
  v_mfma_f32_16x16x32_bf16 v[108:111], a[244:247], v[220:223], v[108:111]
  ds_read_b64_tr_b16 a[238:239], v15 offset:22528
  s_waitcnt lgkmcnt(10)
  v_mfma_f32_16x16x32_bf16 v[112:115], a[248:251], v[216:219], v[112:115]
  ds_read_b64_tr_b16 a[240:241], v12 offset:24576
  v_mfma_f32_16x16x32_bf16 v[116:119], a[248:251], v[220:223], v[116:119]
  ds_read_b64_tr_b16 a[242:243], v12 offset:26624
  v_mfma_f32_16x16x32_bf16 v[120:123], a[252:255], v[216:219], v[120:123]
  ds_read_b64_tr_b16 a[244:245], v13 offset:24576
  v_mfma_f32_16x16x32_bf16 v[124:127], a[252:255], v[220:223], v[124:127]
  ds_read_b64_tr_b16 a[246:247], v13 offset:26624
  s_waitcnt lgkmcnt(9)
  v_mfma_f32_16x16x32_bf16 a[64:67], a[224:227], v[32:35], 0
  ds_read_b64_tr_b16 a[248:249], v14 offset:24576
  v_mfma_f32_16x16x32_bf16 a[68:71], a[224:227], v[36:39], 0
  ds_read_b64_tr_b16 a[250:251], v14 offset:26624
  v_mfma_f32_16x16x32_bf16 a[72:75], a[228:231], v[32:35], 0
  ds_read_b64_tr_b16 a[252:253], v15 offset:24576
  s_waitcnt lgkmcnt(8)
  v_cmp_le_u32 vcc, 0xb0030025, v3
  v_mfma_f32_16x16x32_bf16 a[76:79], a[228:231], v[36:39], 0
  ds_read_b64_tr_b16 a[254:255], v15 offset:26624
  s_waitcnt lgkmcnt(8)
  v_mfma_f32_16x16x32_bf16 a[80:83], a[232:235], v[32:35], 0
  ds_add_u32 v1, v4
  s_cbranch_vccz L_csV_1_3
L_cbV_1_3:
  v_subrev_u32 v12, 131072, v12
  ds_read_b64_tr_b16 a[224:225], v12 offset:16384
  v_mfma_f32_16x16x32_bf16 a[84:87], a[232:235], v[36:39], 0
  ds_read_b64_tr_b16 a[226:227], v12 offset:18432
  v_mfma_f32_16x16x32_bf16 a[88:91], a[236:239], v[32:35], 0
  v_subrev_u32 v13, 131072, v13
  ds_read_b64_tr_b16 a[228:229], v13 offset:16384
  v_mfma_f32_16x16x32_bf16 a[92:95], a[236:239], v[36:39], 0
  ds_read_b64_tr_b16 a[230:231], v13 offset:18432
  s_waitcnt lgkmcnt(9)
  v_mfma_f32_16x16x32_bf16 a[64:67], a[240:243], v[40:43], a[64:67]
  v_subrev_u32 v14, 131072, v14
  ds_read_b64_tr_b16 a[232:233], v14 offset:16384
  v_mfma_f32_16x16x32_bf16 a[68:71], a[240:243], v[44:47], a[68:71]
  ds_read_b64_tr_b16 a[234:235], v14 offset:18432
  v_mfma_f32_16x16x32_bf16 a[72:75], a[244:247], v[40:43], a[72:75]
  v_subrev_u32 v15, 131072, v15
  ds_read_b64_tr_b16 a[236:237], v15 offset:16384
  v_mfma_f32_16x16x32_bf16 a[76:79], a[244:247], v[44:47], a[76:79]
  ds_read_b64_tr_b16 a[238:239], v15 offset:18432
  s_waitcnt lgkmcnt(9)
  v_mfma_f32_16x16x32_bf16 a[80:83], a[248:251], v[40:43], a[80:83]
  ds_read_b64_tr_b16 a[240:241], v12 offset:20480
  v_mfma_f32_16x16x32_bf16 a[84:87], a[248:251], v[44:47], a[84:87]
  ds_read_b64_tr_b16 a[242:243], v12 offset:22528
  v_mfma_f32_16x16x32_bf16 a[88:91], a[252:255], v[40:43], a[88:91]
  ds_read_b64_tr_b16 a[244:245], v13 offset:20480
  v_mfma_f32_16x16x32_bf16 a[92:95], a[252:255], v[44:47], a[92:95]
  ds_read_b64_tr_b16 a[246:247], v13 offset:22528
  s_waitcnt lgkmcnt(8)
  v_mfma_f32_16x16x32_bf16 v[96:99], a[224:227], v[224:227], v[96:99]
  ds_read_b64_tr_b16 a[248:249], v14 offset:20480
  v_mfma_f32_16x16x32_bf16 v[100:103], a[224:227], v[228:231], v[100:103]
  ds_read_b64_tr_b16 a[250:251], v14 offset:22528
  v_mfma_f32_16x16x32_bf16 v[104:107], a[228:231], v[224:227], v[104:107]
  ds_read_b64_tr_b16 a[252:253], v15 offset:20480
  v_mfma_f32_16x16x32_bf16 v[108:111], a[228:231], v[228:231], v[108:111]
  ds_read_b64_tr_b16 a[254:255], v15 offset:22528
  s_waitcnt lgkmcnt(8)
  v_mfma_f32_16x16x32_bf16 v[112:115], a[232:235], v[224:227], v[112:115]
  ds_read_b64_tr_b16 a[224:225], v12 offset:24576
  v_mfma_f32_16x16x32_bf16 v[116:119], a[232:235], v[228:231], v[116:119]
  ds_read_b64_tr_b16 a[226:227], v12 offset:26624
  v_mfma_f32_16x16x32_bf16 v[120:123], a[236:239], v[224:227], v[120:123]
  ds_read_b64_tr_b16 a[228:229], v13 offset:24576
  v_mfma_f32_16x16x32_bf16 v[124:127], a[236:239], v[228:231], v[124:127]
  ds_read_b64_tr_b16 a[230:231], v13 offset:26624
  s_waitcnt lgkmcnt(8)
  v_mfma_f32_16x16x32_bf16 v[96:99], a[240:243], v[232:235], v[96:99]
  ds_read_b64_tr_b16 a[232:233], v14 offset:24576
  v_mfma_f32_16x16x32_bf16 v[100:103], a[240:243], v[236:239], v[100:103]
  ds_read_b64_tr_b16 a[234:235], v14 offset:26624
  v_mfma_f32_16x16x32_bf16 v[104:107], a[244:247], v[232:235], v[104:107]
  ds_read_b64_tr_b16 a[236:237], v15 offset:24576
  ds_read_b32 v3, v2 offset:2048
  v_mfma_f32_16x16x32_bf16 v[108:111], a[244:247], v[236:239], v[108:111]
  ds_read_b64_tr_b16 a[238:239], v15 offset:26624
  s_waitcnt lgkmcnt(9)
  v_mfma_f32_16x16x32_bf16 v[112:115], a[248:251], v[232:235], v[112:115]
  ds_read_b64_tr_b16 a[240:241], v12 offset:28672
  v_mfma_f32_16x16x32_bf16 v[116:119], a[248:251], v[236:239], v[116:119]
  ds_read_b64_tr_b16 a[242:243], v12 offset:30720
  v_mfma_f32_16x16x32_bf16 v[120:123], a[252:255], v[232:235], v[120:123]
  ds_read_b64_tr_b16 a[244:245], v13 offset:28672
  v_mfma_f32_16x16x32_bf16 v[124:127], a[252:255], v[236:239], v[124:127]
  ds_read_b64_tr_b16 a[246:247], v13 offset:30720
  s_waitcnt lgkmcnt(9)
  v_mfma_f32_16x16x32_bf16 v[96:99], a[224:227], v[240:243], v[96:99]
  ds_read_b64_tr_b16 a[248:249], v14 offset:28672
  v_mfma_f32_16x16x32_bf16 v[100:103], a[224:227], v[244:247], v[100:103]
  ds_read_b64_tr_b16 a[250:251], v14 offset:30720
  v_mfma_f32_16x16x32_bf16 v[104:107], a[228:231], v[240:243], v[104:107]
  ds_read_b64_tr_b16 a[252:253], v15 offset:28672
  s_waitcnt lgkmcnt(8)
  v_cmp_le_u32 vcc, 0xb0030026, v3
  v_mfma_f32_16x16x32_bf16 v[108:111], a[228:231], v[244:247], v[108:111]
  ds_read_b64_tr_b16 a[254:255], v15 offset:30720
  s_waitcnt lgkmcnt(8)
  v_mfma_f32_16x16x32_bf16 v[112:115], a[232:235], v[240:243], v[112:115]
  ds_add_u32 v1, v4
  s_cbranch_vccz L_csO_0_3
L_cbO_0_3:
  ds_read_b64_tr_b16 a[224:225], v12 offset:32768
  v_mfma_f32_16x16x32_bf16 v[116:119], a[232:235], v[244:247], v[116:119]
  ds_read_b64_tr_b16 a[226:227], v12 offset:34816
  v_mfma_f32_16x16x32_bf16 v[120:123], a[236:239], v[240:243], v[120:123]
  ds_read_b64_tr_b16 a[228:229], v13 offset:32768
  v_mfma_f32_16x16x32_bf16 v[124:127], a[236:239], v[244:247], v[124:127]
  ds_read_b64_tr_b16 a[230:231], v13 offset:34816
  s_waitcnt lgkmcnt(9)
  v_mfma_f32_16x16x32_bf16 v[96:99], a[240:243], v[248:251], v[96:99]
  ds_read_b64_tr_b16 a[232:233], v14 offset:32768
  v_mfma_f32_16x16x32_bf16 v[100:103], a[240:243], v[252:255], v[100:103]
  ds_read_b64_tr_b16 a[234:235], v14 offset:34816
  v_mfma_f32_16x16x32_bf16 v[104:107], a[244:247], v[248:251], v[104:107]
  ds_read_b64_tr_b16 a[236:237], v15 offset:32768
  ds_read_b32 v3, v2 offset:2048
  v_mfma_f32_16x16x32_bf16 v[108:111], a[244:247], v[252:255], v[108:111]
  ds_read_b64_tr_b16 a[238:239], v15 offset:34816
  s_waitcnt lgkmcnt(10)
  v_mfma_f32_16x16x32_bf16 v[112:115], a[248:251], v[248:251], v[112:115]
  ds_read_b64_tr_b16 a[240:241], v12 offset:36864
  v_mfma_f32_16x16x32_bf16 v[116:119], a[248:251], v[252:255], v[116:119]
  ds_read_b64_tr_b16 a[242:243], v12 offset:38912
  v_mfma_f32_16x16x32_bf16 v[120:123], a[252:255], v[248:251], v[120:123]
  ds_read_b64_tr_b16 a[244:245], v13 offset:36864
  v_mfma_f32_16x16x32_bf16 v[124:127], a[252:255], v[252:255], v[124:127]
  ds_read_b64_tr_b16 a[246:247], v13 offset:38912
  s_waitcnt lgkmcnt(9)
  v_mfma_f32_16x16x32_bf16 a[96:99], a[224:227], v[32:35], 0
  ds_read_b64_tr_b16 a[248:249], v14 offset:36864
  v_mfma_f32_16x16x32_bf16 a[100:103], a[224:227], v[36:39], 0
  ds_read_b64_tr_b16 a[250:251], v14 offset:38912
  v_mfma_f32_16x16x32_bf16 a[104:107], a[228:231], v[32:35], 0
  ds_read_b64_tr_b16 a[252:253], v15 offset:36864
  s_waitcnt lgkmcnt(8)
  v_cmp_le_u32 vcc, 0xb0030027, v3
  v_mfma_f32_16x16x32_bf16 a[108:111], a[228:231], v[36:39], 0
  ds_read_b64_tr_b16 a[254:255], v15 offset:38912
  s_waitcnt lgkmcnt(8)
  v_mfma_f32_16x16x32_bf16 a[112:115], a[232:235], v[32:35], 0
  ds_add_u32 v1, v4
  s_cbranch_vccz L_csV_2_0
L_cbV_2_0:
  ds_read_b64_tr_b16 a[224:225], v12 offset:49152
  v_mfma_f32_16x16x32_bf16 a[116:119], a[232:235], v[36:39], 0
  ds_read_b64_tr_b16 a[226:227], v12 offset:51200
  v_mfma_f32_16x16x32_bf16 a[120:123], a[236:239], v[32:35], 0
  ds_read_b64_tr_b16 a[228:229], v13 offset:49152
  v_mfma_f32_16x16x32_bf16 a[124:127], a[236:239], v[36:39], 0
  ds_read_b64_tr_b16 a[230:231], v13 offset:51200
  s_waitcnt lgkmcnt(9)
  v_mfma_f32_16x16x32_bf16 a[96:99], a[240:243], v[40:43], a[96:99]
  ds_read_b64_tr_b16 a[232:233], v14 offset:49152
  v_mfma_f32_16x16x32_bf16 a[100:103], a[240:243], v[44:47], a[100:103]
  ds_read_b64_tr_b16 a[234:235], v14 offset:51200
  v_mfma_f32_16x16x32_bf16 a[104:107], a[244:247], v[40:43], a[104:107]
  ds_read_b64_tr_b16 a[236:237], v15 offset:49152
  v_mfma_f32_16x16x32_bf16 a[108:111], a[244:247], v[44:47], a[108:111]
  ds_read_b64_tr_b16 a[238:239], v15 offset:51200
  s_waitcnt lgkmcnt(9)
  v_mfma_f32_16x16x32_bf16 a[112:115], a[248:251], v[40:43], a[112:115]
  ds_read_b64_tr_b16 a[240:241], v12 offset:53248
  v_mfma_f32_16x16x32_bf16 a[116:119], a[248:251], v[44:47], a[116:119]
  ds_read_b64_tr_b16 a[242:243], v12 offset:55296
  v_mfma_f32_16x16x32_bf16 a[120:123], a[252:255], v[40:43], a[120:123]
  ds_read_b64_tr_b16 a[244:245], v13 offset:53248
  v_mfma_f32_16x16x32_bf16 a[124:127], a[252:255], v[44:47], a[124:127]
  ds_read_b64_tr_b16 a[246:247], v13 offset:55296
  s_waitcnt lgkmcnt(8)
  v_mfma_f32_16x16x32_bf16 v[64:67], a[224:227], v[128:131], 0
  ds_read_b64_tr_b16 a[248:249], v14 offset:53248
  v_mfma_f32_16x16x32_bf16 v[68:71], a[224:227], v[132:135], 0
  ds_read_b64_tr_b16 a[250:251], v14 offset:55296
  v_mfma_f32_16x16x32_bf16 v[72:75], a[228:231], v[128:131], 0
  ds_read_b64_tr_b16 a[252:253], v15 offset:53248
  v_mfma_f32_16x16x32_bf16 v[76:79], a[228:231], v[132:135], 0
  ds_read_b64_tr_b16 a[254:255], v15 offset:55296
  s_waitcnt lgkmcnt(8)
  v_mfma_f32_16x16x32_bf16 v[80:83], a[232:235], v[128:131], 0
  ds_read_b64_tr_b16 a[224:225], v12 offset:57344
  v_mfma_f32_16x16x32_bf16 v[84:87], a[232:235], v[132:135], 0
  ds_read_b64_tr_b16 a[226:227], v12 offset:59392
  v_mul_f32 v96, v96, v20
  v_mul_f32 v97, v97, v20
  v_cvt_pk_bf16_f32 v48, v96, v97
  v_mfma_f32_16x16x32_bf16 v[88:91], a[236:239], v[128:131], 0
  ds_read_b64_tr_b16 a[228:229], v13 offset:57344
  v_mul_f32 v98, v98, v20
  v_mul_f32 v99, v99, v20
  v_mfma_f32_16x16x32_bf16 v[92:95], a[236:239], v[132:135], 0
  ds_read_b64_tr_b16 a[230:231], v13 offset:59392
  v_cvt_pk_bf16_f32 v49, v98, v99
  s_waitcnt lgkmcnt(8)
  v_mfma_f32_16x16x32_bf16 v[64:67], a[240:243], v[136:139], v[64:67]
  ds_read_b64_tr_b16 a[232:233], v14 offset:57344
  v_mul_f32 v104, v104, v20
  v_mul_f32 v105, v105, v20
  v_cvt_pk_bf16_f32 v50, v104, v105
  v_mfma_f32_16x16x32_bf16 v[68:71], a[240:243], v[140:143], v[68:71]
  ds_read_b64_tr_b16 a[234:235], v14 offset:59392
  v_mul_f32 v106, v106, v20
  v_mul_f32 v107, v107, v20
  v_mfma_f32_16x16x32_bf16 v[72:75], a[244:247], v[136:139], v[72:75]
  ds_read_b64_tr_b16 a[236:237], v15 offset:57344
  ds_read_b32 v3, v2 offset:2048
  v_cvt_pk_bf16_f32 v51, v106, v107
  v_mfma_f32_16x16x32_bf16 v[76:79], a[244:247], v[140:143], v[76:79]
  ds_read_b64_tr_b16 a[238:239], v15 offset:59392
  v_mul_f32 v100, v100, v21
  v_mul_f32 v101, v101, v21
  s_waitcnt lgkmcnt(9)
  v_mfma_f32_16x16x32_bf16 v[80:83], a[248:251], v[136:139], v[80:83]
  ds_read_b64_tr_b16 a[240:241], v12 offset:61440
  v_cvt_pk_bf16_f32 v52, v100, v101
  v_mul_f32 v102, v102, v21
  v_mfma_f32_16x16x32_bf16 v[84:87], a[248:251], v[140:143], v[84:87]
  ds_read_b64_tr_b16 a[242:243], v12 offset:63488
  v_mul_f32 v103, v103, v21
  v_cvt_pk_bf16_f32 v53, v102, v103
  v_mfma_f32_16x16x32_bf16 v[88:91], a[252:255], v[136:139], v[88:91]
  ds_read_b64_tr_b16 a[244:245], v13 offset:61440
  v_mul_f32 v108, v108, v21
  v_mul_f32 v109, v109, v21
  v_cvt_pk_bf16_f32 v54, v108, v109
  v_mfma_f32_16x16x32_bf16 v[92:95], a[252:255], v[140:143], v[92:95]
  ds_read_b64_tr_b16 a[246:247], v13 offset:63488
  v_mul_f32 v110, v110, v21
  s_waitcnt lgkmcnt(9)
  v_mfma_f32_16x16x32_bf16 v[64:67], a[224:227], v[144:147], v[64:67]
  ds_read_b64_tr_b16 a[248:249], v14 offset:61440
  v_mul_f32 v111, v111, v21
  v_cvt_pk_bf16_f32 v55, v110, v111
  v_mfma_f32_16x16x32_bf16 v[68:71], a[224:227], v[148:151], v[68:71]
  ds_read_b64_tr_b16 a[250:251], v14 offset:63488
  v_mul_f32 v112, v112, v20
  v_mul_f32 v113, v113, v20
  v_cvt_pk_bf16_f32 v56, v112, v113
  v_mfma_f32_16x16x32_bf16 v[72:75], a[228:231], v[144:147], v[72:75]
  ds_read_b64_tr_b16 a[252:253], v15 offset:61440
  s_waitcnt lgkmcnt(8)
  v_cmp_le_u32 vcc, 0xb0030028, v3
  v_mul_f32 v114, v114, v20
  v_mfma_f32_16x16x32_bf16 v[76:79], a[228:231], v[148:151], v[76:79]
  ds_read_b64_tr_b16 a[254:255], v15 offset:63488
  v_mul_f32 v115, v115, v20
  v_cvt_pk_bf16_f32 v57, v114, v115
  s_waitcnt lgkmcnt(8)
  v_mfma_f32_16x16x32_bf16 v[80:83], a[232:235], v[144:147], v[80:83]
  ds_add_u32 v1, v4
  s_cbranch_vccz L_csO_0_4
L_cbO_0_4:
  ds_read_b64_tr_b16 a[224:225], v12 offset:40960
  v_mfma_f32_16x16x32_bf16 v[84:87], a[232:235], v[148:151], v[84:87]
  ds_read_b64_tr_b16 a[226:227], v12 offset:43008
  v_mul_f32 v120, v120, v20
  v_mul_f32 v121, v121, v20
  v_cvt_pk_bf16_f32 v58, v120, v121
  v_mfma_f32_16x16x32_bf16 v[88:91], a[236:239], v[144:147], v[88:91]
  ds_read_b64_tr_b16 a[228:229], v13 offset:40960
  v_mul_f32 v122, v122, v20
  v_mul_f32 v123, v123, v20
  v_mfma_f32_16x16x32_bf16 v[92:95], a[236:239], v[148:151], v[92:95]
  ds_read_b64_tr_b16 a[230:231], v13 offset:43008
  v_cvt_pk_bf16_f32 v59, v122, v123
  s_waitcnt lgkmcnt(9)
  v_mfma_f32_16x16x32_bf16 v[64:67], a[240:243], v[152:155], v[64:67]
  ds_read_b64_tr_b16 a[232:233], v14 offset:40960
  v_mul_f32 v116, v116, v21
  v_mul_f32 v117, v117, v21
  v_cvt_pk_bf16_f32 v60, v116, v117
  v_mfma_f32_16x16x32_bf16 v[68:71], a[240:243], v[156:159], v[68:71]
  ds_read_b64_tr_b16 a[234:235], v14 offset:43008
  v_mul_f32 v118, v118, v21
  v_mul_f32 v119, v119, v21
  v_mfma_f32_16x16x32_bf16 v[72:75], a[244:247], v[152:155], v[72:75]
  ds_read_b64_tr_b16 a[236:237], v15 offset:40960
  ds_read_b32 v3, v2 offset:2048
  v_cvt_pk_bf16_f32 v61, v118, v119
  v_mfma_f32_16x16x32_bf16 v[76:79], a[244:247], v[156:159], v[76:79]
  ds_read_b64_tr_b16 a[238:239], v15 offset:43008
  v_mul_f32 v124, v124, v21
  v_mul_f32 v125, v125, v21
  s_waitcnt lgkmcnt(10)
  v_mfma_f32_16x16x32_bf16 v[80:83], a[248:251], v[152:155], v[80:83]
  ds_read_b64_tr_b16 a[240:241], v12 offset:45056
  v_cvt_pk_bf16_f32 v62, v124, v125
  v_mul_f32 v126, v126, v21
  v_mfma_f32_16x16x32_bf16 v[84:87], a[248:251], v[156:159], v[84:87]
  ds_read_b64_tr_b16 a[242:243], v12 offset:47104
  v_mul_f32 v127, v127, v21
  v_cvt_pk_bf16_f32 v63, v126, v127
  v_mfma_f32_16x16x32_bf16 v[88:91], a[252:255], v[152:155], v[88:91]
  ds_read_b64_tr_b16 a[244:245], v13 offset:45056
  v_mfma_f32_16x16x32_bf16 v[92:95], a[252:255], v[156:159], v[92:95]
  ds_read_b64_tr_b16 a[246:247], v13 offset:47104
  s_waitcnt lgkmcnt(9)
  v_mfma_f32_16x16x32_bf16 a[128:131], a[224:227], v[32:35], 0
  ds_read_b64_tr_b16 a[248:249], v14 offset:45056
  v_mfma_f32_16x16x32_bf16 a[132:135], a[224:227], v[36:39], 0
  ds_read_b64_tr_b16 a[250:251], v14 offset:47104
  v_mfma_f32_16x16x32_bf16 a[136:139], a[228:231], v[32:35], 0
  ds_read_b64_tr_b16 a[252:253], v15 offset:45056
  s_waitcnt lgkmcnt(8)
  v_cmp_le_u32 vcc, 0xb0030029, v3
  v_mfma_f32_16x16x32_bf16 a[140:143], a[228:231], v[36:39], 0
  ds_read_b64_tr_b16 a[254:255], v15 offset:47104
  s_waitcnt lgkmcnt(8)
  v_mfma_f32_16x16x32_bf16 a[144:147], a[232:235], v[32:35], 0
  ds_add_u32 v1, v4
  s_cbranch_vccz L_csV_2_1
L_cbV_2_1:
  v_add_u32 v12, 65536, v12
  ds_read_b64_tr_b16 a[224:225], v12 offset:0
  v_mfma_f32_16x16x32_bf16 a[148:151], a[232:235], v[36:39], 0
  ds_read_b64_tr_b16 a[226:227], v12 offset:2048
  v_mfma_f32_16x16x32_bf16 a[152:155], a[236:239], v[32:35], 0
  v_add_u32 v13, 65536, v13
  ds_read_b64_tr_b16 a[228:229], v13 offset:0
  v_mfma_f32_16x16x32_bf16 a[156:159], a[236:239], v[36:39], 0
  ds_read_b64_tr_b16 a[230:231], v13 offset:2048
  s_waitcnt lgkmcnt(9)
  v_mfma_f32_16x16x32_bf16 a[128:131], a[240:243], v[40:43], a[128:131]
  v_add_u32 v14, 65536, v14
  ds_read_b64_tr_b16 a[232:233], v14 offset:0
  v_mfma_f32_16x16x32_bf16 a[132:135], a[240:243], v[44:47], a[132:135]
  ds_read_b64_tr_b16 a[234:235], v14 offset:2048
  v_mfma_f32_16x16x32_bf16 a[136:139], a[244:247], v[40:43], a[136:139]
  v_add_u32 v15, 65536, v15
  ds_read_b64_tr_b16 a[236:237], v15 offset:0
  v_mfma_f32_16x16x32_bf16 a[140:143], a[244:247], v[44:47], a[140:143]
  ds_read_b64_tr_b16 a[238:239], v15 offset:2048
  s_waitcnt lgkmcnt(9)
  v_mfma_f32_16x16x32_bf16 a[144:147], a[248:251], v[40:43], a[144:147]
  ds_read_b64_tr_b16 a[240:241], v12 offset:4096
  v_mfma_f32_16x16x32_bf16 a[148:151], a[248:251], v[44:47], a[148:151]
  ds_read_b64_tr_b16 a[242:243], v12 offset:6144
  v_mfma_f32_16x16x32_bf16 a[152:155], a[252:255], v[40:43], a[152:155]
  ds_read_b64_tr_b16 a[244:245], v13 offset:4096
  v_mfma_f32_16x16x32_bf16 a[156:159], a[252:255], v[44:47], a[156:159]
  ds_read_b64_tr_b16 a[246:247], v13 offset:6144
  s_waitcnt lgkmcnt(8)
  v_mfma_f32_16x16x32_bf16 v[64:67], a[224:227], v[160:163], v[64:67]
  ds_read_b64_tr_b16 a[248:249], v14 offset:4096
  v_mfma_f32_16x16x32_bf16 v[68:71], a[224:227], v[164:167], v[68:71]
  ds_read_b64_tr_b16 a[250:251], v14 offset:6144
  v_mfma_f32_16x16x32_bf16 v[72:75], a[228:231], v[160:163], v[72:75]
  ds_read_b64_tr_b16 a[252:253], v15 offset:4096
  v_mfma_f32_16x16x32_bf16 v[76:79], a[228:231], v[164:167], v[76:79]
  ds_read_b64_tr_b16 a[254:255], v15 offset:6144
  s_waitcnt lgkmcnt(8)
  v_mfma_f32_16x16x32_bf16 v[80:83], a[232:235], v[160:163], v[80:83]
  ds_read_b64_tr_b16 a[224:225], v12 offset:8192
  v_mfma_f32_16x16x32_bf16 v[84:87], a[232:235], v[164:167], v[84:87]
  ds_read_b64_tr_b16 a[226:227], v12 offset:10240
  v_mfma_f32_16x16x32_bf16 v[88:91], a[236:239], v[160:163], v[88:91]
  ds_read_b64_tr_b16 a[228:229], v13 offset:8192
  v_mfma_f32_16x16x32_bf16 v[92:95], a[236:239], v[164:167], v[92:95]
  ds_read_b64_tr_b16 a[230:231], v13 offset:10240
  s_waitcnt lgkmcnt(8)
  v_mfma_f32_16x16x32_bf16 v[64:67], a[240:243], v[168:171], v[64:67]
  ds_read_b64_tr_b16 a[232:233], v14 offset:8192
  v_mfma_f32_16x16x32_bf16 v[68:71], a[240:243], v[172:175], v[68:71]
  ds_read_b64_tr_b16 a[234:235], v14 offset:10240
  v_mfma_f32_16x16x32_bf16 v[72:75], a[244:247], v[168:171], v[72:75]
  ds_read_b64_tr_b16 a[236:237], v15 offset:8192
  ds_read_b32 v3, v2 offset:2048
  v_mfma_f32_16x16x32_bf16 v[76:79], a[244:247], v[172:175], v[76:79]
  ds_read_b64_tr_b16 a[238:239], v15 offset:10240
  s_waitcnt lgkmcnt(9)
  v_mfma_f32_16x16x32_bf16 v[80:83], a[248:251], v[168:171], v[80:83]
  ds_read_b64_tr_b16 a[240:241], v12 offset:12288
  v_mfma_f32_16x16x32_bf16 v[84:87], a[248:251], v[172:175], v[84:87]
  ds_read_b64_tr_b16 a[242:243], v12 offset:14336
  v_mfma_f32_16x16x32_bf16 v[88:91], a[252:255], v[168:171], v[88:91]
  ds_read_b64_tr_b16 a[244:245], v13 offset:12288
  v_mfma_f32_16x16x32_bf16 v[92:95], a[252:255], v[172:175], v[92:95]
  ds_read_b64_tr_b16 a[246:247], v13 offset:14336
  s_waitcnt lgkmcnt(9)
  v_mfma_f32_16x16x32_bf16 v[64:67], a[224:227], v[176:179], v[64:67]
  ds_read_b64_tr_b16 a[248:249], v14 offset:12288
  v_mfma_f32_16x16x32_bf16 v[68:71], a[224:227], v[180:183], v[68:71]
  ds_read_b64_tr_b16 a[250:251], v14 offset:14336
  v_mfma_f32_16x16x32_bf16 v[72:75], a[228:231], v[176:179], v[72:75]
  ds_read_b64_tr_b16 a[252:253], v15 offset:12288
  s_waitcnt lgkmcnt(8)
  v_cmp_le_u32 vcc, 0xb003002a, v3
  v_mfma_f32_16x16x32_bf16 v[76:79], a[228:231], v[180:183], v[76:79]
  ds_read_b64_tr_b16 a[254:255], v15 offset:14336
  s_waitcnt lgkmcnt(8)
  v_mfma_f32_16x16x32_bf16 v[80:83], a[232:235], v[176:179], v[80:83]
  s_cbranch_vccz L_csO_0_5
L_cbO_0_5:
  v_add_u32 v12, 65536, v12
  ds_read_b64_tr_b16 a[224:225], v12 offset:8192
  v_mfma_f32_16x16x32_bf16 v[84:87], a[232:235], v[180:183], v[84:87]
  ds_read_b64_tr_b16 a[226:227], v12 offset:10240
  v_mfma_f32_16x16x32_bf16 v[88:91], a[236:239], v[176:179], v[88:91]
  v_add_u32 v13, 65536, v13
  ds_read_b64_tr_b16 a[228:229], v13 offset:8192
  v_mfma_f32_16x16x32_bf16 v[92:95], a[236:239], v[180:183], v[92:95]
  ds_read_b64_tr_b16 a[230:231], v13 offset:10240
  s_waitcnt lgkmcnt(8)
  v_mfma_f32_16x16x32_bf16 v[64:67], a[240:243], v[184:187], v[64:67]
  v_add_u32 v14, 65536, v14
  ds_read_b64_tr_b16 a[232:233], v14 offset:8192
  v_mfma_f32_16x16x32_bf16 v[68:71], a[240:243], v[188:191], v[68:71]
  ds_read_b64_tr_b16 a[234:235], v14 offset:10240
  v_mfma_f32_16x16x32_bf16 v[72:75], a[244:247], v[184:187], v[72:75]
  v_add_u32 v15, 65536, v15
  ds_read_b64_tr_b16 a[236:237], v15 offset:8192
  ds_read_b32 v3, v2 offset:2048
  v_mfma_f32_16x16x32_bf16 v[76:79], a[244:247], v[188:191], v[76:79]
  ds_read_b64_tr_b16 a[238:239], v15 offset:10240
  s_waitcnt lgkmcnt(9)
  v_mfma_f32_16x16x32_bf16 v[80:83], a[248:251], v[184:187], v[80:83]
  ds_read_b64_tr_b16 a[240:241], v12 offset:12288
  v_mov_b32 v31, L_tab-L_pc+180
  v_mfma_f32_16x16x32_bf16 v[84:87], a[248:251], v[188:191], v[84:87]
  ds_read_b64_tr_b16 a[242:243], v12 offset:14336
  global_load_lds_dword v31, s[22:23]
  v_mfma_f32_16x16x32_bf16 v[88:91], a[252:255], v[184:187], v[88:91]
  ds_read_b64_tr_b16 a[244:245], v13 offset:12288
  v_mfma_f32_16x16x32_bf16 v[92:95], a[252:255], v[188:191], v[92:95]
  ds_read_b64_tr_b16 a[246:247], v13 offset:14336
  s_waitcnt lgkmcnt(9)
  v_mfma_f32_16x16x32_bf16 a[160:163], a[224:227], v[32:35], 0
  ds_read_b64_tr_b16 a[248:249], v14 offset:12288
  v_mfma_f32_16x16x32_bf16 a[164:167], a[224:227], v[36:39], 0
  ds_read_b64_tr_b16 a[250:251], v14 offset:14336
  v_mfma_f32_16x16x32_bf16 a[168:171], a[228:231], v[32:35], 0
  ds_read_b64_tr_b16 a[252:253], v15 offset:12288
  s_waitcnt lgkmcnt(8)
  v_cmp_le_u32 vcc, 0xb003002b, v3
  v_mfma_f32_16x16x32_bf16 a[172:175], a[228:231], v[36:39], 0
  ds_read_b64_tr_b16 a[254:255], v15 offset:14336
  s_waitcnt lgkmcnt(8)
  v_mfma_f32_16x16x32_bf16 a[176:179], a[232:235], v[32:35], 0
  s_cbranch_vccz L_csV_2_2
L_cbV_2_2:
  v_subrev_u32 v12, 65536, v12
  ds_read_b64_tr_b16 a[224:225], v12 offset:16384
  v_mfma_f32_16x16x32_bf16 a[180:183], a[232:235], v[36:39], 0
  ds_read_b64_tr_b16 a[226:227], v12 offset:18432
  v_mfma_f32_16x16x32_bf16 a[184:187], a[236:239], v[32:35], 0
  v_subrev_u32 v13, 65536, v13
  ds_read_b64_tr_b16 a[228:229], v13 offset:16384
  v_mfma_f32_16x16x32_bf16 a[188:191], a[236:239], v[36:39], 0
  ds_read_b64_tr_b16 a[230:231], v13 offset:18432
  s_waitcnt lgkmcnt(8)
  v_mfma_f32_16x16x32_bf16 a[160:163], a[240:243], v[40:43], a[160:163]
  v_subrev_u32 v14, 65536, v14
  ds_read_b64_tr_b16 a[232:233], v14 offset:16384
  v_mfma_f32_16x16x32_bf16 a[164:167], a[240:243], v[44:47], a[164:167]
  ds_read_b64_tr_b16 a[234:235], v14 offset:18432
  v_mfma_f32_16x16x32_bf16 a[168:171], a[244:247], v[40:43], a[168:171]
  v_subrev_u32 v15, 65536, v15
  ds_read_b64_tr_b16 a[236:237], v15 offset:16384
  v_mfma_f32_16x16x32_bf16 a[172:175], a[244:247], v[44:47], a[172:175]
  ds_read_b64_tr_b16 a[238:239], v15 offset:18432
  s_waitcnt lgkmcnt(8)
  v_mfma_f32_16x16x32_bf16 a[176:179], a[248:251], v[40:43], a[176:179]
  ds_read_b64_tr_b16 a[240:241], v12 offset:20480
  v_mov_b32 v31, L_tab-L_pc+184
  v_mfma_f32_16x16x32_bf16 a[180:183], a[248:251], v[44:47], a[180:183]
  ds_read_b64_tr_b16 a[242:243], v12 offset:22528
  global_load_lds_dword v31, s[22:23]
  v_mfma_f32_16x16x32_bf16 a[184:187], a[252:255], v[40:43], a[184:187]
  ds_read_b64_tr_b16 a[244:245], v13 offset:20480
  v_mfma_f32_16x16x32_bf16 a[188:191], a[252:255], v[44:47], a[188:191]
  ds_read_b64_tr_b16 a[246:247], v13 offset:22528
  s_waitcnt lgkmcnt(8)
  v_mfma_f32_16x16x32_bf16 v[64:67], a[224:227], v[192:195], v[64:67]
  ds_read_b64_tr_b16 a[248:249], v14 offset:20480
  v_mfma_f32_16x16x32_bf16 v[68:71], a[224:227], v[196:199], v[68:71]
  ds_read_b64_tr_b16 a[250:251], v14 offset:22528
  v_mfma_f32_16x16x32_bf16 v[72:75], a[228:231], v[192:195], v[72:75]
  ds_read_b64_tr_b16 a[252:253], v15 offset:20480
  v_mfma_f32_16x16x32_bf16 v[76:79], a[228:231], v[196:199], v[76:79]
  ds_read_b64_tr_b16 a[254:255], v15 offset:22528
  s_waitcnt lgkmcnt(8)
  v_mfma_f32_16x16x32_bf16 v[80:83], a[232:235], v[192:195], v[80:83]
  ds_read_b64_tr_b16 a[224:225], v12 offset:24576
  v_mfma_f32_16x16x32_bf16 v[84:87], a[232:235], v[196:199], v[84:87]
  ds_read_b64_tr_b16 a[226:227], v12 offset:26624
  v_mfma_f32_16x16x32_bf16 v[88:91], a[236:239], v[192:195], v[88:91]
  ds_read_b64_tr_b16 a[228:229], v13 offset:24576
  v_mfma_f32_16x16x32_bf16 v[92:95], a[236:239], v[196:199], v[92:95]
  ds_read_b64_tr_b16 a[230:231], v13 offset:26624
  s_waitcnt lgkmcnt(8)
  v_mfma_f32_16x16x32_bf16 v[64:67], a[240:243], v[200:203], v[64:67]
  ds_read_b64_tr_b16 a[232:233], v14 offset:24576
  v_mfma_f32_16x16x32_bf16 v[68:71], a[240:243], v[204:207], v[68:71]
  ds_read_b64_tr_b16 a[234:235], v14 offset:26624
  v_mfma_f32_16x16x32_bf16 v[72:75], a[244:247], v[200:203], v[72:75]
  ds_read_b64_tr_b16 a[236:237], v15 offset:24576
  ds_read_b32 v3, v2 offset:2048
  v_mfma_f32_16x16x32_bf16 v[76:79], a[244:247], v[204:207], v[76:79]
  ds_read_b64_tr_b16 a[238:239], v15 offset:26624
  s_waitcnt lgkmcnt(9)
  v_mfma_f32_16x16x32_bf16 v[80:83], a[248:251], v[200:203], v[80:83]
  ds_read_b64_tr_b16 a[240:241], v12 offset:28672
  v_mfma_f32_16x16x32_bf16 v[84:87], a[248:251], v[204:207], v[84:87]
  ds_read_b64_tr_b16 a[242:243], v12 offset:30720
  v_mfma_f32_16x16x32_bf16 v[88:91], a[252:255], v[200:203], v[88:91]
  ds_read_b64_tr_b16 a[244:245], v13 offset:28672
  v_mfma_f32_16x16x32_bf16 v[92:95], a[252:255], v[204:207], v[92:95]
  ds_read_b64_tr_b16 a[246:247], v13 offset:30720
  s_waitcnt lgkmcnt(9)
  v_mfma_f32_16x16x32_bf16 v[64:67], a[224:227], v[208:211], v[64:67]
  ds_read_b64_tr_b16 a[248:249], v14 offset:28672
  v_mfma_f32_16x16x32_bf16 v[68:71], a[224:227], v[212:215], v[68:71]
  ds_read_b64_tr_b16 a[250:251], v14 offset:30720
  v_mfma_f32_16x16x32_bf16 v[72:75], a[228:231], v[208:211], v[72:75]
  ds_read_b64_tr_b16 a[252:253], v15 offset:28672
  s_waitcnt lgkmcnt(8)
  v_cmp_le_u32 vcc, 0xb003002c, v3
  v_mfma_f32_16x16x32_bf16 v[76:79], a[228:231], v[212:215], v[76:79]
  ds_read_b64_tr_b16 a[254:255], v15 offset:30720
  s_waitcnt lgkmcnt(8)
  v_mfma_f32_16x16x32_bf16 v[80:83], a[232:235], v[208:211], v[80:83]
  s_cbranch_vccz L_csO_0_6
L_cbO_0_6:
  ds_read_b64_tr_b16 a[224:225], v12 offset:32768
  v_mfma_f32_16x16x32_bf16 v[84:87], a[232:235], v[212:215], v[84:87]
  ds_read_b64_tr_b16 a[226:227], v12 offset:34816
  v_mfma_f32_16x16x32_bf16 v[88:91], a[236:239], v[208:211], v[88:91]
  ds_read_b64_tr_b16 a[228:229], v13 offset:32768
  v_mfma_f32_16x16x32_bf16 v[92:95], a[236:239], v[212:215], v[92:95]
  ds_read_b64_tr_b16 a[230:231], v13 offset:34816
  s_waitcnt lgkmcnt(8)
  v_mfma_f32_16x16x32_bf16 v[64:67], a[240:243], v[216:219], v[64:67]
  ds_read_b64_tr_b16 a[232:233], v14 offset:32768
  v_mfma_f32_16x16x32_bf16 v[68:71], a[240:243], v[220:223], v[68:71]
  ds_read_b64_tr_b16 a[234:235], v14 offset:34816
  v_mfma_f32_16x16x32_bf16 v[72:75], a[244:247], v[216:219], v[72:75]
  ds_read_b64_tr_b16 a[236:237], v15 offset:32768
  ds_read_b32 v3, v2 offset:2048
  v_mfma_f32_16x16x32_bf16 v[76:79], a[244:247], v[220:223], v[76:79]
  ds_read_b64_tr_b16 a[238:239], v15 offset:34816
  s_waitcnt lgkmcnt(9)
  v_mfma_f32_16x16x32_bf16 v[80:83], a[248:251], v[216:219], v[80:83]
  ds_read_b64_tr_b16 a[240:241], v12 offset:36864
  v_mov_b32 v31, L_tab-L_pc+188
  v_mfma_f32_16x16x32_bf16 v[84:87], a[248:251], v[220:223], v[84:87]
  ds_read_b64_tr_b16 a[242:243], v12 offset:38912
  global_load_lds_dword v31, s[22:23]
  v_mfma_f32_16x16x32_bf16 v[88:91], a[252:255], v[216:219], v[88:91]
  ds_read_b64_tr_b16 a[244:245], v13 offset:36864
  v_mfma_f32_16x16x32_bf16 v[92:95], a[252:255], v[220:223], v[92:95]
  ds_read_b64_tr_b16 a[246:247], v13 offset:38912
  s_waitcnt lgkmcnt(9)
  v_mfma_f32_16x16x32_bf16 a[192:195], a[224:227], v[32:35], 0
  ds_read_b64_tr_b16 a[248:249], v14 offset:36864
  v_mfma_f32_16x16x32_bf16 a[196:199], a[224:227], v[36:39], 0
  ds_read_b64_tr_b16 a[250:251], v14 offset:38912
  v_mfma_f32_16x16x32_bf16 a[200:203], a[228:231], v[32:35], 0
  ds_read_b64_tr_b16 a[252:253], v15 offset:36864
  s_waitcnt lgkmcnt(8)
  v_cmp_le_u32 vcc, 0xb003002d, v3
  v_mfma_f32_16x16x32_bf16 a[204:207], a[228:231], v[36:39], 0
  ds_read_b64_tr_b16 a[254:255], v15 offset:38912
  s_waitcnt lgkmcnt(8)
  v_mfma_f32_16x16x32_bf16 a[208:211], a[232:235], v[32:35], 0
  s_cbranch_vccz L_csV_2_3
L_cbV_2_3:
  v_subrev_u32 v12, 65536, v12
  ds_read_b64_tr_b16 a[224:225], v12 offset:0
  v_mfma_f32_16x16x32_bf16 a[212:215], a[232:235], v[36:39], 0
  ds_read_b64_tr_b16 a[226:227], v12 offset:2048
  v_mfma_f32_16x16x32_bf16 a[216:219], a[236:239], v[32:35], 0
  v_subrev_u32 v13, 65536, v13
  ds_read_b64_tr_b16 a[228:229], v13 offset:0
  v_mfma_f32_16x16x32_bf16 a[220:223], a[236:239], v[36:39], 0
  ds_read_b64_tr_b16 a[230:231], v13 offset:2048
  s_waitcnt lgkmcnt(8)
  v_mfma_f32_16x16x32_bf16 a[192:195], a[240:243], v[40:43], a[192:195]
  v_subrev_u32 v14, 65536, v14
  ds_read_b64_tr_b16 a[232:233], v14 offset:0
  v_mfma_f32_16x16x32_bf16 a[196:199], a[240:243], v[44:47], a[196:199]
  ds_read_b64_tr_b16 a[234:235], v14 offset:2048
  v_mfma_f32_16x16x32_bf16 a[200:203], a[244:247], v[40:43], a[200:203]
  v_subrev_u32 v15, 65536, v15
  ds_read_b64_tr_b16 a[236:237], v15 offset:0
  v_mfma_f32_16x16x32_bf16 a[204:207], a[244:247], v[44:47], a[204:207]
  ds_read_b64_tr_b16 a[238:239], v15 offset:2048
  s_waitcnt lgkmcnt(8)
  v_mfma_f32_16x16x32_bf16 a[208:211], a[248:251], v[40:43], a[208:211]
  ds_read_b64_tr_b16 a[240:241], v12 offset:4096
  v_mov_b32 v31, L_tab-L_pc+192
  v_mfma_f32_16x16x32_bf16 a[212:215], a[248:251], v[44:47], a[212:215]
  ds_read_b64_tr_b16 a[242:243], v12 offset:6144
  global_load_lds_dword v31, s[22:23]
  v_mfma_f32_16x16x32_bf16 a[216:219], a[252:255], v[40:43], a[216:219]
  ds_read_b64_tr_b16 a[244:245], v13 offset:4096
  v_mfma_f32_16x16x32_bf16 a[220:223], a[252:255], v[44:47], a[220:223]
  ds_read_b64_tr_b16 a[246:247], v13 offset:6144
  s_waitcnt lgkmcnt(8)
  v_mfma_f32_16x16x32_bf16 v[64:67], a[224:227], v[224:227], v[64:67]
  ds_read_b64_tr_b16 a[248:249], v14 offset:4096
  v_mfma_f32_16x16x32_bf16 v[68:71], a[224:227], v[228:231], v[68:71]
  ds_read_b64_tr_b16 a[250:251], v14 offset:6144
  v_mfma_f32_16x16x32_bf16 v[72:75], a[228:231], v[224:227], v[72:75]
  ds_read_b64_tr_b16 a[252:253], v15 offset:4096
  v_mfma_f32_16x16x32_bf16 v[76:79], a[228:231], v[228:231], v[76:79]
  ds_read_b64_tr_b16 a[254:255], v15 offset:6144
  s_waitcnt lgkmcnt(8)
  v_mfma_f32_16x16x32_bf16 v[80:83], a[232:235], v[224:227], v[80:83]
  ds_read_b64_tr_b16 a[224:225], v12 offset:8192
  v_mfma_f32_16x16x32_bf16 v[84:87], a[232:235], v[228:231], v[84:87]
  ds_read_b64_tr_b16 a[226:227], v12 offset:10240
  v_mfma_f32_16x16x32_bf16 v[88:91], a[236:239], v[224:227], v[88:91]
  ds_read_b64_tr_b16 a[228:229], v13 offset:8192
  v_mfma_f32_16x16x32_bf16 v[92:95], a[236:239], v[228:231], v[92:95]
  ds_read_b64_tr_b16 a[230:231], v13 offset:10240
  s_waitcnt lgkmcnt(8)
  v_mfma_f32_16x16x32_bf16 v[64:67], a[240:243], v[232:235], v[64:67]
  ds_read_b64_tr_b16 a[232:233], v14 offset:8192
  v_mfma_f32_16x16x32_bf16 v[68:71], a[240:243], v[236:239], v[68:71]
  ds_read_b64_tr_b16 a[234:235], v14 offset:10240
  v_mfma_f32_16x16x32_bf16 v[72:75], a[244:247], v[232:235], v[72:75]
  ds_read_b64_tr_b16 a[236:237], v15 offset:8192
  ds_read_b32 v3, v2 offset:2048
  v_mfma_f32_16x16x32_bf16 v[76:79], a[244:247], v[236:239], v[76:79]
  ds_read_b64_tr_b16 a[238:239], v15 offset:10240
  s_waitcnt lgkmcnt(9)
  v_mfma_f32_16x16x32_bf16 v[80:83], a[248:251], v[232:235], v[80:83]
  ds_read_b64_tr_b16 a[240:241], v12 offset:12288
  v_mfma_f32_16x16x32_bf16 v[84:87], a[248:251], v[236:239], v[84:87]
  ds_read_b64_tr_b16 a[242:243], v12 offset:14336
  v_mfma_f32_16x16x32_bf16 v[88:91], a[252:255], v[232:235], v[88:91]
  ds_read_b64_tr_b16 a[244:245], v13 offset:12288
  v_mfma_f32_16x16x32_bf16 v[92:95], a[252:255], v[236:239], v[92:95]
  ds_read_b64_tr_b16 a[246:247], v13 offset:14336
  s_waitcnt lgkmcnt(9)
  v_mfma_f32_16x16x32_bf16 v[64:67], a[224:227], v[240:243], v[64:67]
  ds_read_b64_tr_b16 a[248:249], v14 offset:12288
  v_mfma_f32_16x16x32_bf16 v[68:71], a[224:227], v[244:247], v[68:71]
  ds_read_b64_tr_b16 a[250:251], v14 offset:14336
  v_mfma_f32_16x16x32_bf16 v[72:75], a[228:231], v[240:243], v[72:75]
  ds_read_b64_tr_b16 a[252:253], v15 offset:12288
  s_waitcnt lgkmcnt(8)
  v_cmp_le_u32 vcc, 0xb003002e, v3
  v_mfma_f32_16x16x32_bf16 v[76:79], a[228:231], v[244:247], v[76:79]
  ds_read_b64_tr_b16 a[254:255], v15 offset:14336
  s_waitcnt lgkmcnt(8)
  v_mfma_f32_16x16x32_bf16 v[80:83], a[232:235], v[240:243], v[80:83]
  s_cbranch_vccz L_csV_3_0
L_cbV_3_0:
  v_add_u32 v12, 65536, v12
  ds_read_b64_tr_b16 a[224:225], v12 offset:45056
  v_mfma_f32_16x16x32_bf16 v[84:87], a[232:235], v[244:247], v[84:87]
  ds_read_b64_tr_b16 a[226:227], v12 offset:47104
  v_mfma_f32_16x16x32_bf16 v[88:91], a[236:239], v[240:243], v[88:91]
  v_add_u32 v13, 65536, v13
  ds_read_b64_tr_b16 a[228:229], v13 offset:45056
  v_mfma_f32_16x16x32_bf16 v[92:95], a[236:239], v[244:247], v[92:95]
  ds_read_b64_tr_b16 a[230:231], v13 offset:47104
  s_waitcnt lgkmcnt(8)
  v_mfma_f32_16x16x32_bf16 v[64:67], a[240:243], v[248:251], v[64:67]
  v_add_u32 v14, 65536, v14
  ds_read_b64_tr_b16 a[232:233], v14 offset:45056
  v_mfma_f32_16x16x32_bf16 v[68:71], a[240:243], v[252:255], v[68:71]
  ds_read_b64_tr_b16 a[234:235], v14 offset:47104
  v_mfma_f32_16x16x32_bf16 v[72:75], a[244:247], v[248:251], v[72:75]
  v_add_u32 v15, 65536, v15
  ds_read_b64_tr_b16 a[236:237], v15 offset:45056
  v_mfma_f32_16x16x32_bf16 v[76:79], a[244:247], v[252:255], v[76:79]
  ds_read_b64_tr_b16 a[238:239], v15 offset:47104
  s_waitcnt lgkmcnt(8)
  v_mfma_f32_16x16x32_bf16 v[80:83], a[248:251], v[248:251], v[80:83]
  ds_read_b64_tr_b16 a[240:241], v12 offset:49152
  v_mov_b32 v31, L_tab-L_pc+196
  v_mfma_f32_16x16x32_bf16 v[84:87], a[248:251], v[252:255], v[84:87]
  ds_read_b64_tr_b16 a[242:243], v12 offset:51200
  global_load_lds_dword v31, s[22:23]
  v_mfma_f32_16x16x32_bf16 v[88:91], a[252:255], v[248:251], v[88:91]
  ds_read_b64_tr_b16 a[244:245], v13 offset:49152
  v_mfma_f32_16x16x32_bf16 v[92:95], a[252:255], v[252:255], v[92:95]
  ds_read_b64_tr_b16 a[246:247], v13 offset:51200
  s_waitcnt lgkmcnt(8)
  v_mfma_f32_16x16x32_bf16 v[96:99], a[224:227], v[128:131], 0
  ds_read_b64_tr_b16 a[248:249], v14 offset:49152
  v_mfma_f32_16x16x32_bf16 v[100:103], a[224:227], v[132:135], 0
  ds_read_b64_tr_b16 a[250:251], v14 offset:51200
  v_mfma_f32_16x16x32_bf16 v[104:107], a[228:231], v[128:131], 0
  ds_read_b64_tr_b16 a[252:253], v15 offset:49152
  v_mfma_f32_16x16x32_bf16 v[108:111], a[228:231], v[132:135], 0
  ds_read_b64_tr_b16 a[254:255], v15 offset:51200
  s_waitcnt lgkmcnt(8)
  v_mfma_f32_16x16x32_bf16 v[112:115], a[232:235], v[128:131], 0
  ds_read_b64_tr_b16 a[224:225], v12 offset:53248
  v_mfma_f32_16x16x32_bf16 v[116:119], a[232:235], v[132:135], 0
  ds_read_b64_tr_b16 a[226:227], v12 offset:55296
  v_mul_f32 v64, v64, v20
  v_mul_f32 v65, v65, v20
  v_cvt_pk_bf16_f32 v64, v64, v65
  v_mfma_f32_16x16x32_bf16 v[120:123], a[236:239], v[128:131], 0
  ds_read_b64_tr_b16 a[228:229], v13 offset:53248
  v_mul_f32 v66, v66, v20
  v_mul_f32 v67, v67, v20
  v_mfma_f32_16x16x32_bf16 v[124:127], a[236:239], v[132:135], 0
  ds_read_b64_tr_b16 a[230:231], v13 offset:55296
  v_cvt_pk_bf16_f32 v65, v66, v67
  s_waitcnt lgkmcnt(8)
  v_mfma_f32_16x16x32_bf16 v[96:99], a[240:243], v[136:139], v[96:99]
  ds_read_b64_tr_b16 a[232:233], v14 offset:53248
  v_mul_f32 v72, v72, v20
  v_mul_f32 v73, v73, v20
  v_cvt_pk_bf16_f32 v66, v72, v73
  v_mfma_f32_16x16x32_bf16 v[100:103], a[240:243], v[140:143], v[100:103]
  ds_read_b64_tr_b16 a[234:235], v14 offset:55296
  v_mul_f32 v74, v74, v20
  v_mul_f32 v75, v75, v20
  v_mfma_f32_16x16x32_bf16 v[104:107], a[244:247], v[136:139], v[104:107]
  ds_read_b64_tr_b16 a[236:237], v15 offset:53248
  ds_read_b32 v3, v2 offset:2048
  v_cvt_pk_bf16_f32 v67, v74, v75
  v_mfma_f32_16x16x32_bf16 v[108:111], a[244:247], v[140:143], v[108:111]
  ds_read_b64_tr_b16 a[238:239], v15 offset:55296
  v_mul_f32 v68, v68, v21
  v_mul_f32 v69, v69, v21
  s_waitcnt lgkmcnt(9)
  v_mfma_f32_16x16x32_bf16 v[112:115], a[248:251], v[136:139], v[112:115]
  ds_read_b64_tr_b16 a[240:241], v12 offset:57344
  v_cvt_pk_bf16_f32 v68, v68, v69
  v_mul_f32 v70, v70, v21
  v_mfma_f32_16x16x32_bf16 v[116:119], a[248:251], v[140:143], v[116:119]
  ds_read_b64_tr_b16 a[242:243], v12 offset:59392
  v_mul_f32 v71, v71, v21
  v_cvt_pk_bf16_f32 v69, v70, v71
  v_mfma_f32_16x16x32_bf16 v[120:123], a[252:255], v[136:139], v[120:123]
  ds_read_b64_tr_b16 a[244:245], v13 offset:57344
  v_mul_f32 v76, v76, v21
  v_mul_f32 v77, v77, v21
  v_cvt_pk_bf16_f32 v70, v76, v77
  v_mfma_f32_16x16x32_bf16 v[124:127], a[252:255], v[140:143], v[124:127]
  ds_read_b64_tr_b16 a[246:247], v13 offset:59392
  v_mul_f32 v78, v78, v21
  s_waitcnt lgkmcnt(9)
  v_mfma_f32_16x16x32_bf16 v[96:99], a[224:227], v[144:147], v[96:99]
  ds_read_b64_tr_b16 a[248:249], v14 offset:57344
  v_mul_f32 v79, v79, v21
  v_cvt_pk_bf16_f32 v71, v78, v79
  v_mfma_f32_16x16x32_bf16 v[100:103], a[224:227], v[148:151], v[100:103]
  ds_read_b64_tr_b16 a[250:251], v14 offset:59392
  v_mul_f32 v80, v80, v20
  v_mul_f32 v81, v81, v20
  v_cvt_pk_bf16_f32 v72, v80, v81
  v_mfma_f32_16x16x32_bf16 v[104:107], a[228:231], v[144:147], v[104:107]
  ds_read_b64_tr_b16 a[252:253], v15 offset:57344
  s_waitcnt lgkmcnt(8)
  v_cmp_le_u32 vcc, 0xb003002f, v3
  v_mul_f32 v82, v82, v20
  v_mfma_f32_16x16x32_bf16 v[108:111], a[228:231], v[148:151], v[108:111]
  ds_read_b64_tr_b16 a[254:255], v15 offset:59392
  v_mul_f32 v83, v83, v20
  v_cvt_pk_bf16_f32 v73, v82, v83
  s_waitcnt lgkmcnt(8)
  v_mfma_f32_16x16x32_bf16 v[112:115], a[232:235], v[144:147], v[112:115]
  s_cbranch_vccz L_csV_3_1
L_cbV_3_1:
  v_subrev_u32 v12, 65536, v12
  ds_read_b64_tr_b16 a[224:225], v12 offset:16384
  v_mul_f32 v88, v88, v20
  v_mfma_f32_16x16x32_bf16 v[116:119], a[232:235], v[148:151], v[116:119]
  ds_read_b64_tr_b16 a[226:227], v12 offset:18432
  v_mul_f32 v89, v89, v20
  v_cvt_pk_bf16_f32 v74, v88, v89
  v_mfma_f32_16x16x32_bf16 v[120:123], a[236:239], v[144:147], v[120:123]
  v_subrev_u32 v13, 65536, v13
  ds_read_b64_tr_b16 a[228:229], v13 offset:16384
  v_mul_f32 v90, v90, v20
  v_mul_f32 v91, v91, v20
  v_cvt_pk_bf16_f32 v75, v90, v91
  v_mfma_f32_16x16x32_bf16 v[124:127], a[236:239], v[148:151], v[124:127]
  ds_read_b64_tr_b16 a[230:231], v13 offset:18432
  v_mul_f32 v84, v84, v21
  s_waitcnt lgkmcnt(8)
  v_mfma_f32_16x16x32_bf16 v[96:99], a[240:243], v[152:155], v[96:99]
  v_subrev_u32 v14, 65536, v14
  ds_read_b64_tr_b16 a[232:233], v14 offset:16384
  v_mul_f32 v85, v85, v21
  v_cvt_pk_bf16_f32 v76, v84, v85
  v_mfma_f32_16x16x32_bf16 v[100:103], a[240:243], v[156:159], v[100:103]
  ds_read_b64_tr_b16 a[234:235], v14 offset:18432
  v_mul_f32 v86, v86, v21
  v_mul_f32 v87, v87, v21
  v_cvt_pk_bf16_f32 v77, v86, v87
  v_mfma_f32_16x16x32_bf16 v[104:107], a[244:247], v[152:155], v[104:107]
  v_subrev_u32 v15, 65536, v15
  ds_read_b64_tr_b16 a[236:237], v15 offset:16384
  v_mul_f32 v92, v92, v21
  v_mul_f32 v93, v93, v21
  v_mfma_f32_16x16x32_bf16 v[108:111], a[244:247], v[156:159], v[108:111]
  ds_read_b64_tr_b16 a[238:239], v15 offset:18432
  v_cvt_pk_bf16_f32 v78, v92, v93
  s_waitcnt lgkmcnt(8)
  v_mfma_f32_16x16x32_bf16 v[112:115], a[248:251], v[152:155], v[112:115]
  ds_read_b64_tr_b16 a[240:241], v12 offset:20480
  v_mov_b32 v31, L_tab-L_pc+200
  v_mul_f32 v94, v94, v21
  v_mul_f32 v95, v95, v21
  v_mfma_f32_16x16x32_bf16 v[116:119], a[248:251], v[156:159], v[116:119]
  ds_read_b64_tr_b16 a[242:243], v12 offset:22528
  global_load_lds_dword v31, s[22:23]
  v_cvt_pk_bf16_f32 v79, v94, v95
  v_mfma_f32_16x16x32_bf16 v[120:123], a[252:255], v[152:155], v[120:123]
  ds_read_b64_tr_b16 a[244:245], v13 offset:20480
  v_mfma_f32_16x16x32_bf16 v[124:127], a[252:255], v[156:159], v[124:127]
  ds_read_b64_tr_b16 a[246:247], v13 offset:22528
  s_waitcnt lgkmcnt(8)
  v_mfma_f32_16x16x32_bf16 v[96:99], a[224:227], v[160:163], v[96:99]
  ds_read_b64_tr_b16 a[248:249], v14 offset:20480
  v_mfma_f32_16x16x32_bf16 v[100:103], a[224:227], v[164:167], v[100:103]
  ds_read_b64_tr_b16 a[250:251], v14 offset:22528
  s_lshl_b32 s3, s58, 2
  v_mfma_f32_16x16x32_bf16 v[104:107], a[228:231], v[160:163], v[104:107]
  ds_read_b64_tr_b16 a[252:253], v15 offset:20480
  v_lshl_add_u32 v19, v0, 7, s3
  v_mfma_f32_16x16x32_bf16 v[108:111], a[228:231], v[164:167], v[108:111]
  ds_read_b64_tr_b16 a[254:255], v15 offset:22528
  s_waitcnt lgkmcnt(8)
  v_mfma_f32_16x16x32_bf16 v[112:115], a[232:235], v[160:163], v[112:115]
  ds_read_b64_tr_b16 a[224:225], v12 offset:24576
  v_mfma_f32_16x16x32_bf16 v[116:119], a[232:235], v[164:167], v[116:119]
  ds_read_b64_tr_b16 a[226:227], v12 offset:26624
  v_cmp_gt_u32 s[66:67], 16, v0
  v_mfma_f32_16x16x32_bf16 v[120:123], a[236:239], v[160:163], v[120:123]
  ds_read_b64_tr_b16 a[228:229], v13 offset:24576
  v_lshl_add_u32 v30, v0, 4, v2
  v_mfma_f32_16x16x32_bf16 v[124:127], a[236:239], v[164:167], v[124:127]
  ds_read_b64_tr_b16 a[230:231], v13 offset:26624
  s_waitcnt lgkmcnt(8)
  v_mfma_f32_16x16x32_bf16 v[96:99], a[240:243], v[168:171], v[96:99]
  ds_read_b64_tr_b16 a[232:233], v14 offset:24576
  v_mfma_f32_16x16x32_bf16 v[100:103], a[240:243], v[172:175], v[100:103]
  ds_read_b64_tr_b16 a[234:235], v14 offset:26624
  v_cndmask_b32 v19, v2, v19, s[66:67]
  v_mfma_f32_16x16x32_bf16 v[104:107], a[244:247], v[168:171], v[104:107]
  ds_read_b64_tr_b16 a[236:237], v15 offset:24576
  ds_read_b32 v3, v2 offset:2048
  v_mfma_f32_16x16x32_bf16 v[108:111], a[244:247], v[172:175], v[108:111]
  ds_read_b64_tr_b16 a[238:239], v15 offset:26624
  s_waitcnt lgkmcnt(9)
  v_mfma_f32_16x16x32_bf16 v[112:115], a[248:251], v[168:171], v[112:115]
  ds_read_b64_tr_b16 a[240:241], v12 offset:28672
  v_mfma_f32_16x16x32_bf16 v[116:119], a[248:251], v[172:175], v[116:119]
  ds_read_b64_tr_b16 a[242:243], v12 offset:30720
  v_mfma_f32_16x16x32_bf16 v[120:123], a[252:255], v[168:171], v[120:123]
  ds_read_b64_tr_b16 a[244:245], v13 offset:28672
  v_mfma_f32_16x16x32_bf16 v[124:127], a[252:255], v[172:175], v[124:127]
  ds_read_b64_tr_b16 a[246:247], v13 offset:30720
  s_waitcnt lgkmcnt(9)
  v_mfma_f32_16x16x32_bf16 v[96:99], a[224:227], v[176:179], v[96:99]
  ds_read_b64_tr_b16 a[248:249], v14 offset:28672
  v_mfma_f32_16x16x32_bf16 v[100:103], a[224:227], v[180:183], v[100:103]
  ds_read_b64_tr_b16 a[250:251], v14 offset:30720
  v_mfma_f32_16x16x32_bf16 v[104:107], a[228:231], v[176:179], v[104:107]
  ds_read_b64_tr_b16 a[252:253], v15 offset:28672
  s_waitcnt lgkmcnt(8)
  v_cmp_le_u32 vcc, 0xb0030030, v3
  v_mfma_f32_16x16x32_bf16 v[108:111], a[228:231], v[180:183], v[108:111]
  ds_read_b64_tr_b16 a[254:255], v15 offset:30720
  s_waitcnt lgkmcnt(8)
  v_mfma_f32_16x16x32_bf16 v[112:115], a[232:235], v[176:179], v[112:115]
  s_cbranch_vccz L_csV_3_2
L_cbV_3_2:
  ds_read_b64_tr_b16 a[224:225], v12 offset:49152
  v_mfma_f32_16x16x32_bf16 v[116:119], a[232:235], v[180:183], v[116:119]
  ds_read_b64_tr_b16 a[226:227], v12 offset:51200
  v_mfma_f32_16x16x32_bf16 v[120:123], a[236:239], v[176:179], v[120:123]
  ds_read_b64_tr_b16 a[228:229], v13 offset:49152
  v_mfma_f32_16x16x32_bf16 v[124:127], a[236:239], v[180:183], v[124:127]
  ds_read_b64_tr_b16 a[230:231], v13 offset:51200
  s_waitcnt lgkmcnt(8)
  v_mfma_f32_16x16x32_bf16 v[96:99], a[240:243], v[184:187], v[96:99]
  ds_read_b64_tr_b16 a[232:233], v14 offset:49152
  v_mfma_f32_16x16x32_bf16 v[100:103], a[240:243], v[188:191], v[100:103]
  ds_read_b64_tr_b16 a[234:235], v14 offset:51200
  v_mfma_f32_16x16x32_bf16 v[104:107], a[244:247], v[184:187], v[104:107]
  ds_read_b64_tr_b16 a[236:237], v15 offset:49152
  v_mfma_f32_16x16x32_bf16 v[108:111], a[244:247], v[188:191], v[108:111]
  ds_read_b64_tr_b16 a[238:239], v15 offset:51200
  s_waitcnt lgkmcnt(8)
  v_mfma_f32_16x16x32_bf16 v[112:115], a[248:251], v[184:187], v[112:115]
  ds_read_b64_tr_b16 a[240:241], v12 offset:53248
  v_mov_b32 v31, L_tab-L_pc+204
  v_mfma_f32_16x16x32_bf16 v[116:119], a[248:251], v[188:191], v[116:119]
  ds_read_b64_tr_b16 a[242:243], v12 offset:55296
  global_load_lds_dword v31, s[22:23]
  v_mfma_f32_16x16x32_bf16 v[120:123], a[252:255], v[184:187], v[120:123]
  ds_read_b64_tr_b16 a[244:245], v13 offset:53248
  v_mfma_f32_16x16x32_bf16 v[124:127], a[252:255], v[188:191], v[124:127]
  ds_read_b64_tr_b16 a[246:247], v13 offset:55296
  s_waitcnt lgkmcnt(8)
  v_mfma_f32_16x16x32_bf16 v[96:99], a[224:227], v[192:195], v[96:99]
  ds_read_b64_tr_b16 a[248:249], v14 offset:53248
  v_mfma_f32_16x16x32_bf16 v[100:103], a[224:227], v[196:199], v[100:103]
  ds_read_b64_tr_b16 a[250:251], v14 offset:55296
  v_mfma_f32_16x16x32_bf16 v[104:107], a[228:231], v[192:195], v[104:107]
  ds_read_b64_tr_b16 a[252:253], v15 offset:53248
  v_mfma_f32_16x16x32_bf16 v[108:111], a[228:231], v[196:199], v[108:111]
  ds_read_b64_tr_b16 a[254:255], v15 offset:55296
  s_waitcnt lgkmcnt(8)
  v_mfma_f32_16x16x32_bf16 v[112:115], a[232:235], v[192:195], v[112:115]
  ds_read_b64_tr_b16 a[224:225], v12 offset:57344
  v_mfma_f32_16x16x32_bf16 v[116:119], a[232:235], v[196:199], v[116:119]
  ds_read_b64_tr_b16 a[226:227], v12 offset:59392
  v_mfma_f32_16x16x32_bf16 v[120:123], a[236:239], v[192:195], v[120:123]
  ds_read_b64_tr_b16 a[228:229], v13 offset:57344
  v_mfma_f32_16x16x32_bf16 v[124:127], a[236:239], v[196:199], v[124:127]
  ds_read_b64_tr_b16 a[230:231], v13 offset:59392
  s_waitcnt lgkmcnt(8)
  v_mfma_f32_16x16x32_bf16 v[96:99], a[240:243], v[200:203], v[96:99]
  ds_read_b64_tr_b16 a[232:233], v14 offset:57344
  v_mfma_f32_16x16x32_bf16 v[100:103], a[240:243], v[204:207], v[100:103]
  ds_read_b64_tr_b16 a[234:235], v14 offset:59392
  v_mfma_f32_16x16x32_bf16 v[104:107], a[244:247], v[200:203], v[104:107]
  ds_read_b64_tr_b16 a[236:237], v15 offset:57344
  ds_read_b32 v3, v2 offset:2048
  v_mfma_f32_16x16x32_bf16 v[108:111], a[244:247], v[204:207], v[108:111]
  ds_read_b64_tr_b16 a[238:239], v15 offset:59392
  s_waitcnt lgkmcnt(9)
  v_mfma_f32_16x16x32_bf16 v[112:115], a[248:251], v[200:203], v[112:115]
  ds_read_b64_tr_b16 a[240:241], v12 offset:61440
  v_mfma_f32_16x16x32_bf16 v[116:119], a[248:251], v[204:207], v[116:119]
  ds_read_b64_tr_b16 a[242:243], v12 offset:63488
  v_mfma_f32_16x16x32_bf16 v[120:123], a[252:255], v[200:203], v[120:123]
  ds_read_b64_tr_b16 a[244:245], v13 offset:61440
  v_mfma_f32_16x16x32_bf16 v[124:127], a[252:255], v[204:207], v[124:127]
  ds_read_b64_tr_b16 a[246:247], v13 offset:63488
  s_waitcnt lgkmcnt(9)
  v_mfma_f32_16x16x32_bf16 v[96:99], a[224:227], v[208:211], v[96:99]
  ds_read_b64_tr_b16 a[248:249], v14 offset:61440
  v_mfma_f32_16x16x32_bf16 v[100:103], a[224:227], v[212:215], v[100:103]
  ds_read_b64_tr_b16 a[250:251], v14 offset:63488
  v_mfma_f32_16x16x32_bf16 v[104:107], a[228:231], v[208:211], v[104:107]
  ds_read_b64_tr_b16 a[252:253], v15 offset:61440
  s_waitcnt lgkmcnt(8)
  v_cmp_le_u32 vcc, 0xb0030031, v3
  v_mfma_f32_16x16x32_bf16 v[108:111], a[228:231], v[212:215], v[108:111]
  ds_read_b64_tr_b16 a[254:255], v15 offset:63488
  s_waitcnt lgkmcnt(8)
  v_mfma_f32_16x16x32_bf16 v[112:115], a[232:235], v[208:211], v[112:115]
  s_cbranch_vccz L_csV_3_3
L_cbV_3_3:
  ds_read_b64_tr_b16 a[224:225], v12 offset:32768
  v_mfma_f32_16x16x32_bf16 v[116:119], a[232:235], v[212:215], v[116:119]
  ds_read_b64_tr_b16 a[226:227], v12 offset:34816
  v_mfma_f32_16x16x32_bf16 v[120:123], a[236:239], v[208:211], v[120:123]
  ds_read_b64_tr_b16 a[228:229], v13 offset:32768
  v_mfma_f32_16x16x32_bf16 v[124:127], a[236:239], v[212:215], v[124:127]
  ds_read_b64_tr_b16 a[230:231], v13 offset:34816
  s_waitcnt lgkmcnt(8)
  v_mfma_f32_16x16x32_bf16 v[96:99], a[240:243], v[216:219], v[96:99]
  ds_read_b64_tr_b16 a[232:233], v12 offset:36864
  v_mfma_f32_16x16x32_bf16 v[100:103], a[240:243], v[220:223], v[100:103]
  ds_read_b64_tr_b16 a[234:235], v12 offset:38912
  v_mfma_f32_16x16x32_bf16 v[104:107], a[244:247], v[216:219], v[104:107]
  ds_read_b64_tr_b16 a[236:237], v13 offset:36864
  v_mfma_f32_16x16x32_bf16 v[108:111], a[244:247], v[220:223], v[108:111]
  ds_read_b64_tr_b16 a[238:239], v13 offset:38912
  s_waitcnt lgkmcnt(8)
  v_mfma_f32_16x16x32_bf16 v[112:115], a[248:251], v[216:219], v[112:115]
  ds_read_b64_tr_b16 a[240:241], v12 offset:40960
  v_mov_b32 v31, L_tab-L_pc+208
  v_mfma_f32_16x16x32_bf16 v[116:119], a[248:251], v[220:223], v[116:119]
  ds_read_b64_tr_b16 a[242:243], v12 offset:43008
  global_load_lds_dword v31, s[22:23]
  v_mfma_f32_16x16x32_bf16 v[120:123], a[252:255], v[216:219], v[120:123]
  ds_read_b64_tr_b16 a[244:245], v13 offset:40960
  v_mfma_f32_16x16x32_bf16 v[124:127], a[252:255], v[220:223], v[124:127]
  ds_read_b64_tr_b16 a[246:247], v13 offset:43008
  s_waitcnt lgkmcnt(8)
  v_mfma_f32_16x16x32_bf16 v[96:99], a[224:227], v[224:227], v[96:99]
  ds_read_b64_tr_b16 a[248:249], v12 offset:45056
  v_mfma_f32_16x16x32_bf16 v[100:103], a[224:227], v[228:231], v[100:103]
  ds_read_b64_tr_b16 a[250:251], v12 offset:47104
  v_mfma_f32_16x16x32_bf16 v[104:107], a[228:231], v[224:227], v[104:107]
  ds_read_b64_tr_b16 a[252:253], v13 offset:45056
  v_mfma_f32_16x16x32_bf16 v[108:111], a[228:231], v[228:231], v[108:111]
  ds_read_b64_tr_b16 a[254:255], v13 offset:47104
  s_waitcnt lgkmcnt(8)
  v_mfma_f32_16x16x32_bf16 v[96:99], a[232:235], v[232:235], v[96:99]
  ds_read_b64_tr_b16 a[224:225], v14 offset:32768
  v_mfma_f32_16x16x32_bf16 v[100:103], a[232:235], v[236:239], v[100:103]
  ds_read_b64_tr_b16 a[226:227], v14 offset:34816
  v_mfma_f32_16x16x32_bf16 v[104:107], a[236:239], v[232:235], v[104:107]
  ds_read_b64_tr_b16 a[228:229], v15 offset:32768
  v_mfma_f32_16x16x32_bf16 v[108:111], a[236:239], v[236:239], v[108:111]
  ds_read_b64_tr_b16 a[230:231], v15 offset:34816
  s_waitcnt lgkmcnt(8)
  v_mfma_f32_16x16x32_bf16 v[96:99], a[240:243], v[240:243], v[96:99]
  ds_read_b64_tr_b16 a[232:233], v14 offset:36864
  v_mfma_f32_16x16x32_bf16 v[100:103], a[240:243], v[244:247], v[100:103]
  ds_read_b64_tr_b16 a[234:235], v14 offset:38912
  v_mfma_f32_16x16x32_bf16 v[104:107], a[244:247], v[240:243], v[104:107]
  ds_read_b64_tr_b16 a[236:237], v15 offset:36864
  ds_read_b32 v3, v2 offset:2048
  v_mfma_f32_16x16x32_bf16 v[108:111], a[244:247], v[244:247], v[108:111]
  ds_read_b64_tr_b16 a[238:239], v15 offset:38912
  s_waitcnt lgkmcnt(9)
  v_mfma_f32_16x16x32_bf16 v[96:99], a[248:251], v[248:251], v[96:99]
  ds_read_b64_tr_b16 a[240:241], v14 offset:40960
  v_mfma_f32_16x16x32_bf16 v[100:103], a[248:251], v[252:255], v[100:103]
  ds_read_b64_tr_b16 a[242:243], v14 offset:43008
  v_mfma_f32_16x16x32_bf16 v[104:107], a[252:255], v[248:251], v[104:107]
  ds_read_b64_tr_b16 a[244:245], v15 offset:40960
  v_mfma_f32_16x16x32_bf16 v[108:111], a[252:255], v[252:255], v[108:111]
  ds_read_b64_tr_b16 a[246:247], v15 offset:43008
  s_waitcnt lgkmcnt(9)
  v_mfma_f32_16x16x32_bf16 v[112:115], a[224:227], v[224:227], v[112:115]
  ds_read_b64_tr_b16 a[248:249], v14 offset:45056
  v_mfma_f32_16x16x32_bf16 v[116:119], a[224:227], v[228:231], v[116:119]
  ds_read_b64_tr_b16 a[250:251], v14 offset:47104
  v_mfma_f32_16x16x32_bf16 v[120:123], a[228:231], v[224:227], v[120:123]
  ds_read_b64_tr_b16 a[252:253], v15 offset:45056
  s_waitcnt lgkmcnt(8)
  v_cmp_le_u32 vcc, 0xb0030032, v3
  v_mfma_f32_16x16x32_bf16 v[124:127], a[228:231], v[228:231], v[124:127]
  ds_read_b64_tr_b16 a[254:255], v15 offset:47104
  s_waitcnt lgkmcnt(8)
  v_mfma_f32_16x16x32_bf16 v[112:115], a[232:235], v[232:235], v[112:115]
  s_cbranch_vccz L_csO_1_0
L_cbO_1_0:
  v_add_u32 v12, 131072, v12
  ds_read_b64_tr_b16 a[224:225], v12 offset:0
  v_mfma_f32_16x16x32_bf16 v[116:119], a[232:235], v[236:239], v[116:119]
  ds_read_b64_tr_b16 a[226:227], v12 offset:2048
  v_mul_f32 v96, v96, v20
  v_mul_f32 v97, v97, v20
  v_cvt_pk_bf16_f32 v96, v96, v97
  v_mfma_f32_16x16x32_bf16 v[120:123], a[236:239], v[232:235], v[120:123]
  v_add_u32 v13, 131072, v13
  ds_read_b64_tr_b16 a[228:229], v13 offset:0
  v_mul_f32 v98, v98, v20
  v_mul_f32 v99, v99, v20
  v_cvt_pk_bf16_f32 v97, v98, v99
  v_mfma_f32_16x16x32_bf16 v[124:127], a[236:239], v[236:239], v[124:127]
  ds_read_b64_tr_b16 a[230:231], v13 offset:2048
  v_mul_f32 v104, v104, v20
  v_mul_f32 v105, v105, v20
  s_waitcnt lgkmcnt(8)
  v_mfma_f32_16x16x32_bf16 v[112:115], a[240:243], v[240:243], v[112:115]
  v_add_u32 v14, 131072, v14
  ds_read_b64_tr_b16 a[232:233], v14 offset:0
  v_cvt_pk_bf16_f32 v98, v104, v105
  v_mul_f32 v106, v106, v20
  v_mfma_f32_16x16x32_bf16 v[116:119], a[240:243], v[244:247], v[116:119]
  ds_read_b64_tr_b16 a[234:235], v14 offset:2048
  v_mul_f32 v107, v107, v20
  v_cvt_pk_bf16_f32 v99, v106, v107
  v_mul_f32 v100, v100, v21
  v_mfma_f32_16x16x32_bf16 v[120:123], a[244:247], v[240:243], v[120:123]
  v_add_u32 v15, 131072, v15
  ds_read_b64_tr_b16 a[236:237], v15 offset:0
  ds_read_b32 v3, v2 offset:2048
  v_mul_f32 v101, v101, v21
  v_cvt_pk_bf16_f32 v100, v100, v101
  v_mfma_f32_16x16x32_bf16 v[124:127], a[244:247], v[244:247], v[124:127]
  ds_read_b64_tr_b16 a[238:239], v15 offset:2048
  v_mul_f32 v102, v102, v21
  s_waitcnt lgkmcnt(9)
  v_mfma_f32_16x16x32_bf16 v[112:115], a[248:251], v[248:251], v[112:115]
  ds_read_b64_tr_b16 a[240:241], v12 offset:4096
  v_mov_b32 v31, L_tab-L_pc+212
  v_mul_f32 v103, v103, v21
  v_cvt_pk_bf16_f32 v101, v102, v103
  v_mfma_f32_16x16x32_bf16 v[116:119], a[248:251], v[252:255], v[116:119]
  ds_read_b64_tr_b16 a[242:243], v12 offset:6144
  global_load_lds_dword v31, s[22:23]
  v_mul_f32 v108, v108, v21
  v_mul_f32 v109, v109, v21
  v_mfma_f32_16x16x32_bf16 v[120:123], a[252:255], v[248:251], v[120:123]
  ds_read_b64_tr_b16 a[244:245], v13 offset:4096
  v_cvt_pk_bf16_f32 v102, v108, v109
  v_mul_f32 v110, v110, v21
  v_mul_f32 v111, v111, v21
  v_mfma_f32_16x16x32_bf16 v[124:127], a[252:255], v[252:255], v[124:127]
  ds_read_b64_tr_b16 a[246:247], v13 offset:6144
  v_cvt_pk_bf16_f32 v103, v110, v111
  s_waitcnt lgkmcnt(9)
  v_mfma_f32_16x16x32_bf16 a[0:3], a[224:227], v[48:51], a[0:3]
  ds_read_b64_tr_b16 a[248:249], v14 offset:4096
  v_mfma_f32_16x16x32_bf16 a[4:7], a[224:227], v[52:55], a[4:7]
  ds_read_b64_tr_b16 a[250:251], v14 offset:6144
  v_mfma_f32_16x16x32_bf16 a[8:11], a[228:231], v[48:51], a[8:11]
  ds_read_b64_tr_b16 a[252:253], v15 offset:4096
  s_waitcnt lgkmcnt(8)
  v_cmp_le_u32 vcc, 0xb0030033, v3
  v_mfma_f32_16x16x32_bf16 a[12:15], a[228:231], v[52:55], a[12:15]
  ds_read_b64_tr_b16 a[254:255], v15 offset:6144
  s_waitcnt lgkmcnt(8)
  v_mfma_f32_16x16x32_bf16 a[16:19], a[232:235], v[48:51], a[16:19]
  s_cbranch_vccz L_csO_2_0
L_cbO_2_0:
  ds_read_b64_tr_b16 a[224:225], v12 offset:20480
  v_mul_f32 v112, v112, v20
  v_mfma_f32_16x16x32_bf16 a[20:23], a[232:235], v[52:55], a[20:23]
  ds_read_b64_tr_b16 a[226:227], v12 offset:22528
  v_mul_f32 v113, v113, v20
  v_mfma_f32_16x16x32_bf16 a[24:27], a[236:239], v[48:51], a[24:27]
  ds_read_b64_tr_b16 a[228:229], v13 offset:20480
  v_cvt_pk_bf16_f32 v104, v112, v113
  v_mul_f32 v114, v114, v20
  v_mfma_f32_16x16x32_bf16 a[28:31], a[236:239], v[52:55], a[28:31]
  ds_read_b64_tr_b16 a[230:231], v13 offset:22528
  s_waitcnt lgkmcnt(8)
  v_mfma_f32_16x16x32_bf16 a[0:3], a[240:243], v[56:59], a[0:3]
  ds_read_b64_tr_b16 a[232:233], v14 offset:20480
  v_mul_f32 v115, v115, v20
  v_mfma_f32_16x16x32_bf16 a[4:7], a[240:243], v[60:63], a[4:7]
  ds_read_b64_tr_b16 a[234:235], v14 offset:22528
  v_cvt_pk_bf16_f32 v105, v114, v115
  v_mul_f32 v120, v120, v20
  v_mfma_f32_16x16x32_bf16 a[8:11], a[244:247], v[56:59], a[8:11]
  ds_read_b64_tr_b16 a[236:237], v15 offset:20480
  ds_read_b32 v3, v2 offset:2048
  v_mfma_f32_16x16x32_bf16 a[12:15], a[244:247], v[60:63], a[12:15]
  ds_read_b64_tr_b16 a[238:239], v15 offset:22528
  v_mul_f32 v121, v121, v20
  s_waitcnt lgkmcnt(9)
  v_mfma_f32_16x16x32_bf16 a[16:19], a[248:251], v[56:59], a[16:19]
  ds_read_b64_tr_b16 a[240:241], v12 offset:24576
  v_mov_b32 v31, L_tab-L_pc+216
  v_mfma_f32_16x16x32_bf16 a[20:23], a[248:251], v[60:63], a[20:23]
  ds_read_b64_tr_b16 a[242:243], v12 offset:26624
  global_load_lds_dword v31, s[22:23]
  v_cvt_pk_bf16_f32 v106, v120, v121
  v_mfma_f32_16x16x32_bf16 a[24:27], a[252:255], v[56:59], a[24:27]
  ds_read_b64_tr_b16 a[244:245], v13 offset:24576
  v_mul_f32 v122, v122, v20
  v_mfma_f32_16x16x32_bf16 a[28:31], a[252:255], v[60:63], a[28:31]
  ds_read_b64_tr_b16 a[246:247], v13 offset:26624
  v_mul_f32 v123, v123, v20
  s_waitcnt lgkmcnt(9)
  v_mfma_f32_16x16x32_bf16 a[0:3], a[224:227], v[64:67], a[0:3]
  ds_read_b64_tr_b16 a[248:249], v14 offset:24576
  v_cvt_pk_bf16_f32 v107, v122, v123
  v_mfma_f32_16x16x32_bf16 a[4:7], a[224:227], v[68:71], a[4:7]
  ds_read_b64_tr_b16 a[250:251], v14 offset:26624
  v_mul_f32 v116, v116, v21
  v_mfma_f32_16x16x32_bf16 a[8:11], a[228:231], v[64:67], a[8:11]
  ds_read_b64_tr_b16 a[252:253], v15 offset:24576
  s_waitcnt lgkmcnt(8)
  v_cmp_le_u32 vcc, 0xb0030034, v3
  v_mul_f32 v117, v117, v21
  v_mfma_f32_16x16x32_bf16 a[12:15], a[228:231], v[68:71], a[12:15]
  ds_read_b64_tr_b16 a[254:255], v15 offset:26624
  v_cvt_pk_bf16_f32 v108, v116, v117
  s_waitcnt lgkmcnt(8)
  v_mfma_f32_16x16x32_bf16 a[16:19], a[232:235], v[64:67], a[16:19]
  s_cbranch_vccz L_csO_3_0
L_cbO_3_0:
  v_subrev_u32 v12, 65536, v12
  ds_read_b64_tr_b16 a[224:225], v12 offset:0
  v_mfma_f32_16x16x32_bf16 a[20:23], a[232:235], v[68:71], a[20:23]
  ds_read_b64_tr_b16 a[226:227], v12 offset:2048
  v_mul_f32 v118, v118, v21
  v_mfma_f32_16x16x32_bf16 a[24:27], a[236:239], v[64:67], a[24:27]
  v_subrev_u32 v13, 65536, v13
  ds_read_b64_tr_b16 a[228:229], v13 offset:0
  v_mul_f32 v119, v119, v21
  v_cvt_pk_bf16_f32 v109, v118, v119
  v_mfma_f32_16x16x32_bf16 a[28:31], a[236:239], v[68:71], a[28:31]
  ds_read_b64_tr_b16 a[230:231], v13 offset:2048
  s_waitcnt lgkmcnt(8)
  v_mfma_f32_16x16x32_bf16 a[0:3], a[240:243], v[72:75], a[0:3]
  ds_read_b64_tr_b16 a[232:233], v12 offset:4096
  v_mul_f32 v124, v124, v21
  v_mul_f32 v125, v125, v21
  v_mfma_f32_16x16x32_bf16 a[4:7], a[240:243], v[76:79], a[4:7]
  ds_read_b64_tr_b16 a[234:235], v12 offset:6144
  v_cvt_pk_bf16_f32 v110, v124, v125
  v_mfma_f32_16x16x32_bf16 a[8:11], a[244:247], v[72:75], a[8:11]
  ds_read_b64_tr_b16 a[236:237], v13 offset:4096
  ds_read_b32 v3, v2 offset:2048
  v_mfma_f32_16x16x32_bf16 a[12:15], a[244:247], v[76:79], a[12:15]
  ds_read_b64_tr_b16 a[238:239], v13 offset:6144
  v_mul_f32 v126, v126, v21
  s_waitcnt lgkmcnt(9)
  v_mfma_f32_16x16x32_bf16 a[16:19], a[248:251], v[72:75], a[16:19]
  v_subrev_u32 v14, 65536, v14
  ds_read_b64_tr_b16 a[240:241], v14 offset:0
  v_mov_b32 v31, L_tab-L_pc+220
  v_mul_f32 v127, v127, v21
  v_mfma_f32_16x16x32_bf16 a[20:23], a[248:251], v[76:79], a[20:23]
  ds_read_b64_tr_b16 a[242:243], v14 offset:2048
  global_load_lds_dword v31, s[22:23]
  v_mfma_f32_16x16x32_bf16 a[24:27], a[252:255], v[72:75], a[24:27]
  v_subrev_u32 v15, 65536, v15
  ds_read_b64_tr_b16 a[244:245], v15 offset:0
  v_cvt_pk_bf16_f32 v111, v126, v127
  v_mfma_f32_16x16x32_bf16 a[28:31], a[252:255], v[76:79], a[28:31]
  ds_read_b64_tr_b16 a[246:247], v15 offset:2048
  s_waitcnt lgkmcnt(9)
  v_mfma_f32_16x16x32_bf16 a[0:3], a[224:227], v[96:99], a[0:3]
  ds_read_b64_tr_b16 a[248:249], v14 offset:4096
  v_mfma_f32_16x16x32_bf16 a[4:7], a[224:227], v[100:103], a[4:7]
  ds_read_b64_tr_b16 a[250:251], v14 offset:6144
  v_mfma_f32_16x16x32_bf16 a[8:11], a[228:231], v[96:99], a[8:11]
  ds_read_b64_tr_b16 a[252:253], v15 offset:4096
  s_waitcnt lgkmcnt(8)
  v_cmp_le_u32 vcc, 0xb0030035, v3
  v_mfma_f32_16x16x32_bf16 a[12:15], a[228:231], v[100:103], a[12:15]
  ds_read_b64_tr_b16 a[254:255], v15 offset:6144
  s_waitcnt lgkmcnt(8)
  v_mfma_f32_16x16x32_bf16 a[0:3], a[232:235], v[104:107], a[0:3]
  s_cbranch_vccz L_csO_1_1
L_cbO_1_1:
  ds_read_b64_tr_b16 a[224:225], v12 offset:8192
  v_mfma_f32_16x16x32_bf16 a[4:7], a[232:235], v[108:111], a[4:7]
  ds_read_b64_tr_b16 a[226:227], v12 offset:10240
  v_mfma_f32_16x16x32_bf16 a[8:11], a[236:239], v[104:107], a[8:11]
  ds_read_b64_tr_b16 a[228:229], v13 offset:8192
  v_mfma_f32_16x16x32_bf16 a[12:15], a[236:239], v[108:111], a[12:15]
  ds_read_b64_tr_b16 a[230:231], v13 offset:10240
  s_waitcnt lgkmcnt(8)
  v_mfma_f32_16x16x32_bf16 a[16:19], a[240:243], v[96:99], a[16:19]
  ds_read_b64_tr_b16 a[232:233], v14 offset:8192
  v_mfma_f32_16x16x32_bf16 a[20:23], a[240:243], v[100:103], a[20:23]
  ds_read_b64_tr_b16 a[234:235], v14 offset:10240
  v_mfma_f32_16x16x32_bf16 a[24:27], a[244:247], v[96:99], a[24:27]
  ds_read_b64_tr_b16 a[236:237], v15 offset:8192
  ds_read_b32 v3, v2 offset:2048
  v_mfma_f32_16x16x32_bf16 a[28:31], a[244:247], v[100:103], a[28:31]
  ds_read_b64_tr_b16 a[238:239], v15 offset:10240
  s_mul_i32 s63, s100, 12288
  s_waitcnt lgkmcnt(9)
  v_mfma_f32_16x16x32_bf16 a[16:19], a[248:251], v[104:107], a[16:19]
  ds_read_b64_tr_b16 a[240:241], v12 offset:12288
  s_add_u32 s63, s63, s65
  v_accvgpr_read_b32 v128, a0
  v_mfma_f32_16x16x32_bf16 a[20:23], a[248:251], v[108:111], a[20:23]
  ds_read_b64_tr_b16 a[242:243], v12 offset:14336
  v_accvgpr_read_b32 v129, a1
  v_accvgpr_read_b32 v130, a2
  v_mfma_f32_16x16x32_bf16 a[24:27], a[252:255], v[104:107], a[24:27]
  ds_read_b64_tr_b16 a[244:245], v13 offset:12288
  v_accvgpr_read_b32 v131, a3
  v_accvgpr_read_b32 v132, a8
  v_mfma_f32_16x16x32_bf16 a[28:31], a[252:255], v[108:111], a[28:31]
  ds_read_b64_tr_b16 a[246:247], v13 offset:14336
  s_waitcnt lgkmcnt(9)
  v_mfma_f32_16x16x32_bf16 a[32:35], a[224:227], v[48:51], a[32:35]
  ds_read_b64_tr_b16 a[248:249], v14 offset:12288
  v_accvgpr_read_b32 v133, a9
  v_accvgpr_read_b32 v134, a10
  v_mfma_f32_16x16x32_bf16 a[36:39], a[224:227], v[52:55], a[36:39]
  ds_read_b64_tr_b16 a[250:251], v14 offset:14336
  v_accvgpr_read_b32 v135, a11
  v_cvt_pk_bf16_f32 v144, v128, v129
  v_mfma_f32_16x16x32_bf16 a[40:43], a[228:231], v[48:51], a[40:43]
  ds_read_b64_tr_b16 a[252:253], v15 offset:12288
  s_waitcnt lgkmcnt(8)
  v_cmp_le_u32 vcc, 0xb0030036, v3
  v_cvt_pk_bf16_f32 v145, v130, v131
  v_mfma_f32_16x16x32_bf16 a[44:47], a[228:231], v[52:55], a[44:47]
  ds_read_b64_tr_b16 a[254:255], v15 offset:14336
  v_cvt_pk_bf16_f32 v146, v132, v133
  s_waitcnt lgkmcnt(8)
  v_mfma_f32_16x16x32_bf16 a[48:51], a[232:235], v[48:51], a[48:51]
  s_cbranch_vccz L_csO_2_1
L_cbO_2_1:
  v_add_u32 v12, 65536, v12
  ds_read_b64_tr_b16 a[224:225], v12 offset:8192
  v_cvt_pk_bf16_f32 v147, v134, v135
  v_mfma_f32_16x16x32_bf16 a[52:55], a[232:235], v[52:55], a[52:55]
  ds_read_b64_tr_b16 a[226:227], v12 offset:10240
  buffer_store_dwordx4 v[144:147], v5, s[44:47], s63 offen offset:0 sc1
  v_mfma_f32_16x16x32_bf16 a[56:59], a[236:239], v[48:51], a[56:59]
  v_add_u32 v13, 65536, v13
  ds_read_b64_tr_b16 a[228:229], v13 offset:8192
  v_accvgpr_read_b32 v136, a4
  v_accvgpr_read_b32 v137, a5
  v_mfma_f32_16x16x32_bf16 a[60:63], a[236:239], v[52:55], a[60:63]
  ds_read_b64_tr_b16 a[230:231], v13 offset:10240
  v_accvgpr_read_b32 v138, a6
  s_waitcnt lgkmcnt(8)
  v_mfma_f32_16x16x32_bf16 a[32:35], a[240:243], v[56:59], a[32:35]
  v_add_u32 v14, 65536, v14
  ds_read_b64_tr_b16 a[232:233], v14 offset:8192
  v_accvgpr_read_b32 v139, a7
  v_accvgpr_read_b32 v140, a12
  v_mfma_f32_16x16x32_bf16 a[36:39], a[240:243], v[60:63], a[36:39]
  ds_read_b64_tr_b16 a[234:235], v14 offset:10240
  v_accvgpr_read_b32 v141, a13
  v_mfma_f32_16x16x32_bf16 a[40:43], a[244:247], v[56:59], a[40:43]
  v_add_u32 v15, 65536, v15
  ds_read_b64_tr_b16 a[236:237], v15 offset:8192
  ds_read_b32 v3, v2 offset:2048
  v_accvgpr_read_b32 v142, a14
  v_mfma_f32_16x16x32_bf16 a[44:47], a[244:247], v[60:63], a[44:47]
  ds_read_b64_tr_b16 a[238:239], v15 offset:10240
  v_accvgpr_read_b32 v143, a15
  s_waitcnt lgkmcnt(9)
  v_mfma_f32_16x16x32_bf16 a[48:51], a[248:251], v[56:59], a[48:51]
  ds_read_b64_tr_b16 a[240:241], v12 offset:12288
  v_cvt_pk_bf16_f32 v148, v136, v137
  v_cvt_pk_bf16_f32 v149, v138, v139
  v_mfma_f32_16x16x32_bf16 a[52:55], a[248:251], v[60:63], a[52:55]
  ds_read_b64_tr_b16 a[242:243], v12 offset:14336
  v_cvt_pk_bf16_f32 v150, v140, v141
  v_cvt_pk_bf16_f32 v151, v142, v143
  v_mfma_f32_16x16x32_bf16 a[56:59], a[252:255], v[56:59], a[56:59]
  ds_read_b64_tr_b16 a[244:245], v13 offset:12288
  buffer_store_dwordx4 v[148:151], v5, s[44:47], s63 offen offset:2048 sc1
  v_mfma_f32_16x16x32_bf16 a[60:63], a[252:255], v[60:63], a[60:63]
  ds_read_b64_tr_b16 a[246:247], v13 offset:14336
  v_accvgpr_read_b32 v152, a16
  s_waitcnt lgkmcnt(9)
  v_mfma_f32_16x16x32_bf16 a[32:35], a[224:227], v[64:67], a[32:35]
  ds_read_b64_tr_b16 a[248:249], v14 offset:12288
  v_accvgpr_read_b32 v153, a17
  v_accvgpr_read_b32 v154, a18
  v_mfma_f32_16x16x32_bf16 a[36:39], a[224:227], v[68:71], a[36:39]
  ds_read_b64_tr_b16 a[250:251], v14 offset:14336
  v_accvgpr_read_b32 v155, a19
  v_accvgpr_read_b32 v156, a24
  v_mfma_f32_16x16x32_bf16 a[40:43], a[228:231], v[64:67], a[40:43]
  ds_read_b64_tr_b16 a[252:253], v15 offset:12288
  s_waitcnt lgkmcnt(8)
  v_cmp_le_u32 vcc, 0xb0030037, v3
  v_accvgpr_read_b32 v157, a25
  v_mfma_f32_16x16x32_bf16 a[44:47], a[228:231], v[68:71], a[44:47]
  ds_read_b64_tr_b16 a[254:255], v15 offset:14336
  v_accvgpr_read_b32 v158, a26
  s_waitcnt lgkmcnt(8)
  v_mfma_f32_16x16x32_bf16 a[48:51], a[232:235], v[64:67], a[48:51]
  s_cbranch_vccz L_csO_3_1
L_cbO_3_1:
  v_subrev_u32 v12, 65536, v12
  ds_read_b64_tr_b16 a[224:225], v12 offset:16384
  v_accvgpr_read_b32 v159, a27
  v_mfma_f32_16x16x32_bf16 a[52:55], a[232:235], v[68:71], a[52:55]
  ds_read_b64_tr_b16 a[226:227], v12 offset:18432
  v_cvt_pk_bf16_f32 v168, v152, v153
  v_cvt_pk_bf16_f32 v169, v154, v155
  v_mfma_f32_16x16x32_bf16 a[56:59], a[236:239], v[64:67], a[56:59]
  v_subrev_u32 v13, 65536, v13
  ds_read_b64_tr_b16 a[228:229], v13 offset:16384
  v_cvt_pk_bf16_f32 v170, v156, v157
  v_cvt_pk_bf16_f32 v171, v158, v159
  v_mfma_f32_16x16x32_bf16 a[60:63], a[236:239], v[68:71], a[60:63]
  ds_read_b64_tr_b16 a[230:231], v13 offset:18432
  buffer_store_dwordx4 v[168:171], v5, s[44:47], s63 offen offset:256 sc1
  s_waitcnt lgkmcnt(8)
  v_mfma_f32_16x16x32_bf16 a[32:35], a[240:243], v[72:75], a[32:35]
  ds_read_b64_tr_b16 a[232:233], v12 offset:20480
  v_accvgpr_read_b32 v160, a20
  v_accvgpr_read_b32 v161, a21
  v_mfma_f32_16x16x32_bf16 a[36:39], a[240:243], v[76:79], a[36:39]
  ds_read_b64_tr_b16 a[234:235], v12 offset:22528
  v_accvgpr_read_b32 v162, a22
  v_mfma_f32_16x16x32_bf16 a[40:43], a[244:247], v[72:75], a[40:43]
  ds_read_b64_tr_b16 a[236:237], v13 offset:20480
  ds_read_b32 v3, v2 offset:2048
  v_accvgpr_read_b32 v163, a23
  v_mfma_f32_16x16x32_bf16 a[44:47], a[244:247], v[76:79], a[44:47]
  ds_read_b64_tr_b16 a[238:239], v13 offset:22528
  v_accvgpr_read_b32 v164, a28
  s_waitcnt lgkmcnt(9)
  v_mfma_f32_16x16x32_bf16 a[48:51], a[248:251], v[72:75], a[48:51]
  v_subrev_u32 v14, 65536, v14
  ds_read_b64_tr_b16 a[240:241], v14 offset:16384
  v_accvgpr_read_b32 v165, a29
  v_accvgpr_read_b32 v166, a30
  v_mfma_f32_16x16x32_bf16 a[52:55], a[248:251], v[76:79], a[52:55]
  ds_read_b64_tr_b16 a[242:243], v14 offset:18432
  v_accvgpr_read_b32 v167, a31
  v_cvt_pk_bf16_f32 v172, v160, v161
  v_mfma_f32_16x16x32_bf16 a[56:59], a[252:255], v[72:75], a[56:59]
  v_subrev_u32 v15, 65536, v15
  ds_read_b64_tr_b16 a[244:245], v15 offset:16384
  v_cvt_pk_bf16_f32 v173, v162, v163
  v_cvt_pk_bf16_f32 v174, v164, v165
  v_mfma_f32_16x16x32_bf16 a[60:63], a[252:255], v[76:79], a[60:63]
  ds_read_b64_tr_b16 a[246:247], v15 offset:18432
  v_cvt_pk_bf16_f32 v175, v166, v167
  s_waitcnt lgkmcnt(9)
  v_mfma_f32_16x16x32_bf16 a[32:35], a[224:227], v[96:99], a[32:35]
  ds_read_b64_tr_b16 a[248:249], v14 offset:20480
  buffer_store_dwordx4 v[172:175], v5, s[44:47], s63 offen offset:2304 sc1
  s_cmp_eq_u32 s100, 6
  s_cselect_b32 s100, -1, s100
  v_mfma_f32_16x16x32_bf16 a[36:39], a[224:227], v[100:103], a[36:39]
  ds_read_b64_tr_b16 a[250:251], v14 offset:22528
  s_add_u32 s100, s100, 1
  v_mfma_f32_16x16x32_bf16 a[40:43], a[228:231], v[96:99], a[40:43]
  ds_read_b64_tr_b16 a[252:253], v15 offset:20480
  s_waitcnt lgkmcnt(8)
  v_cmp_le_u32 vcc, 0xb0030038, v3
  v_mfma_f32_16x16x32_bf16 a[44:47], a[228:231], v[100:103], a[44:47]
  ds_read_b64_tr_b16 a[254:255], v15 offset:22528
  s_waitcnt lgkmcnt(8)
  v_mfma_f32_16x16x32_bf16 a[32:35], a[232:235], v[104:107], a[32:35]
  s_cbranch_vccz L_csO_1_2
L_cbO_1_2:
  ds_read_b64_tr_b16 a[224:225], v12 offset:24576
  v_mfma_f32_16x16x32_bf16 a[36:39], a[232:235], v[108:111], a[36:39]
  ds_read_b64_tr_b16 a[226:227], v12 offset:26624
  v_mfma_f32_16x16x32_bf16 a[40:43], a[236:239], v[104:107], a[40:43]
  ds_read_b64_tr_b16 a[228:229], v13 offset:24576
  v_mfma_f32_16x16x32_bf16 a[44:47], a[236:239], v[108:111], a[44:47]
  ds_read_b64_tr_b16 a[230:231], v13 offset:26624
  s_waitcnt lgkmcnt(8)
  v_mfma_f32_16x16x32_bf16 a[48:51], a[240:243], v[96:99], a[48:51]
  ds_read_b64_tr_b16 a[232:233], v14 offset:24576
  v_mfma_f32_16x16x32_bf16 a[52:55], a[240:243], v[100:103], a[52:55]
  ds_read_b64_tr_b16 a[234:235], v14 offset:26624
  v_mfma_f32_16x16x32_bf16 a[56:59], a[244:247], v[96:99], a[56:59]
  ds_read_b64_tr_b16 a[236:237], v15 offset:24576
  ds_read_b32 v3, v2 offset:2048
  v_mfma_f32_16x16x32_bf16 a[60:63], a[244:247], v[100:103], a[60:63]
  ds_read_b64_tr_b16 a[238:239], v15 offset:26624
  s_mul_i32 s63, s100, 12288
  s_waitcnt lgkmcnt(9)
  v_mfma_f32_16x16x32_bf16 a[48:51], a[248:251], v[104:107], a[48:51]
  ds_read_b64_tr_b16 a[240:241], v12 offset:28672
  s_add_u32 s63, s63, s65
  v_accvgpr_read_b32 v176, a32
  v_mfma_f32_16x16x32_bf16 a[52:55], a[248:251], v[108:111], a[52:55]
  ds_read_b64_tr_b16 a[242:243], v12 offset:30720
  v_accvgpr_read_b32 v177, a33
  v_accvgpr_read_b32 v178, a34
  v_mfma_f32_16x16x32_bf16 a[56:59], a[252:255], v[104:107], a[56:59]
  ds_read_b64_tr_b16 a[244:245], v13 offset:28672
  v_accvgpr_read_b32 v179, a35
  v_accvgpr_read_b32 v180, a40
  v_mfma_f32_16x16x32_bf16 a[60:63], a[252:255], v[108:111], a[60:63]
  ds_read_b64_tr_b16 a[246:247], v13 offset:30720
  s_waitcnt lgkmcnt(9)
  v_mfma_f32_16x16x32_bf16 a[64:67], a[224:227], v[48:51], a[64:67]
  ds_read_b64_tr_b16 a[248:249], v14 offset:28672
  v_accvgpr_read_b32 v181, a41
  v_accvgpr_read_b32 v182, a42
  v_mfma_f32_16x16x32_bf16 a[68:71], a[224:227], v[52:55], a[68:71]
  ds_read_b64_tr_b16 a[250:251], v14 offset:30720
  v_accvgpr_read_b32 v183, a43
  v_cvt_pk_bf16_f32 v192, v176, v177
  v_mfma_f32_16x16x32_bf16 a[72:75], a[228:231], v[48:51], a[72:75]
  ds_read_b64_tr_b16 a[252:253], v15 offset:28672
  s_waitcnt lgkmcnt(8)
  v_cmp_le_u32 vcc, 0xb0030039, v3
  v_cvt_pk_bf16_f32 v193, v178, v179
  v_mfma_f32_16x16x32_bf16 a[76:79], a[228:231], v[52:55], a[76:79]
  ds_read_b64_tr_b16 a[254:255], v15 offset:30720
  v_cvt_pk_bf16_f32 v194, v180, v181
  s_waitcnt lgkmcnt(8)
  v_mfma_f32_16x16x32_bf16 a[80:83], a[232:235], v[48:51], a[80:83]
  s_cbranch_vccz L_csO_2_2
L_cbO_2_2:
  ds_read_b64_tr_b16 a[224:225], v12 offset:32768
  v_cvt_pk_bf16_f32 v195, v182, v183
  v_mfma_f32_16x16x32_bf16 a[84:87], a[232:235], v[52:55], a[84:87]
  ds_read_b64_tr_b16 a[226:227], v12 offset:34816
  buffer_store_dwordx4 v[192:195], v5, s[44:47], s63 offen offset:0 sc1
  v_mfma_f32_16x16x32_bf16 a[88:91], a[236:239], v[48:51], a[88:91]
  ds_read_b64_tr_b16 a[228:229], v13 offset:32768
  v_accvgpr_read_b32 v184, a36
  v_accvgpr_read_b32 v185, a37
  v_mfma_f32_16x16x32_bf16 a[92:95], a[236:239], v[52:55], a[92:95]
  ds_read_b64_tr_b16 a[230:231], v13 offset:34816
  v_accvgpr_read_b32 v186, a38
  s_waitcnt lgkmcnt(8)
  v_mfma_f32_16x16x32_bf16 a[64:67], a[240:243], v[56:59], a[64:67]
  ds_read_b64_tr_b16 a[232:233], v14 offset:32768
  v_accvgpr_read_b32 v187, a39
  v_accvgpr_read_b32 v188, a44
  v_mfma_f32_16x16x32_bf16 a[68:71], a[240:243], v[60:63], a[68:71]
  ds_read_b64_tr_b16 a[234:235], v14 offset:34816
  v_accvgpr_read_b32 v189, a45
  v_mfma_f32_16x16x32_bf16 a[72:75], a[244:247], v[56:59], a[72:75]
  ds_read_b64_tr_b16 a[236:237], v15 offset:32768
  ds_read_b32 v3, v2 offset:2048
  v_accvgpr_read_b32 v190, a46
  v_mfma_f32_16x16x32_bf16 a[76:79], a[244:247], v[60:63], a[76:79]
  ds_read_b64_tr_b16 a[238:239], v15 offset:34816
  v_accvgpr_read_b32 v191, a47
  s_waitcnt lgkmcnt(9)
  v_mfma_f32_16x16x32_bf16 a[80:83], a[248:251], v[56:59], a[80:83]
  ds_read_b64_tr_b16 a[240:241], v12 offset:36864
  v_cvt_pk_bf16_f32 v196, v184, v185
  v_cvt_pk_bf16_f32 v197, v186, v187
  v_mfma_f32_16x16x32_bf16 a[84:87], a[248:251], v[60:63], a[84:87]
  ds_read_b64_tr_b16 a[242:243], v12 offset:38912
  v_cvt_pk_bf16_f32 v198, v188, v189
  v_cvt_pk_bf16_f32 v199, v190, v191
  v_mfma_f32_16x16x32_bf16 a[88:91], a[252:255], v[56:59], a[88:91]
  ds_read_b64_tr_b16 a[244:245], v13 offset:36864
  buffer_store_dwordx4 v[196:199], v5, s[44:47], s63 offen offset:2048 sc1
  v_mfma_f32_16x16x32_bf16 a[92:95], a[252:255], v[60:63], a[92:95]
  ds_read_b64_tr_b16 a[246:247], v13 offset:38912
  v_accvgpr_read_b32 v200, a48
  s_waitcnt lgkmcnt(9)
  v_mfma_f32_16x16x32_bf16 a[64:67], a[224:227], v[64:67], a[64:67]
  ds_read_b64_tr_b16 a[248:249], v14 offset:36864
  v_accvgpr_read_b32 v201, a49
  v_accvgpr_read_b32 v202, a50
  v_mfma_f32_16x16x32_bf16 a[68:71], a[224:227], v[68:71], a[68:71]
  ds_read_b64_tr_b16 a[250:251], v14 offset:38912
  v_accvgpr_read_b32 v203, a51
  v_accvgpr_read_b32 v204, a56
  v_mfma_f32_16x16x32_bf16 a[72:75], a[228:231], v[64:67], a[72:75]
  ds_read_b64_tr_b16 a[252:253], v15 offset:36864
  s_waitcnt lgkmcnt(8)
  v_cmp_le_u32 vcc, 0xb003003a, v3
  v_accvgpr_read_b32 v205, a57
  v_mfma_f32_16x16x32_bf16 a[76:79], a[228:231], v[68:71], a[76:79]
  ds_read_b64_tr_b16 a[254:255], v15 offset:38912
  v_accvgpr_read_b32 v206, a58
  s_waitcnt lgkmcnt(8)
  v_mfma_f32_16x16x32_bf16 a[80:83], a[232:235], v[64:67], a[80:83]
  s_cbranch_vccz L_csO_3_2
L_cbO_3_2:
  v_subrev_u32 v12, 65536, v12
  ds_read_b64_tr_b16 a[224:225], v12 offset:0
  v_accvgpr_read_b32 v207, a59
  v_mfma_f32_16x16x32_bf16 a[84:87], a[232:235], v[68:71], a[84:87]
  ds_read_b64_tr_b16 a[226:227], v12 offset:2048
  v_cvt_pk_bf16_f32 v216, v200, v201
  v_cvt_pk_bf16_f32 v217, v202, v203
  v_mfma_f32_16x16x32_bf16 a[88:91], a[236:239], v[64:67], a[88:91]
  v_subrev_u32 v13, 65536, v13
  ds_read_b64_tr_b16 a[228:229], v13 offset:0
  v_cvt_pk_bf16_f32 v218, v204, v205
  v_cvt_pk_bf16_f32 v219, v206, v207
  v_mfma_f32_16x16x32_bf16 a[92:95], a[236:239], v[68:71], a[92:95]
  ds_read_b64_tr_b16 a[230:231], v13 offset:2048
  buffer_store_dwordx4 v[216:219], v5, s[44:47], s63 offen offset:256 sc1
  s_waitcnt lgkmcnt(8)
  v_mfma_f32_16x16x32_bf16 a[64:67], a[240:243], v[72:75], a[64:67]
  ds_read_b64_tr_b16 a[232:233], v12 offset:4096
  v_accvgpr_read_b32 v208, a52
  v_accvgpr_read_b32 v209, a53
  v_mfma_f32_16x16x32_bf16 a[68:71], a[240:243], v[76:79], a[68:71]
  ds_read_b64_tr_b16 a[234:235], v12 offset:6144
  v_accvgpr_read_b32 v210, a54
  v_mfma_f32_16x16x32_bf16 a[72:75], a[244:247], v[72:75], a[72:75]
  ds_read_b64_tr_b16 a[236:237], v13 offset:4096
  ds_read_b32 v3, v2 offset:2048
  v_accvgpr_read_b32 v211, a55
  v_mfma_f32_16x16x32_bf16 a[76:79], a[244:247], v[76:79], a[76:79]
  ds_read_b64_tr_b16 a[238:239], v13 offset:6144
  v_accvgpr_read_b32 v212, a60
  s_waitcnt lgkmcnt(9)
  v_mfma_f32_16x16x32_bf16 a[80:83], a[248:251], v[72:75], a[80:83]
  v_subrev_u32 v14, 65536, v14
  ds_read_b64_tr_b16 a[240:241], v14 offset:0
  v_accvgpr_read_b32 v213, a61
  v_accvgpr_read_b32 v214, a62
  v_mfma_f32_16x16x32_bf16 a[84:87], a[248:251], v[76:79], a[84:87]
  ds_read_b64_tr_b16 a[242:243], v14 offset:2048
  v_accvgpr_read_b32 v215, a63
  v_cvt_pk_bf16_f32 v220, v208, v209
  v_mfma_f32_16x16x32_bf16 a[88:91], a[252:255], v[72:75], a[88:91]
  v_subrev_u32 v15, 65536, v15
  ds_read_b64_tr_b16 a[244:245], v15 offset:0
  v_cvt_pk_bf16_f32 v221, v210, v211
  v_cvt_pk_bf16_f32 v222, v212, v213
  v_mfma_f32_16x16x32_bf16 a[92:95], a[252:255], v[76:79], a[92:95]
  ds_read_b64_tr_b16 a[246:247], v15 offset:2048
  v_cvt_pk_bf16_f32 v223, v214, v215
  s_waitcnt lgkmcnt(9)
  v_mfma_f32_16x16x32_bf16 a[64:67], a[224:227], v[96:99], a[64:67]
  ds_read_b64_tr_b16 a[248:249], v14 offset:4096
  buffer_store_dwordx4 v[220:223], v5, s[44:47], s63 offen offset:2304 sc1
  s_cmp_eq_u32 s100, 6
  s_cselect_b32 s100, -1, s100
  v_mfma_f32_16x16x32_bf16 a[68:71], a[224:227], v[100:103], a[68:71]
  ds_read_b64_tr_b16 a[250:251], v14 offset:6144
  s_add_u32 s100, s100, 1
  v_mfma_f32_16x16x32_bf16 a[72:75], a[228:231], v[96:99], a[72:75]
  ds_read_b64_tr_b16 a[252:253], v15 offset:4096
  s_waitcnt lgkmcnt(8)
  v_cmp_le_u32 vcc, 0xb003003b, v3
  v_mfma_f32_16x16x32_bf16 a[76:79], a[228:231], v[100:103], a[76:79]
  ds_read_b64_tr_b16 a[254:255], v15 offset:6144
  s_waitcnt lgkmcnt(8)
  v_mfma_f32_16x16x32_bf16 a[64:67], a[232:235], v[104:107], a[64:67]
  s_cbranch_vccz L_csO_1_3
L_cbO_1_3:
  ds_read_b64_tr_b16 a[224:225], v12 offset:8192
  v_mfma_f32_16x16x32_bf16 a[68:71], a[232:235], v[108:111], a[68:71]
  ds_read_b64_tr_b16 a[226:227], v12 offset:10240
  v_mfma_f32_16x16x32_bf16 a[72:75], a[236:239], v[104:107], a[72:75]
  ds_read_b64_tr_b16 a[228:229], v13 offset:8192
  v_mfma_f32_16x16x32_bf16 a[76:79], a[236:239], v[108:111], a[76:79]
  ds_read_b64_tr_b16 a[230:231], v13 offset:10240
  s_waitcnt lgkmcnt(8)
  v_mfma_f32_16x16x32_bf16 a[80:83], a[240:243], v[96:99], a[80:83]
  ds_read_b64_tr_b16 a[232:233], v14 offset:8192
  v_mfma_f32_16x16x32_bf16 a[84:87], a[240:243], v[100:103], a[84:87]
  ds_read_b64_tr_b16 a[234:235], v14 offset:10240
  v_mfma_f32_16x16x32_bf16 a[88:91], a[244:247], v[96:99], a[88:91]
  ds_read_b64_tr_b16 a[236:237], v15 offset:8192
  ds_read_b32 v3, v2 offset:2048
  v_mfma_f32_16x16x32_bf16 a[92:95], a[244:247], v[100:103], a[92:95]
  ds_read_b64_tr_b16 a[238:239], v15 offset:10240
  s_mul_i32 s63, s100, 12288
  s_waitcnt lgkmcnt(9)
  v_mfma_f32_16x16x32_bf16 a[80:83], a[248:251], v[104:107], a[80:83]
  ds_read_b64_tr_b16 a[240:241], v12 offset:12288
  s_add_u32 s63, s63, s65
  v_accvgpr_read_b32 v128, a64
  v_mfma_f32_16x16x32_bf16 a[84:87], a[248:251], v[108:111], a[84:87]
  ds_read_b64_tr_b16 a[242:243], v12 offset:14336
  v_accvgpr_read_b32 v129, a65
  v_accvgpr_read_b32 v130, a66
  v_mfma_f32_16x16x32_bf16 a[88:91], a[252:255], v[104:107], a[88:91]
  ds_read_b64_tr_b16 a[244:245], v13 offset:12288
  v_accvgpr_read_b32 v131, a67
  v_accvgpr_read_b32 v132, a72
  v_mfma_f32_16x16x32_bf16 a[92:95], a[252:255], v[108:111], a[92:95]
  ds_read_b64_tr_b16 a[246:247], v13 offset:14336
  s_waitcnt lgkmcnt(9)
  v_mfma_f32_16x16x32_bf16 a[96:99], a[224:227], v[48:51], a[96:99]
  ds_read_b64_tr_b16 a[248:249], v14 offset:12288
  v_accvgpr_read_b32 v133, a73
  v_accvgpr_read_b32 v134, a74
  v_mfma_f32_16x16x32_bf16 a[100:103], a[224:227], v[52:55], a[100:103]
  ds_read_b64_tr_b16 a[250:251], v14 offset:14336
  v_accvgpr_read_b32 v135, a75
  v_cvt_pk_bf16_f32 v144, v128, v129
  v_mfma_f32_16x16x32_bf16 a[104:107], a[228:231], v[48:51], a[104:107]
  ds_read_b64_tr_b16 a[252:253], v15 offset:12288
  s_waitcnt lgkmcnt(8)
  v_cmp_le_u32 vcc, 0xb003003c, v3
  v_cvt_pk_bf16_f32 v145, v130, v131
  v_mfma_f32_16x16x32_bf16 a[108:111], a[228:231], v[52:55], a[108:111]
  ds_read_b64_tr_b16 a[254:255], v15 offset:14336
  v_cvt_pk_bf16_f32 v146, v132, v133
  s_waitcnt lgkmcnt(8)
  v_mfma_f32_16x16x32_bf16 a[112:115], a[232:235], v[48:51], a[112:115]
  s_cbranch_vccz L_csO_2_3
L_cbO_2_3:
  v_add_u32 v12, 65536, v12
  ds_read_b64_tr_b16 a[224:225], v12 offset:49152
  v_cvt_pk_bf16_f32 v147, v134, v135
  v_mfma_f32_16x16x32_bf16 a[116:119], a[232:235], v[52:55], a[116:119]
  ds_read_b64_tr_b16 a[226:227], v12 offset:51200
  buffer_store_dwordx4 v[144:147], v5, s[44:47], s63 offen offset:0 sc1
  v_mfma_f32_16x16x32_bf16 a[120:123], a[236:239], v[48:51], a[120:123]
  v_add_u32 v13, 65536, v13
  ds_read_b64_tr_b16 a[228:229], v13 offset:49152
  v_accvgpr_read_b32 v136, a68
  v_accvgpr_read_b32 v137, a69
  v_mfma_f32_16x16x32_bf16 a[124:127], a[236:239], v[52:55], a[124:127]
  ds_read_b64_tr_b16 a[230:231], v13 offset:51200
  v_accvgpr_read_b32 v138, a70
  s_waitcnt lgkmcnt(8)
  v_mfma_f32_16x16x32_bf16 a[96:99], a[240:243], v[56:59], a[96:99]
  v_add_u32 v14, 65536, v14
  ds_read_b64_tr_b16 a[232:233], v14 offset:49152
  v_accvgpr_read_b32 v139, a71
  v_accvgpr_read_b32 v140, a76
  v_mfma_f32_16x16x32_bf16 a[100:103], a[240:243], v[60:63], a[100:103]
  ds_read_b64_tr_b16 a[234:235], v14 offset:51200
  v_accvgpr_read_b32 v141, a77
  v_mfma_f32_16x16x32_bf16 a[104:107], a[244:247], v[56:59], a[104:107]
  v_add_u32 v15, 65536, v15
  ds_read_b64_tr_b16 a[236:237], v15 offset:49152
  ds_read_b32 v3, v2 offset:2048
  v_accvgpr_read_b32 v142, a78
  v_mfma_f32_16x16x32_bf16 a[108:111], a[244:247], v[60:63], a[108:111]
  ds_read_b64_tr_b16 a[238:239], v15 offset:51200
  v_accvgpr_read_b32 v143, a79
  s_waitcnt lgkmcnt(9)
  v_mfma_f32_16x16x32_bf16 a[112:115], a[248:251], v[56:59], a[112:115]
  ds_read_b64_tr_b16 a[240:241], v12 offset:53248
  v_cvt_pk_bf16_f32 v148, v136, v137
  v_cvt_pk_bf16_f32 v149, v138, v139
  v_mfma_f32_16x16x32_bf16 a[116:119], a[248:251], v[60:63], a[116:119]
  ds_read_b64_tr_b16 a[242:243], v12 offset:55296
  v_cvt_pk_bf16_f32 v150, v140, v141
  v_cvt_pk_bf16_f32 v151, v142, v143
  v_mfma_f32_16x16x32_bf16 a[120:123], a[252:255], v[56:59], a[120:123]
  ds_read_b64_tr_b16 a[244:245], v13 offset:53248
  buffer_store_dwordx4 v[148:151], v5, s[44:47], s63 offen offset:2048 sc1
  v_mfma_f32_16x16x32_bf16 a[124:127], a[252:255], v[60:63], a[124:127]
  ds_read_b64_tr_b16 a[246:247], v13 offset:55296
  v_accvgpr_read_b32 v152, a80
  s_waitcnt lgkmcnt(9)
  v_mfma_f32_16x16x32_bf16 a[96:99], a[224:227], v[64:67], a[96:99]
  ds_read_b64_tr_b16 a[248:249], v14 offset:53248
  v_accvgpr_read_b32 v153, a81
  v_accvgpr_read_b32 v154, a82
  v_mfma_f32_16x16x32_bf16 a[100:103], a[224:227], v[68:71], a[100:103]
  ds_read_b64_tr_b16 a[250:251], v14 offset:55296
  v_accvgpr_read_b32 v155, a83
  v_accvgpr_read_b32 v156, a88
  v_mfma_f32_16x16x32_bf16 a[104:107], a[228:231], v[64:67], a[104:107]
  ds_read_b64_tr_b16 a[252:253], v15 offset:53248
  s_waitcnt lgkmcnt(8)
  v_cmp_le_u32 vcc, 0xb003003d, v3
  v_accvgpr_read_b32 v157, a89
  v_mfma_f32_16x16x32_bf16 a[108:111], a[228:231], v[68:71], a[108:111]
  ds_read_b64_tr_b16 a[254:255], v15 offset:55296
  v_accvgpr_read_b32 v158, a90
  s_waitcnt lgkmcnt(8)
  v_mfma_f32_16x16x32_bf16 a[112:115], a[232:235], v[64:67], a[112:115]
  s_cbranch_vccz L_csO_3_3
L_cbO_3_3:
  ds_read_b64_tr_b16 a[224:225], v12 offset:57344
  v_accvgpr_read_b32 v159, a91
  v_mfma_f32_16x16x32_bf16 a[116:119], a[232:235], v[68:71], a[116:119]
  ds_read_b64_tr_b16 a[226:227], v12 offset:59392
  v_cvt_pk_bf16_f32 v168, v152, v153
  v_cvt_pk_bf16_f32 v169, v154, v155
  v_mfma_f32_16x16x32_bf16 a[120:123], a[236:239], v[64:67], a[120:123]
  ds_read_b64_tr_b16 a[228:229], v13 offset:57344
  v_cvt_pk_bf16_f32 v170, v156, v157
  v_cvt_pk_bf16_f32 v171, v158, v159
  v_mfma_f32_16x16x32_bf16 a[124:127], a[236:239], v[68:71], a[124:127]
  ds_read_b64_tr_b16 a[230:231], v13 offset:59392
  buffer_store_dwordx4 v[168:171], v5, s[44:47], s63 offen offset:256 sc1
  s_waitcnt lgkmcnt(8)
  v_mfma_f32_16x16x32_bf16 a[96:99], a[240:243], v[72:75], a[96:99]
  ds_read_b64_tr_b16 a[232:233], v12 offset:61440
  v_accvgpr_read_b32 v160, a84
  v_accvgpr_read_b32 v161, a85
  v_mfma_f32_16x16x32_bf16 a[100:103], a[240:243], v[76:79], a[100:103]
  ds_read_b64_tr_b16 a[234:235], v12 offset:63488
  v_accvgpr_read_b32 v162, a86
  v_mfma_f32_16x16x32_bf16 a[104:107], a[244:247], v[72:75], a[104:107]
  ds_read_b64_tr_b16 a[236:237], v13 offset:61440
  ds_read_b32 v3, v2 offset:2048
  v_accvgpr_read_b32 v163, a87
  v_mfma_f32_16x16x32_bf16 a[108:111], a[244:247], v[76:79], a[108:111]
  ds_read_b64_tr_b16 a[238:239], v13 offset:63488
  v_accvgpr_read_b32 v164, a92
  s_waitcnt lgkmcnt(9)
  v_mfma_f32_16x16x32_bf16 a[112:115], a[248:251], v[72:75], a[112:115]
  ds_read_b64_tr_b16 a[240:241], v14 offset:57344
  v_accvgpr_read_b32 v165, a93
  v_accvgpr_read_b32 v166, a94
  v_mfma_f32_16x16x32_bf16 a[116:119], a[248:251], v[76:79], a[116:119]
  ds_read_b64_tr_b16 a[242:243], v14 offset:59392
  v_accvgpr_read_b32 v167, a95
  v_cvt_pk_bf16_f32 v172, v160, v161
  v_mfma_f32_16x16x32_bf16 a[120:123], a[252:255], v[72:75], a[120:123]
  ds_read_b64_tr_b16 a[244:245], v15 offset:57344
  v_cvt_pk_bf16_f32 v173, v162, v163
  v_cvt_pk_bf16_f32 v174, v164, v165
  v_mfma_f32_16x16x32_bf16 a[124:127], a[252:255], v[76:79], a[124:127]
  ds_read_b64_tr_b16 a[246:247], v15 offset:59392
  v_cvt_pk_bf16_f32 v175, v166, v167
  s_waitcnt lgkmcnt(9)
  v_mfma_f32_16x16x32_bf16 a[96:99], a[224:227], v[96:99], a[96:99]
  ds_read_b64_tr_b16 a[248:249], v14 offset:61440
  buffer_store_dwordx4 v[172:175], v5, s[44:47], s63 offen offset:2304 sc1
  s_cmp_eq_u32 s100, 6
  s_cselect_b32 s100, -1, s100
  v_mfma_f32_16x16x32_bf16 a[100:103], a[224:227], v[100:103], a[100:103]
  ds_read_b64_tr_b16 a[250:251], v14 offset:63488
  s_add_u32 s100, s100, 1
  v_mfma_f32_16x16x32_bf16 a[104:107], a[228:231], v[96:99], a[104:107]
  ds_read_b64_tr_b16 a[252:253], v15 offset:61440
  s_waitcnt lgkmcnt(8)
  v_cmp_le_u32 vcc, 0xb003003e, v3
  v_mfma_f32_16x16x32_bf16 a[108:111], a[228:231], v[100:103], a[108:111]
  ds_read_b64_tr_b16 a[254:255], v15 offset:63488
  s_waitcnt lgkmcnt(8)
  v_mfma_f32_16x16x32_bf16 a[96:99], a[232:235], v[104:107], a[96:99]
  s_cbranch_vccz L_csO_1_4
L_cbO_1_4:
  ds_read_b64_tr_b16 a[224:225], v12 offset:40960
  v_mfma_f32_16x16x32_bf16 a[100:103], a[232:235], v[108:111], a[100:103]
  ds_read_b64_tr_b16 a[226:227], v12 offset:43008
  v_mfma_f32_16x16x32_bf16 a[104:107], a[236:239], v[104:107], a[104:107]
  ds_read_b64_tr_b16 a[228:229], v13 offset:40960
  v_mfma_f32_16x16x32_bf16 a[108:111], a[236:239], v[108:111], a[108:111]
  ds_read_b64_tr_b16 a[230:231], v13 offset:43008
  s_waitcnt lgkmcnt(8)
  v_mfma_f32_16x16x32_bf16 a[112:115], a[240:243], v[96:99], a[112:115]
  ds_read_b64_tr_b16 a[232:233], v14 offset:40960
  v_mfma_f32_16x16x32_bf16 a[116:119], a[240:243], v[100:103], a[116:119]
  ds_read_b64_tr_b16 a[234:235], v14 offset:43008
  v_mfma_f32_16x16x32_bf16 a[120:123], a[244:247], v[96:99], a[120:123]
  ds_read_b64_tr_b16 a[236:237], v15 offset:40960
  ds_read_b32 v3, v2 offset:2048
  v_mfma_f32_16x16x32_bf16 a[124:127], a[244:247], v[100:103], a[124:127]
  ds_read_b64_tr_b16 a[238:239], v15 offset:43008
  s_mul_i32 s63, s100, 12288
  s_waitcnt lgkmcnt(9)
  v_mfma_f32_16x16x32_bf16 a[112:115], a[248:251], v[104:107], a[112:115]
  ds_read_b64_tr_b16 a[240:241], v12 offset:45056
  s_add_u32 s63, s63, s65
  v_accvgpr_read_b32 v176, a96
  v_mfma_f32_16x16x32_bf16 a[116:119], a[248:251], v[108:111], a[116:119]
  ds_read_b64_tr_b16 a[242:243], v12 offset:47104
  v_accvgpr_read_b32 v177, a97
  v_accvgpr_read_b32 v178, a98
  v_mfma_f32_16x16x32_bf16 a[120:123], a[252:255], v[104:107], a[120:123]
  ds_read_b64_tr_b16 a[244:245], v13 offset:45056
  v_accvgpr_read_b32 v179, a99
  v_accvgpr_read_b32 v180, a104
  v_mfma_f32_16x16x32_bf16 a[124:127], a[252:255], v[108:111], a[124:127]
  ds_read_b64_tr_b16 a[246:247], v13 offset:47104
  s_waitcnt lgkmcnt(9)
  v_mfma_f32_16x16x32_bf16 a[128:131], a[224:227], v[48:51], a[128:131]
  ds_read_b64_tr_b16 a[248:249], v14 offset:45056
  v_accvgpr_read_b32 v181, a105
  v_accvgpr_read_b32 v182, a106
  v_mfma_f32_16x16x32_bf16 a[132:135], a[224:227], v[52:55], a[132:135]
  ds_read_b64_tr_b16 a[250:251], v14 offset:47104
  v_accvgpr_read_b32 v183, a107
  v_cvt_pk_bf16_f32 v192, v176, v177
  v_mfma_f32_16x16x32_bf16 a[136:139], a[228:231], v[48:51], a[136:139]
  ds_read_b64_tr_b16 a[252:253], v15 offset:45056
  s_waitcnt lgkmcnt(8)
  v_cmp_le_u32 vcc, 0xb003003f, v3
  v_cvt_pk_bf16_f32 v193, v178, v179
  v_mfma_f32_16x16x32_bf16 a[140:143], a[228:231], v[52:55], a[140:143]
  ds_read_b64_tr_b16 a[254:255], v15 offset:47104
  v_cvt_pk_bf16_f32 v194, v180, v181
  s_waitcnt lgkmcnt(8)
  v_mfma_f32_16x16x32_bf16 a[144:147], a[232:235], v[48:51], a[144:147]
  s_cbranch_vccz L_csO_2_4
L_cbO_2_4:
  v_subrev_u32 v12, 65536, v12
  ds_read_b64_tr_b16 a[224:225], v12 offset:16384
  v_cvt_pk_bf16_f32 v195, v182, v183
  v_mfma_f32_16x16x32_bf16 a[148:151], a[232:235], v[52:55], a[148:151]
  ds_read_b64_tr_b16 a[226:227], v12 offset:18432
  buffer_store_dwordx4 v[192:195], v5, s[44:47], s63 offen offset:0 sc1
  v_mfma_f32_16x16x32_bf16 a[152:155], a[236:239], v[48:51], a[152:155]
  v_subrev_u32 v13, 65536, v13
  ds_read_b64_tr_b16 a[228:229], v13 offset:16384
  v_accvgpr_read_b32 v184, a100
  v_accvgpr_read_b32 v185, a101
  v_mfma_f32_16x16x32_bf16 a[156:159], a[236:239], v[52:55], a[156:159]
  ds_read_b64_tr_b16 a[230:231], v13 offset:18432
  v_accvgpr_read_b32 v186, a102
  s_waitcnt lgkmcnt(8)
  v_mfma_f32_16x16x32_bf16 a[128:131], a[240:243], v[56:59], a[128:131]
  v_subrev_u32 v14, 65536, v14
  ds_read_b64_tr_b16 a[232:233], v14 offset:16384
  v_accvgpr_read_b32 v187, a103
  v_accvgpr_read_b32 v188, a108
  v_mfma_f32_16x16x32_bf16 a[132:135], a[240:243], v[60:63], a[132:135]
  ds_read_b64_tr_b16 a[234:235], v14 offset:18432
  v_accvgpr_read_b32 v189, a109
  v_mfma_f32_16x16x32_bf16 a[136:139], a[244:247], v[56:59], a[136:139]
  v_subrev_u32 v15, 65536, v15
  ds_read_b64_tr_b16 a[236:237], v15 offset:16384
  ds_read_b32 v3, v2 offset:2048
  v_accvgpr_read_b32 v190, a110
  v_mfma_f32_16x16x32_bf16 a[140:143], a[244:247], v[60:63], a[140:143]
  ds_read_b64_tr_b16 a[238:239], v15 offset:18432
  v_accvgpr_read_b32 v191, a111
  s_waitcnt lgkmcnt(9)
  v_mfma_f32_16x16x32_bf16 a[144:147], a[248:251], v[56:59], a[144:147]
  ds_read_b64_tr_b16 a[240:241], v12 offset:20480
  v_cvt_pk_bf16_f32 v196, v184, v185
  v_cvt_pk_bf16_f32 v197, v186, v187
  v_mfma_f32_16x16x32_bf16 a[148:151], a[248:251], v[60:63], a[148:151]
  ds_read_b64_tr_b16 a[242:243], v12 offset:22528
  v_cvt_pk_bf16_f32 v198, v188, v189
  v_cvt_pk_bf16_f32 v199, v190, v191
  v_mfma_f32_16x16x32_bf16 a[152:155], a[252:255], v[56:59], a[152:155]
  ds_read_b64_tr_b16 a[244:245], v13 offset:20480
  buffer_store_dwordx4 v[196:199], v5, s[44:47], s63 offen offset:2048 sc1
  v_mfma_f32_16x16x32_bf16 a[156:159], a[252:255], v[60:63], a[156:159]
  ds_read_b64_tr_b16 a[246:247], v13 offset:22528
  v_accvgpr_read_b32 v200, a112
  s_waitcnt lgkmcnt(9)
  v_mfma_f32_16x16x32_bf16 a[128:131], a[224:227], v[64:67], a[128:131]
  ds_read_b64_tr_b16 a[248:249], v14 offset:20480
  v_accvgpr_read_b32 v201, a113
  v_accvgpr_read_b32 v202, a114
  v_mfma_f32_16x16x32_bf16 a[132:135], a[224:227], v[68:71], a[132:135]
  ds_read_b64_tr_b16 a[250:251], v14 offset:22528
  v_accvgpr_read_b32 v203, a115
  v_accvgpr_read_b32 v204, a120
  v_mfma_f32_16x16x32_bf16 a[136:139], a[228:231], v[64:67], a[136:139]
  ds_read_b64_tr_b16 a[252:253], v15 offset:20480
  s_waitcnt lgkmcnt(8)
  v_cmp_le_u32 vcc, 0xb0030040, v3
  v_accvgpr_read_b32 v205, a121
  v_mfma_f32_16x16x32_bf16 a[140:143], a[228:231], v[68:71], a[140:143]
  ds_read_b64_tr_b16 a[254:255], v15 offset:22528
  v_accvgpr_read_b32 v206, a122
  s_waitcnt lgkmcnt(8)
  v_mfma_f32_16x16x32_bf16 a[144:147], a[232:235], v[64:67], a[144:147]
  s_cbranch_vccz L_csO_3_4
L_cbO_3_4:
  ds_read_b64_tr_b16 a[224:225], v12 offset:24576
  v_accvgpr_read_b32 v207, a123
  v_mfma_f32_16x16x32_bf16 a[148:151], a[232:235], v[68:71], a[148:151]
  ds_read_b64_tr_b16 a[226:227], v12 offset:26624
  v_cvt_pk_bf16_f32 v216, v200, v201
  v_cvt_pk_bf16_f32 v217, v202, v203
  v_mfma_f32_16x16x32_bf16 a[152:155], a[236:239], v[64:67], a[152:155]
  ds_read_b64_tr_b16 a[228:229], v13 offset:24576
  v_cvt_pk_bf16_f32 v218, v204, v205
  v_cvt_pk_bf16_f32 v219, v206, v207
  v_mfma_f32_16x16x32_bf16 a[156:159], a[236:239], v[68:71], a[156:159]
  ds_read_b64_tr_b16 a[230:231], v13 offset:26624
  buffer_store_dwordx4 v[216:219], v5, s[44:47], s63 offen offset:256 sc1
  s_waitcnt lgkmcnt(8)
  v_mfma_f32_16x16x32_bf16 a[128:131], a[240:243], v[72:75], a[128:131]
  ds_read_b64_tr_b16 a[232:233], v12 offset:28672
  v_accvgpr_read_b32 v208, a116
  v_accvgpr_read_b32 v209, a117
  v_mfma_f32_16x16x32_bf16 a[132:135], a[240:243], v[76:79], a[132:135]
  ds_read_b64_tr_b16 a[234:235], v12 offset:30720
  v_accvgpr_read_b32 v210, a118
  v_mfma_f32_16x16x32_bf16 a[136:139], a[244:247], v[72:75], a[136:139]
  ds_read_b64_tr_b16 a[236:237], v13 offset:28672
  ds_read_b32 v3, v2 offset:2048
  v_accvgpr_read_b32 v211, a119
  v_mfma_f32_16x16x32_bf16 a[140:143], a[244:247], v[76:79], a[140:143]
  ds_read_b64_tr_b16 a[238:239], v13 offset:30720
  v_accvgpr_read_b32 v212, a124
  s_waitcnt lgkmcnt(9)
  v_mfma_f32_16x16x32_bf16 a[144:147], a[248:251], v[72:75], a[144:147]
  ds_read_b64_tr_b16 a[240:241], v14 offset:24576
  v_accvgpr_read_b32 v213, a125
  v_accvgpr_read_b32 v214, a126
  v_mfma_f32_16x16x32_bf16 a[148:151], a[248:251], v[76:79], a[148:151]
  ds_read_b64_tr_b16 a[242:243], v14 offset:26624
  v_accvgpr_read_b32 v215, a127
  v_cvt_pk_bf16_f32 v220, v208, v209
  v_mfma_f32_16x16x32_bf16 a[152:155], a[252:255], v[72:75], a[152:155]
  ds_read_b64_tr_b16 a[244:245], v15 offset:24576
  v_cvt_pk_bf16_f32 v221, v210, v211
  v_cvt_pk_bf16_f32 v222, v212, v213
  v_mfma_f32_16x16x32_bf16 a[156:159], a[252:255], v[76:79], a[156:159]
  ds_read_b64_tr_b16 a[246:247], v15 offset:26624
  v_cvt_pk_bf16_f32 v223, v214, v215
  s_waitcnt lgkmcnt(9)
  v_mfma_f32_16x16x32_bf16 a[128:131], a[224:227], v[96:99], a[128:131]
  ds_read_b64_tr_b16 a[248:249], v14 offset:28672
  buffer_store_dwordx4 v[220:223], v5, s[44:47], s63 offen offset:2304 sc1
  s_cmp_eq_u32 s100, 6
  s_cselect_b32 s100, -1, s100
  v_mfma_f32_16x16x32_bf16 a[132:135], a[224:227], v[100:103], a[132:135]
  ds_read_b64_tr_b16 a[250:251], v14 offset:30720
  s_add_u32 s100, s100, 1
  v_mfma_f32_16x16x32_bf16 a[136:139], a[228:231], v[96:99], a[136:139]
  ds_read_b64_tr_b16 a[252:253], v15 offset:28672
  s_waitcnt lgkmcnt(8)
  v_cmp_le_u32 vcc, 0xb0030041, v3
  v_mfma_f32_16x16x32_bf16 a[140:143], a[228:231], v[100:103], a[140:143]
  ds_read_b64_tr_b16 a[254:255], v15 offset:30720
  s_waitcnt lgkmcnt(8)
  v_mfma_f32_16x16x32_bf16 a[128:131], a[232:235], v[104:107], a[128:131]
  s_cbranch_vccz L_csO_1_5
L_cbO_1_5:
  ds_read_b64_tr_b16 a[224:225], v12 offset:49152
  v_mfma_f32_16x16x32_bf16 a[132:135], a[232:235], v[108:111], a[132:135]
  ds_read_b64_tr_b16 a[226:227], v12 offset:51200
  v_mfma_f32_16x16x32_bf16 a[136:139], a[236:239], v[104:107], a[136:139]
  ds_read_b64_tr_b16 a[228:229], v13 offset:49152
  v_mfma_f32_16x16x32_bf16 a[140:143], a[236:239], v[108:111], a[140:143]
  ds_read_b64_tr_b16 a[230:231], v13 offset:51200
  s_waitcnt lgkmcnt(8)
  v_mfma_f32_16x16x32_bf16 a[144:147], a[240:243], v[96:99], a[144:147]
  ds_read_b64_tr_b16 a[232:233], v14 offset:49152
  v_mfma_f32_16x16x32_bf16 a[148:151], a[240:243], v[100:103], a[148:151]
  ds_read_b64_tr_b16 a[234:235], v14 offset:51200
  v_mfma_f32_16x16x32_bf16 a[152:155], a[244:247], v[96:99], a[152:155]
  ds_read_b64_tr_b16 a[236:237], v15 offset:49152
  ds_read_b32 v3, v2 offset:2048
  v_mfma_f32_16x16x32_bf16 a[156:159], a[244:247], v[100:103], a[156:159]
  ds_read_b64_tr_b16 a[238:239], v15 offset:51200
  s_mul_i32 s63, s100, 12288
  s_waitcnt lgkmcnt(9)
  v_mfma_f32_16x16x32_bf16 a[144:147], a[248:251], v[104:107], a[144:147]
  ds_read_b64_tr_b16 a[240:241], v12 offset:53248
  s_add_u32 s63, s63, s65
  v_accvgpr_read_b32 v128, a128
  v_mfma_f32_16x16x32_bf16 a[148:151], a[248:251], v[108:111], a[148:151]
  ds_read_b64_tr_b16 a[242:243], v12 offset:55296
  v_accvgpr_read_b32 v129, a129
  v_accvgpr_read_b32 v130, a130
  v_mfma_f32_16x16x32_bf16 a[152:155], a[252:255], v[104:107], a[152:155]
  ds_read_b64_tr_b16 a[244:245], v13 offset:53248
  v_accvgpr_read_b32 v131, a131
  v_accvgpr_read_b32 v132, a136
  v_mfma_f32_16x16x32_bf16 a[156:159], a[252:255], v[108:111], a[156:159]
  ds_read_b64_tr_b16 a[246:247], v13 offset:55296
  s_waitcnt lgkmcnt(9)
  v_mfma_f32_16x16x32_bf16 a[160:163], a[224:227], v[48:51], a[160:163]
  ds_read_b64_tr_b16 a[248:249], v14 offset:53248
  v_accvgpr_read_b32 v133, a137
  v_accvgpr_read_b32 v134, a138
  v_mfma_f32_16x16x32_bf16 a[164:167], a[224:227], v[52:55], a[164:167]
  ds_read_b64_tr_b16 a[250:251], v14 offset:55296
  v_accvgpr_read_b32 v135, a139
  v_cvt_pk_bf16_f32 v144, v128, v129
  v_mfma_f32_16x16x32_bf16 a[168:171], a[228:231], v[48:51], a[168:171]
  ds_read_b64_tr_b16 a[252:253], v15 offset:53248
  s_waitcnt lgkmcnt(8)
  v_cmp_le_u32 vcc, 0xb0030042, v3
  v_cvt_pk_bf16_f32 v145, v130, v131
  v_mfma_f32_16x16x32_bf16 a[172:175], a[228:231], v[52:55], a[172:175]
  ds_read_b64_tr_b16 a[254:255], v15 offset:55296
  v_cvt_pk_bf16_f32 v146, v132, v133
  s_waitcnt lgkmcnt(8)
  v_mfma_f32_16x16x32_bf16 a[176:179], a[232:235], v[48:51], a[176:179]
  s_cbranch_vccz L_csO_2_5
L_cbO_2_5:
  ds_read_b64_tr_b16 a[224:225], v12 offset:57344
  v_cvt_pk_bf16_f32 v147, v134, v135
  v_mfma_f32_16x16x32_bf16 a[180:183], a[232:235], v[52:55], a[180:183]
  ds_read_b64_tr_b16 a[226:227], v12 offset:59392
  buffer_store_dwordx4 v[144:147], v5, s[44:47], s63 offen offset:0 sc1
  v_mfma_f32_16x16x32_bf16 a[184:187], a[236:239], v[48:51], a[184:187]
  ds_read_b64_tr_b16 a[228:229], v13 offset:57344
  v_accvgpr_read_b32 v136, a132
  v_accvgpr_read_b32 v137, a133
  v_mfma_f32_16x16x32_bf16 a[188:191], a[236:239], v[52:55], a[188:191]
  ds_read_b64_tr_b16 a[230:231], v13 offset:59392
  v_accvgpr_read_b32 v138, a134
  s_waitcnt lgkmcnt(8)
  v_mfma_f32_16x16x32_bf16 a[160:163], a[240:243], v[56:59], a[160:163]
  ds_read_b64_tr_b16 a[232:233], v14 offset:57344
  v_accvgpr_read_b32 v139, a135
  v_accvgpr_read_b32 v140, a140
  v_mfma_f32_16x16x32_bf16 a[164:167], a[240:243], v[60:63], a[164:167]
  ds_read_b64_tr_b16 a[234:235], v14 offset:59392
  v_accvgpr_read_b32 v141, a141
  v_mfma_f32_16x16x32_bf16 a[168:171], a[244:247], v[56:59], a[168:171]
  ds_read_b64_tr_b16 a[236:237], v15 offset:57344
  ds_read_b32 v3, v2 offset:2048
  v_accvgpr_read_b32 v142, a142
  v_mfma_f32_16x16x32_bf16 a[172:175], a[244:247], v[60:63], a[172:175]
  ds_read_b64_tr_b16 a[238:239], v15 offset:59392
  v_accvgpr_read_b32 v143, a143
  s_waitcnt lgkmcnt(9)
  v_mfma_f32_16x16x32_bf16 a[176:179], a[248:251], v[56:59], a[176:179]
  ds_read_b64_tr_b16 a[240:241], v12 offset:61440
  v_cvt_pk_bf16_f32 v148, v136, v137
  v_cvt_pk_bf16_f32 v149, v138, v139
  v_mfma_f32_16x16x32_bf16 a[180:183], a[248:251], v[60:63], a[180:183]
  ds_read_b64_tr_b16 a[242:243], v12 offset:63488
  v_cvt_pk_bf16_f32 v150, v140, v141
  v_cvt_pk_bf16_f32 v151, v142, v143
  v_mfma_f32_16x16x32_bf16 a[184:187], a[252:255], v[56:59], a[184:187]
  ds_read_b64_tr_b16 a[244:245], v13 offset:61440
  buffer_store_dwordx4 v[148:151], v5, s[44:47], s63 offen offset:2048 sc1
  v_mfma_f32_16x16x32_bf16 a[188:191], a[252:255], v[60:63], a[188:191]
  ds_read_b64_tr_b16 a[246:247], v13 offset:63488
  v_accvgpr_read_b32 v152, a144
  v_accvgpr_read_b32 v153, a145
  s_waitcnt lgkmcnt(9)
  v_mfma_f32_16x16x32_bf16 a[160:163], a[224:227], v[64:67], a[160:163]
  ds_read_b64_tr_b16 a[248:249], v14 offset:61440
  v_accvgpr_read_b32 v154, a146
  v_accvgpr_read_b32 v155, a147
  v_mfma_f32_16x16x32_bf16 a[164:167], a[224:227], v[68:71], a[164:167]
  ds_read_b64_tr_b16 a[250:251], v14 offset:63488
  v_accvgpr_read_b32 v156, a152
  v_accvgpr_read_b32 v157, a153
  v_mfma_f32_16x16x32_bf16 a[168:171], a[228:231], v[64:67], a[168:171]
  ds_read_b64_tr_b16 a[252:253], v15 offset:61440
  s_waitcnt lgkmcnt(8)
  v_cmp_le_u32 vcc, 0xb0030043, v3
  v_accvgpr_read_b32 v158, a154
  v_mfma_f32_16x16x32_bf16 a[172:175], a[228:231], v[68:71], a[172:175]
  ds_read_b64_tr_b16 a[254:255], v15 offset:63488
  v_accvgpr_read_b32 v159, a155
  s_waitcnt lgkmcnt(8)
  v_mfma_f32_16x16x32_bf16 a[176:179], a[232:235], v[64:67], a[176:179]
  s_cbranch_vccz L_csO_3_5
L_cbO_3_5:
  ds_read_b64_tr_b16 a[224:225], v12 offset:32768
  v_cvt_pk_bf16_f32 v168, v152, v153
  v_mfma_f32_16x16x32_bf16 a[180:183], a[232:235], v[68:71], a[180:183]
  ds_read_b64_tr_b16 a[226:227], v12 offset:34816
  v_cvt_pk_bf16_f32 v169, v154, v155
  v_cvt_pk_bf16_f32 v170, v156, v157
  v_mfma_f32_16x16x32_bf16 a[184:187], a[236:239], v[64:67], a[184:187]
  ds_read_b64_tr_b16 a[228:229], v13 offset:32768
  v_cvt_pk_bf16_f32 v171, v158, v159
  buffer_store_dwordx4 v[168:171], v5, s[44:47], s63 offen offset:256 sc1
  v_mfma_f32_16x16x32_bf16 a[188:191], a[236:239], v[68:71], a[188:191]
  ds_read_b64_tr_b16 a[230:231], v13 offset:34816
  v_accvgpr_read_b32 v160, a148
  s_waitcnt lgkmcnt(8)
  v_mfma_f32_16x16x32_bf16 a[160:163], a[240:243], v[72:75], a[160:163]
  ds_read_b64_tr_b16 a[232:233], v12 offset:36864
  v_accvgpr_read_b32 v161, a149
  v_accvgpr_read_b32 v162, a150
  v_mfma_f32_16x16x32_bf16 a[164:167], a[240:243], v[76:79], a[164:167]
  ds_read_b64_tr_b16 a[234:235], v12 offset:38912
  v_accvgpr_read_b32 v163, a151
  v_accvgpr_read_b32 v164, a156
  v_mfma_f32_16x16x32_bf16 a[168:171], a[244:247], v[72:75], a[168:171]
  ds_read_b64_tr_b16 a[236:237], v13 offset:36864
  ds_read_b32 v3, v2 offset:2048
  s_waitcnt vmcnt(3)
  v_mov_b32 v8, 1
  ds_add_rtn_u32 v18, v30, v4 offset:1024
  v_mfma_f32_16x16x32_bf16 a[172:175], a[244:247], v[76:79], a[172:175]
  ds_read_b64_tr_b16 a[238:239], v13 offset:38912
  v_accvgpr_read_b32 v165, a157
  s_waitcnt lgkmcnt(10)
  v_mfma_f32_16x16x32_bf16 a[176:179], a[248:251], v[72:75], a[176:179]
  ds_read_b64_tr_b16 a[240:241], v14 offset:32768
  v_accvgpr_read_b32 v166, a158
  v_accvgpr_read_b32 v167, a159
  v_mfma_f32_16x16x32_bf16 a[180:183], a[248:251], v[76:79], a[180:183]
  ds_read_b64_tr_b16 a[242:243], v14 offset:34816
  v_cvt_pk_bf16_f32 v172, v160, v161
  v_cvt_pk_bf16_f32 v173, v162, v163
  v_mfma_f32_16x16x32_bf16 a[184:187], a[252:255], v[72:75], a[184:187]
  ds_read_b64_tr_b16 a[244:245], v15 offset:32768
  v_cvt_pk_bf16_f32 v174, v164, v165
  v_cvt_pk_bf16_f32 v175, v166, v167
  v_mfma_f32_16x16x32_bf16 a[188:191], a[252:255], v[76:79], a[188:191]
  ds_read_b64_tr_b16 a[246:247], v15 offset:34816
  buffer_store_dwordx4 v[172:175], v5, s[44:47], s63 offen offset:2304 sc1
  s_waitcnt lgkmcnt(10)
  v_mfma_f32_16x16x32_bf16 a[160:163], a[224:227], v[96:99], a[160:163]
  ds_read_b64_tr_b16 a[248:249], v14 offset:36864
  s_waitcnt lgkmcnt(6)
  v_cmp_eq_u32 s[66:67], 2, v18
  s_nop 1
  v_cndmask_b32 v18, v2, v19, s[66:67]
  buffer_store_dword v8, v18, s[96:99], 0 offen sc1
  v_mfma_f32_16x16x32_bf16 a[164:167], a[224:227], v[100:103], a[164:167]
  ds_read_b64_tr_b16 a[250:251], v14 offset:38912
  s_cmp_eq_u32 s100, 6
  s_cselect_b32 s100, -1, s100
  v_mfma_f32_16x16x32_bf16 a[168:171], a[228:231], v[96:99], a[168:171]
  ds_read_b64_tr_b16 a[252:253], v15 offset:36864
  v_cmp_le_u32 vcc, 0xb0030044, v3
  s_add_u32 s100, s100, 1
  v_mfma_f32_16x16x32_bf16 a[172:175], a[228:231], v[100:103], a[172:175]
  ds_read_b64_tr_b16 a[254:255], v15 offset:38912
  s_waitcnt lgkmcnt(8)
  v_mfma_f32_16x16x32_bf16 a[160:163], a[232:235], v[104:107], a[160:163]
  s_cbranch_vccz L_csO_1_6
L_cbO_1_6:
  ds_read_b64_tr_b16 a[224:225], v12 offset:40960
  ds_read_b32 v3, v2 offset:2048
  v_mfma_f32_16x16x32_bf16 a[164:167], a[232:235], v[108:111], a[164:167]
  ds_read_b64_tr_b16 a[226:227], v12 offset:43008
  v_mfma_f32_16x16x32_bf16 a[168:171], a[236:239], v[104:107], a[168:171]
  ds_read_b64_tr_b16 a[228:229], v13 offset:40960
  v_mfma_f32_16x16x32_bf16 a[172:175], a[236:239], v[108:111], a[172:175]
  ds_read_b64_tr_b16 a[230:231], v13 offset:43008
  s_waitcnt lgkmcnt(9)
  v_mfma_f32_16x16x32_bf16 a[176:179], a[240:243], v[96:99], a[176:179]
  ds_read_b64_tr_b16 a[232:233], v12 offset:45056
  v_mfma_f32_16x16x32_bf16 a[180:183], a[240:243], v[100:103], a[180:183]
  ds_read_b64_tr_b16 a[234:235], v12 offset:47104
  v_mfma_f32_16x16x32_bf16 a[184:187], a[244:247], v[96:99], a[184:187]
  ds_read_b64_tr_b16 a[236:237], v13 offset:45056
  s_waitcnt lgkmcnt(6)
  v_cmp_le_u32 vcc, 0xb0030045, v3
  v_mfma_f32_16x16x32_bf16 a[188:191], a[244:247], v[100:103], a[188:191]
  ds_read_b64_tr_b16 a[238:239], v13 offset:47104
  s_mul_i32 s63, s100, 12288
  v_mfma_f32_16x16x32_bf16 a[176:179], a[248:251], v[104:107], a[176:179]
  s_cbranch_vccz L_csO_2_6
L_cbO_2_6:
  v_add_u32 v12, 131072, v12
  ds_read_b64_tr_b16 a[240:241], v12 offset:0
  ds_read_b32 v3, v2 offset:2048
  v_mfma_f32_16x16x32_bf16 a[180:183], a[248:251], v[108:111], a[180:183]
  ds_read_b64_tr_b16 a[242:243], v12 offset:2048
  s_add_u32 s63, s63, s65
  v_accvgpr_read_b32 v176, a160
  v_mfma_f32_16x16x32_bf16 a[184:187], a[252:255], v[104:107], a[184:187]
  v_add_u32 v13, 131072, v13
  ds_read_b64_tr_b16 a[244:245], v13 offset:0
  v_accvgpr_read_b32 v177, a161
  v_accvgpr_read_b32 v178, a162
  v_mfma_f32_16x16x32_bf16 a[188:191], a[252:255], v[108:111], a[188:191]
  ds_read_b64_tr_b16 a[246:247], v13 offset:2048
  v_accvgpr_read_b32 v179, a163
  s_waitcnt lgkmcnt(9)
  v_mfma_f32_16x16x32_bf16 a[192:195], a[224:227], v[48:51], a[192:195]
  ds_read_b64_tr_b16 a[248:249], v12 offset:4096
  v_accvgpr_read_b32 v180, a168
  v_accvgpr_read_b32 v181, a169
  v_mfma_f32_16x16x32_bf16 a[196:199], a[224:227], v[52:55], a[196:199]
  ds_read_b64_tr_b16 a[250:251], v12 offset:6144
  v_accvgpr_read_b32 v182, a170
  v_accvgpr_read_b32 v183, a171
  v_mfma_f32_16x16x32_bf16 a[200:203], a[228:231], v[48:51], a[200:203]
  ds_read_b64_tr_b16 a[252:253], v13 offset:4096
  s_waitcnt lgkmcnt(6)
  v_cmp_le_u32 vcc, 0xb0030046, v3
  v_mfma_f32_16x16x32_bf16 a[204:207], a[228:231], v[52:55], a[204:207]
  ds_read_b64_tr_b16 a[254:255], v13 offset:6144
  v_cvt_pk_bf16_f32 v192, v176, v177
  v_mfma_f32_16x16x32_bf16 a[192:195], a[232:235], v[56:59], a[192:195]
  s_cbranch_vccz L_csO_3_6
L_cbO_3_6:
  ds_read_b64_tr_b16 a[224:225], v12 offset:20480
  v_cvt_pk_bf16_f32 v193, v178, v179
  v_mfma_f32_16x16x32_bf16 a[196:199], a[232:235], v[60:63], a[196:199]
  ds_read_b64_tr_b16 a[226:227], v12 offset:22528
  v_cvt_pk_bf16_f32 v194, v180, v181
  v_cvt_pk_bf16_f32 v195, v182, v183
  v_mfma_f32_16x16x32_bf16 a[200:203], a[236:239], v[56:59], a[200:203]
  ds_read_b64_tr_b16 a[228:229], v13 offset:20480
  buffer_store_dwordx4 v[192:195], v5, s[44:47], s63 offen offset:0 sc1
  v_accvgpr_read_b32 v184, a164
  v_mfma_f32_16x16x32_bf16 a[204:207], a[236:239], v[60:63], a[204:207]
  ds_read_b64_tr_b16 a[230:231], v13 offset:22528
  v_accvgpr_read_b32 v185, a165
  s_waitcnt lgkmcnt(8)
  v_mfma_f32_16x16x32_bf16 a[192:195], a[240:243], v[64:67], a[192:195]
  ds_read_b64_tr_b16 a[232:233], v12 offset:24576
  v_accvgpr_read_b32 v186, a166
  v_accvgpr_read_b32 v187, a167
  v_mfma_f32_16x16x32_bf16 a[196:199], a[240:243], v[68:71], a[196:199]
  ds_read_b64_tr_b16 a[234:235], v12 offset:26624
  v_accvgpr_read_b32 v188, a172
  v_mfma_f32_16x16x32_bf16 a[200:203], a[244:247], v[64:67], a[200:203]
  ds_read_b64_tr_b16 a[236:237], v13 offset:24576
  v_accvgpr_read_b32 v189, a173
  v_accvgpr_read_b32 v190, a174
  v_mfma_f32_16x16x32_bf16 a[204:207], a[244:247], v[68:71], a[204:207]
  ds_read_b64_tr_b16 a[238:239], v13 offset:26624
  v_accvgpr_read_b32 v191, a175
  s_waitcnt lgkmcnt(8)
  v_mfma_f32_16x16x32_bf16 a[192:195], a[248:251], v[72:75], a[192:195]
  ds_read_b64_tr_b16 a[240:241], v14 offset:40960
  v_cvt_pk_bf16_f32 v196, v184, v185
  v_cvt_pk_bf16_f32 v197, v186, v187
  v_mfma_f32_16x16x32_bf16 a[196:199], a[248:251], v[76:79], a[196:199]
  ds_read_b64_tr_b16 a[242:243], v14 offset:43008
  v_cvt_pk_bf16_f32 v198, v188, v189
  v_cvt_pk_bf16_f32 v199, v190, v191
  v_mfma_f32_16x16x32_bf16 a[200:203], a[252:255], v[72:75], a[200:203]
  ds_read_b64_tr_b16 a[244:245], v15 offset:40960
  buffer_store_dwordx4 v[196:199], v5, s[44:47], s63 offen offset:2048 sc1
  v_mfma_f32_16x16x32_bf16 a[204:207], a[252:255], v[76:79], a[204:207]
  ds_read_b64_tr_b16 a[246:247], v15 offset:43008
  v_accvgpr_read_b32 v200, a176
  s_waitcnt lgkmcnt(8)
  v_mfma_f32_16x16x32_bf16 a[192:195], a[224:227], v[96:99], a[192:195]
  ds_read_b64_tr_b16 a[248:249], v14 offset:45056
  v_accvgpr_read_b32 v201, a177
  v_accvgpr_read_b32 v202, a178
  v_mfma_f32_16x16x32_bf16 a[196:199], a[224:227], v[100:103], a[196:199]
  ds_read_b64_tr_b16 a[250:251], v14 offset:47104
  v_accvgpr_read_b32 v203, a179
  v_accvgpr_read_b32 v204, a184
  v_mfma_f32_16x16x32_bf16 a[200:203], a[228:231], v[96:99], a[200:203]
  ds_read_b64_tr_b16 a[252:253], v15 offset:45056
  v_accvgpr_read_b32 v205, a185
  v_mfma_f32_16x16x32_bf16 a[204:207], a[228:231], v[100:103], a[204:207]
  ds_read_b64_tr_b16 a[254:255], v15 offset:47104
  v_accvgpr_read_b32 v206, a186
  s_waitcnt lgkmcnt(8)
  v_mfma_f32_16x16x32_bf16 a[192:195], a[232:235], v[104:107], a[192:195]
  v_add_u32 v14, 131072, v14
  ds_read_b64_tr_b16 a[224:225], v14 offset:0
  v_accvgpr_read_b32 v207, a187
  v_cvt_pk_bf16_f32 v216, v200, v201
  v_mfma_f32_16x16x32_bf16 a[196:199], a[232:235], v[108:111], a[196:199]
  ds_read_b64_tr_b16 a[226:227], v14 offset:2048
  v_cvt_pk_bf16_f32 v217, v202, v203
  v_mfma_f32_16x16x32_bf16 a[200:203], a[236:239], v[104:107], a[200:203]
  v_add_u32 v15, 131072, v15
  ds_read_b64_tr_b16 a[228:229], v15 offset:0
  v_cvt_pk_bf16_f32 v218, v204, v205
  v_cvt_pk_bf16_f32 v219, v206, v207
  v_mfma_f32_16x16x32_bf16 a[204:207], a[236:239], v[108:111], a[204:207]
  ds_read_b64_tr_b16 a[230:231], v15 offset:2048
  buffer_store_dwordx4 v[216:219], v5, s[44:47], s63 offen offset:256 sc1
  s_waitcnt lgkmcnt(8)
  v_mfma_f32_16x16x32_bf16 a[208:211], a[240:243], v[48:51], a[208:211]
  ds_read_b64_tr_b16 a[232:233], v14 offset:4096
  v_accvgpr_read_b32 v208, a180
  v_accvgpr_read_b32 v209, a181
  v_mfma_f32_16x16x32_bf16 a[212:215], a[240:243], v[52:55], a[212:215]
  ds_read_b64_tr_b16 a[234:235], v14 offset:6144
  v_accvgpr_read_b32 v210, a182
  v_mfma_f32_16x16x32_bf16 a[216:219], a[244:247], v[48:51], a[216:219]
  ds_read_b64_tr_b16 a[236:237], v15 offset:4096
  v_accvgpr_read_b32 v211, a183
  v_accvgpr_read_b32 v212, a188
  v_mfma_f32_16x16x32_bf16 a[220:223], a[244:247], v[52:55], a[220:223]
  ds_read_b64_tr_b16 a[238:239], v15 offset:6144
  v_accvgpr_read_b32 v213, a189
  s_waitcnt lgkmcnt(8)
  v_mfma_f32_16x16x32_bf16 a[208:211], a[248:251], v[56:59], a[208:211]
  ds_read_b64_tr_b16 a[240:241], v14 offset:20480
  v_accvgpr_read_b32 v214, a190
  v_mfma_f32_16x16x32_bf16 a[212:215], a[248:251], v[60:63], a[212:215]
  ds_read_b64_tr_b16 a[242:243], v14 offset:22528
  v_accvgpr_read_b32 v215, a191
  v_cvt_pk_bf16_f32 v220, v208, v209
  v_mfma_f32_16x16x32_bf16 a[216:219], a[252:255], v[56:59], a[216:219]
  ds_read_b64_tr_b16 a[244:245], v15 offset:20480
  v_cvt_pk_bf16_f32 v221, v210, v211
  v_cvt_pk_bf16_f32 v222, v212, v213
  v_mfma_f32_16x16x32_bf16 a[220:223], a[252:255], v[60:63], a[220:223]
  ds_read_b64_tr_b16 a[246:247], v15 offset:22528
  v_cvt_pk_bf16_f32 v223, v214, v215
  s_waitcnt lgkmcnt(8)
  v_mfma_f32_16x16x32_bf16 a[208:211], a[224:227], v[64:67], a[208:211]
  ds_read_b64_tr_b16 a[248:249], v14 offset:24576
  buffer_store_dwordx4 v[220:223], v5, s[44:47], s63 offen offset:2304 sc1
  v_mfma_f32_16x16x32_bf16 a[212:215], a[224:227], v[68:71], a[212:215]
  ds_read_b64_tr_b16 a[250:251], v14 offset:26624
  s_cmp_eq_u32 s100, 6
  s_cselect_b32 s100, -1, s100
  v_mfma_f32_16x16x32_bf16 a[216:219], a[228:231], v[64:67], a[216:219]
  ds_read_b64_tr_b16 a[252:253], v15 offset:24576
  s_add_u32 s100, s100, 1
  v_mfma_f32_16x16x32_bf16 a[220:223], a[228:231], v[68:71], a[220:223]
  ds_read_b64_tr_b16 a[254:255], v15 offset:26624
  s_mul_i32 s63, s100, 12288
  s_waitcnt lgkmcnt(8)
  v_mfma_f32_16x16x32_bf16 a[208:211], a[232:235], v[72:75], a[208:211]
  s_add_u32 s63, s63, s65
  v_accvgpr_read_b32 v128, a192
  v_accvgpr_read_b32 v129, a193
  v_mfma_f32_16x16x32_bf16 a[212:215], a[232:235], v[76:79], a[212:215]
  v_accvgpr_read_b32 v130, a194
  v_accvgpr_read_b32 v131, a195
  v_mfma_f32_16x16x32_bf16 a[216:219], a[236:239], v[72:75], a[216:219]
  v_accvgpr_read_b32 v132, a200
  v_accvgpr_read_b32 v133, a201
  v_mfma_f32_16x16x32_bf16 a[220:223], a[236:239], v[76:79], a[220:223]
  v_accvgpr_read_b32 v134, a202
  v_accvgpr_read_b32 v135, a203
  s_waitcnt lgkmcnt(4)
  v_mfma_f32_16x16x32_bf16 a[208:211], a[240:243], v[96:99], a[208:211]
  v_cvt_pk_bf16_f32 v144, v128, v129
  v_cvt_pk_bf16_f32 v145, v130, v131
  v_mfma_f32_16x16x32_bf16 a[212:215], a[240:243], v[100:103], a[212:215]
  v_cvt_pk_bf16_f32 v146, v132, v133
  v_cvt_pk_bf16_f32 v147, v134, v135
  buffer_store_dwordx4 v[144:147], v5, s[44:47], s63 offen offset:0 sc1
  v_mfma_f32_16x16x32_bf16 a[216:219], a[244:247], v[96:99], a[216:219]
  v_accvgpr_read_b32 v136, a196
  v_accvgpr_read_b32 v137, a197
  v_mfma_f32_16x16x32_bf16 a[220:223], a[244:247], v[100:103], a[220:223]
  v_accvgpr_read_b32 v138, a198
  v_accvgpr_read_b32 v139, a199
  s_waitcnt lgkmcnt(0)
  v_mfma_f32_16x16x32_bf16 a[208:211], a[248:251], v[104:107], a[208:211]
  v_accvgpr_read_b32 v140, a204
  v_accvgpr_read_b32 v141, a205
  v_mfma_f32_16x16x32_bf16 a[212:215], a[248:251], v[108:111], a[212:215]
  v_accvgpr_read_b32 v142, a206
  v_accvgpr_read_b32 v143, a207
  v_cvt_pk_bf16_f32 v148, v136, v137
  v_mfma_f32_16x16x32_bf16 a[216:219], a[252:255], v[104:107], a[216:219]
  v_cvt_pk_bf16_f32 v149, v138, v139
  v_cvt_pk_bf16_f32 v150, v140, v141
  v_mfma_f32_16x16x32_bf16 a[220:223], a[252:255], v[108:111], a[220:223]
  v_cvt_pk_bf16_f32 v151, v142, v143
  buffer_store_dwordx4 v[148:151], v5, s[44:47], s63 offen offset:2048 sc1
  v_accvgpr_read_b32 v152, a208
  v_accvgpr_read_b32 v153, a209
  v_accvgpr_read_b32 v154, a210
  v_accvgpr_read_b32 v155, a211
  v_accvgpr_read_b32 v156, a216
  v_accvgpr_read_b32 v157, a217
  v_accvgpr_read_b32 v158, a218
  v_accvgpr_read_b32 v159, a219
  v_cvt_pk_bf16_f32 v168, v152, v153
  v_cvt_pk_bf16_f32 v169, v154, v155
  v_cvt_pk_bf16_f32 v170, v156, v157
  v_cvt_pk_bf16_f32 v171, v158, v159
  buffer_store_dwordx4 v[168:171], v5, s[44:47], s63 offen offset:256 sc1
  v_accvgpr_read_b32 v160, a212
  v_accvgpr_read_b32 v161, a213
  v_accvgpr_read_b32 v162, a214
  v_accvgpr_read_b32 v163, a215
  v_accvgpr_read_b32 v164, a220
  v_accvgpr_read_b32 v165, a221
  v_accvgpr_read_b32 v166, a222
  v_accvgpr_read_b32 v167, a223
  v_cvt_pk_bf16_f32 v172, v160, v161
  v_cvt_pk_bf16_f32 v173, v162, v163
  v_cvt_pk_bf16_f32 v174, v164, v165
  v_cvt_pk_bf16_f32 v175, v166, v167
  buffer_store_dwordx4 v[172:175], v5, s[44:47], s63 offen offset:2304 sc1
  s_cmp_eq_u32 s56, 7
  s_cselect_b32 s100, 0, s56
  s_mul_i32 s3, s59, 1376256
  s_add_u32 s48, s14, s3
  s_addc_u32 s49, s15, 0
  s_mov_b32 s50, 1376256
  s_mov_b32 s51, 0x20000
  s_mov_b32 s52, s16
  s_mov_b32 s53, s17
  s_mov_b32 s54, 1376256
  s_mov_b32 s55, 0x20000
  v_lshrrev_b32 v41, 4, v0
  v_mul_u32_u24 v40, 86016, v41
  v_and_b32 v42, 15, v0
  v_lshl_add_u32 v40, v42, 4, v40
  v_bfe_u32 v44, v0, 2, 2
  v_mul_u32_u24 v43, 1792, v44
  v_and_b32 v45, 3, v0
  v_lshl_add_u32 v43, v45, 3, v43
  v_and_b32 v46, 1, v0
  v_lshl_add_u32 v43, v41, 5, v43
  v_lshlrev_b32 v46, 4, v46
  v_mov_b32 v47, 0x3f80
  v_lshlrev_b32 v46, v46, v47
  v_bfe_u32 v47, v0, 1, 3
  v_cmp_eq_u32 vcc, 0, v47
  s_nop 1
  v_cndmask_b32 v48, 0, v46, vcc
  v_cmp_eq_u32 vcc, 1, v47
  s_nop 1
  v_cndmask_b32 v49, 0, v46, vcc
  v_cmp_eq_u32 vcc, 2, v47
  s_nop 1
  v_cndmask_b32 v50, 0, v46, vcc
  v_cmp_eq_u32 vcc, 3, v47
  s_nop 1
  v_cndmask_b32 v51, 0, v46, vcc
  s_lshl_b32 s3, s58, 7
  v_lshl_add_u32 v52, v42, 2, s3
  s_mul_i32 s88, s56, 172032
  s_mul_i32 s3, s57, 896
  s_add_u32 s88, s88, s3
  s_mul_i32 s3, s58, 3
  s_add_u32 s3, s3, 0
  s_and_b32 s90, s3, 1
  s_lshl_b32 s90, s90, 6
  s_lshr_b32 s3, s3, 1
  s_mul_i32 s3, s3, 7168
  s_add_u32 s90, s90, s3
  s_add_u32 s90, s90, s88
  s_mul_i32 s3, s58, 3
  s_add_u32 s3, s3, 1
  s_and_b32 s91, s3, 1
  s_lshl_b32 s91, s91, 6
  s_lshr_b32 s3, s3, 1
  s_mul_i32 s3, s3, 7168
  s_add_u32 s91, s91, s3
  s_add_u32 s91, s91, s88
  s_mul_i32 s3, s58, 3
  s_add_u32 s3, s3, 2
  s_and_b32 s92, s3, 1
  s_lshl_b32 s92, s92, 6
  s_lshr_b32 s3, s3, 1
  s_mul_i32 s3, s3, 7168
  s_add_u32 s92, s92, s3
  s_add_u32 s92, s92, s88
  s_mul_i32 s65, s58, 768
  s_waitcnt vmcnt(0)
  v_mov_b32 v8, 2
  ds_add_rtn_u32 v18, v30, v4 offset:1028
  s_waitcnt lgkmcnt(0)
  v_cmp_eq_u32 s[66:67], 2, v18
  s_nop 1
  v_cndmask_b32 v18, v2, v19, s[66:67]
  buffer_store_dword v8, v18, s[96:99], 0 offen sc1
  s_bitcmp1_b32 s66, 0
  s_cbranch_scc0 L_end
L_fl1:
  buffer_load_dword v55, v52, s[96:99], 0 offen sc1
  s_waitcnt vmcnt(0)
  v_cmp_ge_u32 vcc, 1, v55
  s_cbranch_vccz L_flok1
  s_mov_b32 s3, 2
L_fg1:
  s_nop 15
  s_sub_u32 s3, s3, 1
  s_cmp_lg_u32 s3, 0
  s_cbranch_scc1 L_fg1
  s_branch L_fl1
L_flok1:
  s_add_u32 s86, s100, 4
  s_sub_u32 s3, s86, 7
  s_cselect_b32 s86, s86, s3
  s_mul_i32 s63, s86, 12288
  s_add_u32 s63, s63, s65
  buffer_load_dwordx4 v[64:67], v40, s[48:51], s63 offen offset:0 sc1
  buffer_load_dwordx4 v[68:71], v40, s[48:51], s63 offen offset:256 sc1
  buffer_load_dwordx4 v[72:75], v40, s[48:51], s63 offen offset:512 sc1
  s_add_u32 s63, s63, 344064
  buffer_load_dwordx4 v[76:79], v40, s[48:51], s63 offen offset:0 sc1
  buffer_load_dwordx4 v[80:83], v40, s[48:51], s63 offen offset:256 sc1
  buffer_load_dwordx4 v[84:87], v40, s[48:51], s63 offen offset:512 sc1
  s_add_u32 s63, s63, 344064
  buffer_load_dwordx4 v[88:91], v40, s[48:51], s63 offen offset:0 sc1
  buffer_load_dwordx4 v[92:95], v40, s[48:51], s63 offen offset:256 sc1
  buffer_load_dwordx4 v[96:99], v40, s[48:51], s63 offen offset:512 sc1
  s_add_u32 s63, s63, 344064
  buffer_load_dwordx4 v[100:103], v40, s[48:51], s63 offen offset:0 sc1
  buffer_load_dwordx4 v[104:107], v40, s[48:51], s63 offen offset:256 sc1
  buffer_load_dwordx4 v[108:111], v40, s[48:51], s63 offen offset:512 sc1
  s_add_u32 s86, s100, 5
  s_sub_u32 s3, s86, 7
  s_cselect_b32 s86, s86, s3
  s_mul_i32 s63, s86, 12288
  s_add_u32 s63, s63, s65
  buffer_load_dwordx4 v[112:115], v40, s[48:51], s63 offen offset:0 sc1
  buffer_load_dwordx4 v[116:119], v40, s[48:51], s63 offen offset:256 sc1
  buffer_load_dwordx4 v[120:123], v40, s[48:51], s63 offen offset:512 sc1
  s_add_u32 s63, s63, 344064
  buffer_load_dwordx4 v[124:127], v40, s[48:51], s63 offen offset:0 sc1
  buffer_load_dwordx4 v[128:131], v40, s[48:51], s63 offen offset:256 sc1
  buffer_load_dwordx4 v[132:135], v40, s[48:51], s63 offen offset:512 sc1
  s_add_u32 s63, s63, 344064
  buffer_load_dwordx4 v[136:139], v40, s[48:51], s63 offen offset:0 sc1
  buffer_load_dwordx4 v[140:143], v40, s[48:51], s63 offen offset:256 sc1
  buffer_load_dwordx4 v[144:147], v40, s[48:51], s63 offen offset:512 sc1
  s_add_u32 s63, s63, 344064
  buffer_load_dwordx4 v[148:151], v40, s[48:51], s63 offen offset:0 sc1
  buffer_load_dwordx4 v[152:155], v40, s[48:51], s63 offen offset:256 sc1
  buffer_load_dwordx4 v[156:159], v40, s[48:51], s63 offen offset:512 sc1
  s_add_u32 s86, s100, 6
  s_sub_u32 s3, s86, 7
  s_cselect_b32 s86, s86, s3
  s_mul_i32 s63, s86, 12288
  s_add_u32 s63, s63, s65
  buffer_load_dwordx4 v[160:163], v40, s[48:51], s63 offen offset:0 sc1
  buffer_load_dwordx4 v[164:167], v40, s[48:51], s63 offen offset:256 sc1
  buffer_load_dwordx4 v[168:171], v40, s[48:51], s63 offen offset:512 sc1
  s_add_u32 s63, s63, 344064
  buffer_load_dwordx4 v[172:175], v40, s[48:51], s63 offen offset:0 sc1
  buffer_load_dwordx4 v[176:179], v40, s[48:51], s63 offen offset:256 sc1
  buffer_load_dwordx4 v[180:183], v40, s[48:51], s63 offen offset:512 sc1
  s_add_u32 s63, s63, 344064
  buffer_load_dwordx4 v[184:187], v40, s[48:51], s63 offen offset:0 sc1
  buffer_load_dwordx4 v[188:191], v40, s[48:51], s63 offen offset:256 sc1
  buffer_load_dwordx4 v[192:195], v40, s[48:51], s63 offen offset:512 sc1
  s_add_u32 s63, s63, 344064
  buffer_load_dwordx4 v[196:199], v40, s[48:51], s63 offen offset:0 sc1
  buffer_load_dwordx4 v[200:203], v40, s[48:51], s63 offen offset:256 sc1
  buffer_load_dwordx4 v[204:207], v40, s[48:51], s63 offen offset:512 sc1
  s_waitcnt vmcnt(35)
  v_mfma_f32_16x16x32_bf16 v[8:11], v[48:51], v[64:67], 0
  s_waitcnt vmcnt(34)
  v_mfma_f32_16x16x32_bf16 v[12:15], v[48:51], v[68:71], 0
  s_waitcnt vmcnt(33)
  v_mfma_f32_16x16x32_bf16 v[16:19], v[48:51], v[72:75], 0
  s_waitcnt vmcnt(32)
  v_mfma_f32_16x16x32_bf16 v[8:11], v[48:51], v[76:79], v[8:11]
  s_waitcnt vmcnt(31)
  v_mfma_f32_16x16x32_bf16 v[12:15], v[48:51], v[80:83], v[12:15]
  s_waitcnt vmcnt(30)
  v_mfma_f32_16x16x32_bf16 v[16:19], v[48:51], v[84:87], v[16:19]
  s_waitcnt vmcnt(29)
  v_mfma_f32_16x16x32_bf16 v[8:11], v[48:51], v[88:91], v[8:11]
  s_waitcnt vmcnt(28)
  v_mfma_f32_16x16x32_bf16 v[12:15], v[48:51], v[92:95], v[12:15]
  s_waitcnt vmcnt(27)
  v_mfma_f32_16x16x32_bf16 v[16:19], v[48:51], v[96:99], v[16:19]
  s_waitcnt vmcnt(26)
  v_mfma_f32_16x16x32_bf16 v[8:11], v[48:51], v[100:103], v[8:11]
  s_waitcnt vmcnt(25)
  v_mfma_f32_16x16x32_bf16 v[12:15], v[48:51], v[104:107], v[12:15]
  s_waitcnt vmcnt(24)
  v_mfma_f32_16x16x32_bf16 v[16:19], v[48:51], v[108:111], v[16:19]
  s_add_u32 s86, s100, 4
  s_sub_u32 s3, s86, 7
  s_cselect_b32 s86, s86, s3
  s_lshl_b32 s86, s86, 7
  s_nop 4
  s_mov_b32 exec_hi, 0
  v_cvt_pk_bf16_f32 v56, v8, v9
  v_cvt_pk_bf16_f32 v57, v10, v11
  s_add_u32 s3, s90, s86
  buffer_store_dwordx2 v[56:57], v43, s[52:55], s3 offen
  v_cvt_pk_bf16_f32 v58, v12, v13
  v_cvt_pk_bf16_f32 v59, v14, v15
  s_add_u32 s3, s91, s86
  buffer_store_dwordx2 v[58:59], v43, s[52:55], s3 offen
  s_nop 1
  v_cvt_pk_bf16_f32 v60, v16, v17
  v_cvt_pk_bf16_f32 v61, v18, v19
  s_add_u32 s3, s92, s86
  buffer_store_dwordx2 v[60:61], v43, s[52:55], s3 offen
  s_mov_b32 exec_hi, -1
  s_waitcnt vmcnt(26)
  v_mfma_f32_16x16x32_bf16 v[20:23], v[48:51], v[112:115], 0
  s_waitcnt vmcnt(25)
  v_mfma_f32_16x16x32_bf16 v[24:27], v[48:51], v[116:119], 0
  s_waitcnt vmcnt(24)
  v_mfma_f32_16x16x32_bf16 v[28:31], v[48:51], v[120:123], 0
  s_waitcnt vmcnt(23)
  v_mfma_f32_16x16x32_bf16 v[20:23], v[48:51], v[124:127], v[20:23]
  s_waitcnt vmcnt(22)
  v_mfma_f32_16x16x32_bf16 v[24:27], v[48:51], v[128:131], v[24:27]
  s_waitcnt vmcnt(21)
  v_mfma_f32_16x16x32_bf16 v[28:31], v[48:51], v[132:135], v[28:31]
  s_waitcnt vmcnt(20)
  v_mfma_f32_16x16x32_bf16 v[20:23], v[48:51], v[136:139], v[20:23]
  s_waitcnt vmcnt(19)
  v_mfma_f32_16x16x32_bf16 v[24:27], v[48:51], v[140:143], v[24:27]
  s_waitcnt vmcnt(18)
  v_mfma_f32_16x16x32_bf16 v[28:31], v[48:51], v[144:147], v[28:31]
  s_waitcnt vmcnt(17)
  v_mfma_f32_16x16x32_bf16 v[20:23], v[48:51], v[148:151], v[20:23]
  s_waitcnt vmcnt(16)
  v_mfma_f32_16x16x32_bf16 v[24:27], v[48:51], v[152:155], v[24:27]
  s_waitcnt vmcnt(15)
  v_mfma_f32_16x16x32_bf16 v[28:31], v[48:51], v[156:159], v[28:31]
  s_add_u32 s86, s100, 5
  s_sub_u32 s3, s86, 7
  s_cselect_b32 s86, s86, s3
  s_lshl_b32 s86, s86, 7
  s_nop 4
  s_mov_b32 exec_hi, 0
  v_cvt_pk_bf16_f32 v56, v20, v21
  v_cvt_pk_bf16_f32 v57, v22, v23
  s_add_u32 s3, s90, s86
  buffer_store_dwordx2 v[56:57], v43, s[52:55], s3 offen
  v_cvt_pk_bf16_f32 v58, v24, v25
  v_cvt_pk_bf16_f32 v59, v26, v27
  s_add_u32 s3, s91, s86
  buffer_store_dwordx2 v[58:59], v43, s[52:55], s3 offen
  s_nop 1
  v_cvt_pk_bf16_f32 v60, v28, v29
  v_cvt_pk_bf16_f32 v61, v30, v31
  s_add_u32 s3, s92, s86
  buffer_store_dwordx2 v[60:61], v43, s[52:55], s3 offen
  s_mov_b32 exec_hi, -1
  s_waitcnt vmcnt(17)
  v_mfma_f32_16x16x32_bf16 v[8:11], v[48:51], v[160:163], 0
  s_waitcnt vmcnt(16)
  v_mfma_f32_16x16x32_bf16 v[12:15], v[48:51], v[164:167], 0
  s_waitcnt vmcnt(15)
  v_mfma_f32_16x16x32_bf16 v[16:19], v[48:51], v[168:171], 0
  s_waitcnt vmcnt(14)
  v_mfma_f32_16x16x32_bf16 v[8:11], v[48:51], v[172:175], v[8:11]
  s_waitcnt vmcnt(13)
  v_mfma_f32_16x16x32_bf16 v[12:15], v[48:51], v[176:179], v[12:15]
  s_waitcnt vmcnt(12)
  v_mfma_f32_16x16x32_bf16 v[16:19], v[48:51], v[180:183], v[16:19]
  s_waitcnt vmcnt(11)
  v_mfma_f32_16x16x32_bf16 v[8:11], v[48:51], v[184:187], v[8:11]
  s_waitcnt vmcnt(10)
  v_mfma_f32_16x16x32_bf16 v[12:15], v[48:51], v[188:191], v[12:15]
  s_waitcnt vmcnt(9)
  v_mfma_f32_16x16x32_bf16 v[16:19], v[48:51], v[192:195], v[16:19]
  s_waitcnt vmcnt(8)
  v_mfma_f32_16x16x32_bf16 v[8:11], v[48:51], v[196:199], v[8:11]
  s_waitcnt vmcnt(7)
  v_mfma_f32_16x16x32_bf16 v[12:15], v[48:51], v[200:203], v[12:15]
  s_waitcnt vmcnt(6)
  v_mfma_f32_16x16x32_bf16 v[16:19], v[48:51], v[204:207], v[16:19]
  s_add_u32 s86, s100, 6
  s_sub_u32 s3, s86, 7
  s_cselect_b32 s86, s86, s3
  s_lshl_b32 s86, s86, 7
  s_nop 4
  s_mov_b32 exec_hi, 0
  v_cvt_pk_bf16_f32 v56, v8, v9
  v_cvt_pk_bf16_f32 v57, v10, v11
  s_add_u32 s3, s90, s86
  buffer_store_dwordx2 v[56:57], v43, s[52:55], s3 offen
  v_cvt_pk_bf16_f32 v58, v12, v13
  v_cvt_pk_bf16_f32 v59, v14, v15
  s_add_u32 s3, s91, s86
  buffer_store_dwordx2 v[58:59], v43, s[52:55], s3 offen
  s_nop 1
  v_cvt_pk_bf16_f32 v60, v16, v17
  v_cvt_pk_bf16_f32 v61, v18, v19
  s_add_u32 s3, s92, s86
  buffer_store_dwordx2 v[60:61], v43, s[52:55], s3 offen
  s_mov_b32 exec_hi, -1
L_fin:
L_end:
  s_endpgm
L_lsQ_6:
  ds_read_b32 v32, v37
  s_nop 15
  s_waitcnt lgkmcnt(0)
  v_cmp_gt_u32 vcc, 0xb0030001, v32
  s_cbranch_vccnz L_lsQ_6
  s_branch L_lbQ_6
L_lsQ_7:
  ds_read_b32 v32, v37
  s_nop 15
  s_waitcnt lgkmcnt(0)
  v_cmp_gt_u32 vcc, 0xb0030002, v32
  s_cbranch_vccnz L_lsQ_7
  s_branch L_lbQ_7
L_lsQ_8:
  ds_read_b32 v32, v37
  s_nop 15
  s_waitcnt lgkmcnt(0)
  v_cmp_gt_u32 vcc, 0xb0030003, v32
  s_cbranch_vccnz L_lsQ_8
  s_branch L_lbQ_8
L_lsQ_9:
  ds_read_b32 v32, v37
  s_nop 15
  s_waitcnt lgkmcnt(0)
  v_cmp_gt_u32 vcc, 0xb0030004, v32
  s_cbranch_vccnz L_lsQ_9
  s_branch L_lbQ_9
L_lsQ_10:
  ds_read_b32 v32, v37
  s_nop 15
  s_waitcnt lgkmcnt(0)
  v_cmp_gt_u32 vcc, 0xb0030005, v32
  s_cbranch_vccnz L_lsQ_10
  s_branch L_lbQ_10
L_lsQ_11:
  ds_read_b32 v32, v37
  s_nop 15
  s_waitcnt lgkmcnt(0)
  v_cmp_gt_u32 vcc, 0xb0030006, v32
  s_cbranch_vccnz L_lsQ_11
  s_branch L_lbQ_11
L_lsQ_12:
  ds_read_b32 v32, v37
  s_nop 15
  s_waitcnt lgkmcnt(0)
  v_cmp_gt_u32 vcc, 0xb0030007, v32
  s_cbranch_vccnz L_lsQ_12
  s_branch L_lbQ_12
L_lsQ_13:
  ds_read_b32 v32, v37
  s_nop 15
  s_waitcnt lgkmcnt(0)
  v_cmp_gt_u32 vcc, 0xb0030008, v32
  s_cbranch_vccnz L_lsQ_13
  s_branch L_lbQ_13
L_lsK_0:
  ds_read_b32 v32, v37
  s_nop 15
  s_waitcnt lgkmcnt(0)
  v_cmp_gt_u32 vcc, 0xb0030009, v32
  s_cbranch_vccnz L_lsK_0
  s_branch L_lbK_0
L_lsK_1:
  ds_read_b32 v32, v36
  s_nop 15
  s_waitcnt lgkmcnt(0)
  v_cmp_gt_u32 vcc, 0x1, v32
  s_cbranch_vccnz L_lsK_1
  s_branch L_lbK_1
L_lsK_3:
  ds_read_b32 v32, v36
  s_nop 15
  s_waitcnt lgkmcnt(0)
  v_cmp_gt_u32 vcc, 0x2, v32
  s_cbranch_vccnz L_lsK_3
  s_branch L_lbK_3
L_lsK_4:
  ds_read_b32 v32, v36
  s_nop 15
  s_waitcnt lgkmcnt(0)
  v_cmp_gt_u32 vcc, 0x3, v32
  s_cbranch_vccnz L_lsK_4
  s_branch L_lbK_4
L_lsK_5:
  ds_read_b32 v32, v36
  s_nop 15
  s_waitcnt lgkmcnt(0)
  v_cmp_gt_u32 vcc, 0x4, v32
  s_cbranch_vccnz L_lsK_5
  s_branch L_lbK_5
L_lsC_1:
  ds_read_b32 v32, v36
  s_nop 15
  s_waitcnt lgkmcnt(0)
  v_cmp_gt_u32 vcc, 0x5, v32
  s_cbranch_vccnz L_lsC_1
  s_branch L_lbC_1
L_lsK_8:
  ds_read_b32 v32, v36
  s_nop 15
  s_waitcnt lgkmcnt(0)
  v_cmp_gt_u32 vcc, 0x6, v32
  s_cbranch_vccnz L_lsK_8
  s_branch L_lbK_8
L_lsK_9:
  ds_read_b32 v32, v36
  s_nop 15
  s_waitcnt lgkmcnt(0)
  v_cmp_gt_u32 vcc, 0x7, v32
  s_cbranch_vccnz L_lsK_9
  s_branch L_lbK_9
L_lsK_11:
  ds_read_b32 v32, v36
  s_nop 15
  s_waitcnt lgkmcnt(0)
  v_cmp_gt_u32 vcc, 0x8, v32
  s_cbranch_vccnz L_lsK_11
  s_branch L_lbK_11
L_lsC_2:
  ds_read_b32 v32, v36
  s_nop 15
  s_waitcnt lgkmcnt(0)
  v_cmp_gt_u32 vcc, 0x9, v32
  s_cbranch_vccnz L_lsC_2
  s_branch L_lbC_2
L_lsK_12:
  ds_read_b32 v32, v36
  s_nop 15
  s_waitcnt lgkmcnt(0)
  v_cmp_gt_u32 vcc, 0xa, v32
  s_cbranch_vccnz L_lsK_12
  s_branch L_lbK_12
L_lsK_13:
  ds_read_b32 v32, v36
  s_nop 15
  s_waitcnt lgkmcnt(0)
  v_cmp_gt_u32 vcc, 0xb, v32
  s_cbranch_vccnz L_lsK_13
  s_branch L_lbK_13
L_lsK_15:
  ds_read_b32 v32, v36
  s_nop 15
  s_waitcnt lgkmcnt(0)
  v_cmp_gt_u32 vcc, 0xc, v32
  s_cbranch_vccnz L_lsK_15
  s_branch L_lbK_15
L_lsC_3:
  ds_read_b32 v32, v36
  s_nop 15
  s_waitcnt lgkmcnt(0)
  v_cmp_gt_u32 vcc, 0xd, v32
  s_cbranch_vccnz L_lsC_3
  s_branch L_lbC_3
L_lsV_0_0:
  ds_read_b32 v32, v36
  s_nop 15
  s_waitcnt lgkmcnt(0)
  v_cmp_gt_u32 vcc, 0xe, v32
  s_cbranch_vccnz L_lsV_0_0
  s_branch L_lbV_0_0
L_lsV_0_1:
  ds_read_b32 v32, v36
  s_nop 15
  s_waitcnt lgkmcnt(0)
  v_cmp_gt_u32 vcc, 0xf, v32
  s_cbranch_vccnz L_lsV_0_1
  s_branch L_lbV_0_1
L_lsV_0_2:
  ds_read_b32 v32, v36
  s_nop 15
  s_waitcnt lgkmcnt(0)
  v_cmp_gt_u32 vcc, 0x10, v32
  s_cbranch_vccnz L_lsV_0_2
  s_branch L_lbV_0_2
L_lsV_0_3:
  ds_read_b32 v32, v36
  s_nop 15
  s_waitcnt lgkmcnt(0)
  v_cmp_gt_u32 vcc, 0x11, v32
  s_cbranch_vccnz L_lsV_0_3
  s_branch L_lbV_0_3
L_lsV_1_0:
  ds_read_b32 v32, v36
  s_nop 15
  s_waitcnt lgkmcnt(0)
  v_cmp_gt_u32 vcc, 0x12, v32
  s_cbranch_vccnz L_lsV_1_0
  s_branch L_lbV_1_0
L_lsV_1_1:
  ds_read_b32 v32, v36
  s_nop 15
  s_waitcnt lgkmcnt(0)
  v_cmp_gt_u32 vcc, 0x13, v32
  s_cbranch_vccnz L_lsV_1_1
  s_branch L_lbV_1_1
L_lsV_1_2:
  ds_read_b32 v32, v36
  s_nop 15
  s_waitcnt lgkmcnt(0)
  v_cmp_gt_u32 vcc, 0x14, v32
  s_cbranch_vccnz L_lsV_1_2
  s_branch L_lbV_1_2
L_lsV_1_3:
  ds_read_b32 v32, v36
  s_nop 15
  s_waitcnt lgkmcnt(0)
  v_cmp_gt_u32 vcc, 0x15, v32
  s_cbranch_vccnz L_lsV_1_3
  s_branch L_lbV_1_3
L_lsO_0_3:
  ds_read_b32 v32, v36
  s_nop 15
  s_waitcnt lgkmcnt(0)
  v_cmp_gt_u32 vcc, 0x16, v32
  s_cbranch_vccnz L_lsO_0_3
  s_branch L_lbO_0_3
L_lsV_2_0:
  ds_read_b32 v32, v36
  s_nop 15
  s_waitcnt lgkmcnt(0)
  v_cmp_gt_u32 vcc, 0x17, v32
  s_cbranch_vccnz L_lsV_2_0
  s_branch L_lbV_2_0
L_lsV_2_1:
  ds_read_b32 v32, v36
  s_nop 15
  s_waitcnt lgkmcnt(0)
  v_cmp_gt_u32 vcc, 0x18, v32
  s_cbranch_vccnz L_lsV_2_1
  s_branch L_lbV_2_1
L_lsO_0_5:
  ds_read_b32 v32, v36
  s_nop 15
  s_waitcnt lgkmcnt(0)
  v_cmp_gt_u32 vcc, 0x19, v32
  s_cbranch_vccnz L_lsO_0_5
  s_branch L_lbO_0_5
L_lsV_2_2:
  ds_read_b32 v32, v36
  s_nop 15
  s_waitcnt lgkmcnt(0)
  v_cmp_gt_u32 vcc, 0x1a, v32
  s_cbranch_vccnz L_lsV_2_2
  s_branch L_lbV_2_2
L_lsO_0_6:
  ds_read_b32 v32, v36
  s_nop 15
  s_waitcnt lgkmcnt(0)
  v_cmp_gt_u32 vcc, 0x1b, v32
  s_cbranch_vccnz L_lsO_0_6
  s_branch L_lbO_0_6
L_lsV_2_3:
  ds_read_b32 v32, v36
  s_nop 15
  s_waitcnt lgkmcnt(0)
  v_cmp_gt_u32 vcc, 0x1c, v32
  s_cbranch_vccnz L_lsV_2_3
  s_branch L_lbV_2_3
L_lsV_3_0:
  ds_read_b32 v32, v36
  s_nop 15
  s_waitcnt lgkmcnt(0)
  v_cmp_gt_u32 vcc, 0x1e, v32
  s_cbranch_vccnz L_lsV_3_0
  s_branch L_lbV_3_0
L_lsV_3_1:
  ds_read_b32 v32, v36
  s_nop 15
  s_waitcnt lgkmcnt(0)
  v_cmp_gt_u32 vcc, 0x20, v32
  s_cbranch_vccnz L_lsV_3_1
  s_branch L_lbV_3_1
L_lsV_3_2:
  ds_read_b32 v32, v36
  s_nop 15
  s_waitcnt lgkmcnt(0)
  v_cmp_gt_u32 vcc, 0x22, v32
  s_cbranch_vccnz L_lsV_3_2
  s_branch L_lbV_3_2
L_lsV_3_3:
  ds_read_b32 v32, v36
  s_nop 15
  s_waitcnt lgkmcnt(0)
  v_cmp_gt_u32 vcc, 0x23, v32
  s_cbranch_vccnz L_lsV_3_3
  s_branch L_lbV_3_3
L_lsO_3_0:
  ds_read_b32 v32, v37
  s_nop 15
  s_waitcnt lgkmcnt(0)
  v_cmp_gt_u32 vcc, 0xb003002d, v32
  s_cbranch_vccnz L_lsO_3_0
  s_branch L_lbO_3_0
L_lsO_2_1:
  ds_read_b32 v32, v37
  s_nop 15
  s_waitcnt lgkmcnt(0)
  v_cmp_gt_u32 vcc, 0xb003002e, v32
  s_cbranch_vccnz L_lsO_2_1
  s_branch L_lbO_2_1
L_lsO_3_1:
  ds_read_b32 v32, v37
  s_nop 15
  s_waitcnt lgkmcnt(0)
  v_cmp_gt_u32 vcc, 0xb003002f, v32
  s_cbranch_vccnz L_lsO_3_1
  s_branch L_lbO_3_1
L_lsO_2_2:
  ds_read_b32 v32, v37
  s_nop 15
  s_waitcnt lgkmcnt(0)
  v_cmp_gt_u32 vcc, 0xb0030030, v32
  s_cbranch_vccnz L_lsO_2_2
  s_branch L_lbO_2_2
L_lsO_3_2:
  ds_read_b32 v32, v37
  s_nop 15
  s_waitcnt lgkmcnt(0)
  v_cmp_gt_u32 vcc, 0xb0030031, v32
  s_cbranch_vccnz L_lsO_3_2
  s_branch L_lbO_3_2
L_lsO_2_3:
  ds_read_b32 v32, v37
  s_nop 15
  s_waitcnt lgkmcnt(0)
  v_cmp_gt_u32 vcc, 0xb0030032, v32
  s_cbranch_vccnz L_lsO_2_3
  s_branch L_lbO_2_3
L_lsO_2_4:
  ds_read_b32 v32, v37
  s_nop 15
  s_waitcnt lgkmcnt(0)
  v_cmp_gt_u32 vcc, 0xb0030033, v32
  s_cbranch_vccnz L_lsO_2_4
  s_branch L_lbO_2_4
L_lsO_1_5:
  ds_read_b32 v32, v37
  s_nop 15
  s_waitcnt lgkmcnt(0)
  v_cmp_gt_u32 vcc, 0xb0030034, v32
  s_cbranch_vccnz L_lsO_1_5
  s_branch L_lbO_1_5
L_lsO_3_5:
  ds_read_b32 v32, v37
  s_nop 15
  s_waitcnt lgkmcnt(0)
  v_cmp_gt_u32 vcc, 0xb0030035, v32
  s_cbranch_vccnz L_lsO_3_5
  s_branch L_lbO_3_5
L_lsO_2_6:
  ds_read_b32 v32, v37
  s_nop 15
  s_waitcnt lgkmcnt(0)
  v_cmp_gt_u32 vcc, 0xb0030036, v32
  s_cbranch_vccnz L_lsO_2_6
  s_branch L_lbO_2_6
L_lsO_3_6:
  ds_read_b32 v32, v37
  s_nop 15
  s_waitcnt lgkmcnt(0)
  v_cmp_gt_u32 vcc, 0xb0030037, v32
  s_cbranch_vccnz L_lsO_3_6
  s_branch L_lbO_3_6
L_arrx:
  global_load_dword v54, v53, s[18:19] sc1
  s_waitcnt vmcnt(0)
  s_branch L_arr
L_csQ_0:
  ds_read_b32 v3, v2 offset:2048
  s_waitcnt lgkmcnt(0)
  v_cmp_le_u32 vcc, 0xb0030001, v3
  s_cbranch_vccz L_csQ_0
  s_branch L_cbQ_0
L_csQ_1:
  ds_read_b32 v3, v2 offset:2048
  s_waitcnt lgkmcnt(0)
  v_cmp_le_u32 vcc, 0xb0030002, v3
  s_cbranch_vccz L_csQ_1
  s_branch L_cbQ_1
L_csQ_2:
  ds_read_b32 v3, v2 offset:2048
  s_waitcnt lgkmcnt(0)
  v_cmp_le_u32 vcc, 0xb0030003, v3
  s_cbranch_vccz L_csQ_2
  s_branch L_cbQ_2
L_csQ_3:
  ds_read_b32 v3, v2 offset:2048
  s_waitcnt lgkmcnt(0)
  v_cmp_le_u32 vcc, 0xb0030004, v3
  s_cbranch_vccz L_csQ_3
  s_branch L_cbQ_3
L_csQ_4:
  ds_read_b32 v3, v2 offset:2048
  s_waitcnt lgkmcnt(0)
  v_cmp_le_u32 vcc, 0xb0030005, v3
  s_cbranch_vccz L_csQ_4
  s_branch L_cbQ_4
L_csQ_5:
  ds_read_b32 v3, v2 offset:2048
  s_waitcnt lgkmcnt(0)
  v_cmp_le_u32 vcc, 0xb0030006, v3
  s_cbranch_vccz L_csQ_5
  s_branch L_cbQ_5
L_csQ_6:
  ds_read_b32 v3, v2 offset:2048
  s_waitcnt lgkmcnt(0)
  v_cmp_le_u32 vcc, 0xb0030007, v3
  s_cbranch_vccz L_csQ_6
  s_branch L_cbQ_6
L_csQ_7:
  ds_read_b32 v3, v2 offset:2048
  s_waitcnt lgkmcnt(0)
  v_cmp_le_u32 vcc, 0xb0030008, v3
  s_cbranch_vccz L_csQ_7
  s_branch L_cbQ_7
L_csQ_8:
  ds_read_b32 v3, v2 offset:2048
  s_waitcnt lgkmcnt(0)
  v_cmp_le_u32 vcc, 0xb0030009, v3
  s_cbranch_vccz L_csQ_8
  s_branch L_cbQ_8
L_csQ_9:
  ds_read_b32 v3, v2 offset:2048
  s_waitcnt lgkmcnt(0)
  v_cmp_le_u32 vcc, 0xb003000a, v3
  s_cbranch_vccz L_csQ_9
  s_branch L_cbQ_9
L_csQ_10:
  ds_read_b32 v3, v2 offset:2048
  s_waitcnt lgkmcnt(0)
  v_cmp_le_u32 vcc, 0xb003000b, v3
  s_cbranch_vccz L_csQ_10
  s_branch L_cbQ_10
L_csQ_11:
  ds_read_b32 v3, v2 offset:2048
  s_waitcnt lgkmcnt(0)
  v_cmp_le_u32 vcc, 0xb003000c, v3
  s_cbranch_vccz L_csQ_11
  s_branch L_cbQ_11
L_csQ_12:
  ds_read_b32 v3, v2 offset:2048
  s_waitcnt lgkmcnt(0)
  v_cmp_le_u32 vcc, 0xb003000d, v3
  s_cbranch_vccz L_csQ_12
  s_branch L_cbQ_12
L_csQ_13:
  ds_read_b32 v3, v2 offset:2048
  s_waitcnt lgkmcnt(0)
  v_cmp_le_u32 vcc, 0xb003000e, v3
  s_cbranch_vccz L_csQ_13
  s_branch L_cbQ_13
L_csK_0:
  ds_read_b32 v3, v2 offset:2048
  s_waitcnt lgkmcnt(0)
  v_cmp_le_u32 vcc, 0xb003000f, v3
  s_cbranch_vccz L_csK_0
  s_branch L_cbK_0
L_csK_1:
  ds_read_b32 v3, v2 offset:2048
  s_waitcnt lgkmcnt(0)
  v_cmp_le_u32 vcc, 0xb0030010, v3
  s_cbranch_vccz L_csK_1
  s_branch L_cbK_1
L_csK_2:
  ds_read_b32 v3, v2 offset:1036
  s_waitcnt lgkmcnt(0)
  v_cmp_le_u32 vcc, 0x1, v3
  s_cbranch_vccz L_csK_2
  s_branch L_cbK_2
L_csK_3:
  ds_read_b32 v3, v2 offset:2048
  s_waitcnt lgkmcnt(0)
  v_cmp_le_u32 vcc, 0xb0030011, v3
  s_cbranch_vccz L_csK_3
  s_branch L_cbK_3
L_csK_4:
  ds_read_b32 v3, v2 offset:2048
  s_waitcnt lgkmcnt(0)
  v_cmp_le_u32 vcc, 0xb0030012, v3
  s_cbranch_vccz L_csK_4
  s_branch L_cbK_4
L_csK_5:
  ds_read_b32 v3, v2 offset:2048
  s_waitcnt lgkmcnt(0)
  v_cmp_le_u32 vcc, 0xb0030013, v3
  s_cbranch_vccz L_csK_5
  s_branch L_cbK_5
L_csK_6:
  ds_read_b32 v3, v2 offset:1036
  s_waitcnt lgkmcnt(0)
  v_cmp_le_u32 vcc, 0x2, v3
  s_cbranch_vccz L_csK_6
  s_branch L_cbK_6
L_csK_7:
  ds_read_b32 v3, v2 offset:2048
  s_waitcnt lgkmcnt(0)
  v_cmp_le_u32 vcc, 0xb0030014, v3
  s_cbranch_vccz L_csK_7
  s_branch L_cbK_7
L_csK_8:
  ds_read_b32 v3, v2 offset:2048
  s_waitcnt lgkmcnt(0)
  v_cmp_le_u32 vcc, 0xb0030015, v3
  s_cbranch_vccz L_csK_8
  s_branch L_cbK_8
L_csK_9:
  ds_read_b32 v3, v2 offset:2048
  s_waitcnt lgkmcnt(0)
  v_cmp_le_u32 vcc, 0xb0030016, v3
  s_cbranch_vccz L_csK_9
  s_branch L_cbK_9
L_csK_10:
  ds_read_b32 v3, v2 offset:1036
  s_waitcnt lgkmcnt(0)
  v_cmp_le_u32 vcc, 0x3, v3
  s_cbranch_vccz L_csK_10
  s_branch L_cbK_10
L_csK_11:
  ds_read_b32 v3, v2 offset:2048
  s_waitcnt lgkmcnt(0)
  v_cmp_le_u32 vcc, 0xb0030017, v3
  s_cbranch_vccz L_csK_11
  s_branch L_cbK_11
L_csK_12:
  ds_read_b32 v3, v2 offset:2048
  s_waitcnt lgkmcnt(0)
  v_cmp_le_u32 vcc, 0xb0030018, v3
  s_cbranch_vccz L_csK_12
  s_branch L_cbK_12
L_csK_13:
  ds_read_b32 v3, v2 offset:2048
  s_waitcnt lgkmcnt(0)
  v_cmp_le_u32 vcc, 0xb0030019, v3
  s_cbranch_vccz L_csK_13
  s_branch L_cbK_13
L_csK_14:
  ds_read_b32 v3, v2 offset:1036
  s_waitcnt lgkmcnt(0)
  v_cmp_le_u32 vcc, 0x4, v3
  s_cbranch_vccz L_csK_14
  s_branch L_cbK_14
L_csK_15:
  ds_read_b32 v3, v2 offset:2048
  s_waitcnt lgkmcnt(0)
  v_cmp_le_u32 vcc, 0xb003001a, v3
  s_cbranch_vccz L_csK_15
  s_branch L_cbK_15
L_csV_0_0:
  ds_read_b32 v3, v2 offset:2048
  s_waitcnt lgkmcnt(0)
  v_cmp_le_u32 vcc, 0xb003001b, v3
  s_cbranch_vccz L_csV_0_0
  s_branch L_cbV_0_0
L_csV_0_1:
  ds_read_b32 v3, v2 offset:2048
  s_waitcnt lgkmcnt(0)
  v_cmp_le_u32 vcc, 0xb003001c, v3
  s_cbranch_vccz L_csV_0_1
  s_branch L_cbV_0_1
L_csV_0_2:
  ds_read_b32 v3, v2 offset:2048
  s_waitcnt lgkmcnt(0)
  v_cmp_le_u32 vcc, 0xb003001d, v3
  s_cbranch_vccz L_csV_0_2
  s_branch L_cbV_0_2
L_csV_0_3:
  ds_read_b32 v3, v2 offset:2048
  s_waitcnt lgkmcnt(0)
  v_cmp_le_u32 vcc, 0xb003001e, v3
  s_cbranch_vccz L_csV_0_3
  s_branch L_cbV_0_3
L_csV_1_0:
  ds_read_b32 v3, v2 offset:2048
  s_waitcnt lgkmcnt(0)
  v_cmp_le_u32 vcc, 0xb003001f, v3
  s_cbranch_vccz L_csV_1_0
  s_branch L_cbV_1_0
L_csO_0_0:
  ds_read_b32 v3, v2 offset:2048
  s_waitcnt lgkmcnt(0)
  v_cmp_le_u32 vcc, 0xb0030020, v3
  s_cbranch_vccz L_csO_0_0
  s_branch L_cbO_0_0
L_csV_1_1:
  ds_read_b32 v3, v2 offset:2048
  s_waitcnt lgkmcnt(0)
  v_cmp_le_u32 vcc, 0xb0030021, v3
  s_cbranch_vccz L_csV_1_1
  s_branch L_cbV_1_1
L_csO_0_1:
  ds_read_b32 v3, v2 offset:2048
  s_waitcnt lgkmcnt(0)
  v_cmp_le_u32 vcc, 0xb0030022, v3
  s_cbranch_vccz L_csO_0_1
  s_branch L_cbO_0_1
L_csV_1_2:
  ds_read_b32 v3, v2 offset:2048
  s_waitcnt lgkmcnt(0)
  v_cmp_le_u32 vcc, 0xb0030023, v3
  s_cbranch_vccz L_csV_1_2
  s_branch L_cbV_1_2
L_csO_0_2:
  ds_read_b32 v3, v2 offset:2048
  s_waitcnt lgkmcnt(0)
  v_cmp_le_u32 vcc, 0xb0030024, v3
  s_cbranch_vccz L_csO_0_2
  s_branch L_cbO_0_2
L_csV_1_3:
  ds_read_b32 v3, v2 offset:2048
  s_waitcnt lgkmcnt(0)
  v_cmp_le_u32 vcc, 0xb0030025, v3
  s_cbranch_vccz L_csV_1_3
  s_branch L_cbV_1_3
L_csO_0_3:
  ds_read_b32 v3, v2 offset:2048
  s_waitcnt lgkmcnt(0)
  v_cmp_le_u32 vcc, 0xb0030026, v3
  s_cbranch_vccz L_csO_0_3
  s_branch L_cbO_0_3
L_csV_2_0:
  ds_read_b32 v3, v2 offset:2048
  s_waitcnt lgkmcnt(0)
  v_cmp_le_u32 vcc, 0xb0030027, v3
  s_cbranch_vccz L_csV_2_0
  s_branch L_cbV_2_0
L_csO_0_4:
  ds_read_b32 v3, v2 offset:2048
  s_waitcnt lgkmcnt(0)
  v_cmp_le_u32 vcc, 0xb0030028, v3
  s_cbranch_vccz L_csO_0_4
  s_branch L_cbO_0_4
L_csV_2_1:
  ds_read_b32 v3, v2 offset:2048
  s_waitcnt lgkmcnt(0)
  v_cmp_le_u32 vcc, 0xb0030029, v3
  s_cbranch_vccz L_csV_2_1
  s_branch L_cbV_2_1
L_csO_0_5:
  ds_read_b32 v3, v2 offset:2048
  s_waitcnt lgkmcnt(0)
  v_cmp_le_u32 vcc, 0xb003002a, v3
  s_cbranch_vccz L_csO_0_5
  s_branch L_cbO_0_5
L_csV_2_2:
  ds_read_b32 v3, v2 offset:2048
  s_waitcnt lgkmcnt(0)
  v_cmp_le_u32 vcc, 0xb003002b, v3
  s_cbranch_vccz L_csV_2_2
  s_branch L_cbV_2_2
L_csO_0_6:
  ds_read_b32 v3, v2 offset:2048
  s_waitcnt lgkmcnt(0)
  v_cmp_le_u32 vcc, 0xb003002c, v3
  s_cbranch_vccz L_csO_0_6
  s_branch L_cbO_0_6
L_csV_2_3:
  ds_read_b32 v3, v2 offset:2048
  s_waitcnt lgkmcnt(0)
  v_cmp_le_u32 vcc, 0xb003002d, v3
  s_cbranch_vccz L_csV_2_3
  s_branch L_cbV_2_3
L_csV_3_0:
  ds_read_b32 v3, v2 offset:2048
  s_waitcnt lgkmcnt(0)
  v_cmp_le_u32 vcc, 0xb003002e, v3
  s_cbranch_vccz L_csV_3_0
  s_branch L_cbV_3_0
L_csV_3_1:
  ds_read_b32 v3, v2 offset:2048
  s_waitcnt lgkmcnt(0)
  v_cmp_le_u32 vcc, 0xb003002f, v3
  s_cbranch_vccz L_csV_3_1
  s_branch L_cbV_3_1
L_csV_3_2:
  ds_read_b32 v3, v2 offset:2048
  s_waitcnt lgkmcnt(0)
  v_cmp_le_u32 vcc, 0xb0030030, v3
  s_cbranch_vccz L_csV_3_2
  s_branch L_cbV_3_2
L_csV_3_3:
  ds_read_b32 v3, v2 offset:2048
  s_waitcnt lgkmcnt(0)
  v_cmp_le_u32 vcc, 0xb0030031, v3
  s_cbranch_vccz L_csV_3_3
  s_branch L_cbV_3_3
L_csO_1_0:
  ds_read_b32 v3, v2 offset:2048
  s_waitcnt lgkmcnt(0)
  v_cmp_le_u32 vcc, 0xb0030032, v3
  s_cbranch_vccz L_csO_1_0
  s_branch L_cbO_1_0
L_csO_2_0:
  ds_read_b32 v3, v2 offset:2048
  s_waitcnt lgkmcnt(0)
  v_cmp_le_u32 vcc, 0xb0030033, v3
  s_cbranch_vccz L_csO_2_0
  s_branch L_cbO_2_0
L_csO_3_0:
  ds_read_b32 v3, v2 offset:2048
  s_waitcnt lgkmcnt(0)
  v_cmp_le_u32 vcc, 0xb0030034, v3
  s_cbranch_vccz L_csO_3_0
  s_branch L_cbO_3_0
L_csO_1_1:
  ds_read_b32 v3, v2 offset:2048
  s_waitcnt lgkmcnt(0)
  v_cmp_le_u32 vcc, 0xb0030035, v3
  s_cbranch_vccz L_csO_1_1
  s_branch L_cbO_1_1
L_csO_2_1:
  ds_read_b32 v3, v2 offset:2048
  s_waitcnt lgkmcnt(0)
  v_cmp_le_u32 vcc, 0xb0030036, v3
  s_cbranch_vccz L_csO_2_1
  s_branch L_cbO_2_1
L_csO_3_1:
  ds_read_b32 v3, v2 offset:2048
  s_waitcnt lgkmcnt(0)
  v_cmp_le_u32 vcc, 0xb0030037, v3
  s_cbranch_vccz L_csO_3_1
  s_branch L_cbO_3_1
L_csO_1_2:
  ds_read_b32 v3, v2 offset:2048
  s_waitcnt lgkmcnt(0)
  v_cmp_le_u32 vcc, 0xb0030038, v3
  s_cbranch_vccz L_csO_1_2
  s_branch L_cbO_1_2
L_csO_2_2:
  ds_read_b32 v3, v2 offset:2048
  s_waitcnt lgkmcnt(0)
  v_cmp_le_u32 vcc, 0xb0030039, v3
  s_cbranch_vccz L_csO_2_2
  s_branch L_cbO_2_2
L_csO_3_2:
  ds_read_b32 v3, v2 offset:2048
  s_waitcnt lgkmcnt(0)
  v_cmp_le_u32 vcc, 0xb003003a, v3
  s_cbranch_vccz L_csO_3_2
  s_branch L_cbO_3_2
L_csO_1_3:
  ds_read_b32 v3, v2 offset:2048
  s_waitcnt lgkmcnt(0)
  v_cmp_le_u32 vcc, 0xb003003b, v3
  s_cbranch_vccz L_csO_1_3
  s_branch L_cbO_1_3
L_csO_2_3:
  ds_read_b32 v3, v2 offset:2048
  s_waitcnt lgkmcnt(0)
  v_cmp_le_u32 vcc, 0xb003003c, v3
  s_cbranch_vccz L_csO_2_3
  s_branch L_cbO_2_3
L_csO_3_3:
  ds_read_b32 v3, v2 offset:2048
  s_waitcnt lgkmcnt(0)
  v_cmp_le_u32 vcc, 0xb003003d, v3
  s_cbranch_vccz L_csO_3_3
  s_branch L_cbO_3_3
L_csO_1_4:
  ds_read_b32 v3, v2 offset:2048
  s_waitcnt lgkmcnt(0)
  v_cmp_le_u32 vcc, 0xb003003e, v3
  s_cbranch_vccz L_csO_1_4
  s_branch L_cbO_1_4
L_csO_2_4:
  ds_read_b32 v3, v2 offset:2048
  s_waitcnt lgkmcnt(0)
  v_cmp_le_u32 vcc, 0xb003003f, v3
  s_cbranch_vccz L_csO_2_4
  s_branch L_cbO_2_4
L_csO_3_4:
  ds_read_b32 v3, v2 offset:2048
  s_waitcnt lgkmcnt(0)
  v_cmp_le_u32 vcc, 0xb0030040, v3
  s_cbranch_vccz L_csO_3_4
  s_branch L_cbO_3_4
L_csO_1_5:
  ds_read_b32 v3, v2 offset:2048
  s_waitcnt lgkmcnt(0)
  v_cmp_le_u32 vcc, 0xb0030041, v3
  s_cbranch_vccz L_csO_1_5
  s_branch L_cbO_1_5
L_csO_2_5:
  ds_read_b32 v3, v2 offset:2048
  s_waitcnt lgkmcnt(0)
  v_cmp_le_u32 vcc, 0xb0030042, v3
  s_cbranch_vccz L_csO_2_5
  s_branch L_cbO_2_5
L_csO_3_5:
  ds_read_b32 v3, v2 offset:2048
  s_waitcnt lgkmcnt(0)
  v_cmp_le_u32 vcc, 0xb0030043, v3
  s_cbranch_vccz L_csO_3_5
  s_branch L_cbO_3_5
L_csO_1_6:
  ds_read_b32 v3, v2 offset:2048
  s_waitcnt lgkmcnt(0)
  v_cmp_le_u32 vcc, 0xb0030044, v3
  s_cbranch_vccz L_csO_1_6
  s_branch L_cbO_1_6
L_csO_2_6:
  ds_read_b32 v3, v2 offset:2048
  s_waitcnt lgkmcnt(0)
  v_cmp_le_u32 vcc, 0xb0030045, v3
  s_cbranch_vccz L_csO_2_6
  s_branch L_cbO_2_6
L_csO_3_6:
  ds_read_b32 v3, v2 offset:2048
  s_waitcnt lgkmcnt(0)
  v_cmp_le_u32 vcc, 0xb0030046, v3
  s_cbranch_vccz L_csO_3_6
  s_branch L_cbO_3_6
  s_endpgm
L_codeend:
.section .rodata,"a"
.p2align 6
.amdhsa_kernel concat_heads__mha_block_cached__gqa_block_cached__near_ridge_kernel
  .amdhsa_next_free_vgpr 512
  .amdhsa_next_free_sgpr 101
  .amdhsa_accum_offset 256
  .amdhsa_group_segment_fixed_size 0
  .amdhsa_kernarg_size 104
  .amdhsa_user_sgpr_count 2
  .amdhsa_user_sgpr_kernarg_segment_ptr 1
  .amdhsa_system_sgpr_workgroup_id_x 1
.end_amdhsa_kernel
```
